```python
import torch

def _softmax(x, axis=-1):
    return torch.softmax(x, dim=axis)

def _gelu(x):
    return torch.nn.functional.gelu(x, approximate='tanh')

def _silu(x):
    return torch.nn.functional.silu(x)

def _sigmoid(x):
    return torch.sigmoid(x)

def _layernorm(x, axis=-1, eps=1e-05):
    m = x.mean(dim=axis, keepdim=True)
    v = x.var(dim=axis, keepdim=True, unbiased=False)
    return (x - m) / torch.sqrt(v + eps)

def _scatter_add(tgt, idx, src, axis=0):
    return tgt.clone().index_add_(axis, idx, src)

def _segment_sum(src, seg, n):
    out = torch.zeros((n,) + src.shape[1:], dtype=src.dtype)
    return out.index_add_(0, seg, src)

def _pad(x, pw):
    flat = tuple((v for pair in reversed(pw) for v in pair))
    return torch.nn.functional.pad(x, flat)
kernel_name = 'gated_mix__spectral_gfnet__memory_aug_recurrent_mem_tr__prompt'

def setup_inputs():

    _w = lambda a: (lambda t: t.to(torch.bfloat16) if t.is_floating_point() else t)(torch.as_tensor(a))

    def _A_setup():
        B, S, D = (1, 2048, 640)
        Df = D // 2 + 1
        return {'x': _w((lambda *s: torch.randn(*s, dtype=torch.bfloat16) * 0.05)(B, S, D)), 'w_r': _w((lambda *s: torch.randn(*s, dtype=torch.bfloat16) * 3.2)(S, Df) * 0.02), 'w_i': _w((lambda *s: torch.randn(*s, dtype=torch.bfloat16) * 3.2)(S, Df) * 0.02)}
    _A_in = _A_setup()

    def _B_setup():
        B, S, Dm = (1, 2048, 640)
        H, Dh = (32, 128)
        M, seg = (8, 32)
        seg = min(seg, S)
        S = S // seg * seg
        return {'x': _w((lambda *s: torch.randn(*s, dtype=torch.bfloat16) * 0.05)(B, S, Dm)), 'mem0': _w((lambda *s: torch.randn(*s, dtype=torch.bfloat16) * 0.4)(B, M, Dm)), 'Wq': _w((lambda *s: torch.randn(*s, dtype=torch.bfloat16) * 6.4)(Dm, H, Dh) * Dm ** (-0.5)), 'Wk': _w((lambda *s: torch.randn(*s, dtype=torch.bfloat16) * 6.4)(Dm, H, Dh) * Dm ** (-0.5)), 'Wv': _w((lambda *s: torch.randn(*s, dtype=torch.bfloat16) * 0.4)(Dm, H, Dh) * Dm ** (-0.5)), 'Wo': _w((lambda *s: torch.randn(*s, dtype=torch.bfloat16) * 0.4)(H, Dh, Dm) * (H * Dh) ** (-0.5)), 'seg_len': seg}
    _B_in = _B_setup()
    return {'A_x': _A_in['x'], 'A_w_r': _A_in['w_r'], 'A_w_i': _A_in['w_i'], 'B_x': _B_in['x'], 'B_mem0': _B_in['mem0'], 'B_Wq': _B_in['Wq'], 'B_Wk': _B_in['Wk'], 'B_Wv': _B_in['Wv'], 'B_Wo': _B_in['Wo'], 'B_seg_len': _B_in['seg_len'], 'gate_w': _w((lambda *s: torch.randn(*s, dtype=torch.bfloat16) * 0.05)(640) * 16.0)}

def reference(A_x, A_w_r, A_w_i, B_x, B_mem0, B_Wq, B_Wk, B_Wv, B_Wo, B_seg_len, gate_w):

    def _A_ref(x, w_r, w_i):
        B, S, D = x.shape
        X = (lambda x, axes=(-2, -1): torch.fft.rfft2(x.float(), dim=axes))(x, axes=(-2, -1))
        W = w_r + 1j * w_i
        X = X * W
        y = (lambda x, s, axes=(-2, -1): torch.fft.irfft2(x, s=s, dim=axes).to(torch.bfloat16))(X, (S, D), axes=(-2, -1))
        return y

    def _B_ref(x, mem0, Wq, Wk, Wv, Wo, seg_len):
        B, S, Dm = x.shape
        H, Dh = (Wq.shape[1], Wq.shape[2])
        M = mem0.shape[1]
        scale = Dh ** (-0.5)
        n_seg = S // seg_len
        L = M + seg_len
        idx = torch.arange(L)
        mask = (idx[:, None] < M) | (idx[:, None] >= idx[None, :])
        mem = mem0
        outs = []
        for s in range(n_seg):
            xs = x[:, s * seg_len:(s + 1) * seg_len, :].clone()
            h = torch.concatenate([mem, xs], axis=1)
            q = torch.einsum('btd,dhe->bhte', h, Wq)
            k = torch.einsum('btd,dhe->bhte', h, Wk)
            v = torch.einsum('btd,dhe->bhte', h, Wv)
            scores = torch.einsum('bhqe,bhke->bhqk', q, k) * scale
            scores = torch.where(mask[None, None], scores, -1000000000.0)
            p = _softmax(scores, axis=-1)
            o = torch.einsum('bhqk,bhke->bhqe', p, v)
            o = torch.einsum('bhte,hed->btd', o, Wo)
            mem = o[:, :M, :].clone()
            outs.append(o[:, M:, :])
        return torch.concatenate(outs, axis=1)
    x = A_x
    g = _sigmoid((x * gate_w).sum(-1, keepdims=True))
    a = _A_ref(x, A_w_r, A_w_i)
    b = _B_ref(x, B_mem0, B_Wq, B_Wk, B_Wv, B_Wo, B_seg_len)
    return g * a + (1 - g) * b
```

```asm
; @launch kernel=prep_kernel grid=(1529,1,1) block=(256,1,1) lds=32768
; @launch kernel=rec_kernel grid=(1961,1,1) block=(256,1,1) lds=131072
.amdgcn_target "amdgcn-amd-amdhsa--gfx950"
.text
.globl prep_kernel
.p2align 8
.type prep_kernel,@function
prep_kernel:
    s_cmp_ge_u32 s2, 1529
    s_cbranch_scc1 Lp_end
    s_load_dwordx2 s[4:5], s[0:1], 104
    s_load_dwordx2 s[40:41], s[0:1], 40
    s_load_dwordx2 s[42:43], s[0:1], 48
    s_load_dwordx2 s[44:45], s[0:1], 56
    s_load_dwordx2 s[46:47], s[0:1], 64
    s_load_dwordx2 s[48:49], s[0:1], 0
    s_load_dwordx2 s[50:51], s[0:1], 80
    s_load_dwordx2 s[52:53], s[0:1], 32
    s_waitcnt lgkmcnt(0)
    s_mov_b32 s8, s4
    s_and_b32 s9, s5, 0xffff
    s_mov_b32 s10, 0x10000000
    s_mov_b32 s11, 0x00020000
    v_and_b32 v1, 63, v0
    v_lshrrev_b32 v2, 6, v0
    s_cmp_ge_u32 s2, 640
    s_cbranch_scc1 Lp_notT
    s_cmp_ge_u32 s2, 480
    s_cbranch_scc1 Lp_T2
    s_mov_b32 s16, 0
    s_mov_b32 s17, s2
    s_mov_b32 s12, s40
    s_mov_b32 s13, s41
    s_cmp_ge_u32 s2, 160
    s_cbranch_scc0 Lp_T1a
    s_mov_b32 s16, 1
    s_sub_u32 s17, s2, 160
    s_mov_b32 s12, s42
    s_mov_b32 s13, s43
    s_cmp_ge_u32 s2, 320
    s_cbranch_scc0 Lp_T1a
    s_mov_b32 s16, 2
    s_sub_u32 s17, s2, 320
    s_mov_b32 s12, s44
    s_mov_b32 s13, s45
Lp_T1a:
    s_and_b32 s13, s13, 0xffff
    s_mov_b32 s14, 0x500000
    s_mov_b32 s15, 0x00020000
    s_and_b32 s19, s17, 31
    s_lshr_b32 s18, s17, 5
    s_lshl_b32 s18, s18, 2
    v_add_u32 v3, s18, v2
    v_lshlrev_b32 v4, 18, v3
    v_lshl_add_u32 v4, v1, 2, v4
    s_lshl_b32 s20, s19, 8
    s_mov_b32 s21, 8192
    s_lshl_b32 s22, s16, 12
    s_lshl_b32 s23, s19, 7
    s_add_u32 s22, s22, s23
    s_mul_i32 s22, s22, 1280
    s_lshl_b32 s23, s18, 6
    s_add_u32 s22, s22, s23
    s_add_u32 s22, s22, 0x0
    v_mov_b32 v5, s22
    s_mov_b32 s25, 1280
    s_branch Lp_Tgo
Lp_T2:
    s_mov_b32 s12, s46
    s_and_b32 s13, s47, 0xffff
    s_mov_b32 s14, 0x500000
    s_mov_b32 s15, 0x00020000
    s_sub_u32 s17, s2, 480
    s_lshl_b32 s17, s17, 2
    v_add_u32 v3, s17, v2
    v_lshrrev_b32 v7, 7, v3
    v_and_b32 v8, 127, v3
    v_mul_u32_u24 v4, 40960, v8
    v_lshl_add_u32 v4, v7, 8, v4
    v_lshl_add_u32 v4, v1, 2, v4
    s_mov_b32 s20, 0
    s_mov_b32 s21, 1280
    v_mul_u32_u24 v5, 1064960, v7
    v_lshrrev_b32 v9, 2, v8
    v_lshl_add_u32 v5, v9, 8, v5
    v_add_u32 v5, 0xf00000, v5
    s_mov_b32 s25, 8320
Lp_Tgo:
    buffer_load_dword v16, v4, s[12:15], s20 offen
    s_add_u32 s20, s20, s21
    buffer_load_dword v17, v4, s[12:15], s20 offen
    s_add_u32 s20, s20, s21
    buffer_load_dword v18, v4, s[12:15], s20 offen
    s_add_u32 s20, s20, s21
    buffer_load_dword v19, v4, s[12:15], s20 offen
    s_add_u32 s20, s20, s21
    buffer_load_dword v20, v4, s[12:15], s20 offen
    s_add_u32 s20, s20, s21
    buffer_load_dword v21, v4, s[12:15], s20 offen
    s_add_u32 s20, s20, s21
    buffer_load_dword v22, v4, s[12:15], s20 offen
    s_add_u32 s20, s20, s21
    buffer_load_dword v23, v4, s[12:15], s20 offen
    s_add_u32 s20, s20, s21
    buffer_load_dword v24, v4, s[12:15], s20 offen
    s_add_u32 s20, s20, s21
    buffer_load_dword v25, v4, s[12:15], s20 offen
    s_add_u32 s20, s20, s21
    buffer_load_dword v26, v4, s[12:15], s20 offen
    s_add_u32 s20, s20, s21
    buffer_load_dword v27, v4, s[12:15], s20 offen
    s_add_u32 s20, s20, s21
    buffer_load_dword v28, v4, s[12:15], s20 offen
    s_add_u32 s20, s20, s21
    buffer_load_dword v29, v4, s[12:15], s20 offen
    s_add_u32 s20, s20, s21
    buffer_load_dword v30, v4, s[12:15], s20 offen
    s_add_u32 s20, s20, s21
    buffer_load_dword v31, v4, s[12:15], s20 offen
    s_add_u32 s20, s20, s21
    buffer_load_dword v32, v4, s[12:15], s20 offen
    s_add_u32 s20, s20, s21
    buffer_load_dword v33, v4, s[12:15], s20 offen
    s_add_u32 s20, s20, s21
    buffer_load_dword v34, v4, s[12:15], s20 offen
    s_add_u32 s20, s20, s21
    buffer_load_dword v35, v4, s[12:15], s20 offen
    s_add_u32 s20, s20, s21
    buffer_load_dword v36, v4, s[12:15], s20 offen
    s_add_u32 s20, s20, s21
    buffer_load_dword v37, v4, s[12:15], s20 offen
    s_add_u32 s20, s20, s21
    buffer_load_dword v38, v4, s[12:15], s20 offen
    s_add_u32 s20, s20, s21
    buffer_load_dword v39, v4, s[12:15], s20 offen
    s_add_u32 s20, s20, s21
    buffer_load_dword v40, v4, s[12:15], s20 offen
    s_add_u32 s20, s20, s21
    buffer_load_dword v41, v4, s[12:15], s20 offen
    s_add_u32 s20, s20, s21
    buffer_load_dword v42, v4, s[12:15], s20 offen
    s_add_u32 s20, s20, s21
    buffer_load_dword v43, v4, s[12:15], s20 offen
    s_add_u32 s20, s20, s21
    buffer_load_dword v44, v4, s[12:15], s20 offen
    s_add_u32 s20, s20, s21
    buffer_load_dword v45, v4, s[12:15], s20 offen
    s_add_u32 s20, s20, s21
    buffer_load_dword v46, v4, s[12:15], s20 offen
    s_add_u32 s20, s20, s21
    buffer_load_dword v47, v4, s[12:15], s20 offen
    s_add_u32 s20, s20, s21
    s_mov_b32 s23, 0x05040100
    s_mov_b32 s24, 0x07060302
    s_waitcnt vmcnt(0)
    v_perm_b32 v48, v17, v16, s23
    v_perm_b32 v52, v17, v16, s24
    v_perm_b32 v49, v19, v18, s23
    v_perm_b32 v53, v19, v18, s24
    v_perm_b32 v50, v21, v20, s23
    v_perm_b32 v54, v21, v20, s24
    v_perm_b32 v51, v23, v22, s23
    v_perm_b32 v55, v23, v22, s24
    v_perm_b32 v56, v25, v24, s23
    v_perm_b32 v60, v25, v24, s24
    v_perm_b32 v57, v27, v26, s23
    v_perm_b32 v61, v27, v26, s24
    v_perm_b32 v58, v29, v28, s23
    v_perm_b32 v62, v29, v28, s24
    v_perm_b32 v59, v31, v30, s23
    v_perm_b32 v63, v31, v30, s24
    v_perm_b32 v64, v33, v32, s23
    v_perm_b32 v68, v33, v32, s24
    v_perm_b32 v65, v35, v34, s23
    v_perm_b32 v69, v35, v34, s24
    v_perm_b32 v66, v37, v36, s23
    v_perm_b32 v70, v37, v36, s24
    v_perm_b32 v67, v39, v38, s23
    v_perm_b32 v71, v39, v38, s24
    v_perm_b32 v72, v41, v40, s23
    v_perm_b32 v76, v41, v40, s24
    v_perm_b32 v73, v43, v42, s23
    v_perm_b32 v77, v43, v42, s24
    v_perm_b32 v74, v45, v44, s23
    v_perm_b32 v78, v45, v44, s24
    v_perm_b32 v75, v47, v46, s23
    v_perm_b32 v79, v47, v46, s24
    v_lshlrev_b32 v6, 1, v1
    v_add_u32 v7, 0, v6
    v_and_b32 v8, 15, v7
    v_lshlrev_b32 v9, 2, v2
    v_xor_b32 v8, v8, v9
    v_lshlrev_b32 v7, 8, v7
    v_xor_b32 v9, 0, v8
    v_lshl_add_u32 v9, v9, 4, v7
    ds_write_b128 v9, v[48:51]
    v_xor_b32 v9, 1, v8
    v_lshl_add_u32 v9, v9, 4, v7
    ds_write_b128 v9, v[56:59]
    v_xor_b32 v9, 2, v8
    v_lshl_add_u32 v9, v9, 4, v7
    ds_write_b128 v9, v[64:67]
    v_xor_b32 v9, 3, v8
    v_lshl_add_u32 v9, v9, 4, v7
    ds_write_b128 v9, v[72:75]
    v_add_u32 v7, 1, v6
    v_and_b32 v8, 15, v7
    v_lshlrev_b32 v9, 2, v2
    v_xor_b32 v8, v8, v9
    v_lshlrev_b32 v7, 8, v7
    v_xor_b32 v9, 0, v8
    v_lshl_add_u32 v9, v9, 4, v7
    ds_write_b128 v9, v[52:55]
    v_xor_b32 v9, 1, v8
    v_lshl_add_u32 v9, v9, 4, v7
    ds_write_b128 v9, v[60:63]
    v_xor_b32 v9, 2, v8
    v_lshl_add_u32 v9, v9, 4, v7
    ds_write_b128 v9, v[68:71]
    v_xor_b32 v9, 3, v8
    v_lshl_add_u32 v9, v9, 4, v7
    ds_write_b128 v9, v[76:79]
    s_waitcnt lgkmcnt(0)
    s_barrier
    v_lshrrev_b32 v6, 4, v0
    v_and_b32 v7, 15, v0
    v_xor_b32 v8, v6, v7
    v_lshlrev_b32 v8, 4, v8
    v_lshl_add_u32 v8, v6, 8, v8
    v_mul_lo_u32 v9, s25, v6
    v_lshl_add_u32 v9, v7, 4, v9
    v_add_u32 v9, v9, v5
    s_lshl_b32 s25, s25, 4
    s_mov_b32 s26, 0
    ds_read_b128 v[16:19], v8 offset:0
    ds_read_b128 v[20:23], v8 offset:4096
    ds_read_b128 v[24:27], v8 offset:8192
    ds_read_b128 v[28:31], v8 offset:12288
    ds_read_b128 v[32:35], v8 offset:16384
    ds_read_b128 v[36:39], v8 offset:20480
    ds_read_b128 v[40:43], v8 offset:24576
    ds_read_b128 v[44:47], v8 offset:28672
    s_waitcnt lgkmcnt(7)
    buffer_store_dwordx4 v[16:19], v9, s[8:11], s26 offen
    s_add_u32 s26, s26, s25
    s_waitcnt lgkmcnt(6)
    buffer_store_dwordx4 v[20:23], v9, s[8:11], s26 offen
    s_add_u32 s26, s26, s25
    s_waitcnt lgkmcnt(5)
    buffer_store_dwordx4 v[24:27], v9, s[8:11], s26 offen
    s_add_u32 s26, s26, s25
    s_waitcnt lgkmcnt(4)
    buffer_store_dwordx4 v[28:31], v9, s[8:11], s26 offen
    s_add_u32 s26, s26, s25
    s_waitcnt lgkmcnt(3)
    buffer_store_dwordx4 v[32:35], v9, s[8:11], s26 offen
    s_add_u32 s26, s26, s25
    s_waitcnt lgkmcnt(2)
    buffer_store_dwordx4 v[36:39], v9, s[8:11], s26 offen
    s_add_u32 s26, s26, s25
    s_waitcnt lgkmcnt(1)
    buffer_store_dwordx4 v[40:43], v9, s[8:11], s26 offen
    s_add_u32 s26, s26, s25
    s_waitcnt lgkmcnt(0)
    buffer_store_dwordx4 v[44:47], v9, s[8:11], s26 offen
    s_add_u32 s26, s26, s25
    s_branch Lp_end
Lp_notT:
    s_cmp_ge_u32 s2, 888
    s_cbranch_scc1 Lp_notF
    s_mov_b32 s12, s8
    s_mov_b32 s13, s9
    s_mov_b32 s14, 0x6780000
    s_mov_b32 s15, 0x00020000
    s_sub_u32 s17, s2, 640
    s_lshl_b32 s17, s17, 16
    s_add_u32 s17, s17, 0x5802800
    v_lshlrev_b32 v4, 4, v0
    v_mov_b32 v8, -1
    v_mov_b32 v9, -1
    v_mov_b32 v10, -1
    v_mov_b32 v11, -1
    buffer_store_dwordx4 v[8:11], v4, s[12:15], s17 offen
    s_add_u32 s17, s17, 4096
    buffer_store_dwordx4 v[8:11], v4, s[12:15], s17 offen
    s_add_u32 s17, s17, 4096
    buffer_store_dwordx4 v[8:11], v4, s[12:15], s17 offen
    s_add_u32 s17, s17, 4096
    buffer_store_dwordx4 v[8:11], v4, s[12:15], s17 offen
    s_add_u32 s17, s17, 4096
    buffer_store_dwordx4 v[8:11], v4, s[12:15], s17 offen
    s_add_u32 s17, s17, 4096
    buffer_store_dwordx4 v[8:11], v4, s[12:15], s17 offen
    s_add_u32 s17, s17, 4096
    buffer_store_dwordx4 v[8:11], v4, s[12:15], s17 offen
    s_add_u32 s17, s17, 4096
    buffer_store_dwordx4 v[8:11], v4, s[12:15], s17 offen
    s_add_u32 s17, s17, 4096
    buffer_store_dwordx4 v[8:11], v4, s[12:15], s17 offen
    s_add_u32 s17, s17, 4096
    buffer_store_dwordx4 v[8:11], v4, s[12:15], s17 offen
    s_add_u32 s17, s17, 4096
    buffer_store_dwordx4 v[8:11], v4, s[12:15], s17 offen
    s_add_u32 s17, s17, 4096
    buffer_store_dwordx4 v[8:11], v4, s[12:15], s17 offen
    s_add_u32 s17, s17, 4096
    buffer_store_dwordx4 v[8:11], v4, s[12:15], s17 offen
    s_add_u32 s17, s17, 4096
    buffer_store_dwordx4 v[8:11], v4, s[12:15], s17 offen
    s_add_u32 s17, s17, 4096
    buffer_store_dwordx4 v[8:11], v4, s[12:15], s17 offen
    s_add_u32 s17, s17, 4096
    buffer_store_dwordx4 v[8:11], v4, s[12:15], s17 offen
    s_add_u32 s17, s17, 4096
    s_branch Lp_end
Lp_notF:
    s_cmp_ge_u32 s2, 1368
    s_cbranch_scc1 Lp_notCD
    s_cmp_ge_u32 s2, 1128
    s_cbranch_scc1 Lp_D
    s_sub_u32 s17, s2, 888
    s_lshl_b32 s17, s17, 8
    v_add_u32 v3, s17, v0
    v_mul_u32_u24 v4, 52429, v3
    v_lshrrev_b32 v4, 22, v4
    v_mul_u32_u24 v5, 80, v4
    v_sub_u32 v5, v3, v5
    v_lshlrev_b32 v5, 3, v5
    v_cmp_le_u32 vcc, 384, v4
    v_subrev_u32 v6, 384, v4
    s_nop 0
    v_cndmask_b32 v6, v4, v6, vcc
    v_mov_b32 v7, 160
    v_cndmask_b32 v7, 0, v7, vcc
    v_cmp_gt_u32 vcc, 321, v6
    v_mov_b32 v9, 1.0
    s_nop 0
    v_cndmask_b32 v9, 0, v9, vcc
    s_mov_b32 s18, 0x3acccccd
    v_add_u32 v10, 0, v5
    v_mul_u32_u24 v10, v10, v6
    v_lshrrev_b32 v11, 7, v10
    v_mul_u32_u24 v11, 52429, v11
    v_lshrrev_b32 v11, 18, v11
    v_mul_u32_u24 v11, 640, v11
    v_sub_u32 v10, v10, v11
    v_add_u32 v10, v10, v7
    v_cvt_f32_u32 v10, v10
    v_mul_f32 v10, s18, v10
    v_cos_f32 v10, v10
    s_nop 0
    v_mul_f32 v16, v10, v9
    v_add_u32 v10, 1, v5
    v_mul_u32_u24 v10, v10, v6
    v_lshrrev_b32 v11, 7, v10
    v_mul_u32_u24 v11, 52429, v11
    v_lshrrev_b32 v11, 18, v11
    v_mul_u32_u24 v11, 640, v11
    v_sub_u32 v10, v10, v11
    v_add_u32 v10, v10, v7
    v_cvt_f32_u32 v10, v10
    v_mul_f32 v10, s18, v10
    v_cos_f32 v10, v10
    s_nop 0
    v_mul_f32 v17, v10, v9
    v_add_u32 v10, 2, v5
    v_mul_u32_u24 v10, v10, v6
    v_lshrrev_b32 v11, 7, v10
    v_mul_u32_u24 v11, 52429, v11
    v_lshrrev_b32 v11, 18, v11
    v_mul_u32_u24 v11, 640, v11
    v_sub_u32 v10, v10, v11
    v_add_u32 v10, v10, v7
    v_cvt_f32_u32 v10, v10
    v_mul_f32 v10, s18, v10
    v_cos_f32 v10, v10
    s_nop 0
    v_mul_f32 v18, v10, v9
    v_add_u32 v10, 3, v5
    v_mul_u32_u24 v10, v10, v6
    v_lshrrev_b32 v11, 7, v10
    v_mul_u32_u24 v11, 52429, v11
    v_lshrrev_b32 v11, 18, v11
    v_mul_u32_u24 v11, 640, v11
    v_sub_u32 v10, v10, v11
    v_add_u32 v10, v10, v7
    v_cvt_f32_u32 v10, v10
    v_mul_f32 v10, s18, v10
    v_cos_f32 v10, v10
    s_nop 0
    v_mul_f32 v19, v10, v9
    v_add_u32 v10, 4, v5
    v_mul_u32_u24 v10, v10, v6
    v_lshrrev_b32 v11, 7, v10
    v_mul_u32_u24 v11, 52429, v11
    v_lshrrev_b32 v11, 18, v11
    v_mul_u32_u24 v11, 640, v11
    v_sub_u32 v10, v10, v11
    v_add_u32 v10, v10, v7
    v_cvt_f32_u32 v10, v10
    v_mul_f32 v10, s18, v10
    v_cos_f32 v10, v10
    s_nop 0
    v_mul_f32 v20, v10, v9
    v_add_u32 v10, 5, v5
    v_mul_u32_u24 v10, v10, v6
    v_lshrrev_b32 v11, 7, v10
    v_mul_u32_u24 v11, 52429, v11
    v_lshrrev_b32 v11, 18, v11
    v_mul_u32_u24 v11, 640, v11
    v_sub_u32 v10, v10, v11
    v_add_u32 v10, v10, v7
    v_cvt_f32_u32 v10, v10
    v_mul_f32 v10, s18, v10
    v_cos_f32 v10, v10
    s_nop 0
    v_mul_f32 v21, v10, v9
    v_add_u32 v10, 6, v5
    v_mul_u32_u24 v10, v10, v6
    v_lshrrev_b32 v11, 7, v10
    v_mul_u32_u24 v11, 52429, v11
    v_lshrrev_b32 v11, 18, v11
    v_mul_u32_u24 v11, 640, v11
    v_sub_u32 v10, v10, v11
    v_add_u32 v10, v10, v7
    v_cvt_f32_u32 v10, v10
    v_mul_f32 v10, s18, v10
    v_cos_f32 v10, v10
    s_nop 0
    v_mul_f32 v22, v10, v9
    v_add_u32 v10, 7, v5
    v_mul_u32_u24 v10, v10, v6
    v_lshrrev_b32 v11, 7, v10
    v_mul_u32_u24 v11, 52429, v11
    v_lshrrev_b32 v11, 18, v11
    v_mul_u32_u24 v11, 640, v11
    v_sub_u32 v10, v10, v11
    v_add_u32 v10, v10, v7
    v_cvt_f32_u32 v10, v10
    v_mul_f32 v10, s18, v10
    v_cos_f32 v10, v10
    s_nop 0
    v_mul_f32 v23, v10, v9
    v_mul_u32_u24 v12, 1280, v4
    v_lshl_add_u32 v12, v5, 1, v12
    v_add_u32 v13, 0x8e00000, v12
    v_add_u32 v12, 0x8d00000, v12
    v_cvt_pk_bf16_f32 v24, v16, v17
    v_lshlrev_b32 v32, 16, v24
    v_and_b32 v33, 0xffff0000, v24
    v_sub_f32 v32, v16, v32
    v_sub_f32 v33, v17, v33
    v_cvt_pk_bf16_f32 v28, v32, v33
    v_cvt_pk_bf16_f32 v25, v18, v19
    v_lshlrev_b32 v32, 16, v25
    v_and_b32 v33, 0xffff0000, v25
    v_sub_f32 v32, v18, v32
    v_sub_f32 v33, v19, v33
    v_cvt_pk_bf16_f32 v29, v32, v33
    v_cvt_pk_bf16_f32 v26, v20, v21
    v_lshlrev_b32 v32, 16, v26
    v_and_b32 v33, 0xffff0000, v26
    v_sub_f32 v32, v20, v32
    v_sub_f32 v33, v21, v33
    v_cvt_pk_bf16_f32 v30, v32, v33
    v_cvt_pk_bf16_f32 v27, v22, v23
    v_lshlrev_b32 v32, 16, v27
    v_and_b32 v33, 0xffff0000, v27
    v_sub_f32 v32, v22, v32
    v_sub_f32 v33, v23, v33
    v_cvt_pk_bf16_f32 v31, v32, v33
    buffer_store_dwordx4 v[24:27], v12, s[8:11], 0 offen
    buffer_store_dwordx4 v[28:31], v13, s[8:11], 0 offen
    s_branch Lp_end
Lp_D:
    s_sub_u32 s17, s2, 1128
    s_lshl_b32 s17, s17, 8
    v_add_u32 v3, s17, v0
    v_mul_u32_u24 v4, 43691, v3
    v_lshrrev_b32 v4, 22, v4
    v_mul_u32_u24 v5, 96, v4
    v_sub_u32 v5, v3, v5
    v_lshlrev_b32 v5, 3, v5
    v_cmp_le_u32 vcc, 384, v5
    v_subrev_u32 v6, 384, v5
    s_nop 0
    v_cndmask_b32 v6, v5, v6, vcc
    v_mov_b32 v7, 160
    v_cndmask_b32 v7, 0, v7, vcc
    s_mov_b32 s18, 0x3acccccd
    v_mov_b32 v14, 0x35cccccd
    v_mov_b32 v15, 0x354ccccd
    v_add_u32 v8, 0, v6
    v_cmp_gt_u32 vcc, 321, v8
    s_nop 1
    v_cndmask_b32 v9, 0, v14, vcc
    v_cmp_eq_u32 vcc, 0, v7
    s_nop 1
    v_cndmask_b32 v11, 0, v15, vcc
    v_cmp_eq_u32 vcc, 0, v8
    s_nop 1
    v_cndmask_b32 v9, v9, v11, vcc
    v_cmp_eq_u32 vcc, 320, v8
    s_nop 1
    v_cndmask_b32 v9, v9, v11, vcc
    v_mul_u32_u24 v10, v8, v4
    v_lshrrev_b32 v11, 7, v10
    v_mul_u32_u24 v11, 52429, v11
    v_lshrrev_b32 v11, 18, v11
    v_mul_u32_u24 v11, 640, v11
    v_sub_u32 v10, v10, v11
    v_add_u32 v10, v10, v7
    v_cvt_f32_u32 v10, v10
    v_mul_f32 v10, s18, v10
    v_cos_f32 v10, v10
    s_nop 0
    v_mul_f32 v16, v10, v9
    v_add_u32 v8, 1, v6
    v_cmp_gt_u32 vcc, 321, v8
    s_nop 1
    v_cndmask_b32 v9, 0, v14, vcc
    v_cmp_eq_u32 vcc, 0, v7
    s_nop 1
    v_cndmask_b32 v11, 0, v15, vcc
    v_cmp_eq_u32 vcc, 0, v8
    s_nop 1
    v_cndmask_b32 v9, v9, v11, vcc
    v_cmp_eq_u32 vcc, 320, v8
    s_nop 1
    v_cndmask_b32 v9, v9, v11, vcc
    v_mul_u32_u24 v10, v8, v4
    v_lshrrev_b32 v11, 7, v10
    v_mul_u32_u24 v11, 52429, v11
    v_lshrrev_b32 v11, 18, v11
    v_mul_u32_u24 v11, 640, v11
    v_sub_u32 v10, v10, v11
    v_add_u32 v10, v10, v7
    v_cvt_f32_u32 v10, v10
    v_mul_f32 v10, s18, v10
    v_cos_f32 v10, v10
    s_nop 0
    v_mul_f32 v17, v10, v9
    v_add_u32 v8, 2, v6
    v_cmp_gt_u32 vcc, 321, v8
    s_nop 1
    v_cndmask_b32 v9, 0, v14, vcc
    v_cmp_eq_u32 vcc, 0, v7
    s_nop 1
    v_cndmask_b32 v11, 0, v15, vcc
    v_cmp_eq_u32 vcc, 0, v8
    s_nop 1
    v_cndmask_b32 v9, v9, v11, vcc
    v_cmp_eq_u32 vcc, 320, v8
    s_nop 1
    v_cndmask_b32 v9, v9, v11, vcc
    v_mul_u32_u24 v10, v8, v4
    v_lshrrev_b32 v11, 7, v10
    v_mul_u32_u24 v11, 52429, v11
    v_lshrrev_b32 v11, 18, v11
    v_mul_u32_u24 v11, 640, v11
    v_sub_u32 v10, v10, v11
    v_add_u32 v10, v10, v7
    v_cvt_f32_u32 v10, v10
    v_mul_f32 v10, s18, v10
    v_cos_f32 v10, v10
    s_nop 0
    v_mul_f32 v18, v10, v9
    v_add_u32 v8, 3, v6
    v_cmp_gt_u32 vcc, 321, v8
    s_nop 1
    v_cndmask_b32 v9, 0, v14, vcc
    v_cmp_eq_u32 vcc, 0, v7
    s_nop 1
    v_cndmask_b32 v11, 0, v15, vcc
    v_cmp_eq_u32 vcc, 0, v8
    s_nop 1
    v_cndmask_b32 v9, v9, v11, vcc
    v_cmp_eq_u32 vcc, 320, v8
    s_nop 1
    v_cndmask_b32 v9, v9, v11, vcc
    v_mul_u32_u24 v10, v8, v4
    v_lshrrev_b32 v11, 7, v10
    v_mul_u32_u24 v11, 52429, v11
    v_lshrrev_b32 v11, 18, v11
    v_mul_u32_u24 v11, 640, v11
    v_sub_u32 v10, v10, v11
    v_add_u32 v10, v10, v7
    v_cvt_f32_u32 v10, v10
    v_mul_f32 v10, s18, v10
    v_cos_f32 v10, v10
    s_nop 0
    v_mul_f32 v19, v10, v9
    v_add_u32 v8, 4, v6
    v_cmp_gt_u32 vcc, 321, v8
    s_nop 1
    v_cndmask_b32 v9, 0, v14, vcc
    v_cmp_eq_u32 vcc, 0, v7
    s_nop 1
    v_cndmask_b32 v11, 0, v15, vcc
    v_cmp_eq_u32 vcc, 0, v8
    s_nop 1
    v_cndmask_b32 v9, v9, v11, vcc
    v_cmp_eq_u32 vcc, 320, v8
    s_nop 1
    v_cndmask_b32 v9, v9, v11, vcc
    v_mul_u32_u24 v10, v8, v4
    v_lshrrev_b32 v11, 7, v10
    v_mul_u32_u24 v11, 52429, v11
    v_lshrrev_b32 v11, 18, v11
    v_mul_u32_u24 v11, 640, v11
    v_sub_u32 v10, v10, v11
    v_add_u32 v10, v10, v7
    v_cvt_f32_u32 v10, v10
    v_mul_f32 v10, s18, v10
    v_cos_f32 v10, v10
    s_nop 0
    v_mul_f32 v20, v10, v9
    v_add_u32 v8, 5, v6
    v_cmp_gt_u32 vcc, 321, v8
    s_nop 1
    v_cndmask_b32 v9, 0, v14, vcc
    v_cmp_eq_u32 vcc, 0, v7
    s_nop 1
    v_cndmask_b32 v11, 0, v15, vcc
    v_cmp_eq_u32 vcc, 0, v8
    s_nop 1
    v_cndmask_b32 v9, v9, v11, vcc
    v_cmp_eq_u32 vcc, 320, v8
    s_nop 1
    v_cndmask_b32 v9, v9, v11, vcc
    v_mul_u32_u24 v10, v8, v4
    v_lshrrev_b32 v11, 7, v10
    v_mul_u32_u24 v11, 52429, v11
    v_lshrrev_b32 v11, 18, v11
    v_mul_u32_u24 v11, 640, v11
    v_sub_u32 v10, v10, v11
    v_add_u32 v10, v10, v7
    v_cvt_f32_u32 v10, v10
    v_mul_f32 v10, s18, v10
    v_cos_f32 v10, v10
    s_nop 0
    v_mul_f32 v21, v10, v9
    v_add_u32 v8, 6, v6
    v_cmp_gt_u32 vcc, 321, v8
    s_nop 1
    v_cndmask_b32 v9, 0, v14, vcc
    v_cmp_eq_u32 vcc, 0, v7
    s_nop 1
    v_cndmask_b32 v11, 0, v15, vcc
    v_cmp_eq_u32 vcc, 0, v8
    s_nop 1
    v_cndmask_b32 v9, v9, v11, vcc
    v_cmp_eq_u32 vcc, 320, v8
    s_nop 1
    v_cndmask_b32 v9, v9, v11, vcc
    v_mul_u32_u24 v10, v8, v4
    v_lshrrev_b32 v11, 7, v10
    v_mul_u32_u24 v11, 52429, v11
    v_lshrrev_b32 v11, 18, v11
    v_mul_u32_u24 v11, 640, v11
    v_sub_u32 v10, v10, v11
    v_add_u32 v10, v10, v7
    v_cvt_f32_u32 v10, v10
    v_mul_f32 v10, s18, v10
    v_cos_f32 v10, v10
    s_nop 0
    v_mul_f32 v22, v10, v9
    v_add_u32 v8, 7, v6
    v_cmp_gt_u32 vcc, 321, v8
    s_nop 1
    v_cndmask_b32 v9, 0, v14, vcc
    v_cmp_eq_u32 vcc, 0, v7
    s_nop 1
    v_cndmask_b32 v11, 0, v15, vcc
    v_cmp_eq_u32 vcc, 0, v8
    s_nop 1
    v_cndmask_b32 v9, v9, v11, vcc
    v_cmp_eq_u32 vcc, 320, v8
    s_nop 1
    v_cndmask_b32 v9, v9, v11, vcc
    v_mul_u32_u24 v10, v8, v4
    v_lshrrev_b32 v11, 7, v10
    v_mul_u32_u24 v11, 52429, v11
    v_lshrrev_b32 v11, 18, v11
    v_mul_u32_u24 v11, 640, v11
    v_sub_u32 v10, v10, v11
    v_add_u32 v10, v10, v7
    v_cvt_f32_u32 v10, v10
    v_mul_f32 v10, s18, v10
    v_cos_f32 v10, v10
    s_nop 0
    v_mul_f32 v23, v10, v9
    v_mul_u32_u24 v12, 1536, v4
    v_lshl_add_u32 v12, v5, 1, v12
    v_add_u32 v13, 0x9d00000, v12
    v_add_u32 v12, 0x9c00000, v12
    v_cvt_pk_bf16_f32 v24, v16, v17
    v_lshlrev_b32 v32, 16, v24
    v_and_b32 v33, 0xffff0000, v24
    v_sub_f32 v32, v16, v32
    v_sub_f32 v33, v17, v33
    v_cvt_pk_bf16_f32 v28, v32, v33
    v_cvt_pk_bf16_f32 v25, v18, v19
    v_lshlrev_b32 v32, 16, v25
    v_and_b32 v33, 0xffff0000, v25
    v_sub_f32 v32, v18, v32
    v_sub_f32 v33, v19, v33
    v_cvt_pk_bf16_f32 v29, v32, v33
    v_cvt_pk_bf16_f32 v26, v20, v21
    v_lshlrev_b32 v32, 16, v26
    v_and_b32 v33, 0xffff0000, v26
    v_sub_f32 v32, v20, v32
    v_sub_f32 v33, v21, v33
    v_cvt_pk_bf16_f32 v30, v32, v33
    v_cvt_pk_bf16_f32 v27, v22, v23
    v_lshlrev_b32 v32, 16, v27
    v_and_b32 v33, 0xffff0000, v27
    v_sub_f32 v32, v22, v32
    v_sub_f32 v33, v23, v33
    v_cvt_pk_bf16_f32 v31, v32, v33
    buffer_store_dwordx4 v[24:27], v12, s[8:11], 0 offen
    buffer_store_dwordx4 v[28:31], v13, s[8:11], 0 offen
    s_branch Lp_end
Lp_notCD:
    s_cmp_ge_u32 s2, 1432
    s_cbranch_scc1 Lp_M
    s_mov_b32 s12, s48
    s_and_b32 s13, s49, 0xffff
    s_mov_b32 s14, 0x280000
    s_mov_b32 s15, 0x00020000
    s_mov_b32 s16, s50
    s_and_b32 s17, s51, 0xffff
    s_mov_b32 s18, 0x500
    s_mov_b32 s19, 0x00020000
    v_mul_u32_u24 v3, 20, v1
    buffer_load_dwordx4 v[8:11], v3, s[16:19], 0 offen
    buffer_load_dword v12, v3, s[16:19], 0 offen offset:16
    s_sub_u32 s20, s2, 1368
    s_lshl_b32 s20, s20, 2
    v_add_u32 v4, s20, v2
    v_lshlrev_b32 v4, 3, v4
    v_mul_u32_u24 v5, 1280, v4
    v_add_u32 v5, v5, v3
    v_lshlrev_b32 v6, 2, v4
    v_add_u32 v6, 0x9e00000, v6
    s_waitcnt vmcnt(0)
    v_lshlrev_b32 v20, 16, v8
    v_and_b32 v21, 0xffff0000, v8
    v_lshlrev_b32 v22, 16, v9
    v_and_b32 v23, 0xffff0000, v9
    v_lshlrev_b32 v24, 16, v10
    v_and_b32 v25, 0xffff0000, v10
    v_lshlrev_b32 v26, 16, v11
    v_and_b32 v27, 0xffff0000, v11
    v_lshlrev_b32 v28, 16, v12
    v_and_b32 v29, 0xffff0000, v12
    s_mov_b32 s21, 0x3fb8aa3b
    buffer_load_dwordx4 v[32:35], v5, s[12:15], 0 offen
    buffer_load_dword v36, v5, s[12:15], 0 offen offset:16
    v_add_u32 v5, 1280, v5
    v_mov_b32 v40, 0
    s_waitcnt vmcnt(0)
    v_lshlrev_b32 v41, 16, v32
    v_and_b32 v42, 0xffff0000, v32
    v_mul_f32 v41, v41, v20
    v_mul_f32 v42, v42, v21
    v_cvt_pk_bf16_f32 v43, v41, v42
    v_lshlrev_b32 v41, 16, v43
    v_and_b32 v42, 0xffff0000, v43
    v_add_f32 v40, v40, v41
    v_add_f32 v40, v40, v42
    v_lshlrev_b32 v41, 16, v33
    v_and_b32 v42, 0xffff0000, v33
    v_mul_f32 v41, v41, v22
    v_mul_f32 v42, v42, v23
    v_cvt_pk_bf16_f32 v43, v41, v42
    v_lshlrev_b32 v41, 16, v43
    v_and_b32 v42, 0xffff0000, v43
    v_add_f32 v40, v40, v41
    v_add_f32 v40, v40, v42
    v_lshlrev_b32 v41, 16, v34
    v_and_b32 v42, 0xffff0000, v34
    v_mul_f32 v41, v41, v24
    v_mul_f32 v42, v42, v25
    v_cvt_pk_bf16_f32 v43, v41, v42
    v_lshlrev_b32 v41, 16, v43
    v_and_b32 v42, 0xffff0000, v43
    v_add_f32 v40, v40, v41
    v_add_f32 v40, v40, v42
    v_lshlrev_b32 v41, 16, v35
    v_and_b32 v42, 0xffff0000, v35
    v_mul_f32 v41, v41, v26
    v_mul_f32 v42, v42, v27
    v_cvt_pk_bf16_f32 v43, v41, v42
    v_lshlrev_b32 v41, 16, v43
    v_and_b32 v42, 0xffff0000, v43
    v_add_f32 v40, v40, v41
    v_add_f32 v40, v40, v42
    v_lshlrev_b32 v41, 16, v36
    v_and_b32 v42, 0xffff0000, v36
    v_mul_f32 v41, v41, v28
    v_mul_f32 v42, v42, v29
    v_cvt_pk_bf16_f32 v43, v41, v42
    v_lshlrev_b32 v41, 16, v43
    v_and_b32 v42, 0xffff0000, v43
    v_add_f32 v40, v40, v41
    v_add_f32 v40, v40, v42
    s_nop 1
    v_add_f32_dpp v40, v40, v40 row_ror:1 row_mask:0xf bank_mask:0xf
    s_nop 1
    v_add_f32_dpp v40, v40, v40 row_ror:2 row_mask:0xf bank_mask:0xf
    s_nop 1
    v_add_f32_dpp v40, v40, v40 row_ror:4 row_mask:0xf bank_mask:0xf
    s_nop 1
    v_add_f32_dpp v40, v40, v40 row_ror:8 row_mask:0xf bank_mask:0xf
    v_mov_b32 v41, v40
    s_nop 1
    v_permlane16_swap_b32 v40, v41
    s_nop 0
    v_add_f32 v40, v40, v41
    v_mov_b32 v41, v40
    s_nop 1
    v_permlane32_swap_b32 v40, v41
    s_nop 0
    v_add_f32 v40, v40, v41
    v_cvt_pk_bf16_f32 v40, v40, v40
    v_lshlrev_b32 v40, 16, v40
    v_mul_f32 v41, s21, v40
    v_sub_f32 v41, 0, v41
    v_exp_f32 v41, v41
    s_nop 0
    v_add_f32 v41, 1.0, v41
    v_rcp_f32 v41, v41
    s_nop 0
    v_cvt_pk_bf16_f32 v41, v41, v41
    v_lshlrev_b32 v41, 16, v41
    s_mov_b64 s[30:31], exec
    s_mov_b64 exec, 1
    buffer_store_dword v41, v6, s[8:11], 0 offen offset:0
    s_mov_b64 exec, s[30:31]
    buffer_load_dwordx4 v[32:35], v5, s[12:15], 0 offen
    buffer_load_dword v36, v5, s[12:15], 0 offen offset:16
    v_add_u32 v5, 1280, v5
    v_mov_b32 v40, 0
    s_waitcnt vmcnt(0)
    v_lshlrev_b32 v41, 16, v32
    v_and_b32 v42, 0xffff0000, v32
    v_mul_f32 v41, v41, v20
    v_mul_f32 v42, v42, v21
    v_cvt_pk_bf16_f32 v43, v41, v42
    v_lshlrev_b32 v41, 16, v43
    v_and_b32 v42, 0xffff0000, v43
    v_add_f32 v40, v40, v41
    v_add_f32 v40, v40, v42
    v_lshlrev_b32 v41, 16, v33
    v_and_b32 v42, 0xffff0000, v33
    v_mul_f32 v41, v41, v22
    v_mul_f32 v42, v42, v23
    v_cvt_pk_bf16_f32 v43, v41, v42
    v_lshlrev_b32 v41, 16, v43
    v_and_b32 v42, 0xffff0000, v43
    v_add_f32 v40, v40, v41
    v_add_f32 v40, v40, v42
    v_lshlrev_b32 v41, 16, v34
    v_and_b32 v42, 0xffff0000, v34
    v_mul_f32 v41, v41, v24
    v_mul_f32 v42, v42, v25
    v_cvt_pk_bf16_f32 v43, v41, v42
    v_lshlrev_b32 v41, 16, v43
    v_and_b32 v42, 0xffff0000, v43
    v_add_f32 v40, v40, v41
    v_add_f32 v40, v40, v42
    v_lshlrev_b32 v41, 16, v35
    v_and_b32 v42, 0xffff0000, v35
    v_mul_f32 v41, v41, v26
    v_mul_f32 v42, v42, v27
    v_cvt_pk_bf16_f32 v43, v41, v42
    v_lshlrev_b32 v41, 16, v43
    v_and_b32 v42, 0xffff0000, v43
    v_add_f32 v40, v40, v41
    v_add_f32 v40, v40, v42
    v_lshlrev_b32 v41, 16, v36
    v_and_b32 v42, 0xffff0000, v36
    v_mul_f32 v41, v41, v28
    v_mul_f32 v42, v42, v29
    v_cvt_pk_bf16_f32 v43, v41, v42
    v_lshlrev_b32 v41, 16, v43
    v_and_b32 v42, 0xffff0000, v43
    v_add_f32 v40, v40, v41
    v_add_f32 v40, v40, v42
    s_nop 1
    v_add_f32_dpp v40, v40, v40 row_ror:1 row_mask:0xf bank_mask:0xf
    s_nop 1
    v_add_f32_dpp v40, v40, v40 row_ror:2 row_mask:0xf bank_mask:0xf
    s_nop 1
    v_add_f32_dpp v40, v40, v40 row_ror:4 row_mask:0xf bank_mask:0xf
    s_nop 1
    v_add_f32_dpp v40, v40, v40 row_ror:8 row_mask:0xf bank_mask:0xf
    v_mov_b32 v41, v40
    s_nop 1
    v_permlane16_swap_b32 v40, v41
    s_nop 0
    v_add_f32 v40, v40, v41
    v_mov_b32 v41, v40
    s_nop 1
    v_permlane32_swap_b32 v40, v41
    s_nop 0
    v_add_f32 v40, v40, v41
    v_cvt_pk_bf16_f32 v40, v40, v40
    v_lshlrev_b32 v40, 16, v40
    v_mul_f32 v41, s21, v40
    v_sub_f32 v41, 0, v41
    v_exp_f32 v41, v41
    s_nop 0
    v_add_f32 v41, 1.0, v41
    v_rcp_f32 v41, v41
    s_nop 0
    v_cvt_pk_bf16_f32 v41, v41, v41
    v_lshlrev_b32 v41, 16, v41
    s_mov_b64 s[30:31], exec
    s_mov_b64 exec, 1
    buffer_store_dword v41, v6, s[8:11], 0 offen offset:4
    s_mov_b64 exec, s[30:31]
    buffer_load_dwordx4 v[32:35], v5, s[12:15], 0 offen
    buffer_load_dword v36, v5, s[12:15], 0 offen offset:16
    v_add_u32 v5, 1280, v5
    v_mov_b32 v40, 0
    s_waitcnt vmcnt(0)
    v_lshlrev_b32 v41, 16, v32
    v_and_b32 v42, 0xffff0000, v32
    v_mul_f32 v41, v41, v20
    v_mul_f32 v42, v42, v21
    v_cvt_pk_bf16_f32 v43, v41, v42
    v_lshlrev_b32 v41, 16, v43
    v_and_b32 v42, 0xffff0000, v43
    v_add_f32 v40, v40, v41
    v_add_f32 v40, v40, v42
    v_lshlrev_b32 v41, 16, v33
    v_and_b32 v42, 0xffff0000, v33
    v_mul_f32 v41, v41, v22
    v_mul_f32 v42, v42, v23
    v_cvt_pk_bf16_f32 v43, v41, v42
    v_lshlrev_b32 v41, 16, v43
    v_and_b32 v42, 0xffff0000, v43
    v_add_f32 v40, v40, v41
    v_add_f32 v40, v40, v42
    v_lshlrev_b32 v41, 16, v34
    v_and_b32 v42, 0xffff0000, v34
    v_mul_f32 v41, v41, v24
    v_mul_f32 v42, v42, v25
    v_cvt_pk_bf16_f32 v43, v41, v42
    v_lshlrev_b32 v41, 16, v43
    v_and_b32 v42, 0xffff0000, v43
    v_add_f32 v40, v40, v41
    v_add_f32 v40, v40, v42
    v_lshlrev_b32 v41, 16, v35
    v_and_b32 v42, 0xffff0000, v35
    v_mul_f32 v41, v41, v26
    v_mul_f32 v42, v42, v27
    v_cvt_pk_bf16_f32 v43, v41, v42
    v_lshlrev_b32 v41, 16, v43
    v_and_b32 v42, 0xffff0000, v43
    v_add_f32 v40, v40, v41
    v_add_f32 v40, v40, v42
    v_lshlrev_b32 v41, 16, v36
    v_and_b32 v42, 0xffff0000, v36
    v_mul_f32 v41, v41, v28
    v_mul_f32 v42, v42, v29
    v_cvt_pk_bf16_f32 v43, v41, v42
    v_lshlrev_b32 v41, 16, v43
    v_and_b32 v42, 0xffff0000, v43
    v_add_f32 v40, v40, v41
    v_add_f32 v40, v40, v42
    s_nop 1
    v_add_f32_dpp v40, v40, v40 row_ror:1 row_mask:0xf bank_mask:0xf
    s_nop 1
    v_add_f32_dpp v40, v40, v40 row_ror:2 row_mask:0xf bank_mask:0xf
    s_nop 1
    v_add_f32_dpp v40, v40, v40 row_ror:4 row_mask:0xf bank_mask:0xf
    s_nop 1
    v_add_f32_dpp v40, v40, v40 row_ror:8 row_mask:0xf bank_mask:0xf
    v_mov_b32 v41, v40
    s_nop 1
    v_permlane16_swap_b32 v40, v41
    s_nop 0
    v_add_f32 v40, v40, v41
    v_mov_b32 v41, v40
    s_nop 1
    v_permlane32_swap_b32 v40, v41
    s_nop 0
    v_add_f32 v40, v40, v41
    v_cvt_pk_bf16_f32 v40, v40, v40
    v_lshlrev_b32 v40, 16, v40
    v_mul_f32 v41, s21, v40
    v_sub_f32 v41, 0, v41
    v_exp_f32 v41, v41
    s_nop 0
    v_add_f32 v41, 1.0, v41
    v_rcp_f32 v41, v41
    s_nop 0
    v_cvt_pk_bf16_f32 v41, v41, v41
    v_lshlrev_b32 v41, 16, v41
    s_mov_b64 s[30:31], exec
    s_mov_b64 exec, 1
    buffer_store_dword v41, v6, s[8:11], 0 offen offset:8
    s_mov_b64 exec, s[30:31]
    buffer_load_dwordx4 v[32:35], v5, s[12:15], 0 offen
    buffer_load_dword v36, v5, s[12:15], 0 offen offset:16
    v_add_u32 v5, 1280, v5
    v_mov_b32 v40, 0
    s_waitcnt vmcnt(0)
    v_lshlrev_b32 v41, 16, v32
    v_and_b32 v42, 0xffff0000, v32
    v_mul_f32 v41, v41, v20
    v_mul_f32 v42, v42, v21
    v_cvt_pk_bf16_f32 v43, v41, v42
    v_lshlrev_b32 v41, 16, v43
    v_and_b32 v42, 0xffff0000, v43
    v_add_f32 v40, v40, v41
    v_add_f32 v40, v40, v42
    v_lshlrev_b32 v41, 16, v33
    v_and_b32 v42, 0xffff0000, v33
    v_mul_f32 v41, v41, v22
    v_mul_f32 v42, v42, v23
    v_cvt_pk_bf16_f32 v43, v41, v42
    v_lshlrev_b32 v41, 16, v43
    v_and_b32 v42, 0xffff0000, v43
    v_add_f32 v40, v40, v41
    v_add_f32 v40, v40, v42
    v_lshlrev_b32 v41, 16, v34
    v_and_b32 v42, 0xffff0000, v34
    v_mul_f32 v41, v41, v24
    v_mul_f32 v42, v42, v25
    v_cvt_pk_bf16_f32 v43, v41, v42
    v_lshlrev_b32 v41, 16, v43
    v_and_b32 v42, 0xffff0000, v43
    v_add_f32 v40, v40, v41
    v_add_f32 v40, v40, v42
    v_lshlrev_b32 v41, 16, v35
    v_and_b32 v42, 0xffff0000, v35
    v_mul_f32 v41, v41, v26
    v_mul_f32 v42, v42, v27
    v_cvt_pk_bf16_f32 v43, v41, v42
    v_lshlrev_b32 v41, 16, v43
    v_and_b32 v42, 0xffff0000, v43
    v_add_f32 v40, v40, v41
    v_add_f32 v40, v40, v42
    v_lshlrev_b32 v41, 16, v36
    v_and_b32 v42, 0xffff0000, v36
    v_mul_f32 v41, v41, v28
    v_mul_f32 v42, v42, v29
    v_cvt_pk_bf16_f32 v43, v41, v42
    v_lshlrev_b32 v41, 16, v43
    v_and_b32 v42, 0xffff0000, v43
    v_add_f32 v40, v40, v41
    v_add_f32 v40, v40, v42
    s_nop 1
    v_add_f32_dpp v40, v40, v40 row_ror:1 row_mask:0xf bank_mask:0xf
    s_nop 1
    v_add_f32_dpp v40, v40, v40 row_ror:2 row_mask:0xf bank_mask:0xf
    s_nop 1
    v_add_f32_dpp v40, v40, v40 row_ror:4 row_mask:0xf bank_mask:0xf
    s_nop 1
    v_add_f32_dpp v40, v40, v40 row_ror:8 row_mask:0xf bank_mask:0xf
    v_mov_b32 v41, v40
    s_nop 1
    v_permlane16_swap_b32 v40, v41
    s_nop 0
    v_add_f32 v40, v40, v41
    v_mov_b32 v41, v40
    s_nop 1
    v_permlane32_swap_b32 v40, v41
    s_nop 0
    v_add_f32 v40, v40, v41
    v_cvt_pk_bf16_f32 v40, v40, v40
    v_lshlrev_b32 v40, 16, v40
    v_mul_f32 v41, s21, v40
    v_sub_f32 v41, 0, v41
    v_exp_f32 v41, v41
    s_nop 0
    v_add_f32 v41, 1.0, v41
    v_rcp_f32 v41, v41
    s_nop 0
    v_cvt_pk_bf16_f32 v41, v41, v41
    v_lshlrev_b32 v41, 16, v41
    s_mov_b64 s[30:31], exec
    s_mov_b64 exec, 1
    buffer_store_dword v41, v6, s[8:11], 0 offen offset:12
    s_mov_b64 exec, s[30:31]
    buffer_load_dwordx4 v[32:35], v5, s[12:15], 0 offen
    buffer_load_dword v36, v5, s[12:15], 0 offen offset:16
    v_add_u32 v5, 1280, v5
    v_mov_b32 v40, 0
    s_waitcnt vmcnt(0)
    v_lshlrev_b32 v41, 16, v32
    v_and_b32 v42, 0xffff0000, v32
    v_mul_f32 v41, v41, v20
    v_mul_f32 v42, v42, v21
    v_cvt_pk_bf16_f32 v43, v41, v42
    v_lshlrev_b32 v41, 16, v43
    v_and_b32 v42, 0xffff0000, v43
    v_add_f32 v40, v40, v41
    v_add_f32 v40, v40, v42
    v_lshlrev_b32 v41, 16, v33
    v_and_b32 v42, 0xffff0000, v33
    v_mul_f32 v41, v41, v22
    v_mul_f32 v42, v42, v23
    v_cvt_pk_bf16_f32 v43, v41, v42
    v_lshlrev_b32 v41, 16, v43
    v_and_b32 v42, 0xffff0000, v43
    v_add_f32 v40, v40, v41
    v_add_f32 v40, v40, v42
    v_lshlrev_b32 v41, 16, v34
    v_and_b32 v42, 0xffff0000, v34
    v_mul_f32 v41, v41, v24
    v_mul_f32 v42, v42, v25
    v_cvt_pk_bf16_f32 v43, v41, v42
    v_lshlrev_b32 v41, 16, v43
    v_and_b32 v42, 0xffff0000, v43
    v_add_f32 v40, v40, v41
    v_add_f32 v40, v40, v42
    v_lshlrev_b32 v41, 16, v35
    v_and_b32 v42, 0xffff0000, v35
    v_mul_f32 v41, v41, v26
    v_mul_f32 v42, v42, v27
    v_cvt_pk_bf16_f32 v43, v41, v42
    v_lshlrev_b32 v41, 16, v43
    v_and_b32 v42, 0xffff0000, v43
    v_add_f32 v40, v40, v41
    v_add_f32 v40, v40, v42
    v_lshlrev_b32 v41, 16, v36
    v_and_b32 v42, 0xffff0000, v36
    v_mul_f32 v41, v41, v28
    v_mul_f32 v42, v42, v29
    v_cvt_pk_bf16_f32 v43, v41, v42
    v_lshlrev_b32 v41, 16, v43
    v_and_b32 v42, 0xffff0000, v43
    v_add_f32 v40, v40, v41
    v_add_f32 v40, v40, v42
    s_nop 1
    v_add_f32_dpp v40, v40, v40 row_ror:1 row_mask:0xf bank_mask:0xf
    s_nop 1
    v_add_f32_dpp v40, v40, v40 row_ror:2 row_mask:0xf bank_mask:0xf
    s_nop 1
    v_add_f32_dpp v40, v40, v40 row_ror:4 row_mask:0xf bank_mask:0xf
    s_nop 1
    v_add_f32_dpp v40, v40, v40 row_ror:8 row_mask:0xf bank_mask:0xf
    v_mov_b32 v41, v40
    s_nop 1
    v_permlane16_swap_b32 v40, v41
    s_nop 0
    v_add_f32 v40, v40, v41
    v_mov_b32 v41, v40
    s_nop 1
    v_permlane32_swap_b32 v40, v41
    s_nop 0
    v_add_f32 v40, v40, v41
    v_cvt_pk_bf16_f32 v40, v40, v40
    v_lshlrev_b32 v40, 16, v40
    v_mul_f32 v41, s21, v40
    v_sub_f32 v41, 0, v41
    v_exp_f32 v41, v41
    s_nop 0
    v_add_f32 v41, 1.0, v41
    v_rcp_f32 v41, v41
    s_nop 0
    v_cvt_pk_bf16_f32 v41, v41, v41
    v_lshlrev_b32 v41, 16, v41
    s_mov_b64 s[30:31], exec
    s_mov_b64 exec, 1
    buffer_store_dword v41, v6, s[8:11], 0 offen offset:16
    s_mov_b64 exec, s[30:31]
    buffer_load_dwordx4 v[32:35], v5, s[12:15], 0 offen
    buffer_load_dword v36, v5, s[12:15], 0 offen offset:16
    v_add_u32 v5, 1280, v5
    v_mov_b32 v40, 0
    s_waitcnt vmcnt(0)
    v_lshlrev_b32 v41, 16, v32
    v_and_b32 v42, 0xffff0000, v32
    v_mul_f32 v41, v41, v20
    v_mul_f32 v42, v42, v21
    v_cvt_pk_bf16_f32 v43, v41, v42
    v_lshlrev_b32 v41, 16, v43
    v_and_b32 v42, 0xffff0000, v43
    v_add_f32 v40, v40, v41
    v_add_f32 v40, v40, v42
    v_lshlrev_b32 v41, 16, v33
    v_and_b32 v42, 0xffff0000, v33
    v_mul_f32 v41, v41, v22
    v_mul_f32 v42, v42, v23
    v_cvt_pk_bf16_f32 v43, v41, v42
    v_lshlrev_b32 v41, 16, v43
    v_and_b32 v42, 0xffff0000, v43
    v_add_f32 v40, v40, v41
    v_add_f32 v40, v40, v42
    v_lshlrev_b32 v41, 16, v34
    v_and_b32 v42, 0xffff0000, v34
    v_mul_f32 v41, v41, v24
    v_mul_f32 v42, v42, v25
    v_cvt_pk_bf16_f32 v43, v41, v42
    v_lshlrev_b32 v41, 16, v43
    v_and_b32 v42, 0xffff0000, v43
    v_add_f32 v40, v40, v41
    v_add_f32 v40, v40, v42
    v_lshlrev_b32 v41, 16, v35
    v_and_b32 v42, 0xffff0000, v35
    v_mul_f32 v41, v41, v26
    v_mul_f32 v42, v42, v27
    v_cvt_pk_bf16_f32 v43, v41, v42
    v_lshlrev_b32 v41, 16, v43
    v_and_b32 v42, 0xffff0000, v43
    v_add_f32 v40, v40, v41
    v_add_f32 v40, v40, v42
    v_lshlrev_b32 v41, 16, v36
    v_and_b32 v42, 0xffff0000, v36
    v_mul_f32 v41, v41, v28
    v_mul_f32 v42, v42, v29
    v_cvt_pk_bf16_f32 v43, v41, v42
    v_lshlrev_b32 v41, 16, v43
    v_and_b32 v42, 0xffff0000, v43
    v_add_f32 v40, v40, v41
    v_add_f32 v40, v40, v42
    s_nop 1
    v_add_f32_dpp v40, v40, v40 row_ror:1 row_mask:0xf bank_mask:0xf
    s_nop 1
    v_add_f32_dpp v40, v40, v40 row_ror:2 row_mask:0xf bank_mask:0xf
    s_nop 1
    v_add_f32_dpp v40, v40, v40 row_ror:4 row_mask:0xf bank_mask:0xf
    s_nop 1
    v_add_f32_dpp v40, v40, v40 row_ror:8 row_mask:0xf bank_mask:0xf
    v_mov_b32 v41, v40
    s_nop 1
    v_permlane16_swap_b32 v40, v41
    s_nop 0
    v_add_f32 v40, v40, v41
    v_mov_b32 v41, v40
    s_nop 1
    v_permlane32_swap_b32 v40, v41
    s_nop 0
    v_add_f32 v40, v40, v41
    v_cvt_pk_bf16_f32 v40, v40, v40
    v_lshlrev_b32 v40, 16, v40
    v_mul_f32 v41, s21, v40
    v_sub_f32 v41, 0, v41
    v_exp_f32 v41, v41
    s_nop 0
    v_add_f32 v41, 1.0, v41
    v_rcp_f32 v41, v41
    s_nop 0
    v_cvt_pk_bf16_f32 v41, v41, v41
    v_lshlrev_b32 v41, 16, v41
    s_mov_b64 s[30:31], exec
    s_mov_b64 exec, 1
    buffer_store_dword v41, v6, s[8:11], 0 offen offset:20
    s_mov_b64 exec, s[30:31]
    buffer_load_dwordx4 v[32:35], v5, s[12:15], 0 offen
    buffer_load_dword v36, v5, s[12:15], 0 offen offset:16
    v_add_u32 v5, 1280, v5
    v_mov_b32 v40, 0
    s_waitcnt vmcnt(0)
    v_lshlrev_b32 v41, 16, v32
    v_and_b32 v42, 0xffff0000, v32
    v_mul_f32 v41, v41, v20
    v_mul_f32 v42, v42, v21
    v_cvt_pk_bf16_f32 v43, v41, v42
    v_lshlrev_b32 v41, 16, v43
    v_and_b32 v42, 0xffff0000, v43
    v_add_f32 v40, v40, v41
    v_add_f32 v40, v40, v42
    v_lshlrev_b32 v41, 16, v33
    v_and_b32 v42, 0xffff0000, v33
    v_mul_f32 v41, v41, v22
    v_mul_f32 v42, v42, v23
    v_cvt_pk_bf16_f32 v43, v41, v42
    v_lshlrev_b32 v41, 16, v43
    v_and_b32 v42, 0xffff0000, v43
    v_add_f32 v40, v40, v41
    v_add_f32 v40, v40, v42
    v_lshlrev_b32 v41, 16, v34
    v_and_b32 v42, 0xffff0000, v34
    v_mul_f32 v41, v41, v24
    v_mul_f32 v42, v42, v25
    v_cvt_pk_bf16_f32 v43, v41, v42
    v_lshlrev_b32 v41, 16, v43
    v_and_b32 v42, 0xffff0000, v43
    v_add_f32 v40, v40, v41
    v_add_f32 v40, v40, v42
    v_lshlrev_b32 v41, 16, v35
    v_and_b32 v42, 0xffff0000, v35
    v_mul_f32 v41, v41, v26
    v_mul_f32 v42, v42, v27
    v_cvt_pk_bf16_f32 v43, v41, v42
    v_lshlrev_b32 v41, 16, v43
    v_and_b32 v42, 0xffff0000, v43
    v_add_f32 v40, v40, v41
    v_add_f32 v40, v40, v42
    v_lshlrev_b32 v41, 16, v36
    v_and_b32 v42, 0xffff0000, v36
    v_mul_f32 v41, v41, v28
    v_mul_f32 v42, v42, v29
    v_cvt_pk_bf16_f32 v43, v41, v42
    v_lshlrev_b32 v41, 16, v43
    v_and_b32 v42, 0xffff0000, v43
    v_add_f32 v40, v40, v41
    v_add_f32 v40, v40, v42
    s_nop 1
    v_add_f32_dpp v40, v40, v40 row_ror:1 row_mask:0xf bank_mask:0xf
    s_nop 1
    v_add_f32_dpp v40, v40, v40 row_ror:2 row_mask:0xf bank_mask:0xf
    s_nop 1
    v_add_f32_dpp v40, v40, v40 row_ror:4 row_mask:0xf bank_mask:0xf
    s_nop 1
    v_add_f32_dpp v40, v40, v40 row_ror:8 row_mask:0xf bank_mask:0xf
    v_mov_b32 v41, v40
    s_nop 1
    v_permlane16_swap_b32 v40, v41
    s_nop 0
    v_add_f32 v40, v40, v41
    v_mov_b32 v41, v40
    s_nop 1
    v_permlane32_swap_b32 v40, v41
    s_nop 0
    v_add_f32 v40, v40, v41
    v_cvt_pk_bf16_f32 v40, v40, v40
    v_lshlrev_b32 v40, 16, v40
    v_mul_f32 v41, s21, v40
    v_sub_f32 v41, 0, v41
    v_exp_f32 v41, v41
    s_nop 0
    v_add_f32 v41, 1.0, v41
    v_rcp_f32 v41, v41
    s_nop 0
    v_cvt_pk_bf16_f32 v41, v41, v41
    v_lshlrev_b32 v41, 16, v41
    s_mov_b64 s[30:31], exec
    s_mov_b64 exec, 1
    buffer_store_dword v41, v6, s[8:11], 0 offen offset:24
    s_mov_b64 exec, s[30:31]
    buffer_load_dwordx4 v[32:35], v5, s[12:15], 0 offen
    buffer_load_dword v36, v5, s[12:15], 0 offen offset:16
    v_add_u32 v5, 1280, v5
    v_mov_b32 v40, 0
    s_waitcnt vmcnt(0)
    v_lshlrev_b32 v41, 16, v32
    v_and_b32 v42, 0xffff0000, v32
    v_mul_f32 v41, v41, v20
    v_mul_f32 v42, v42, v21
    v_cvt_pk_bf16_f32 v43, v41, v42
    v_lshlrev_b32 v41, 16, v43
    v_and_b32 v42, 0xffff0000, v43
    v_add_f32 v40, v40, v41
    v_add_f32 v40, v40, v42
    v_lshlrev_b32 v41, 16, v33
    v_and_b32 v42, 0xffff0000, v33
    v_mul_f32 v41, v41, v22
    v_mul_f32 v42, v42, v23
    v_cvt_pk_bf16_f32 v43, v41, v42
    v_lshlrev_b32 v41, 16, v43
    v_and_b32 v42, 0xffff0000, v43
    v_add_f32 v40, v40, v41
    v_add_f32 v40, v40, v42
    v_lshlrev_b32 v41, 16, v34
    v_and_b32 v42, 0xffff0000, v34
    v_mul_f32 v41, v41, v24
    v_mul_f32 v42, v42, v25
    v_cvt_pk_bf16_f32 v43, v41, v42
    v_lshlrev_b32 v41, 16, v43
    v_and_b32 v42, 0xffff0000, v43
    v_add_f32 v40, v40, v41
    v_add_f32 v40, v40, v42
    v_lshlrev_b32 v41, 16, v35
    v_and_b32 v42, 0xffff0000, v35
    v_mul_f32 v41, v41, v26
    v_mul_f32 v42, v42, v27
    v_cvt_pk_bf16_f32 v43, v41, v42
    v_lshlrev_b32 v41, 16, v43
    v_and_b32 v42, 0xffff0000, v43
    v_add_f32 v40, v40, v41
    v_add_f32 v40, v40, v42
    v_lshlrev_b32 v41, 16, v36
    v_and_b32 v42, 0xffff0000, v36
    v_mul_f32 v41, v41, v28
    v_mul_f32 v42, v42, v29
    v_cvt_pk_bf16_f32 v43, v41, v42
    v_lshlrev_b32 v41, 16, v43
    v_and_b32 v42, 0xffff0000, v43
    v_add_f32 v40, v40, v41
    v_add_f32 v40, v40, v42
    s_nop 1
    v_add_f32_dpp v40, v40, v40 row_ror:1 row_mask:0xf bank_mask:0xf
    s_nop 1
    v_add_f32_dpp v40, v40, v40 row_ror:2 row_mask:0xf bank_mask:0xf
    s_nop 1
    v_add_f32_dpp v40, v40, v40 row_ror:4 row_mask:0xf bank_mask:0xf
    s_nop 1
    v_add_f32_dpp v40, v40, v40 row_ror:8 row_mask:0xf bank_mask:0xf
    v_mov_b32 v41, v40
    s_nop 1
    v_permlane16_swap_b32 v40, v41
    s_nop 0
    v_add_f32 v40, v40, v41
    v_mov_b32 v41, v40
    s_nop 1
    v_permlane32_swap_b32 v40, v41
    s_nop 0
    v_add_f32 v40, v40, v41
    v_cvt_pk_bf16_f32 v40, v40, v40
    v_lshlrev_b32 v40, 16, v40
    v_mul_f32 v41, s21, v40
    v_sub_f32 v41, 0, v41
    v_exp_f32 v41, v41
    s_nop 0
    v_add_f32 v41, 1.0, v41
    v_rcp_f32 v41, v41
    s_nop 0
    v_cvt_pk_bf16_f32 v41, v41, v41
    v_lshlrev_b32 v41, 16, v41
    s_mov_b64 s[30:31], exec
    s_mov_b64 exec, 1
    buffer_store_dword v41, v6, s[8:11], 0 offen offset:28
    s_mov_b64 exec, s[30:31]
    s_branch Lp_end
Lp_M:
    s_cmp_ge_u32 s2, 1433
    s_cbranch_scc0 Lp_M2
    s_sub_u32 s17, s2, 1433
    s_lshl_b32 s17, s17, 16
    s_add_u32 s17, s17, 0x9600000
    v_lshlrev_b32 v4, 4, v0
    v_mov_b32 v8, 0
    v_mov_b32 v9, 0
    v_mov_b32 v10, 0
    v_mov_b32 v11, 0
    buffer_store_dwordx4 v[8:11], v4, s[8:11], s17 offen
    s_add_u32 s17, s17, 4096
    buffer_store_dwordx4 v[8:11], v4, s[8:11], s17 offen
    s_add_u32 s17, s17, 4096
    buffer_store_dwordx4 v[8:11], v4, s[8:11], s17 offen
    s_add_u32 s17, s17, 4096
    buffer_store_dwordx4 v[8:11], v4, s[8:11], s17 offen
    s_add_u32 s17, s17, 4096
    buffer_store_dwordx4 v[8:11], v4, s[8:11], s17 offen
    s_add_u32 s17, s17, 4096
    buffer_store_dwordx4 v[8:11], v4, s[8:11], s17 offen
    s_add_u32 s17, s17, 4096
    buffer_store_dwordx4 v[8:11], v4, s[8:11], s17 offen
    s_add_u32 s17, s17, 4096
    buffer_store_dwordx4 v[8:11], v4, s[8:11], s17 offen
    s_add_u32 s17, s17, 4096
    buffer_store_dwordx4 v[8:11], v4, s[8:11], s17 offen
    s_add_u32 s17, s17, 4096
    buffer_store_dwordx4 v[8:11], v4, s[8:11], s17 offen
    s_add_u32 s17, s17, 4096
    buffer_store_dwordx4 v[8:11], v4, s[8:11], s17 offen
    s_add_u32 s17, s17, 4096
    buffer_store_dwordx4 v[8:11], v4, s[8:11], s17 offen
    s_add_u32 s17, s17, 4096
    buffer_store_dwordx4 v[8:11], v4, s[8:11], s17 offen
    s_add_u32 s17, s17, 4096
    buffer_store_dwordx4 v[8:11], v4, s[8:11], s17 offen
    s_add_u32 s17, s17, 4096
    buffer_store_dwordx4 v[8:11], v4, s[8:11], s17 offen
    s_add_u32 s17, s17, 4096
    buffer_store_dwordx4 v[8:11], v4, s[8:11], s17 offen
    s_add_u32 s17, s17, 4096
    s_branch Lp_end
Lp_M2:
    v_lshlrev_b32 v4, 4, v0
    v_add_u32 v4, 0x9f00000, v4
    v_mov_b32 v8, 0
    v_mov_b32 v9, 0
    v_mov_b32 v10, 0
    v_mov_b32 v11, 0
    buffer_store_dwordx4 v[8:11], v4, s[8:11], 0 offen
    v_add_u32 v4, 4096, v4
    buffer_store_dwordx4 v[8:11], v4, s[8:11], 0 offen
    v_add_u32 v4, 4096, v4
    buffer_store_dwordx4 v[8:11], v4, s[8:11], 0 offen
    v_add_u32 v4, 4096, v4
    buffer_store_dwordx4 v[8:11], v4, s[8:11], 0 offen
    v_add_u32 v4, 4096, v4
    s_mov_b32 s12, s52
    s_and_b32 s13, s53, 0xffff
    s_mov_b32 s14, 0x2800
    s_mov_b32 s15, 0x00020000
    v_mov_b32 v20, 0x7fc07fc0
    v_add_u32 v3, 0, v0
    v_and_b32 v4, 7, v3
    v_mul_u32_u24 v4, 1280, v4
    v_lshrrev_b32 v5, 3, v3
    v_lshl_add_u32 v4, v5, 4, v4
    v_lshlrev_b32 v5, 4, v3
    v_add_u32 v5, 0x5800000, v5
    v_cmp_gt_u32 vcc, 640, v3
    s_and_saveexec_b64 s[30:31], vcc
    s_cbranch_execz Lp_Ms_1
    buffer_load_dwordx4 v[8:11], v4, s[12:15], 0 offen
    s_waitcnt vmcnt(0)
    v_cmp_eq_u32 vcc, -1, v8
    s_nop 1
    v_cndmask_b32 v8, v8, v20, vcc
    v_cmp_eq_u32 vcc, -1, v9
    s_nop 1
    v_cndmask_b32 v9, v9, v20, vcc
    v_cmp_eq_u32 vcc, -1, v10
    s_nop 1
    v_cndmask_b32 v10, v10, v20, vcc
    v_cmp_eq_u32 vcc, -1, v11
    s_nop 1
    v_cndmask_b32 v11, v11, v20, vcc
    buffer_store_dwordx4 v[8:11], v5, s[8:11], 0 offen
    s_waitcnt vmcnt(0)
Lp_Ms_1:
    s_mov_b64 exec, s[30:31]
    v_add_u32 v3, 256, v0
    v_and_b32 v4, 7, v3
    v_mul_u32_u24 v4, 1280, v4
    v_lshrrev_b32 v5, 3, v3
    v_lshl_add_u32 v4, v5, 4, v4
    v_lshlrev_b32 v5, 4, v3
    v_add_u32 v5, 0x5800000, v5
    v_cmp_gt_u32 vcc, 640, v3
    s_and_saveexec_b64 s[30:31], vcc
    s_cbranch_execz Lp_Ms_2
    buffer_load_dwordx4 v[8:11], v4, s[12:15], 0 offen
    s_waitcnt vmcnt(0)
    v_cmp_eq_u32 vcc, -1, v8
    s_nop 1
    v_cndmask_b32 v8, v8, v20, vcc
    v_cmp_eq_u32 vcc, -1, v9
    s_nop 1
    v_cndmask_b32 v9, v9, v20, vcc
    v_cmp_eq_u32 vcc, -1, v10
    s_nop 1
    v_cndmask_b32 v10, v10, v20, vcc
    v_cmp_eq_u32 vcc, -1, v11
    s_nop 1
    v_cndmask_b32 v11, v11, v20, vcc
    buffer_store_dwordx4 v[8:11], v5, s[8:11], 0 offen
    s_waitcnt vmcnt(0)
Lp_Ms_2:
    s_mov_b64 exec, s[30:31]
    v_add_u32 v3, 512, v0
    v_and_b32 v4, 7, v3
    v_mul_u32_u24 v4, 1280, v4
    v_lshrrev_b32 v5, 3, v3
    v_lshl_add_u32 v4, v5, 4, v4
    v_lshlrev_b32 v5, 4, v3
    v_add_u32 v5, 0x5800000, v5
    v_cmp_gt_u32 vcc, 640, v3
    s_and_saveexec_b64 s[30:31], vcc
    s_cbranch_execz Lp_Ms_3
    buffer_load_dwordx4 v[8:11], v4, s[12:15], 0 offen
    s_waitcnt vmcnt(0)
    v_cmp_eq_u32 vcc, -1, v8
    s_nop 1
    v_cndmask_b32 v8, v8, v20, vcc
    v_cmp_eq_u32 vcc, -1, v9
    s_nop 1
    v_cndmask_b32 v9, v9, v20, vcc
    v_cmp_eq_u32 vcc, -1, v10
    s_nop 1
    v_cndmask_b32 v10, v10, v20, vcc
    v_cmp_eq_u32 vcc, -1, v11
    s_nop 1
    v_cndmask_b32 v11, v11, v20, vcc
    buffer_store_dwordx4 v[8:11], v5, s[8:11], 0 offen
    s_waitcnt vmcnt(0)
Lp_Ms_3:
    s_mov_b64 exec, s[30:31]
Lp_end:
    s_endpgm
.globl rec_kernel
.p2align 8
.type rec_kernel,@function
rec_kernel:
    s_cmp_ge_u32 s2, 128
    s_cbranch_scc1 Lbg_entry
    s_setprio 3
    s_load_dwordx2 s[4:5], s[0:1], 104
    s_waitcnt lgkmcnt(0)
    s_mov_b32 s8, s4
    s_and_b32 s9, s5, 0xffff
    s_mov_b32 s10, 0x10000000
    s_mov_b32 s11, 0x00020000
    s_and_b32 s12, s2, 7
    s_lshr_b32 s13, s2, 3
    s_lshl_b32 s14, s12, 2
    s_lshr_b32 s15, s13, 2
    s_add_u32 s14, s14, s15
    s_and_b32 s15, s13, 3
    v_and_b32 v1, 63, v0
    v_lshrrev_b32 v2, 6, v0
    v_and_b32 v3, 15, v0
    v_bfe_u32 v4, v0, 4, 2
    v_mov_b32 v32, 0xfffffffe
    s_nop 0
    v_readfirstlane_b32 s16, v2
    v_and_b32 v6, 7, v3
    v_lshl_add_u32 v6, v4, 3, v6
    v_lshlrev_b32 v6, 4, v6
    v_mul_u32_u24 v7, 2560, v2
    v_add_u32 v14, v6, v7
    v_add_u32 v14, 0x5800000, v14
    s_cmp_ge_u32 s13, 20
    s_cselect_b32 s19, 20, 0
    s_sub_u32 s19, s13, s19
    s_lshl_b32 s19, s19, 7
    s_add_u32 s19, s19, 0x580007c
    v_add_u32 v15, s19, v7
    s_mul_i32 s17, s14, 6144
    s_add_u32 s17, s17, 0x5900000
    v_lshlrev_b32 v7, 9, v2
    v_add_u32 v16, v6, v7
    v_add_u32 v16, s17, v16
    v_and_b32 v8, 31, v1
    v_lshlrev_b32 v8, 3, v8
    v_add_u32 v17, v7, v8
    v_add_u32 v17, s17, v17
    v_add_u32 v17, 4096, v17
    s_lshl_b32 s18, s15, 9
    s_add_u32 s18, s18, s17
    v_lshlrev_b32 v18, 11, v2
    v_lshl_add_u32 v18, v1, 3, v18
    v_add_u32 v18, s18, v18
    s_mul_i32 s18, s14, 20480
    s_mul_i32 s19, s15, 5120
    s_add_u32 s18, s18, s19
    s_add_u32 s18, s18, 0x6500000
    v_lshlrev_b32 v19, 9, v2
    v_lshl_add_u32 v19, v4, 7, v19
    v_lshl_add_u32 v19, v3, 4, v19
    v_add_u32 v19, s18, v19
    s_mov_b32 s18, s2
    s_cmp_lt_u32 s18, 80
    s_cselect_b32 s20, 1, 0
    s_cmp_eq_u32 s16, 3
    s_cselect_b32 s20, s20, 0
    v_mul_u32_u24 v20, 20480, v4
    v_lshl_add_u32 v20, v3, 4, v20
    s_lshl_b32 s19, s18, 8
    s_add_u32 s19, s19, 0x6500000
    v_add_u32 v20, s19, v20
    v_and_b32 v7, 7, v3
    v_lshlrev_b32 v7, 4, v7
    v_lshrrev_b32 v8, 3, v3
    v_lshl_add_u32 v21, v8, 3, v7
    s_lshl_b32 s19, s18, 7
    s_add_u32 s19, s19, 0x5802800
    v_add_u32 v21, s19, v21
    v_mul_u32_u24 v22, 16640, v3
    v_lshl_add_u32 v22, v2, 6, v22
    v_lshl_add_u32 v22, v4, 4, v22
    s_lshl_b32 s19, s14, 8
    s_add_u32 s19, s19, 0x1502000
    v_add_u32 v22, s19, v22
    v_lshl_add_u32 v7, v2, 5, v3
    v_mul_u32_u24 v23, 4224, v7
    v_lshl_add_u32 v23, v4, 3, v23
    s_mul_i32 s19, s14, 540672
    s_add_u32 s19, s19, 0x3600000
    v_add_u32 v23, s19, v23
    v_lshlrev_b32 v24, 4, v1
    v_and_b32 v7, 1, v1
    v_bfe_u32 v8, v1, 1, 3
    v_bfe_u32 v9, v1, 4, 1
    v_lshl_add_u32 v9, v9, 1, v7
    v_lshl_add_u32 v9, v9, 4, v8
    v_cmp_eq_u32 vcc, 2, v2
    s_nop 1
    v_and_b32 v10, 31, v1
    v_cndmask_b32 v9, v9, v10, vcc
    v_lshlrev_b32 v9, 4, v9
    v_lshrrev_b32 v10, 5, v1
    v_lshl_add_u32 v10, v2, 1, v10
    v_lshl_add_u32 v25, v10, 10, v9
    v_add_u32 v26, 24576, v24
    v_add_u32 v27, 36864, v24
    v_mul_u32_u24 v7, 6144, v2
    v_add_u32 v228, v24, v7
    v_mul_u32_u24 v7, 3072, v2
    v_add_u32 v229, v24, v7
    v_add_u32 v229, 24576, v229
    v_mul_u32_u24 v7, 1024, v2
    v_add_u32 v230, v24, v7
    v_add_u32 v230, 36864, v230
    s_lshl_b32 s19, s14, 7
    s_lshl_b32 s21, s15, 5
    s_add_u32 s19, s19, s21
    v_add_u32 v7, s19, v3
    v_mul_u32_u24 v7, 1280, v7
    v_mul_u32_u24 v8, 320, v2
    v_add_u32 v7, v7, v8
    v_lshl_add_u32 v7, v4, 4, v7
    s_mov_b32 s19, 0x0
    buffer_load_dwordx4 a[0:3], v7, s[8:11], s19 offen offset:0
    buffer_load_dwordx4 a[4:7], v7, s[8:11], s19 offen offset:64
    buffer_load_dwordx4 a[8:11], v7, s[8:11], s19 offen offset:128
    buffer_load_dwordx4 a[12:15], v7, s[8:11], s19 offen offset:192
    buffer_load_dwordx4 a[16:19], v7, s[8:11], s19 offen offset:256
    s_mov_b32 s19, 0x5000
    buffer_load_dwordx4 a[20:23], v7, s[8:11], s19 offen offset:0
    buffer_load_dwordx4 a[24:27], v7, s[8:11], s19 offen offset:64
    buffer_load_dwordx4 a[28:31], v7, s[8:11], s19 offen offset:128
    buffer_load_dwordx4 a[32:35], v7, s[8:11], s19 offen offset:192
    buffer_load_dwordx4 a[36:39], v7, s[8:11], s19 offen offset:256
    s_mov_b32 s19, 0x500000
    buffer_load_dwordx4 a[40:43], v7, s[8:11], s19 offen offset:0
    buffer_load_dwordx4 a[44:47], v7, s[8:11], s19 offen offset:64
    buffer_load_dwordx4 a[48:51], v7, s[8:11], s19 offen offset:128
    buffer_load_dwordx4 a[52:55], v7, s[8:11], s19 offen offset:192
    buffer_load_dwordx4 a[56:59], v7, s[8:11], s19 offen offset:256
    s_mov_b32 s19, 0x505000
    buffer_load_dwordx4 a[60:63], v7, s[8:11], s19 offen offset:0
    buffer_load_dwordx4 a[64:67], v7, s[8:11], s19 offen offset:64
    buffer_load_dwordx4 a[68:71], v7, s[8:11], s19 offen offset:128
    buffer_load_dwordx4 a[72:75], v7, s[8:11], s19 offen offset:192
    buffer_load_dwordx4 a[76:79], v7, s[8:11], s19 offen offset:256
    s_mov_b32 s19, 0xa00000
    buffer_load_dwordx4 a[80:83], v7, s[8:11], s19 offen offset:0
    buffer_load_dwordx4 a[84:87], v7, s[8:11], s19 offen offset:64
    buffer_load_dwordx4 a[88:91], v7, s[8:11], s19 offen offset:128
    buffer_load_dwordx4 a[92:95], v7, s[8:11], s19 offen offset:192
    buffer_load_dwordx4 a[96:99], v7, s[8:11], s19 offen offset:256
    s_mov_b32 s19, 0xa05000
    buffer_load_dwordx4 a[100:103], v7, s[8:11], s19 offen offset:0
    buffer_load_dwordx4 a[104:107], v7, s[8:11], s19 offen offset:64
    buffer_load_dwordx4 a[108:111], v7, s[8:11], s19 offen offset:128
    buffer_load_dwordx4 a[112:115], v7, s[8:11], s19 offen offset:192
    buffer_load_dwordx4 a[116:119], v7, s[8:11], s19 offen offset:256
    s_mul_i32 s19, s15, 160
    s_lshl_b32 s21, s14, 8
    s_add_u32 s21, s21, 0xf00000
    v_add_u32 v8, 0, v2
    v_min_u32 v8, 9, v8
    v_lshl_add_u32 v7, v8, 4, v3
    v_add_u32 v7, s19, v7
    v_mul_u32_u24 v7, 8320, v7
    v_lshl_add_u32 v7, v4, 3, v7
    buffer_load_dwordx2 a[120:121], v7, s[8:11], s21 offen offset:0
    buffer_load_dwordx2 a[122:123], v7, s[8:11], s21 offen offset:32
    buffer_load_dwordx2 a[124:125], v7, s[8:11], s21 offen offset:64
    buffer_load_dwordx2 a[126:127], v7, s[8:11], s21 offen offset:96
    buffer_load_dwordx2 a[128:129], v7, s[8:11], s21 offen offset:128
    buffer_load_dwordx2 a[130:131], v7, s[8:11], s21 offen offset:160
    buffer_load_dwordx2 a[132:133], v7, s[8:11], s21 offen offset:192
    buffer_load_dwordx2 a[134:135], v7, s[8:11], s21 offen offset:224
    v_add_u32 v8, 4, v2
    v_min_u32 v8, 9, v8
    v_lshl_add_u32 v7, v8, 4, v3
    v_add_u32 v7, s19, v7
    v_mul_u32_u24 v7, 8320, v7
    v_lshl_add_u32 v7, v4, 3, v7
    buffer_load_dwordx2 a[136:137], v7, s[8:11], s21 offen offset:0
    buffer_load_dwordx2 a[138:139], v7, s[8:11], s21 offen offset:32
    buffer_load_dwordx2 a[140:141], v7, s[8:11], s21 offen offset:64
    buffer_load_dwordx2 a[142:143], v7, s[8:11], s21 offen offset:96
    buffer_load_dwordx2 a[144:145], v7, s[8:11], s21 offen offset:128
    buffer_load_dwordx2 a[146:147], v7, s[8:11], s21 offen offset:160
    buffer_load_dwordx2 a[148:149], v7, s[8:11], s21 offen offset:192
    buffer_load_dwordx2 a[150:151], v7, s[8:11], s21 offen offset:224
    v_add_u32 v8, 8, v2
    v_min_u32 v8, 9, v8
    v_lshl_add_u32 v7, v8, 4, v3
    v_add_u32 v7, s19, v7
    v_mul_u32_u24 v7, 8320, v7
    v_lshl_add_u32 v7, v4, 3, v7
    buffer_load_dwordx2 a[152:153], v7, s[8:11], s21 offen offset:0
    buffer_load_dwordx2 a[154:155], v7, s[8:11], s21 offen offset:32
    buffer_load_dwordx2 a[156:157], v7, s[8:11], s21 offen offset:64
    buffer_load_dwordx2 a[158:159], v7, s[8:11], s21 offen offset:96
    buffer_load_dwordx2 a[160:161], v7, s[8:11], s21 offen offset:128
    buffer_load_dwordx2 a[162:163], v7, s[8:11], s21 offen offset:160
    buffer_load_dwordx2 a[164:165], v7, s[8:11], s21 offen offset:192
    buffer_load_dwordx2 a[166:167], v7, s[8:11], s21 offen offset:224
    v_mov_b32 v36, 0
    v_mov_b32 v37, 0
    v_mov_b32 v38, 0
    v_mov_b32 v39, 0
    v_mov_b32 v40, 0
    v_mov_b32 v41, 0
    v_mov_b32 v42, 0
    v_mov_b32 v43, 0
    v_mov_b32 v44, 0
    v_mov_b32 v45, 0
    v_mov_b32 v46, 0
    v_mov_b32 v47, 0
    v_mov_b32 v48, 0
    v_mov_b32 v49, 0
    v_mov_b32 v50, 0
    v_mov_b32 v51, 0
    v_mov_b32 v52, 0
    v_mov_b32 v53, 0
    v_mov_b32 v54, 0
    v_mov_b32 v55, 0
    v_mov_b32 v56, 0
    v_mov_b32 v60, 0
    v_mov_b32 v64, 0
    v_mov_b32 v57, 0
    v_mov_b32 v61, 0
    v_mov_b32 v65, 0
    v_mov_b32 v58, 0
    v_mov_b32 v62, 0
    v_mov_b32 v66, 0
    v_mov_b32 v59, 0
    v_mov_b32 v63, 0
    v_mov_b32 v67, 0
    s_mov_b32 s24, 0
    s_mov_b32 s25, 0
    s_mov_b32 s26, 0
    s_mov_b32 s27, 0
    s_mov_b32 s28, 0
    s_mov_b32 s29, 0
    s_mov_b32 s32, 0x00ff00ff
    s_mov_b32 s33, 0x00ff00ff
    s_mov_b32 s34, -1
    s_mov_b32 s35, 0
    s_mov_b32 s36, 0xffff
    s_mov_b32 s37, 0
    s_mov_b32 s38, 0x3db504f3
    s_mov_b32 s39, 0x3fb8aa3b
    v_mov_b32 v28, s38
    v_mov_b32 v29, s38
    s_mov_b32 s40, 266240
    s_mov_b32 s41, 67584
    v_mov_b32 v34, 0
    s_mov_b32 s48, 0x9f00900
    s_mov_b32 s30, 0
    v_mov_b32 v7, 0
    s_mov_b64 exec, 1
Lwc_4:
    buffer_load_dword v6, v7, s[8:11], s48 offen sc1
    s_waitcnt vmcnt(0)
    v_cmp_le_u32 vcc, 128, v6
    s_cbranch_vccnz Lwo_5x
    s_sleep 4
    s_add_u32 s30, s30, 1
    s_cmp_lt_u32 s30, 400000
    s_cbranch_scc1 Lwc_4
Lwo_5x:
    s_mov_b64 exec, -1
Lwo_5:
    buffer_load_dwordx4 v[68:71], v22, s[8:11], s28 offen sc1
    s_add_u32 s42, s28, s40
    buffer_load_dwordx4 v[72:75], v22, s[8:11], s42 offen sc1
    buffer_load_dwordx2 v[76:77], v23, s[8:11], s29 offen sc1
    buffer_load_dwordx2 v[78:79], v23, s[8:11], s29 offen offset:32 sc1
    s_add_u32 s42, s29, s41
    buffer_load_dwordx2 v[80:81], v23, s[8:11], s42 offen sc1
    buffer_load_dwordx2 v[82:83], v23, s[8:11], s42 offen offset:32 sc1
    s_waitcnt vmcnt(0)
Lr_step:
    s_add_u32 s48, s24, 1
    s_lshr_b32 s48, s48, 2
    s_min_u32 s48, s48, 15
    s_lshl_b32 s48, s48, 7
    s_add_u32 s48, s48, 0x9f03000
    buffer_load_dword v33, v34, s[8:11], s48 offen sc1
    s_mov_b32 s30, 0
    s_cmp_eq_u32 s20, 0
    s_cbranch_scc1 Lr_sl1
    s_sleep 15
    s_branch Lr_sl2
Lr_sl1:
    s_sleep 40
Lr_sl2:
    s_mov_b64 exec, 1
Lr_p1:
    buffer_load_dword v6, v15, s[8:11], s25 offen sc1
    s_waitcnt vmcnt(0)
    v_cmp_eq_u32 vcc, -1, v6
    s_cbranch_vccz Lr_p1o
    s_add_u32 s30, s30, 1
    s_cmp_lt_u32 s30, 2000000
    s_cbranch_scc1 Lr_p1
Lr_p1o:
    s_mov_b64 exec, s[32:33]
Lr_b1:
    buffer_load_dwordx4 v[36:39], v14, s[8:11], s25 offen offset:0 sc1
    buffer_load_dwordx4 v[40:43], v14, s[8:11], s25 offen offset:512 sc1
    buffer_load_dwordx4 v[44:47], v14, s[8:11], s25 offen offset:1024 sc1
    buffer_load_dwordx4 v[48:51], v14, s[8:11], s25 offen offset:1536 sc1
    buffer_load_dwordx4 v[52:55], v14, s[8:11], s25 offen offset:2048 sc1
    s_waitcnt vmcnt(0)
    v_max3_u32 v6, v36, v37, v38
    v_max3_u32 v6, v6, v39, v40
    v_max3_u32 v6, v6, v41, v42
    v_max3_u32 v6, v6, v43, v44
    v_max3_u32 v6, v6, v45, v46
    v_max3_u32 v6, v6, v47, v48
    v_max3_u32 v6, v6, v49, v50
    v_max3_u32 v6, v6, v51, v52
    v_max3_u32 v6, v6, v53, v54
    v_max_u32 v6, v6, v55
    v_cmp_eq_u32 vcc, -1, v6
    s_cbranch_vccz Lr_b1o
    s_add_u32 s30, s30, 1
    s_cmp_lt_u32 s30, 2000000
    s_cbranch_scc1 Lr_b1
Lr_b1o:
    s_mov_b64 exec, -1
    v_mfma_f32_16x16x32_bf16 v[96:99], a[0:3], v[36:39], 0
    v_mfma_f32_16x16x32_bf16 v[100:103], a[20:23], v[36:39], 0
    v_mfma_f32_16x16x32_bf16 v[104:107], a[40:43], v[36:39], 0
    v_mfma_f32_16x16x32_bf16 v[108:111], a[60:63], v[36:39], 0
    v_mfma_f32_16x16x32_bf16 v[112:115], v[36:39], a[80:83], 0
    v_mfma_f32_16x16x32_bf16 v[116:119], v[36:39], a[100:103], 0
    v_mfma_f32_16x16x32_bf16 v[96:99], a[4:7], v[40:43], v[96:99]
    v_mfma_f32_16x16x32_bf16 v[100:103], a[24:27], v[40:43], v[100:103]
    v_mfma_f32_16x16x32_bf16 v[104:107], a[44:47], v[40:43], v[104:107]
    v_mfma_f32_16x16x32_bf16 v[108:111], a[64:67], v[40:43], v[108:111]
    v_mfma_f32_16x16x32_bf16 v[112:115], v[40:43], a[84:87], v[112:115]
    v_mfma_f32_16x16x32_bf16 v[116:119], v[40:43], a[104:107], v[116:119]
    v_mfma_f32_16x16x32_bf16 v[96:99], a[8:11], v[44:47], v[96:99]
    v_mfma_f32_16x16x32_bf16 v[100:103], a[28:31], v[44:47], v[100:103]
    v_mfma_f32_16x16x32_bf16 v[104:107], a[48:51], v[44:47], v[104:107]
    v_mfma_f32_16x16x32_bf16 v[108:111], a[68:71], v[44:47], v[108:111]
    v_mfma_f32_16x16x32_bf16 v[112:115], v[44:47], a[88:91], v[112:115]
    v_mfma_f32_16x16x32_bf16 v[116:119], v[44:47], a[108:111], v[116:119]
    v_mfma_f32_16x16x32_bf16 v[96:99], a[12:15], v[48:51], v[96:99]
    v_mfma_f32_16x16x32_bf16 v[100:103], a[32:35], v[48:51], v[100:103]
    v_mfma_f32_16x16x32_bf16 v[104:107], a[52:55], v[48:51], v[104:107]
    v_mfma_f32_16x16x32_bf16 v[108:111], a[72:75], v[48:51], v[108:111]
    v_mfma_f32_16x16x32_bf16 v[112:115], v[48:51], a[92:95], v[112:115]
    v_mfma_f32_16x16x32_bf16 v[116:119], v[48:51], a[112:115], v[116:119]
    v_mfma_f32_16x16x32_bf16 v[96:99], a[16:19], v[52:55], v[96:99]
    v_mfma_f32_16x16x32_bf16 v[100:103], a[36:39], v[52:55], v[100:103]
    v_mfma_f32_16x16x32_bf16 v[104:107], a[56:59], v[52:55], v[104:107]
    v_mfma_f32_16x16x32_bf16 v[108:111], a[76:79], v[52:55], v[108:111]
    v_mfma_f32_16x16x32_bf16 v[112:115], v[52:55], a[96:99], v[112:115]
    v_mfma_f32_16x16x32_bf16 v[116:119], v[52:55], a[116:119], v[116:119]
    s_nop 7
    ds_write_b128 v228, v[96:99] offset:0
    ds_write_b128 v228, v[100:103] offset:1024
    ds_write_b128 v228, v[104:107] offset:2048
    ds_write_b128 v228, v[108:111] offset:3072
    ds_write_b128 v228, v[112:115] offset:4096
    ds_write_b128 v228, v[116:119] offset:5120
    s_waitcnt lgkmcnt(0)
    s_barrier
    s_cmp_eq_u32 s16, 3
    s_cbranch_scc1 Lr_s1done
    ds_read_b128 v[120:123], v25 offset:0
    ds_read_b128 v[124:127], v25 offset:6144
    ds_read_b128 v[128:131], v25 offset:12288
    ds_read_b128 v[132:135], v25 offset:18432
    s_waitcnt lgkmcnt(0)
    v_add_f32 v120, v120, v124
    v_add_f32 v128, v128, v132
    v_add_f32 v121, v121, v125
    v_add_f32 v129, v129, v133
    v_add_f32 v122, v122, v126
    v_add_f32 v130, v130, v134
    v_add_f32 v123, v123, v127
    v_add_f32 v131, v131, v135
    v_add_f32 v120, v120, v128
    v_add_f32 v121, v121, v129
    v_add_f32 v122, v122, v130
    v_add_f32 v123, v123, v131
    v_cvt_pk_bf16_f32 v6, v120, v121
    v_cvt_pk_bf16_f32 v7, v122, v123
    v_min_u32 v6, v32, v6
    v_min_u32 v7, v32, v7
    buffer_store_dwordx2 v[6:7], v18, s[8:11], s26 offen sc1
Lr_s1done:
    s_mov_b32 s30, 0
    s_sleep 13
Lr_b2:
    s_mov_b64 exec, s[32:33]
    buffer_load_dwordx4 v[56:59], v16, s[8:11], s26 offen sc1
    buffer_load_dwordx4 v[60:63], v16, s[8:11], s26 offen offset:2048 sc1
    s_mov_b64 exec, s[34:35]
    buffer_load_dwordx2 v[64:65], v17, s[8:11], s26 offen sc1
    buffer_load_dwordx2 v[66:67], v17, s[8:11], s26 offen offset:256 sc1
    s_mov_b64 exec, -1
    s_waitcnt vmcnt(0)
    v_max3_u32 v6, v56, v57, v58
    v_max3_u32 v6, v6, v59, v60
    v_max3_u32 v6, v6, v61, v62
    v_max3_u32 v6, v6, v63, v64
    v_max3_u32 v6, v6, v65, v66
    v_max_u32 v6, v6, v67
    v_cmp_eq_u32 vcc, -1, v6
    s_cbranch_vccz Lr_b2o
    s_add_u32 s30, s30, 1
    s_cmp_lt_u32 s30, 2000000
    s_cbranch_scc1 Lr_b2
Lr_b2o:
    v_mfma_f32_16x16x32_bf16 v[84:87], v[60:63], v[56:59], 0
    v_mfma_f32_16x16x32_bf16 v[88:91], v[68:71], v[56:59], 0
    v_mfma_f32_16x16x32_bf16 v[92:95], v[72:75], v[56:59], 0
    s_nop 7
    ds_write_b128 v229, v[84:87] offset:0
    ds_write_b128 v229, v[88:91] offset:1024
    ds_write_b128 v229, v[92:95] offset:2048
    s_waitcnt lgkmcnt(0)
    s_barrier
    ds_read_b128 v[120:123], v26 offset:0
    ds_read_b128 v[124:127], v26 offset:1024
    ds_read_b128 v[128:131], v26 offset:2048
    ds_read_b128 v[132:135], v26 offset:3072
    ds_read_b128 v[136:139], v26 offset:4096
    ds_read_b128 v[140:143], v26 offset:5120
    ds_read_b128 v[144:147], v26 offset:6144
    ds_read_b128 v[148:151], v26 offset:7168
    ds_read_b128 v[152:155], v26 offset:8192
    ds_read_b128 v[156:159], v26 offset:9216
    ds_read_b128 v[160:163], v26 offset:10240
    ds_read_b128 v[164:167], v26 offset:11264
    s_waitcnt lgkmcnt(0)
    v_pk_add_f32 v[120:121], v[120:121], v[132:133]
    v_pk_add_f32 v[144:145], v[144:145], v[156:157]
    v_pk_add_f32 v[122:123], v[122:123], v[134:135]
    v_pk_add_f32 v[146:147], v[146:147], v[158:159]
    v_pk_add_f32 v[124:125], v[124:125], v[136:137]
    v_pk_add_f32 v[148:149], v[148:149], v[160:161]
    v_pk_add_f32 v[126:127], v[126:127], v[138:139]
    v_pk_add_f32 v[150:151], v[150:151], v[162:163]
    v_pk_add_f32 v[128:129], v[128:129], v[140:141]
    v_pk_add_f32 v[152:153], v[152:153], v[164:165]
    v_pk_add_f32 v[130:131], v[130:131], v[142:143]
    v_pk_add_f32 v[154:155], v[154:155], v[166:167]
    v_pk_add_f32 v[84:85], v[120:121], v[144:145]
    v_pk_add_f32 v[86:87], v[122:123], v[146:147]
    v_pk_add_f32 v[88:89], v[124:125], v[148:149]
    v_pk_add_f32 v[90:91], v[126:127], v[150:151]
    v_pk_add_f32 v[92:93], v[128:129], v[152:153]
    v_pk_add_f32 v[94:95], v[130:131], v[154:155]
    v_cvt_pk_bf16_f32 v120, v84, v85
    v_cvt_pk_bf16_f32 v121, v86, v87
    v_cvt_pk_bf16_f32 v122, v88, v89
    v_cvt_pk_bf16_f32 v123, v90, v91
    v_cvt_pk_bf16_f32 v124, v92, v93
    v_cvt_pk_bf16_f32 v125, v94, v95
    v_lshlrev_b32 v84, 16, v120
    v_and_b32 v85, 0xffff0000, v120
    v_lshlrev_b32 v86, 16, v121
    v_and_b32 v87, 0xffff0000, v121
    v_lshlrev_b32 v88, 16, v122
    v_and_b32 v89, 0xffff0000, v122
    v_lshlrev_b32 v90, 16, v123
    v_and_b32 v91, 0xffff0000, v123
    v_lshlrev_b32 v92, 16, v124
    v_and_b32 v93, 0xffff0000, v124
    v_lshlrev_b32 v94, 16, v125
    v_and_b32 v95, 0xffff0000, v125
    v_pk_mul_f32 v[84:85], v[84:85], v[28:29]
    v_pk_mul_f32 v[86:87], v[86:87], v[28:29]
    v_pk_mul_f32 v[88:89], v[88:89], v[28:29]
    v_pk_mul_f32 v[90:91], v[90:91], v[28:29]
    v_pk_mul_f32 v[92:93], v[92:93], v[28:29]
    v_pk_mul_f32 v[94:95], v[94:95], v[28:29]
    v_cvt_pk_bf16_f32 v120, v84, v85
    v_cvt_pk_bf16_f32 v121, v86, v87
    v_cvt_pk_bf16_f32 v122, v88, v89
    v_cvt_pk_bf16_f32 v123, v90, v91
    v_cvt_pk_bf16_f32 v124, v92, v93
    v_cvt_pk_bf16_f32 v125, v94, v95
    v_lshlrev_b32 v84, 16, v120
    v_and_b32 v85, 0xffff0000, v120
    v_lshlrev_b32 v86, 16, v121
    v_and_b32 v87, 0xffff0000, v121
    v_lshlrev_b32 v88, 16, v122
    v_and_b32 v89, 0xffff0000, v122
    v_lshlrev_b32 v90, 16, v123
    v_and_b32 v91, 0xffff0000, v123
    v_lshlrev_b32 v92, 16, v124
    v_and_b32 v93, 0xffff0000, v124
    v_lshlrev_b32 v94, 16, v125
    v_and_b32 v95, 0xffff0000, v125
    s_mov_b32 exec_lo, 0
    v_mov_b32 v84, 0xff800000
    v_mov_b32 v85, 0xff800000
    v_mov_b32 v86, 0xff800000
    v_mov_b32 v87, 0xff800000
    s_mov_b64 exec, -1
    v_max3_f32 v6, v84, v85, v86
    v_max3_f32 v7, v87, v88, v89
    v_max3_f32 v8, v90, v91, v92
    v_max3_f32 v9, v93, v94, v95
    v_max_f32 v8, v8, v9
    v_max3_f32 v6, v6, v7, v8
    v_mov_b32 v7, v6
    s_nop 1
    v_permlane16_swap_b32 v6, v7
    s_nop 0
    v_max_f32 v6, v6, v7
    v_mov_b32 v7, v6
    s_nop 1
    v_permlane32_swap_b32 v6, v7
    s_nop 0
    v_max_f32 v6, v6, v7
    v_mul_f32 v6, s39, v6
    v_fma_f32 v84, v84, s39, -v6
    v_fma_f32 v85, v85, s39, -v6
    v_fma_f32 v86, v86, s39, -v6
    v_fma_f32 v87, v87, s39, -v6
    v_fma_f32 v88, v88, s39, -v6
    v_fma_f32 v89, v89, s39, -v6
    v_fma_f32 v90, v90, s39, -v6
    v_fma_f32 v91, v91, s39, -v6
    v_fma_f32 v92, v92, s39, -v6
    v_fma_f32 v93, v93, s39, -v6
    v_fma_f32 v94, v94, s39, -v6
    v_fma_f32 v95, v95, s39, -v6
    v_exp_f32 v84, v84
    v_exp_f32 v85, v85
    v_exp_f32 v86, v86
    v_exp_f32 v87, v87
    v_exp_f32 v88, v88
    v_exp_f32 v89, v89
    v_exp_f32 v90, v90
    v_exp_f32 v91, v91
    v_exp_f32 v92, v92
    v_exp_f32 v93, v93
    v_exp_f32 v94, v94
    v_exp_f32 v95, v95
    s_nop 0
    v_pk_add_f32 v[120:121], v[84:85], v[86:87]
    v_pk_add_f32 v[122:123], v[88:89], v[90:91]
    v_pk_add_f32 v[124:125], v[92:93], v[94:95]
    v_pk_add_f32 v[120:121], v[120:121], v[122:123]
    v_pk_add_f32 v[120:121], v[120:121], v[124:125]
    v_add_f32 v6, v120, v121
    v_mov_b32 v7, v6
    s_nop 1
    v_permlane16_swap_b32 v6, v7
    s_nop 0
    v_add_f32 v6, v6, v7
    v_mov_b32 v7, v6
    s_nop 1
    v_permlane32_swap_b32 v6, v7
    s_nop 0
    v_add_f32 v6, v6, v7
    v_rcp_f32 v6, v6
    s_nop 0
    v_mov_b32 v7, v6
    v_pk_mul_f32 v[84:85], v[84:85], v[6:7]
    v_pk_mul_f32 v[86:87], v[86:87], v[6:7]
    v_pk_mul_f32 v[88:89], v[88:89], v[6:7]
    v_pk_mul_f32 v[90:91], v[90:91], v[6:7]
    v_pk_mul_f32 v[92:93], v[92:93], v[6:7]
    v_pk_mul_f32 v[94:95], v[94:95], v[6:7]
    v_cvt_pk_bf16_f32 v172, v84, v85
    v_cvt_pk_bf16_f32 v173, v86, v87
    v_cvt_pk_bf16_f32 v168, v88, v89
    v_cvt_pk_bf16_f32 v169, v90, v91
    v_cvt_pk_bf16_f32 v170, v92, v93
    v_cvt_pk_bf16_f32 v171, v94, v95
    s_nop 1
    v_mfma_f32_16x16x32_bf16 v[176:179], v[76:79], v[168:171], 0
    v_mfma_f32_16x16x32_bf16 v[180:183], v[80:83], v[168:171], 0
    v_mfma_f32_16x16x16_bf16 v[176:179], v[64:65], v[172:173], v[176:179]
    v_mfma_f32_16x16x16_bf16 v[180:183], v[66:67], v[172:173], v[180:183]
    s_add_u32 s28, s28, 532480
    s_add_u32 s29, s29, 64
    s_nop 5
    s_nop 1
    v_cvt_pk_bf16_f32 v184, v176, v177
    v_cvt_pk_bf16_f32 v185, v178, v179
    v_cvt_pk_bf16_f32 v186, v180, v181
    v_cvt_pk_bf16_f32 v187, v182, v183
    ds_write_b128 v230, v[184:187]
    s_waitcnt lgkmcnt(0)
    s_barrier
    ds_read_b128 v[120:123], v27 offset:0
    ds_read_b128 v[124:127], v27 offset:1024
    ds_read_b128 v[128:131], v27 offset:2048
    ds_read_b128 v[132:135], v27 offset:3072
    s_waitcnt lgkmcnt(3)
    v_mfma_f32_16x16x32_bf16 v[188:191], a[120:123], v[120:123], 0
    v_mfma_f32_16x16x32_bf16 v[192:195], a[136:139], v[120:123], 0
    v_mfma_f32_16x16x32_bf16 v[196:199], a[152:155], v[120:123], 0
    s_waitcnt lgkmcnt(2)
    v_mfma_f32_16x16x32_bf16 v[188:191], a[124:127], v[124:127], v[188:191]
    v_mfma_f32_16x16x32_bf16 v[192:195], a[140:143], v[124:127], v[192:195]
    v_mfma_f32_16x16x32_bf16 v[196:199], a[156:159], v[124:127], v[196:199]
    s_waitcnt lgkmcnt(1)
    v_mfma_f32_16x16x32_bf16 v[188:191], a[128:131], v[128:131], v[188:191]
    v_mfma_f32_16x16x32_bf16 v[192:195], a[144:147], v[128:131], v[192:195]
    v_mfma_f32_16x16x32_bf16 v[196:199], a[160:163], v[128:131], v[196:199]
    s_waitcnt lgkmcnt(0)
    v_mfma_f32_16x16x32_bf16 v[188:191], a[132:135], v[132:135], v[188:191]
    v_mfma_f32_16x16x32_bf16 v[192:195], a[148:151], v[132:135], v[192:195]
    v_mfma_f32_16x16x32_bf16 v[196:199], a[164:167], v[132:135], v[196:199]
    s_mov_b64 exec, s[32:33]
    s_nop 4
    v_min_u32 v188, v32, v188
    v_min_u32 v189, v32, v189
    v_min_u32 v190, v32, v190
    v_min_u32 v191, v32, v191
    v_min_u32 v192, v32, v192
    v_min_u32 v193, v32, v193
    v_min_u32 v194, v32, v194
    v_min_u32 v195, v32, v195
    buffer_store_dwordx4 v[188:191], v19, s[8:11], s27 offen sc1
    buffer_store_dwordx4 v[192:195], v19, s[8:11], s27 offen offset:2048 sc1
    s_cmp_ge_u32 s16, 2
    s_cbranch_scc1 Lr_s2a
    v_min_u32 v196, v32, v196
    v_min_u32 v197, v32, v197
    v_min_u32 v198, v32, v198
    v_min_u32 v199, v32, v199
    s_add_u32 s43, s27, 4096
    buffer_store_dwordx4 v[196:199], v19, s[8:11], s43 offen sc1
Lr_s2a:
    s_mov_b64 exec, -1
Lr_s2done:
    s_cmp_eq_u32 s20, 0
    s_cbranch_scc1 Lr_s3done
    s_mov_b32 s30, 0
    s_sleep 17
Lr_b3:
    s_mov_b32 s42, s27
    buffer_load_dwordx4 v[120:123], v20, s[8:11], s42 offen sc1
    s_add_u32 s42, s42, 81920
    buffer_load_dwordx4 v[124:127], v20, s[8:11], s42 offen sc1
    s_add_u32 s42, s42, 81920
    buffer_load_dwordx4 v[128:131], v20, s[8:11], s42 offen sc1
    s_add_u32 s42, s42, 81920
    buffer_load_dwordx4 v[132:135], v20, s[8:11], s42 offen sc1
    s_add_u32 s42, s42, 81920
    buffer_load_dwordx4 v[136:139], v20, s[8:11], s42 offen sc1
    s_add_u32 s42, s42, 81920
    buffer_load_dwordx4 v[140:143], v20, s[8:11], s42 offen sc1
    s_add_u32 s42, s42, 81920
    buffer_load_dwordx4 v[144:147], v20, s[8:11], s42 offen sc1
    s_add_u32 s42, s42, 81920
    buffer_load_dwordx4 v[148:151], v20, s[8:11], s42 offen sc1
    s_waitcnt vmcnt(0)
    v_max3_u32 v6, v120, v121, v122
    v_max3_u32 v6, v6, v123, v124
    v_max3_u32 v6, v6, v125, v126
    v_max3_u32 v6, v6, v127, v128
    v_max3_u32 v6, v6, v129, v130
    v_max3_u32 v6, v6, v131, v132
    v_max3_u32 v6, v6, v133, v134
    v_max3_u32 v6, v6, v135, v136
    v_max3_u32 v6, v6, v137, v138
    v_max3_u32 v6, v6, v139, v140
    v_max3_u32 v6, v6, v141, v142
    v_max3_u32 v6, v6, v143, v144
    v_max3_u32 v6, v6, v145, v146
    v_max3_u32 v6, v6, v147, v148
    v_max3_u32 v6, v6, v149, v150
    v_max_u32 v6, v6, v151
    v_cmp_eq_u32 vcc, -1, v6
    s_cbranch_vccz Lr_b3o
    s_add_u32 s30, s30, 1
    s_cmp_lt_u32 s30, 2000000
    s_cbranch_scc1 Lr_b3
Lr_b3o:
    v_add_f32 v120, v120, v124
    v_add_f32 v128, v128, v132
    v_add_f32 v136, v136, v140
    v_add_f32 v144, v144, v148
    v_add_f32 v120, v120, v128
    v_add_f32 v136, v136, v144
    v_add_f32 v120, v120, v136
    v_add_f32 v121, v121, v125
    v_add_f32 v129, v129, v133
    v_add_f32 v137, v137, v141
    v_add_f32 v145, v145, v149
    v_add_f32 v121, v121, v129
    v_add_f32 v137, v137, v145
    v_add_f32 v121, v121, v137
    v_add_f32 v122, v122, v126
    v_add_f32 v130, v130, v134
    v_add_f32 v138, v138, v142
    v_add_f32 v146, v146, v150
    v_add_f32 v122, v122, v130
    v_add_f32 v138, v138, v146
    v_add_f32 v122, v122, v138
    v_add_f32 v123, v123, v127
    v_add_f32 v131, v131, v135
    v_add_f32 v139, v139, v143
    v_add_f32 v147, v147, v151
    v_add_f32 v123, v123, v131
    v_add_f32 v139, v139, v147
    v_add_f32 v123, v123, v139
    v_mov_b32 v124, v120
    v_mov_b32 v125, v121
    v_mov_b32 v126, v122
    v_mov_b32 v127, v123
    s_nop 1
    v_permlane16_swap_b32 v120, v124
    v_permlane16_swap_b32 v121, v125
    v_permlane16_swap_b32 v122, v126
    v_permlane16_swap_b32 v123, v127
    s_nop 0
    v_add_f32 v120, v120, v124
    v_add_f32 v121, v121, v125
    v_add_f32 v122, v122, v126
    v_add_f32 v123, v123, v127
    v_mov_b32 v124, v120
    v_mov_b32 v125, v121
    v_mov_b32 v126, v122
    v_mov_b32 v127, v123
    s_nop 1
    v_permlane32_swap_b32 v120, v124
    v_permlane32_swap_b32 v121, v125
    v_permlane32_swap_b32 v122, v126
    v_permlane32_swap_b32 v123, v127
    s_nop 0
    v_add_f32 v120, v120, v124
    v_add_f32 v121, v121, v125
    v_add_f32 v122, v122, v126
    v_add_f32 v123, v123, v127
    v_cvt_pk_bf16_f32 v6, v120, v121
    v_cvt_pk_bf16_f32 v7, v122, v123
    v_min_u32 v6, v32, v6
    v_min_u32 v7, v32, v7
    s_mov_b64 exec, s[36:37]
    buffer_store_dwordx2 v[6:7], v21, s[8:11], s25 offen sc1
    s_mov_b64 exec, -1
    v_mov_b32 v120, -1
    v_mov_b32 v121, -1
    v_mov_b32 v122, -1
    v_mov_b32 v123, -1
    s_mov_b32 s42, s27
    buffer_store_dwordx4 v[120:123], v20, s[8:11], s42 offen sc1
    s_add_u32 s42, s42, 81920
    buffer_store_dwordx4 v[120:123], v20, s[8:11], s42 offen sc1
    s_add_u32 s42, s42, 81920
    buffer_store_dwordx4 v[120:123], v20, s[8:11], s42 offen sc1
    s_add_u32 s42, s42, 81920
    buffer_store_dwordx4 v[120:123], v20, s[8:11], s42 offen sc1
    s_add_u32 s42, s42, 81920
    buffer_store_dwordx4 v[120:123], v20, s[8:11], s42 offen sc1
    s_add_u32 s42, s42, 81920
    buffer_store_dwordx4 v[120:123], v20, s[8:11], s42 offen sc1
    s_add_u32 s42, s42, 81920
    buffer_store_dwordx4 v[120:123], v20, s[8:11], s42 offen sc1
    s_add_u32 s42, s42, 81920
    buffer_store_dwordx4 v[120:123], v20, s[8:11], s42 offen sc1
Lr_s3done:
    s_cmp_eq_u32 s24, 63
    s_cbranch_scc1 Lr_nopf
    s_cmp_eq_u32 s24, 0
    s_cbranch_scc1 Lr_kvok
    v_cmp_le_u32 vcc, 64, v33
    s_cbranch_vccnz Lr_kvok
    s_mov_b32 s30, 0
    v_mov_b32 v7, 0
    s_mov_b64 exec, 1
Lwc_6:
    buffer_load_dword v6, v7, s[8:11], s48 offen sc1
    s_waitcnt vmcnt(0)
    v_cmp_le_u32 vcc, 64, v6
    s_cbranch_vccnz Lwo_7x
    s_sleep 4
    s_add_u32 s30, s30, 1
    s_cmp_lt_u32 s30, 400000
    s_cbranch_scc1 Lwc_6
Lwo_7x:
    s_mov_b64 exec, -1
Lwo_7:
Lr_kvok:
    buffer_load_dwordx4 v[68:71], v22, s[8:11], s28 offen sc1
    s_add_u32 s42, s28, s40
    buffer_load_dwordx4 v[72:75], v22, s[8:11], s42 offen sc1
    buffer_load_dwordx2 v[76:77], v23, s[8:11], s29 offen sc1
    buffer_load_dwordx2 v[78:79], v23, s[8:11], s29 offen offset:32 sc1
    s_add_u32 s42, s29, s41
    buffer_load_dwordx2 v[80:81], v23, s[8:11], s42 offen sc1
    buffer_load_dwordx2 v[82:83], v23, s[8:11], s42 offen offset:32 sc1
Lr_nopf:
    s_add_u32 s25, s25, 10240
    s_add_u32 s26, s26, 196608
    s_add_u32 s24, s24, 1
    s_and_b32 s27, s24, 3
    s_mul_i32 s27, s27, 655360
    s_cmp_lt_u32 s24, 64
    s_cbranch_scc1 Lr_step
Lr_end:
    s_endpgm
Lbg_entry:
    s_sub_u32 s2, s2, 128
    s_cmp_lt_u32 s2, 128
    s_cbranch_scc0 Lbg_k1
    s_add_u32 s16, s2, 64
    s_mov_b32 s17, 0
    s_mov_b32 s37, 0x9f00900
    s_branch Lg_entry64
Lbg_k1:
    s_sub_u32 s2, s2, 128
    s_cmp_lt_u32 s2, 128
    s_cbranch_scc1 Lbg_kv
    s_sub_u32 s2, s2, 128
    s_cmp_lt_u32 s2, 32
    s_cbranch_scc1 Lbg_kv2
    s_sub_u32 s2, s2, 32
    s_cmp_lt_u32 s2, 96
    s_cbranch_scc1 Lf1_entry
    s_sub_u32 s2, s2, 96
    s_cmp_lt_u32 s2, 81
    s_cbranch_scc1 Lf2_entry
    s_sub_u32 s2, s2, 49
    s_cmp_lt_u32 s2, 224
    s_cbranch_scc1 Lbg_kv2
    s_sub_u32 s2, s2, 224
    s_cmp_ge_u32 s2, 128
    s_cbranch_scc1 Lbg_ao
    s_lshr_b32 s17, s2, 4
    s_and_b32 s16, s2, 15
    s_lshl_b32 s37, s17, 8
    s_add_u32 s37, s37, 0x9f00000
    s_branch Lg_entry256
Lbg_kv2:
    s_lshr_b32 s17, s2, 5
    s_add_u32 s17, s17, 1
    s_and_b32 s16, s2, 31
    s_add_u32 s16, s16, 16
    s_lshl_b32 s37, s17, 8
    s_add_u32 s37, s37, 0x9f03000
    s_branch Lg_entry256
Lbg_kv:
    s_lshr_b32 s17, s2, 6
    s_and_b32 s16, s2, 63
    s_add_u32 s16, s16, 32
    s_lshl_b32 s37, s17, 7
    s_add_u32 s37, s37, 0x9f03000
    s_branch Lg_entry128
Lbg_ao:
    s_sub_u32 s2, s2, 128
    s_cmp_ge_u32 s2, 648
    s_cbranch_scc1 Lbg_t2
    s_mul_i32 s3, s2, 2731
    s_lshr_b32 s3, s3, 16
    s_mul_i32 s4, s3, 24
    s_sub_u32 s4, s2, s4
    s_cmp_lt_u32 s4, 16
    s_cbranch_scc0 Lbg_out
Lbg_att:
    s_lshl_b32 s2, s3, 4
    s_add_u32 s2, s2, s4
    s_branch Latt_entry
Lbg_out:
    s_mov_b32 s16, s3
    s_mov_b32 s29, s3
    s_sub_u32 s17, s4, 16
    s_branch Lout_entry
Lbg_t2:
    s_sub_u32 s2, s2, 648
    s_cmp_ge_u32 s2, 80
    s_cbranch_scc1 Lbg_t3
    s_lshr_b32 s3, s2, 4
    s_add_u32 s3, s3, 27
    s_and_b32 s4, s2, 15
    s_branch Lbg_att
Lbg_t3:
    s_sub_u32 s2, s2, 80
    s_cmp_ge_u32 s2, 40
    s_cbranch_scc1 Lbg_n27
    s_mov_b32 s29, 27
    s_and_b32 s16, s2, 1
    s_add_u32 s16, s16, 54
    s_lshr_b32 s17, s2, 1
    s_branch Lout_entry_d
Lbg_n27:
    s_sub_u32 s2, s2, 40
    s_cmp_ge_u32 s2, 40
    s_cbranch_scc1 Lbg_n28
    s_mov_b32 s29, 28
    s_and_b32 s16, s2, 1
    s_add_u32 s16, s16, 56
    s_lshr_b32 s17, s2, 1
    s_branch Lout_entry_d
Lbg_n28:
    s_sub_u32 s2, s2, 40
    s_cmp_ge_u32 s2, 40
    s_cbranch_scc1 Lbg_n29
    s_mov_b32 s29, 29
    s_and_b32 s16, s2, 1
    s_add_u32 s16, s16, 58
    s_lshr_b32 s17, s2, 1
    s_branch Lout_entry_d
Lbg_n29:
    s_sub_u32 s2, s2, 40
    s_cmp_ge_u32 s2, 40
    s_cbranch_scc1 Lbg_n30
    s_mov_b32 s29, 30
    s_and_b32 s16, s2, 1
    s_add_u32 s16, s16, 60
    s_lshr_b32 s17, s2, 1
    s_branch Lout_entry_d
Lbg_n30:
    s_sub_u32 s2, s2, 40
    s_cmp_ge_u32 s2, 160
    s_cbranch_scc1 Lbg_n31
    s_mov_b32 s29, 31
    s_and_b32 s16, s2, 3
    s_add_u32 s16, s16, 124
    s_lshr_b32 s17, s2, 2
    s_branch Lout_entry_m
Lbg_n31:
    s_sub_u32 s2, s2, 160
Lbg_end:
    s_endpgm
Lf2_entry:
    s_cmp_ge_u32 s2, 81
    s_cbranch_scc1 Lf2_end
    s_load_dwordx2 s[4:5], s[0:1], 104
    s_load_dwordx2 s[6:7], s[0:1], 8
    s_load_dwordx2 s[20:21], s[0:1], 16
    s_waitcnt lgkmcnt(0)
    s_mov_b32 s8, s4
    s_and_b32 s9, s5, 0xffff
    s_mov_b32 s10, 0x10000000
    s_mov_b32 s11, 0x00020000
    s_mov_b32 s12, s6
    s_and_b32 s13, s7, 0xffff
    s_mov_b32 s14, 0x141000
    s_mov_b32 s15, 0x00020000
    s_mov_b32 s16, s20
    s_and_b32 s17, s21, 0xffff
    s_mov_b32 s18, 0x141000
    s_mov_b32 s19, 0x00020000
    v_and_b32 v1, 15, v0
    v_bfe_u32 v2, v0, 4, 2
    v_lshlrev_b32 v4, 2, v2
    v_lshrrev_b32 v3, 6, v0
    s_lshl_b32 s22, s2, 2
    v_add_u32 v3, s22, v3
    s_nop 0
    v_readfirstlane_b32 s23, v3
    s_nop 2
    s_cmp_lt_u32 s23, 321
    s_cbranch_scc1 Lf2_go
    v_mov_b32 v160, 0
    v_mov_b32 v161, 0
    v_mov_b32 v162, 0
    v_mov_b32 v163, 0
    v_mov_b32 v164, 0
    v_mov_b32 v165, 0
    v_mov_b32 v166, 0
    v_mov_b32 v167, 0
    v_mov_b32 v168, 0
    v_mov_b32 v169, 0
    v_mov_b32 v170, 0
    v_mov_b32 v171, 0
    v_mov_b32 v172, 0
    v_mov_b32 v173, 0
    v_mov_b32 v174, 0
    v_mov_b32 v175, 0
    v_mov_b32 v176, 0
    v_mov_b32 v177, 0
    v_mov_b32 v178, 0
    v_mov_b32 v179, 0
    v_mov_b32 v180, 0
    v_mov_b32 v181, 0
    v_mov_b32 v182, 0
    v_mov_b32 v183, 0
    v_mov_b32 v184, 0
    v_mov_b32 v185, 0
    v_mov_b32 v186, 0
    v_mov_b32 v187, 0
    v_mov_b32 v188, 0
    v_mov_b32 v189, 0
    v_mov_b32 v190, 0
    v_mov_b32 v191, 0
    v_mov_b32 v192, 0
    v_mov_b32 v193, 0
    v_mov_b32 v194, 0
    v_mov_b32 v195, 0
    v_mov_b32 v196, 0
    v_mov_b32 v197, 0
    v_mov_b32 v198, 0
    v_mov_b32 v199, 0
    v_mov_b32 v200, 0
    v_mov_b32 v201, 0
    v_mov_b32 v202, 0
    v_mov_b32 v203, 0
    v_mov_b32 v204, 0
    v_mov_b32 v205, 0
    v_mov_b32 v206, 0
    v_mov_b32 v207, 0
    v_mov_b32 v208, 0
    v_mov_b32 v209, 0
    v_mov_b32 v210, 0
    v_mov_b32 v211, 0
    v_mov_b32 v212, 0
    v_mov_b32 v213, 0
    v_mov_b32 v214, 0
    v_mov_b32 v215, 0
    v_mov_b32 v216, 0
    v_mov_b32 v217, 0
    v_mov_b32 v218, 0
    v_mov_b32 v219, 0
    v_mov_b32 v220, 0
    v_mov_b32 v221, 0
    v_mov_b32 v222, 0
    v_mov_b32 v223, 0
    s_branch Lf2_st
Lf2_go:
    s_mov_b32 s26, 0x9f00880
    s_mov_b32 s27, 0
    v_mov_b32 v7, 0
    s_mov_b64 exec, 1
Lwc_8:
    buffer_load_dword v6, v7, s[8:11], s26 offen sc1
    s_waitcnt vmcnt(0)
    v_cmp_le_u32 vcc, 96, v6
    s_cbranch_vccnz Lwo_9x
    s_sleep 48
    s_add_u32 s27, s27, 1
    s_cmp_lt_u32 s27, 400000
    s_cbranch_scc1 Lwc_8
Lwo_9x:
    s_mov_b64 exec, -1
Lwo_9:
    v_lshlrev_b32 v6, 13, v3
    v_lshl_add_u32 v6, v2, 8, v6
    v_lshl_add_u32 v6, v1, 2, v6
    s_mov_b32 s24, 0x8f00000
    s_mov_b32 s25, 0x8f01000
    buffer_load_dword v32, v6, s[8:11], s24 offen offset:0 sc1
    buffer_load_dword v33, v6, s[8:11], s24 offen offset:1024 sc1
    buffer_load_dword v34, v6, s[8:11], s24 offen offset:2048 sc1
    buffer_load_dword v35, v6, s[8:11], s24 offen offset:3072 sc1
    buffer_load_dword v36, v6, s[8:11], s25 offen offset:0 sc1
    buffer_load_dword v37, v6, s[8:11], s25 offen offset:1024 sc1
    buffer_load_dword v38, v6, s[8:11], s25 offen offset:2048 sc1
    buffer_load_dword v39, v6, s[8:11], s25 offen offset:3072 sc1
    buffer_load_dword v40, v6, s[8:11], s24 offen offset:64 sc1
    buffer_load_dword v41, v6, s[8:11], s24 offen offset:1088 sc1
    buffer_load_dword v42, v6, s[8:11], s24 offen offset:2112 sc1
    buffer_load_dword v43, v6, s[8:11], s24 offen offset:3136 sc1
    buffer_load_dword v44, v6, s[8:11], s25 offen offset:64 sc1
    buffer_load_dword v45, v6, s[8:11], s25 offen offset:1088 sc1
    buffer_load_dword v46, v6, s[8:11], s25 offen offset:2112 sc1
    buffer_load_dword v47, v6, s[8:11], s25 offen offset:3136 sc1
    buffer_load_dword v48, v6, s[8:11], s24 offen offset:128 sc1
    buffer_load_dword v49, v6, s[8:11], s24 offen offset:1152 sc1
    buffer_load_dword v50, v6, s[8:11], s24 offen offset:2176 sc1
    buffer_load_dword v51, v6, s[8:11], s24 offen offset:3200 sc1
    buffer_load_dword v52, v6, s[8:11], s25 offen offset:128 sc1
    buffer_load_dword v53, v6, s[8:11], s25 offen offset:1152 sc1
    buffer_load_dword v54, v6, s[8:11], s25 offen offset:2176 sc1
    buffer_load_dword v55, v6, s[8:11], s25 offen offset:3200 sc1
    buffer_load_dword v56, v6, s[8:11], s24 offen offset:192 sc1
    buffer_load_dword v57, v6, s[8:11], s24 offen offset:1216 sc1
    buffer_load_dword v58, v6, s[8:11], s24 offen offset:2240 sc1
    buffer_load_dword v59, v6, s[8:11], s24 offen offset:3264 sc1
    buffer_load_dword v60, v6, s[8:11], s25 offen offset:192 sc1
    buffer_load_dword v61, v6, s[8:11], s25 offen offset:1216 sc1
    buffer_load_dword v62, v6, s[8:11], s25 offen offset:2240 sc1
    buffer_load_dword v63, v6, s[8:11], s25 offen offset:3264 sc1
    s_mov_b32 s24, 0x9200000
    s_mov_b32 s25, 0x9201000
    buffer_load_dword v64, v6, s[8:11], s24 offen offset:0 sc1
    buffer_load_dword v65, v6, s[8:11], s24 offen offset:1024 sc1
    buffer_load_dword v66, v6, s[8:11], s24 offen offset:2048 sc1
    buffer_load_dword v67, v6, s[8:11], s24 offen offset:3072 sc1
    buffer_load_dword v68, v6, s[8:11], s25 offen offset:0 sc1
    buffer_load_dword v69, v6, s[8:11], s25 offen offset:1024 sc1
    buffer_load_dword v70, v6, s[8:11], s25 offen offset:2048 sc1
    buffer_load_dword v71, v6, s[8:11], s25 offen offset:3072 sc1
    buffer_load_dword v72, v6, s[8:11], s24 offen offset:64 sc1
    buffer_load_dword v73, v6, s[8:11], s24 offen offset:1088 sc1
    buffer_load_dword v74, v6, s[8:11], s24 offen offset:2112 sc1
    buffer_load_dword v75, v6, s[8:11], s24 offen offset:3136 sc1
    buffer_load_dword v76, v6, s[8:11], s25 offen offset:64 sc1
    buffer_load_dword v77, v6, s[8:11], s25 offen offset:1088 sc1
    buffer_load_dword v78, v6, s[8:11], s25 offen offset:2112 sc1
    buffer_load_dword v79, v6, s[8:11], s25 offen offset:3136 sc1
    buffer_load_dword v80, v6, s[8:11], s24 offen offset:128 sc1
    buffer_load_dword v81, v6, s[8:11], s24 offen offset:1152 sc1
    buffer_load_dword v82, v6, s[8:11], s24 offen offset:2176 sc1
    buffer_load_dword v83, v6, s[8:11], s24 offen offset:3200 sc1
    buffer_load_dword v84, v6, s[8:11], s25 offen offset:128 sc1
    buffer_load_dword v85, v6, s[8:11], s25 offen offset:1152 sc1
    buffer_load_dword v86, v6, s[8:11], s25 offen offset:2176 sc1
    buffer_load_dword v87, v6, s[8:11], s25 offen offset:3200 sc1
    buffer_load_dword v88, v6, s[8:11], s24 offen offset:192 sc1
    buffer_load_dword v89, v6, s[8:11], s24 offen offset:1216 sc1
    buffer_load_dword v90, v6, s[8:11], s24 offen offset:2240 sc1
    buffer_load_dword v91, v6, s[8:11], s24 offen offset:3264 sc1
    buffer_load_dword v92, v6, s[8:11], s25 offen offset:192 sc1
    buffer_load_dword v93, v6, s[8:11], s25 offen offset:1216 sc1
    buffer_load_dword v94, v6, s[8:11], s25 offen offset:2240 sc1
    buffer_load_dword v95, v6, s[8:11], s25 offen offset:3264 sc1
    v_mov_b32 v96, 0
    v_mov_b32 v97, 0
    v_mov_b32 v98, 0
    v_mov_b32 v99, 0
    v_mov_b32 v100, 0
    v_mov_b32 v101, 0
    v_mov_b32 v102, 0
    v_mov_b32 v103, 0
    v_mov_b32 v104, 0
    v_mov_b32 v105, 0
    v_mov_b32 v106, 0
    v_mov_b32 v107, 0
    v_mov_b32 v108, 0
    v_mov_b32 v109, 0
    v_mov_b32 v110, 0
    v_mov_b32 v111, 0
    v_mov_b32 v112, 0
    v_mov_b32 v113, 0
    v_mov_b32 v114, 0
    v_mov_b32 v115, 0
    v_mov_b32 v116, 0
    v_mov_b32 v117, 0
    v_mov_b32 v118, 0
    v_mov_b32 v119, 0
    v_mov_b32 v120, 0
    v_mov_b32 v121, 0
    v_mov_b32 v122, 0
    v_mov_b32 v123, 0
    v_mov_b32 v124, 0
    v_mov_b32 v125, 0
    v_mov_b32 v126, 0
    v_mov_b32 v127, 0
    v_mov_b32 v128, 0
    v_mov_b32 v129, 0
    v_mov_b32 v130, 0
    v_mov_b32 v131, 0
    v_mov_b32 v132, 0
    v_mov_b32 v133, 0
    v_mov_b32 v134, 0
    v_mov_b32 v135, 0
    v_mov_b32 v136, 0
    v_mov_b32 v137, 0
    v_mov_b32 v138, 0
    v_mov_b32 v139, 0
    v_mov_b32 v140, 0
    v_mov_b32 v141, 0
    v_mov_b32 v142, 0
    v_mov_b32 v143, 0
    v_mov_b32 v144, 0
    v_mov_b32 v145, 0
    v_mov_b32 v146, 0
    v_mov_b32 v147, 0
    v_mov_b32 v148, 0
    v_mov_b32 v149, 0
    v_mov_b32 v150, 0
    v_mov_b32 v151, 0
    v_mov_b32 v152, 0
    v_mov_b32 v153, 0
    v_mov_b32 v154, 0
    v_mov_b32 v155, 0
    v_mov_b32 v156, 0
    v_mov_b32 v157, 0
    v_mov_b32 v158, 0
    v_mov_b32 v159, 0
    s_waitcnt vmcnt(0)
    v_add_u32 v14, 0, v2
    v_add_u32 v15, 0, v1
    v_mul_u32_u24 v14, v14, v15
    v_and_b32 v14, 31, v14
    v_cvt_f32_u32 v14, v14
    v_mul_f32 v14, 0.03125, v14
    v_cos_f32 v16, v14
    v_sin_f32 v15, v14
    s_nop 0
    v_sub_f32 v17, 0, v15
    v_mov_b32 v18, v15
    s_nop 0
    v_mfma_f32_16x16x4_f32 v[96:99], v32, v16, v[96:99]
    v_add_u32 v14, 4, v2
    v_add_u32 v15, 0, v1
    v_mfma_f32_16x16x4_f32 v[104:107], v40, v16, v[104:107]
    v_mul_u32_u24 v14, v14, v15
    v_and_b32 v14, 31, v14
    v_mfma_f32_16x16x4_f32 v[112:115], v48, v16, v[112:115]
    v_cvt_f32_u32 v14, v14
    v_mul_f32 v14, 0.03125, v14
    v_mfma_f32_16x16x4_f32 v[120:123], v56, v16, v[120:123]
    v_cos_f32 v19, v14
    v_sin_f32 v15, v14
    v_mfma_f32_16x16x4_f32 v[128:131], v32, v17, v[128:131]
    s_nop 0
    v_sub_f32 v20, 0, v15
    v_mfma_f32_16x16x4_f32 v[136:139], v40, v17, v[136:139]
    v_mov_b32 v21, v15
    v_mfma_f32_16x16x4_f32 v[144:147], v48, v17, v[144:147]
    v_mfma_f32_16x16x4_f32 v[152:155], v56, v17, v[152:155]
    v_mfma_f32_16x16x4_f32 v[96:99], v64, v18, v[96:99]
    v_mfma_f32_16x16x4_f32 v[104:107], v72, v18, v[104:107]
    v_mfma_f32_16x16x4_f32 v[112:115], v80, v18, v[112:115]
    v_mfma_f32_16x16x4_f32 v[120:123], v88, v18, v[120:123]
    v_mfma_f32_16x16x4_f32 v[128:131], v64, v16, v[128:131]
    v_mfma_f32_16x16x4_f32 v[136:139], v72, v16, v[136:139]
    v_mfma_f32_16x16x4_f32 v[144:147], v80, v16, v[144:147]
    v_mfma_f32_16x16x4_f32 v[152:155], v88, v16, v[152:155]
    s_nop 0
    v_mfma_f32_16x16x4_f32 v[96:99], v33, v19, v[96:99]
    v_add_u32 v14, 8, v2
    v_add_u32 v15, 0, v1
    v_mfma_f32_16x16x4_f32 v[104:107], v41, v19, v[104:107]
    v_mul_u32_u24 v14, v14, v15
    v_and_b32 v14, 31, v14
    v_mfma_f32_16x16x4_f32 v[112:115], v49, v19, v[112:115]
    v_cvt_f32_u32 v14, v14
    v_mul_f32 v14, 0.03125, v14
    v_mfma_f32_16x16x4_f32 v[120:123], v57, v19, v[120:123]
    v_cos_f32 v16, v14
    v_sin_f32 v15, v14
    v_mfma_f32_16x16x4_f32 v[128:131], v33, v20, v[128:131]
    s_nop 0
    v_sub_f32 v17, 0, v15
    v_mfma_f32_16x16x4_f32 v[136:139], v41, v20, v[136:139]
    v_mov_b32 v18, v15
    v_mfma_f32_16x16x4_f32 v[144:147], v49, v20, v[144:147]
    v_mfma_f32_16x16x4_f32 v[152:155], v57, v20, v[152:155]
    v_mfma_f32_16x16x4_f32 v[96:99], v65, v21, v[96:99]
    v_mfma_f32_16x16x4_f32 v[104:107], v73, v21, v[104:107]
    v_mfma_f32_16x16x4_f32 v[112:115], v81, v21, v[112:115]
    v_mfma_f32_16x16x4_f32 v[120:123], v89, v21, v[120:123]
    v_mfma_f32_16x16x4_f32 v[128:131], v65, v19, v[128:131]
    v_mfma_f32_16x16x4_f32 v[136:139], v73, v19, v[136:139]
    v_mfma_f32_16x16x4_f32 v[144:147], v81, v19, v[144:147]
    v_mfma_f32_16x16x4_f32 v[152:155], v89, v19, v[152:155]
    s_nop 0
    v_mfma_f32_16x16x4_f32 v[96:99], v34, v16, v[96:99]
    v_add_u32 v14, 12, v2
    v_add_u32 v15, 0, v1
    v_mfma_f32_16x16x4_f32 v[104:107], v42, v16, v[104:107]
    v_mul_u32_u24 v14, v14, v15
    v_and_b32 v14, 31, v14
    v_mfma_f32_16x16x4_f32 v[112:115], v50, v16, v[112:115]
    v_cvt_f32_u32 v14, v14
    v_mul_f32 v14, 0.03125, v14
    v_mfma_f32_16x16x4_f32 v[120:123], v58, v16, v[120:123]
    v_cos_f32 v19, v14
    v_sin_f32 v15, v14
    v_mfma_f32_16x16x4_f32 v[128:131], v34, v17, v[128:131]
    s_nop 0
    v_sub_f32 v20, 0, v15
    v_mfma_f32_16x16x4_f32 v[136:139], v42, v17, v[136:139]
    v_mov_b32 v21, v15
    v_mfma_f32_16x16x4_f32 v[144:147], v50, v17, v[144:147]
    v_mfma_f32_16x16x4_f32 v[152:155], v58, v17, v[152:155]
    v_mfma_f32_16x16x4_f32 v[96:99], v66, v18, v[96:99]
    v_mfma_f32_16x16x4_f32 v[104:107], v74, v18, v[104:107]
    v_mfma_f32_16x16x4_f32 v[112:115], v82, v18, v[112:115]
    v_mfma_f32_16x16x4_f32 v[120:123], v90, v18, v[120:123]
    v_mfma_f32_16x16x4_f32 v[128:131], v66, v16, v[128:131]
    v_mfma_f32_16x16x4_f32 v[136:139], v74, v16, v[136:139]
    v_mfma_f32_16x16x4_f32 v[144:147], v82, v16, v[144:147]
    v_mfma_f32_16x16x4_f32 v[152:155], v90, v16, v[152:155]
    s_nop 0
    v_mfma_f32_16x16x4_f32 v[96:99], v35, v19, v[96:99]
    v_add_u32 v14, 16, v2
    v_add_u32 v15, 0, v1
    v_mfma_f32_16x16x4_f32 v[104:107], v43, v19, v[104:107]
    v_mul_u32_u24 v14, v14, v15
    v_and_b32 v14, 31, v14
    v_mfma_f32_16x16x4_f32 v[112:115], v51, v19, v[112:115]
    v_cvt_f32_u32 v14, v14
    v_mul_f32 v14, 0.03125, v14
    v_mfma_f32_16x16x4_f32 v[120:123], v59, v19, v[120:123]
    v_cos_f32 v16, v14
    v_sin_f32 v15, v14
    v_mfma_f32_16x16x4_f32 v[128:131], v35, v20, v[128:131]
    s_nop 0
    v_sub_f32 v17, 0, v15
    v_mfma_f32_16x16x4_f32 v[136:139], v43, v20, v[136:139]
    v_mov_b32 v18, v15
    v_mfma_f32_16x16x4_f32 v[144:147], v51, v20, v[144:147]
    v_mfma_f32_16x16x4_f32 v[152:155], v59, v20, v[152:155]
    v_mfma_f32_16x16x4_f32 v[96:99], v67, v21, v[96:99]
    v_mfma_f32_16x16x4_f32 v[104:107], v75, v21, v[104:107]
    v_mfma_f32_16x16x4_f32 v[112:115], v83, v21, v[112:115]
    v_mfma_f32_16x16x4_f32 v[120:123], v91, v21, v[120:123]
    v_mfma_f32_16x16x4_f32 v[128:131], v67, v19, v[128:131]
    v_mfma_f32_16x16x4_f32 v[136:139], v75, v19, v[136:139]
    v_mfma_f32_16x16x4_f32 v[144:147], v83, v19, v[144:147]
    v_mfma_f32_16x16x4_f32 v[152:155], v91, v19, v[152:155]
    s_nop 0
    v_mfma_f32_16x16x4_f32 v[96:99], v36, v16, v[96:99]
    v_add_u32 v14, 20, v2
    v_add_u32 v15, 0, v1
    v_mfma_f32_16x16x4_f32 v[104:107], v44, v16, v[104:107]
    v_mul_u32_u24 v14, v14, v15
    v_and_b32 v14, 31, v14
    v_mfma_f32_16x16x4_f32 v[112:115], v52, v16, v[112:115]
    v_cvt_f32_u32 v14, v14
    v_mul_f32 v14, 0.03125, v14
    v_mfma_f32_16x16x4_f32 v[120:123], v60, v16, v[120:123]
    v_cos_f32 v19, v14
    v_sin_f32 v15, v14
    v_mfma_f32_16x16x4_f32 v[128:131], v36, v17, v[128:131]
    s_nop 0
    v_sub_f32 v20, 0, v15
    v_mfma_f32_16x16x4_f32 v[136:139], v44, v17, v[136:139]
    v_mov_b32 v21, v15
    v_mfma_f32_16x16x4_f32 v[144:147], v52, v17, v[144:147]
    v_mfma_f32_16x16x4_f32 v[152:155], v60, v17, v[152:155]
    v_mfma_f32_16x16x4_f32 v[96:99], v68, v18, v[96:99]
    v_mfma_f32_16x16x4_f32 v[104:107], v76, v18, v[104:107]
    v_mfma_f32_16x16x4_f32 v[112:115], v84, v18, v[112:115]
    v_mfma_f32_16x16x4_f32 v[120:123], v92, v18, v[120:123]
    v_mfma_f32_16x16x4_f32 v[128:131], v68, v16, v[128:131]
    v_mfma_f32_16x16x4_f32 v[136:139], v76, v16, v[136:139]
    v_mfma_f32_16x16x4_f32 v[144:147], v84, v16, v[144:147]
    v_mfma_f32_16x16x4_f32 v[152:155], v92, v16, v[152:155]
    s_nop 0
    v_mfma_f32_16x16x4_f32 v[96:99], v37, v19, v[96:99]
    v_add_u32 v14, 24, v2
    v_add_u32 v15, 0, v1
    v_mfma_f32_16x16x4_f32 v[104:107], v45, v19, v[104:107]
    v_mul_u32_u24 v14, v14, v15
    v_and_b32 v14, 31, v14
    v_mfma_f32_16x16x4_f32 v[112:115], v53, v19, v[112:115]
    v_cvt_f32_u32 v14, v14
    v_mul_f32 v14, 0.03125, v14
    v_mfma_f32_16x16x4_f32 v[120:123], v61, v19, v[120:123]
    v_cos_f32 v16, v14
    v_sin_f32 v15, v14
    v_mfma_f32_16x16x4_f32 v[128:131], v37, v20, v[128:131]
    s_nop 0
    v_sub_f32 v17, 0, v15
    v_mfma_f32_16x16x4_f32 v[136:139], v45, v20, v[136:139]
    v_mov_b32 v18, v15
    v_mfma_f32_16x16x4_f32 v[144:147], v53, v20, v[144:147]
    v_mfma_f32_16x16x4_f32 v[152:155], v61, v20, v[152:155]
    v_mfma_f32_16x16x4_f32 v[96:99], v69, v21, v[96:99]
    v_mfma_f32_16x16x4_f32 v[104:107], v77, v21, v[104:107]
    v_mfma_f32_16x16x4_f32 v[112:115], v85, v21, v[112:115]
    v_mfma_f32_16x16x4_f32 v[120:123], v93, v21, v[120:123]
    v_mfma_f32_16x16x4_f32 v[128:131], v69, v19, v[128:131]
    v_mfma_f32_16x16x4_f32 v[136:139], v77, v19, v[136:139]
    v_mfma_f32_16x16x4_f32 v[144:147], v85, v19, v[144:147]
    v_mfma_f32_16x16x4_f32 v[152:155], v93, v19, v[152:155]
    s_nop 0
    v_mfma_f32_16x16x4_f32 v[96:99], v38, v16, v[96:99]
    v_add_u32 v14, 28, v2
    v_add_u32 v15, 0, v1
    v_mfma_f32_16x16x4_f32 v[104:107], v46, v16, v[104:107]
    v_mul_u32_u24 v14, v14, v15
    v_and_b32 v14, 31, v14
    v_mfma_f32_16x16x4_f32 v[112:115], v54, v16, v[112:115]
    v_cvt_f32_u32 v14, v14
    v_mul_f32 v14, 0.03125, v14
    v_mfma_f32_16x16x4_f32 v[120:123], v62, v16, v[120:123]
    v_cos_f32 v19, v14
    v_sin_f32 v15, v14
    v_mfma_f32_16x16x4_f32 v[128:131], v38, v17, v[128:131]
    s_nop 0
    v_sub_f32 v20, 0, v15
    v_mfma_f32_16x16x4_f32 v[136:139], v46, v17, v[136:139]
    v_mov_b32 v21, v15
    v_mfma_f32_16x16x4_f32 v[144:147], v54, v17, v[144:147]
    v_mfma_f32_16x16x4_f32 v[152:155], v62, v17, v[152:155]
    v_mfma_f32_16x16x4_f32 v[96:99], v70, v18, v[96:99]
    v_mfma_f32_16x16x4_f32 v[104:107], v78, v18, v[104:107]
    v_mfma_f32_16x16x4_f32 v[112:115], v86, v18, v[112:115]
    v_mfma_f32_16x16x4_f32 v[120:123], v94, v18, v[120:123]
    v_mfma_f32_16x16x4_f32 v[128:131], v70, v16, v[128:131]
    v_mfma_f32_16x16x4_f32 v[136:139], v78, v16, v[136:139]
    v_mfma_f32_16x16x4_f32 v[144:147], v86, v16, v[144:147]
    v_mfma_f32_16x16x4_f32 v[152:155], v94, v16, v[152:155]
    s_nop 0
    v_mfma_f32_16x16x4_f32 v[96:99], v39, v19, v[96:99]
    v_add_u32 v14, 0, v2
    v_add_u32 v15, 16, v1
    v_mfma_f32_16x16x4_f32 v[104:107], v47, v19, v[104:107]
    v_mul_u32_u24 v14, v14, v15
    v_and_b32 v14, 31, v14
    v_mfma_f32_16x16x4_f32 v[112:115], v55, v19, v[112:115]
    v_cvt_f32_u32 v14, v14
    v_mul_f32 v14, 0.03125, v14
    v_mfma_f32_16x16x4_f32 v[120:123], v63, v19, v[120:123]
    v_cos_f32 v16, v14
    v_sin_f32 v15, v14
    v_mfma_f32_16x16x4_f32 v[128:131], v39, v20, v[128:131]
    s_nop 0
    v_sub_f32 v17, 0, v15
    v_mfma_f32_16x16x4_f32 v[136:139], v47, v20, v[136:139]
    v_mov_b32 v18, v15
    v_mfma_f32_16x16x4_f32 v[144:147], v55, v20, v[144:147]
    v_mfma_f32_16x16x4_f32 v[152:155], v63, v20, v[152:155]
    v_mfma_f32_16x16x4_f32 v[96:99], v71, v21, v[96:99]
    v_mfma_f32_16x16x4_f32 v[104:107], v79, v21, v[104:107]
    v_mfma_f32_16x16x4_f32 v[112:115], v87, v21, v[112:115]
    v_mfma_f32_16x16x4_f32 v[120:123], v95, v21, v[120:123]
    v_mfma_f32_16x16x4_f32 v[128:131], v71, v19, v[128:131]
    v_mfma_f32_16x16x4_f32 v[136:139], v79, v19, v[136:139]
    v_mfma_f32_16x16x4_f32 v[144:147], v87, v19, v[144:147]
    v_mfma_f32_16x16x4_f32 v[152:155], v95, v19, v[152:155]
    s_nop 0
    v_mfma_f32_16x16x4_f32 v[100:103], v32, v16, v[100:103]
    v_add_u32 v14, 4, v2
    v_add_u32 v15, 16, v1
    v_mfma_f32_16x16x4_f32 v[108:111], v40, v16, v[108:111]
    v_mul_u32_u24 v14, v14, v15
    v_and_b32 v14, 31, v14
    v_mfma_f32_16x16x4_f32 v[116:119], v48, v16, v[116:119]
    v_cvt_f32_u32 v14, v14
    v_mul_f32 v14, 0.03125, v14
    v_mfma_f32_16x16x4_f32 v[124:127], v56, v16, v[124:127]
    v_cos_f32 v19, v14
    v_sin_f32 v15, v14
    v_mfma_f32_16x16x4_f32 v[132:135], v32, v17, v[132:135]
    s_nop 0
    v_sub_f32 v20, 0, v15
    v_mfma_f32_16x16x4_f32 v[140:143], v40, v17, v[140:143]
    v_mov_b32 v21, v15
    v_mfma_f32_16x16x4_f32 v[148:151], v48, v17, v[148:151]
    v_mfma_f32_16x16x4_f32 v[156:159], v56, v17, v[156:159]
    v_mfma_f32_16x16x4_f32 v[100:103], v64, v18, v[100:103]
    v_mfma_f32_16x16x4_f32 v[108:111], v72, v18, v[108:111]
    v_mfma_f32_16x16x4_f32 v[116:119], v80, v18, v[116:119]
    v_mfma_f32_16x16x4_f32 v[124:127], v88, v18, v[124:127]
    v_mfma_f32_16x16x4_f32 v[132:135], v64, v16, v[132:135]
    v_mfma_f32_16x16x4_f32 v[140:143], v72, v16, v[140:143]
    v_mfma_f32_16x16x4_f32 v[148:151], v80, v16, v[148:151]
    v_mfma_f32_16x16x4_f32 v[156:159], v88, v16, v[156:159]
    s_nop 0
    v_mfma_f32_16x16x4_f32 v[100:103], v33, v19, v[100:103]
    v_add_u32 v14, 8, v2
    v_add_u32 v15, 16, v1
    v_mfma_f32_16x16x4_f32 v[108:111], v41, v19, v[108:111]
    v_mul_u32_u24 v14, v14, v15
    v_and_b32 v14, 31, v14
    v_mfma_f32_16x16x4_f32 v[116:119], v49, v19, v[116:119]
    v_cvt_f32_u32 v14, v14
    v_mul_f32 v14, 0.03125, v14
    v_mfma_f32_16x16x4_f32 v[124:127], v57, v19, v[124:127]
    v_cos_f32 v16, v14
    v_sin_f32 v15, v14
    v_mfma_f32_16x16x4_f32 v[132:135], v33, v20, v[132:135]
    s_nop 0
    v_sub_f32 v17, 0, v15
    v_mfma_f32_16x16x4_f32 v[140:143], v41, v20, v[140:143]
    v_mov_b32 v18, v15
    v_mfma_f32_16x16x4_f32 v[148:151], v49, v20, v[148:151]
    v_mfma_f32_16x16x4_f32 v[156:159], v57, v20, v[156:159]
    v_mfma_f32_16x16x4_f32 v[100:103], v65, v21, v[100:103]
    v_mfma_f32_16x16x4_f32 v[108:111], v73, v21, v[108:111]
    v_mfma_f32_16x16x4_f32 v[116:119], v81, v21, v[116:119]
    v_mfma_f32_16x16x4_f32 v[124:127], v89, v21, v[124:127]
    v_mfma_f32_16x16x4_f32 v[132:135], v65, v19, v[132:135]
    v_mfma_f32_16x16x4_f32 v[140:143], v73, v19, v[140:143]
    v_mfma_f32_16x16x4_f32 v[148:151], v81, v19, v[148:151]
    v_mfma_f32_16x16x4_f32 v[156:159], v89, v19, v[156:159]
    s_nop 0
    v_mfma_f32_16x16x4_f32 v[100:103], v34, v16, v[100:103]
    v_add_u32 v14, 12, v2
    v_add_u32 v15, 16, v1
    v_mfma_f32_16x16x4_f32 v[108:111], v42, v16, v[108:111]
    v_mul_u32_u24 v14, v14, v15
    v_and_b32 v14, 31, v14
    v_mfma_f32_16x16x4_f32 v[116:119], v50, v16, v[116:119]
    v_cvt_f32_u32 v14, v14
    v_mul_f32 v14, 0.03125, v14
    v_mfma_f32_16x16x4_f32 v[124:127], v58, v16, v[124:127]
    v_cos_f32 v19, v14
    v_sin_f32 v15, v14
    v_mfma_f32_16x16x4_f32 v[132:135], v34, v17, v[132:135]
    s_nop 0
    v_sub_f32 v20, 0, v15
    v_mfma_f32_16x16x4_f32 v[140:143], v42, v17, v[140:143]
    v_mov_b32 v21, v15
    v_mfma_f32_16x16x4_f32 v[148:151], v50, v17, v[148:151]
    v_mfma_f32_16x16x4_f32 v[156:159], v58, v17, v[156:159]
    v_mfma_f32_16x16x4_f32 v[100:103], v66, v18, v[100:103]
    v_mfma_f32_16x16x4_f32 v[108:111], v74, v18, v[108:111]
    v_mfma_f32_16x16x4_f32 v[116:119], v82, v18, v[116:119]
    v_mfma_f32_16x16x4_f32 v[124:127], v90, v18, v[124:127]
    v_mfma_f32_16x16x4_f32 v[132:135], v66, v16, v[132:135]
    v_mfma_f32_16x16x4_f32 v[140:143], v74, v16, v[140:143]
    v_mfma_f32_16x16x4_f32 v[148:151], v82, v16, v[148:151]
    v_mfma_f32_16x16x4_f32 v[156:159], v90, v16, v[156:159]
    s_nop 0
    v_mfma_f32_16x16x4_f32 v[100:103], v35, v19, v[100:103]
    v_add_u32 v14, 16, v2
    v_add_u32 v15, 16, v1
    v_mfma_f32_16x16x4_f32 v[108:111], v43, v19, v[108:111]
    v_mul_u32_u24 v14, v14, v15
    v_and_b32 v14, 31, v14
    v_mfma_f32_16x16x4_f32 v[116:119], v51, v19, v[116:119]
    v_cvt_f32_u32 v14, v14
    v_mul_f32 v14, 0.03125, v14
    v_mfma_f32_16x16x4_f32 v[124:127], v59, v19, v[124:127]
    v_cos_f32 v16, v14
    v_sin_f32 v15, v14
    v_mfma_f32_16x16x4_f32 v[132:135], v35, v20, v[132:135]
    s_nop 0
    v_sub_f32 v17, 0, v15
    v_mfma_f32_16x16x4_f32 v[140:143], v43, v20, v[140:143]
    v_mov_b32 v18, v15
    v_mfma_f32_16x16x4_f32 v[148:151], v51, v20, v[148:151]
    v_mfma_f32_16x16x4_f32 v[156:159], v59, v20, v[156:159]
    v_mfma_f32_16x16x4_f32 v[100:103], v67, v21, v[100:103]
    v_mfma_f32_16x16x4_f32 v[108:111], v75, v21, v[108:111]
    v_mfma_f32_16x16x4_f32 v[116:119], v83, v21, v[116:119]
    v_mfma_f32_16x16x4_f32 v[124:127], v91, v21, v[124:127]
    v_mfma_f32_16x16x4_f32 v[132:135], v67, v19, v[132:135]
    v_mfma_f32_16x16x4_f32 v[140:143], v75, v19, v[140:143]
    v_mfma_f32_16x16x4_f32 v[148:151], v83, v19, v[148:151]
    v_mfma_f32_16x16x4_f32 v[156:159], v91, v19, v[156:159]
    s_nop 0
    v_mfma_f32_16x16x4_f32 v[100:103], v36, v16, v[100:103]
    v_add_u32 v14, 20, v2
    v_add_u32 v15, 16, v1
    v_mfma_f32_16x16x4_f32 v[108:111], v44, v16, v[108:111]
    v_mul_u32_u24 v14, v14, v15
    v_and_b32 v14, 31, v14
    v_mfma_f32_16x16x4_f32 v[116:119], v52, v16, v[116:119]
    v_cvt_f32_u32 v14, v14
    v_mul_f32 v14, 0.03125, v14
    v_mfma_f32_16x16x4_f32 v[124:127], v60, v16, v[124:127]
    v_cos_f32 v19, v14
    v_sin_f32 v15, v14
    v_mfma_f32_16x16x4_f32 v[132:135], v36, v17, v[132:135]
    s_nop 0
    v_sub_f32 v20, 0, v15
    v_mfma_f32_16x16x4_f32 v[140:143], v44, v17, v[140:143]
    v_mov_b32 v21, v15
    v_mfma_f32_16x16x4_f32 v[148:151], v52, v17, v[148:151]
    v_mfma_f32_16x16x4_f32 v[156:159], v60, v17, v[156:159]
    v_mfma_f32_16x16x4_f32 v[100:103], v68, v18, v[100:103]
    v_mfma_f32_16x16x4_f32 v[108:111], v76, v18, v[108:111]
    v_mfma_f32_16x16x4_f32 v[116:119], v84, v18, v[116:119]
    v_mfma_f32_16x16x4_f32 v[124:127], v92, v18, v[124:127]
    v_mfma_f32_16x16x4_f32 v[132:135], v68, v16, v[132:135]
    v_mfma_f32_16x16x4_f32 v[140:143], v76, v16, v[140:143]
    v_mfma_f32_16x16x4_f32 v[148:151], v84, v16, v[148:151]
    v_mfma_f32_16x16x4_f32 v[156:159], v92, v16, v[156:159]
    s_nop 0
    v_mfma_f32_16x16x4_f32 v[100:103], v37, v19, v[100:103]
    v_add_u32 v14, 24, v2
    v_add_u32 v15, 16, v1
    v_mfma_f32_16x16x4_f32 v[108:111], v45, v19, v[108:111]
    v_mul_u32_u24 v14, v14, v15
    v_and_b32 v14, 31, v14
    v_mfma_f32_16x16x4_f32 v[116:119], v53, v19, v[116:119]
    v_cvt_f32_u32 v14, v14
    v_mul_f32 v14, 0.03125, v14
    v_mfma_f32_16x16x4_f32 v[124:127], v61, v19, v[124:127]
    v_cos_f32 v16, v14
    v_sin_f32 v15, v14
    v_mfma_f32_16x16x4_f32 v[132:135], v37, v20, v[132:135]
    s_nop 0
    v_sub_f32 v17, 0, v15
    v_mfma_f32_16x16x4_f32 v[140:143], v45, v20, v[140:143]
    v_mov_b32 v18, v15
    v_mfma_f32_16x16x4_f32 v[148:151], v53, v20, v[148:151]
    v_mfma_f32_16x16x4_f32 v[156:159], v61, v20, v[156:159]
    v_mfma_f32_16x16x4_f32 v[100:103], v69, v21, v[100:103]
    v_mfma_f32_16x16x4_f32 v[108:111], v77, v21, v[108:111]
    v_mfma_f32_16x16x4_f32 v[116:119], v85, v21, v[116:119]
    v_mfma_f32_16x16x4_f32 v[124:127], v93, v21, v[124:127]
    v_mfma_f32_16x16x4_f32 v[132:135], v69, v19, v[132:135]
    v_mfma_f32_16x16x4_f32 v[140:143], v77, v19, v[140:143]
    v_mfma_f32_16x16x4_f32 v[148:151], v85, v19, v[148:151]
    v_mfma_f32_16x16x4_f32 v[156:159], v93, v19, v[156:159]
    s_nop 0
    v_mfma_f32_16x16x4_f32 v[100:103], v38, v16, v[100:103]
    v_add_u32 v14, 28, v2
    v_add_u32 v15, 16, v1
    v_mfma_f32_16x16x4_f32 v[108:111], v46, v16, v[108:111]
    v_mul_u32_u24 v14, v14, v15
    v_and_b32 v14, 31, v14
    v_mfma_f32_16x16x4_f32 v[116:119], v54, v16, v[116:119]
    v_cvt_f32_u32 v14, v14
    v_mul_f32 v14, 0.03125, v14
    v_mfma_f32_16x16x4_f32 v[124:127], v62, v16, v[124:127]
    v_cos_f32 v19, v14
    v_sin_f32 v15, v14
    v_mfma_f32_16x16x4_f32 v[132:135], v38, v17, v[132:135]
    s_nop 0
    v_sub_f32 v20, 0, v15
    v_mfma_f32_16x16x4_f32 v[140:143], v46, v17, v[140:143]
    v_mov_b32 v21, v15
    v_mfma_f32_16x16x4_f32 v[148:151], v54, v17, v[148:151]
    v_mfma_f32_16x16x4_f32 v[156:159], v62, v17, v[156:159]
    v_mfma_f32_16x16x4_f32 v[100:103], v70, v18, v[100:103]
    v_mfma_f32_16x16x4_f32 v[108:111], v78, v18, v[108:111]
    v_mfma_f32_16x16x4_f32 v[116:119], v86, v18, v[116:119]
    v_mfma_f32_16x16x4_f32 v[124:127], v94, v18, v[124:127]
    v_mfma_f32_16x16x4_f32 v[132:135], v70, v16, v[132:135]
    v_mfma_f32_16x16x4_f32 v[140:143], v78, v16, v[140:143]
    v_mfma_f32_16x16x4_f32 v[148:151], v86, v16, v[148:151]
    v_mfma_f32_16x16x4_f32 v[156:159], v94, v16, v[156:159]
    s_nop 0
    v_mfma_f32_16x16x4_f32 v[100:103], v39, v19, v[100:103]
    v_mfma_f32_16x16x4_f32 v[108:111], v47, v19, v[108:111]
    v_mfma_f32_16x16x4_f32 v[116:119], v55, v19, v[116:119]
    v_mfma_f32_16x16x4_f32 v[124:127], v63, v19, v[124:127]
    v_mfma_f32_16x16x4_f32 v[132:135], v39, v20, v[132:135]
    v_mfma_f32_16x16x4_f32 v[140:143], v47, v20, v[140:143]
    v_mfma_f32_16x16x4_f32 v[148:151], v55, v20, v[148:151]
    v_mfma_f32_16x16x4_f32 v[156:159], v63, v20, v[156:159]
    v_mfma_f32_16x16x4_f32 v[100:103], v71, v21, v[100:103]
    v_mfma_f32_16x16x4_f32 v[108:111], v79, v21, v[108:111]
    v_mfma_f32_16x16x4_f32 v[116:119], v87, v21, v[116:119]
    v_mfma_f32_16x16x4_f32 v[124:127], v95, v21, v[124:127]
    v_mfma_f32_16x16x4_f32 v[132:135], v71, v19, v[132:135]
    v_mfma_f32_16x16x4_f32 v[140:143], v79, v19, v[140:143]
    v_mfma_f32_16x16x4_f32 v[148:151], v87, v19, v[148:151]
    v_mfma_f32_16x16x4_f32 v[156:159], v95, v19, v[156:159]
    v_lshlrev_b32 v6, 5, v4
    v_add_u32 v6, v6, v1
    v_mul_u32_u24 v6, 321, v6
    v_add_u32 v6, v6, v3
    v_lshlrev_b32 v6, 1, v6
    s_mov_b32 s24, 0
    buffer_load_ushort v32, v6, s[12:15], s24 offen
    buffer_load_ushort v64, v6, s[16:19], s24 offen
    s_mov_b32 s24, 20544
    buffer_load_ushort v33, v6, s[12:15], s24 offen
    buffer_load_ushort v65, v6, s[16:19], s24 offen
    s_mov_b32 s24, 41088
    buffer_load_ushort v34, v6, s[12:15], s24 offen
    buffer_load_ushort v66, v6, s[16:19], s24 offen
    s_mov_b32 s24, 61632
    buffer_load_ushort v35, v6, s[12:15], s24 offen
    buffer_load_ushort v67, v6, s[16:19], s24 offen
    s_mov_b32 s24, 10272
    buffer_load_ushort v36, v6, s[12:15], s24 offen
    buffer_load_ushort v68, v6, s[16:19], s24 offen
    s_mov_b32 s24, 30816
    buffer_load_ushort v37, v6, s[12:15], s24 offen
    buffer_load_ushort v69, v6, s[16:19], s24 offen
    s_mov_b32 s24, 51360
    buffer_load_ushort v38, v6, s[12:15], s24 offen
    buffer_load_ushort v70, v6, s[16:19], s24 offen
    s_mov_b32 s24, 71904
    buffer_load_ushort v39, v6, s[12:15], s24 offen
    buffer_load_ushort v71, v6, s[16:19], s24 offen
    s_mov_b32 s24, 328704
    buffer_load_ushort v40, v6, s[12:15], s24 offen
    buffer_load_ushort v72, v6, s[16:19], s24 offen
    s_mov_b32 s24, 349248
    buffer_load_ushort v41, v6, s[12:15], s24 offen
    buffer_load_ushort v73, v6, s[16:19], s24 offen
    s_mov_b32 s24, 369792
    buffer_load_ushort v42, v6, s[12:15], s24 offen
    buffer_load_ushort v74, v6, s[16:19], s24 offen
    s_mov_b32 s24, 390336
    buffer_load_ushort v43, v6, s[12:15], s24 offen
    buffer_load_ushort v75, v6, s[16:19], s24 offen
    s_mov_b32 s24, 338976
    buffer_load_ushort v44, v6, s[12:15], s24 offen
    buffer_load_ushort v76, v6, s[16:19], s24 offen
    s_mov_b32 s24, 359520
    buffer_load_ushort v45, v6, s[12:15], s24 offen
    buffer_load_ushort v77, v6, s[16:19], s24 offen
    s_mov_b32 s24, 380064
    buffer_load_ushort v46, v6, s[12:15], s24 offen
    buffer_load_ushort v78, v6, s[16:19], s24 offen
    s_mov_b32 s24, 400608
    buffer_load_ushort v47, v6, s[12:15], s24 offen
    buffer_load_ushort v79, v6, s[16:19], s24 offen
    s_mov_b32 s24, 657408
    buffer_load_ushort v48, v6, s[12:15], s24 offen
    buffer_load_ushort v80, v6, s[16:19], s24 offen
    s_mov_b32 s24, 677952
    buffer_load_ushort v49, v6, s[12:15], s24 offen
    buffer_load_ushort v81, v6, s[16:19], s24 offen
    s_mov_b32 s24, 698496
    buffer_load_ushort v50, v6, s[12:15], s24 offen
    buffer_load_ushort v82, v6, s[16:19], s24 offen
    s_mov_b32 s24, 719040
    buffer_load_ushort v51, v6, s[12:15], s24 offen
    buffer_load_ushort v83, v6, s[16:19], s24 offen
    s_mov_b32 s24, 667680
    buffer_load_ushort v52, v6, s[12:15], s24 offen
    buffer_load_ushort v84, v6, s[16:19], s24 offen
    s_mov_b32 s24, 688224
    buffer_load_ushort v53, v6, s[12:15], s24 offen
    buffer_load_ushort v85, v6, s[16:19], s24 offen
    s_mov_b32 s24, 708768
    buffer_load_ushort v54, v6, s[12:15], s24 offen
    buffer_load_ushort v86, v6, s[16:19], s24 offen
    s_mov_b32 s24, 729312
    buffer_load_ushort v55, v6, s[12:15], s24 offen
    buffer_load_ushort v87, v6, s[16:19], s24 offen
    s_mov_b32 s24, 986112
    buffer_load_ushort v56, v6, s[12:15], s24 offen
    buffer_load_ushort v88, v6, s[16:19], s24 offen
    s_mov_b32 s24, 1006656
    buffer_load_ushort v57, v6, s[12:15], s24 offen
    buffer_load_ushort v89, v6, s[16:19], s24 offen
    s_mov_b32 s24, 1027200
    buffer_load_ushort v58, v6, s[12:15], s24 offen
    buffer_load_ushort v90, v6, s[16:19], s24 offen
    s_mov_b32 s24, 1047744
    buffer_load_ushort v59, v6, s[12:15], s24 offen
    buffer_load_ushort v91, v6, s[16:19], s24 offen
    s_mov_b32 s24, 996384
    buffer_load_ushort v60, v6, s[12:15], s24 offen
    buffer_load_ushort v92, v6, s[16:19], s24 offen
    s_mov_b32 s24, 1016928
    buffer_load_ushort v61, v6, s[12:15], s24 offen
    buffer_load_ushort v93, v6, s[16:19], s24 offen
    s_mov_b32 s24, 1037472
    buffer_load_ushort v62, v6, s[12:15], s24 offen
    buffer_load_ushort v94, v6, s[16:19], s24 offen
    s_mov_b32 s24, 1058016
    buffer_load_ushort v63, v6, s[12:15], s24 offen
    buffer_load_ushort v95, v6, s[16:19], s24 offen
    s_nop 9
    v_add_u32 v14, 0, v4
    v_add_u32 v15, 0, v1
    v_mul_u32_u24 v14, v14, v15
    v_cvt_f32_u32 v14, v14
    v_mul_f32 v14, 0.00048828125, v14
    v_cos_f32 v8, v14
    v_sin_f32 v9, v14
    s_nop 0
    v_mul_f32 v10, v96, v8
    v_mul_f32 v11, v128, v8
    v_fma_f32 v10, v128, v9, v10
    v_fma_f32 v128, -v96, v9, v11
    v_mov_b32 v96, v10
    v_add_u32 v14, 1, v4
    v_add_u32 v15, 0, v1
    v_mul_u32_u24 v14, v14, v15
    v_cvt_f32_u32 v14, v14
    v_mul_f32 v14, 0.00048828125, v14
    v_cos_f32 v8, v14
    v_sin_f32 v9, v14
    s_nop 0
    v_mul_f32 v10, v97, v8
    v_mul_f32 v11, v129, v8
    v_fma_f32 v10, v129, v9, v10
    v_fma_f32 v129, -v97, v9, v11
    v_mov_b32 v97, v10
    v_add_u32 v14, 2, v4
    v_add_u32 v15, 0, v1
    v_mul_u32_u24 v14, v14, v15
    v_cvt_f32_u32 v14, v14
    v_mul_f32 v14, 0.00048828125, v14
    v_cos_f32 v8, v14
    v_sin_f32 v9, v14
    s_nop 0
    v_mul_f32 v10, v98, v8
    v_mul_f32 v11, v130, v8
    v_fma_f32 v10, v130, v9, v10
    v_fma_f32 v130, -v98, v9, v11
    v_mov_b32 v98, v10
    v_add_u32 v14, 3, v4
    v_add_u32 v15, 0, v1
    v_mul_u32_u24 v14, v14, v15
    v_cvt_f32_u32 v14, v14
    v_mul_f32 v14, 0.00048828125, v14
    v_cos_f32 v8, v14
    v_sin_f32 v9, v14
    s_nop 0
    v_mul_f32 v10, v99, v8
    v_mul_f32 v11, v131, v8
    v_fma_f32 v10, v131, v9, v10
    v_fma_f32 v131, -v99, v9, v11
    v_mov_b32 v99, v10
    v_add_u32 v14, 0, v4
    v_add_u32 v15, 16, v1
    v_mul_u32_u24 v14, v14, v15
    v_cvt_f32_u32 v14, v14
    v_mul_f32 v14, 0.00048828125, v14
    v_cos_f32 v8, v14
    v_sin_f32 v9, v14
    s_nop 0
    v_mul_f32 v10, v100, v8
    v_mul_f32 v11, v132, v8
    v_fma_f32 v10, v132, v9, v10
    v_fma_f32 v132, -v100, v9, v11
    v_mov_b32 v100, v10
    v_add_u32 v14, 1, v4
    v_add_u32 v15, 16, v1
    v_mul_u32_u24 v14, v14, v15
    v_cvt_f32_u32 v14, v14
    v_mul_f32 v14, 0.00048828125, v14
    v_cos_f32 v8, v14
    v_sin_f32 v9, v14
    s_nop 0
    v_mul_f32 v10, v101, v8
    v_mul_f32 v11, v133, v8
    v_fma_f32 v10, v133, v9, v10
    v_fma_f32 v133, -v101, v9, v11
    v_mov_b32 v101, v10
    v_add_u32 v14, 2, v4
    v_add_u32 v15, 16, v1
    v_mul_u32_u24 v14, v14, v15
    v_cvt_f32_u32 v14, v14
    v_mul_f32 v14, 0.00048828125, v14
    v_cos_f32 v8, v14
    v_sin_f32 v9, v14
    s_nop 0
    v_mul_f32 v10, v102, v8
    v_mul_f32 v11, v134, v8
    v_fma_f32 v10, v134, v9, v10
    v_fma_f32 v134, -v102, v9, v11
    v_mov_b32 v102, v10
    v_add_u32 v14, 3, v4
    v_add_u32 v15, 16, v1
    v_mul_u32_u24 v14, v14, v15
    v_cvt_f32_u32 v14, v14
    v_mul_f32 v14, 0.00048828125, v14
    v_cos_f32 v8, v14
    v_sin_f32 v9, v14
    s_nop 0
    v_mul_f32 v10, v103, v8
    v_mul_f32 v11, v135, v8
    v_fma_f32 v10, v135, v9, v10
    v_fma_f32 v135, -v103, v9, v11
    v_mov_b32 v103, v10
    v_add_u32 v14, 16, v4
    v_add_u32 v15, 0, v1
    v_mul_u32_u24 v14, v14, v15
    v_cvt_f32_u32 v14, v14
    v_mul_f32 v14, 0.00048828125, v14
    v_cos_f32 v8, v14
    v_sin_f32 v9, v14
    s_nop 0
    v_mul_f32 v10, v104, v8
    v_mul_f32 v11, v136, v8
    v_fma_f32 v10, v136, v9, v10
    v_fma_f32 v136, -v104, v9, v11
    v_mov_b32 v104, v10
    v_add_u32 v14, 17, v4
    v_add_u32 v15, 0, v1
    v_mul_u32_u24 v14, v14, v15
    v_cvt_f32_u32 v14, v14
    v_mul_f32 v14, 0.00048828125, v14
    v_cos_f32 v8, v14
    v_sin_f32 v9, v14
    s_nop 0
    v_mul_f32 v10, v105, v8
    v_mul_f32 v11, v137, v8
    v_fma_f32 v10, v137, v9, v10
    v_fma_f32 v137, -v105, v9, v11
    v_mov_b32 v105, v10
    v_add_u32 v14, 18, v4
    v_add_u32 v15, 0, v1
    v_mul_u32_u24 v14, v14, v15
    v_cvt_f32_u32 v14, v14
    v_mul_f32 v14, 0.00048828125, v14
    v_cos_f32 v8, v14
    v_sin_f32 v9, v14
    s_nop 0
    v_mul_f32 v10, v106, v8
    v_mul_f32 v11, v138, v8
    v_fma_f32 v10, v138, v9, v10
    v_fma_f32 v138, -v106, v9, v11
    v_mov_b32 v106, v10
    v_add_u32 v14, 19, v4
    v_add_u32 v15, 0, v1
    v_mul_u32_u24 v14, v14, v15
    v_cvt_f32_u32 v14, v14
    v_mul_f32 v14, 0.00048828125, v14
    v_cos_f32 v8, v14
    v_sin_f32 v9, v14
    s_nop 0
    v_mul_f32 v10, v107, v8
    v_mul_f32 v11, v139, v8
    v_fma_f32 v10, v139, v9, v10
    v_fma_f32 v139, -v107, v9, v11
    v_mov_b32 v107, v10
    v_add_u32 v14, 16, v4
    v_add_u32 v15, 16, v1
    v_mul_u32_u24 v14, v14, v15
    v_cvt_f32_u32 v14, v14
    v_mul_f32 v14, 0.00048828125, v14
    v_cos_f32 v8, v14
    v_sin_f32 v9, v14
    s_nop 0
    v_mul_f32 v10, v108, v8
    v_mul_f32 v11, v140, v8
    v_fma_f32 v10, v140, v9, v10
    v_fma_f32 v140, -v108, v9, v11
    v_mov_b32 v108, v10
    v_add_u32 v14, 17, v4
    v_add_u32 v15, 16, v1
    v_mul_u32_u24 v14, v14, v15
    v_cvt_f32_u32 v14, v14
    v_mul_f32 v14, 0.00048828125, v14
    v_cos_f32 v8, v14
    v_sin_f32 v9, v14
    s_nop 0
    v_mul_f32 v10, v109, v8
    v_mul_f32 v11, v141, v8
    v_fma_f32 v10, v141, v9, v10
    v_fma_f32 v141, -v109, v9, v11
    v_mov_b32 v109, v10
    v_add_u32 v14, 18, v4
    v_add_u32 v15, 16, v1
    v_mul_u32_u24 v14, v14, v15
    v_cvt_f32_u32 v14, v14
    v_mul_f32 v14, 0.00048828125, v14
    v_cos_f32 v8, v14
    v_sin_f32 v9, v14
    s_nop 0
    v_mul_f32 v10, v110, v8
    v_mul_f32 v11, v142, v8
    v_fma_f32 v10, v142, v9, v10
    v_fma_f32 v142, -v110, v9, v11
    v_mov_b32 v110, v10
    v_add_u32 v14, 19, v4
    v_add_u32 v15, 16, v1
    v_mul_u32_u24 v14, v14, v15
    v_cvt_f32_u32 v14, v14
    v_mul_f32 v14, 0.00048828125, v14
    v_cos_f32 v8, v14
    v_sin_f32 v9, v14
    s_nop 0
    v_mul_f32 v10, v111, v8
    v_mul_f32 v11, v143, v8
    v_fma_f32 v10, v143, v9, v10
    v_fma_f32 v143, -v111, v9, v11
    v_mov_b32 v111, v10
    v_add_u32 v14, 32, v4
    v_add_u32 v15, 0, v1
    v_mul_u32_u24 v14, v14, v15
    v_cvt_f32_u32 v14, v14
    v_mul_f32 v14, 0.00048828125, v14
    v_cos_f32 v8, v14
    v_sin_f32 v9, v14
    s_nop 0
    v_mul_f32 v10, v112, v8
    v_mul_f32 v11, v144, v8
    v_fma_f32 v10, v144, v9, v10
    v_fma_f32 v144, -v112, v9, v11
    v_mov_b32 v112, v10
    v_add_u32 v14, 33, v4
    v_add_u32 v15, 0, v1
    v_mul_u32_u24 v14, v14, v15
    v_cvt_f32_u32 v14, v14
    v_mul_f32 v14, 0.00048828125, v14
    v_cos_f32 v8, v14
    v_sin_f32 v9, v14
    s_nop 0
    v_mul_f32 v10, v113, v8
    v_mul_f32 v11, v145, v8
    v_fma_f32 v10, v145, v9, v10
    v_fma_f32 v145, -v113, v9, v11
    v_mov_b32 v113, v10
    v_add_u32 v14, 34, v4
    v_add_u32 v15, 0, v1
    v_mul_u32_u24 v14, v14, v15
    v_cvt_f32_u32 v14, v14
    v_mul_f32 v14, 0.00048828125, v14
    v_cos_f32 v8, v14
    v_sin_f32 v9, v14
    s_nop 0
    v_mul_f32 v10, v114, v8
    v_mul_f32 v11, v146, v8
    v_fma_f32 v10, v146, v9, v10
    v_fma_f32 v146, -v114, v9, v11
    v_mov_b32 v114, v10
    v_add_u32 v14, 35, v4
    v_add_u32 v15, 0, v1
    v_mul_u32_u24 v14, v14, v15
    v_cvt_f32_u32 v14, v14
    v_mul_f32 v14, 0.00048828125, v14
    v_cos_f32 v8, v14
    v_sin_f32 v9, v14
    s_nop 0
    v_mul_f32 v10, v115, v8
    v_mul_f32 v11, v147, v8
    v_fma_f32 v10, v147, v9, v10
    v_fma_f32 v147, -v115, v9, v11
    v_mov_b32 v115, v10
    v_add_u32 v14, 32, v4
    v_add_u32 v15, 16, v1
    v_mul_u32_u24 v14, v14, v15
    v_cvt_f32_u32 v14, v14
    v_mul_f32 v14, 0.00048828125, v14
    v_cos_f32 v8, v14
    v_sin_f32 v9, v14
    s_nop 0
    v_mul_f32 v10, v116, v8
    v_mul_f32 v11, v148, v8
    v_fma_f32 v10, v148, v9, v10
    v_fma_f32 v148, -v116, v9, v11
    v_mov_b32 v116, v10
    v_add_u32 v14, 33, v4
    v_add_u32 v15, 16, v1
    v_mul_u32_u24 v14, v14, v15
    v_cvt_f32_u32 v14, v14
    v_mul_f32 v14, 0.00048828125, v14
    v_cos_f32 v8, v14
    v_sin_f32 v9, v14
    s_nop 0
    v_mul_f32 v10, v117, v8
    v_mul_f32 v11, v149, v8
    v_fma_f32 v10, v149, v9, v10
    v_fma_f32 v149, -v117, v9, v11
    v_mov_b32 v117, v10
    v_add_u32 v14, 34, v4
    v_add_u32 v15, 16, v1
    v_mul_u32_u24 v14, v14, v15
    v_cvt_f32_u32 v14, v14
    v_mul_f32 v14, 0.00048828125, v14
    v_cos_f32 v8, v14
    v_sin_f32 v9, v14
    s_nop 0
    v_mul_f32 v10, v118, v8
    v_mul_f32 v11, v150, v8
    v_fma_f32 v10, v150, v9, v10
    v_fma_f32 v150, -v118, v9, v11
    v_mov_b32 v118, v10
    v_add_u32 v14, 35, v4
    v_add_u32 v15, 16, v1
    v_mul_u32_u24 v14, v14, v15
    v_cvt_f32_u32 v14, v14
    v_mul_f32 v14, 0.00048828125, v14
    v_cos_f32 v8, v14
    v_sin_f32 v9, v14
    s_nop 0
    v_mul_f32 v10, v119, v8
    v_mul_f32 v11, v151, v8
    v_fma_f32 v10, v151, v9, v10
    v_fma_f32 v151, -v119, v9, v11
    v_mov_b32 v119, v10
    v_add_u32 v14, 48, v4
    v_add_u32 v15, 0, v1
    v_mul_u32_u24 v14, v14, v15
    v_cvt_f32_u32 v14, v14
    v_mul_f32 v14, 0.00048828125, v14
    v_cos_f32 v8, v14
    v_sin_f32 v9, v14
    s_nop 0
    v_mul_f32 v10, v120, v8
    v_mul_f32 v11, v152, v8
    v_fma_f32 v10, v152, v9, v10
    v_fma_f32 v152, -v120, v9, v11
    v_mov_b32 v120, v10
    v_add_u32 v14, 49, v4
    v_add_u32 v15, 0, v1
    v_mul_u32_u24 v14, v14, v15
    v_cvt_f32_u32 v14, v14
    v_mul_f32 v14, 0.00048828125, v14
    v_cos_f32 v8, v14
    v_sin_f32 v9, v14
    s_nop 0
    v_mul_f32 v10, v121, v8
    v_mul_f32 v11, v153, v8
    v_fma_f32 v10, v153, v9, v10
    v_fma_f32 v153, -v121, v9, v11
    v_mov_b32 v121, v10
    v_add_u32 v14, 50, v4
    v_add_u32 v15, 0, v1
    v_mul_u32_u24 v14, v14, v15
    v_cvt_f32_u32 v14, v14
    v_mul_f32 v14, 0.00048828125, v14
    v_cos_f32 v8, v14
    v_sin_f32 v9, v14
    s_nop 0
    v_mul_f32 v10, v122, v8
    v_mul_f32 v11, v154, v8
    v_fma_f32 v10, v154, v9, v10
    v_fma_f32 v154, -v122, v9, v11
    v_mov_b32 v122, v10
    v_add_u32 v14, 51, v4
    v_add_u32 v15, 0, v1
    v_mul_u32_u24 v14, v14, v15
    v_cvt_f32_u32 v14, v14
    v_mul_f32 v14, 0.00048828125, v14
    v_cos_f32 v8, v14
    v_sin_f32 v9, v14
    s_nop 0
    v_mul_f32 v10, v123, v8
    v_mul_f32 v11, v155, v8
    v_fma_f32 v10, v155, v9, v10
    v_fma_f32 v155, -v123, v9, v11
    v_mov_b32 v123, v10
    v_add_u32 v14, 48, v4
    v_add_u32 v15, 16, v1
    v_mul_u32_u24 v14, v14, v15
    v_cvt_f32_u32 v14, v14
    v_mul_f32 v14, 0.00048828125, v14
    v_cos_f32 v8, v14
    v_sin_f32 v9, v14
    s_nop 0
    v_mul_f32 v10, v124, v8
    v_mul_f32 v11, v156, v8
    v_fma_f32 v10, v156, v9, v10
    v_fma_f32 v156, -v124, v9, v11
    v_mov_b32 v124, v10
    v_add_u32 v14, 49, v4
    v_add_u32 v15, 16, v1
    v_mul_u32_u24 v14, v14, v15
    v_cvt_f32_u32 v14, v14
    v_mul_f32 v14, 0.00048828125, v14
    v_cos_f32 v8, v14
    v_sin_f32 v9, v14
    s_nop 0
    v_mul_f32 v10, v125, v8
    v_mul_f32 v11, v157, v8
    v_fma_f32 v10, v157, v9, v10
    v_fma_f32 v157, -v125, v9, v11
    v_mov_b32 v125, v10
    v_add_u32 v14, 50, v4
    v_add_u32 v15, 16, v1
    v_mul_u32_u24 v14, v14, v15
    v_cvt_f32_u32 v14, v14
    v_mul_f32 v14, 0.00048828125, v14
    v_cos_f32 v8, v14
    v_sin_f32 v9, v14
    s_nop 0
    v_mul_f32 v10, v126, v8
    v_mul_f32 v11, v158, v8
    v_fma_f32 v10, v158, v9, v10
    v_fma_f32 v158, -v126, v9, v11
    v_mov_b32 v126, v10
    v_add_u32 v14, 51, v4
    v_add_u32 v15, 16, v1
    v_mul_u32_u24 v14, v14, v15
    v_cvt_f32_u32 v14, v14
    v_mul_f32 v14, 0.00048828125, v14
    v_cos_f32 v8, v14
    v_sin_f32 v9, v14
    s_nop 0
    v_mul_f32 v10, v127, v8
    v_mul_f32 v11, v159, v8
    v_fma_f32 v10, v159, v9, v10
    v_fma_f32 v159, -v127, v9, v11
    v_mov_b32 v127, v10
    v_mov_b32 v160, 0
    v_mov_b32 v161, 0
    v_mov_b32 v162, 0
    v_mov_b32 v163, 0
    v_mov_b32 v164, 0
    v_mov_b32 v165, 0
    v_mov_b32 v166, 0
    v_mov_b32 v167, 0
    v_mov_b32 v168, 0
    v_mov_b32 v169, 0
    v_mov_b32 v170, 0
    v_mov_b32 v171, 0
    v_mov_b32 v172, 0
    v_mov_b32 v173, 0
    v_mov_b32 v174, 0
    v_mov_b32 v175, 0
    v_mov_b32 v176, 0
    v_mov_b32 v177, 0
    v_mov_b32 v178, 0
    v_mov_b32 v179, 0
    v_mov_b32 v180, 0
    v_mov_b32 v181, 0
    v_mov_b32 v182, 0
    v_mov_b32 v183, 0
    v_mov_b32 v184, 0
    v_mov_b32 v185, 0
    v_mov_b32 v186, 0
    v_mov_b32 v187, 0
    v_mov_b32 v188, 0
    v_mov_b32 v189, 0
    v_mov_b32 v190, 0
    v_mov_b32 v191, 0
    v_mov_b32 v192, 0
    v_mov_b32 v193, 0
    v_mov_b32 v194, 0
    v_mov_b32 v195, 0
    v_mov_b32 v196, 0
    v_mov_b32 v197, 0
    v_mov_b32 v198, 0
    v_mov_b32 v199, 0
    v_mov_b32 v200, 0
    v_mov_b32 v201, 0
    v_mov_b32 v202, 0
    v_mov_b32 v203, 0
    v_mov_b32 v204, 0
    v_mov_b32 v205, 0
    v_mov_b32 v206, 0
    v_mov_b32 v207, 0
    v_mov_b32 v208, 0
    v_mov_b32 v209, 0
    v_mov_b32 v210, 0
    v_mov_b32 v211, 0
    v_mov_b32 v212, 0
    v_mov_b32 v213, 0
    v_mov_b32 v214, 0
    v_mov_b32 v215, 0
    v_mov_b32 v216, 0
    v_mov_b32 v217, 0
    v_mov_b32 v218, 0
    v_mov_b32 v219, 0
    v_mov_b32 v220, 0
    v_mov_b32 v221, 0
    v_mov_b32 v222, 0
    v_mov_b32 v223, 0
    v_add_u32 v14, 0, v1
    v_add_u32 v15, 0, v4
    v_mul_u32_u24 v14, v14, v15
    v_and_b32 v14, 63, v14
    v_cvt_f32_u32 v14, v14
    v_mul_f32 v14, 0.015625, v14
    v_cos_f32 v16, v14
    v_sin_f32 v15, v14
    s_nop 0
    v_sub_f32 v17, 0, v15
    v_mov_b32 v18, v15
    s_nop 0
    v_mfma_f32_16x16x4_f32 v[160:163], v16, v96, v[160:163]
    v_add_u32 v14, 16, v1
    v_add_u32 v15, 0, v4
    v_mfma_f32_16x16x4_f32 v[164:167], v16, v100, v[164:167]
    v_mul_u32_u24 v14, v14, v15
    v_and_b32 v14, 63, v14
    v_mfma_f32_16x16x4_f32 v[192:195], v17, v96, v[192:195]
    v_cvt_f32_u32 v14, v14
    v_mul_f32 v14, 0.015625, v14
    v_mfma_f32_16x16x4_f32 v[196:199], v17, v100, v[196:199]
    v_cos_f32 v19, v14
    v_sin_f32 v15, v14
    v_mfma_f32_16x16x4_f32 v[160:163], v18, v128, v[160:163]
    s_nop 0
    v_sub_f32 v20, 0, v15
    v_mfma_f32_16x16x4_f32 v[164:167], v18, v132, v[164:167]
    v_mov_b32 v21, v15
    v_mfma_f32_16x16x4_f32 v[192:195], v16, v128, v[192:195]
    v_mfma_f32_16x16x4_f32 v[196:199], v16, v132, v[196:199]
    s_nop 0
    v_mfma_f32_16x16x4_f32 v[168:171], v19, v96, v[168:171]
    v_add_u32 v14, 32, v1
    v_add_u32 v15, 0, v4
    v_mfma_f32_16x16x4_f32 v[172:175], v19, v100, v[172:175]
    v_mul_u32_u24 v14, v14, v15
    v_and_b32 v14, 63, v14
    v_mfma_f32_16x16x4_f32 v[200:203], v20, v96, v[200:203]
    v_cvt_f32_u32 v14, v14
    v_mul_f32 v14, 0.015625, v14
    v_mfma_f32_16x16x4_f32 v[204:207], v20, v100, v[204:207]
    v_cos_f32 v16, v14
    v_sin_f32 v15, v14
    v_mfma_f32_16x16x4_f32 v[168:171], v21, v128, v[168:171]
    s_nop 0
    v_sub_f32 v17, 0, v15
    v_mfma_f32_16x16x4_f32 v[172:175], v21, v132, v[172:175]
    v_mov_b32 v18, v15
    v_mfma_f32_16x16x4_f32 v[200:203], v19, v128, v[200:203]
    v_mfma_f32_16x16x4_f32 v[204:207], v19, v132, v[204:207]
    s_nop 0
    v_mfma_f32_16x16x4_f32 v[176:179], v16, v96, v[176:179]
    v_add_u32 v14, 48, v1
    v_add_u32 v15, 0, v4
    v_mfma_f32_16x16x4_f32 v[180:183], v16, v100, v[180:183]
    v_mul_u32_u24 v14, v14, v15
    v_and_b32 v14, 63, v14
    v_mfma_f32_16x16x4_f32 v[208:211], v17, v96, v[208:211]
    v_cvt_f32_u32 v14, v14
    v_mul_f32 v14, 0.015625, v14
    v_mfma_f32_16x16x4_f32 v[212:215], v17, v100, v[212:215]
    v_cos_f32 v19, v14
    v_sin_f32 v15, v14
    v_mfma_f32_16x16x4_f32 v[176:179], v18, v128, v[176:179]
    s_nop 0
    v_sub_f32 v20, 0, v15
    v_mfma_f32_16x16x4_f32 v[180:183], v18, v132, v[180:183]
    v_mov_b32 v21, v15
    v_mfma_f32_16x16x4_f32 v[208:211], v16, v128, v[208:211]
    v_mfma_f32_16x16x4_f32 v[212:215], v16, v132, v[212:215]
    s_nop 0
    v_mfma_f32_16x16x4_f32 v[184:187], v19, v96, v[184:187]
    v_add_u32 v14, 0, v1
    v_add_u32 v15, 1, v4
    v_mfma_f32_16x16x4_f32 v[188:191], v19, v100, v[188:191]
    v_mul_u32_u24 v14, v14, v15
    v_and_b32 v14, 63, v14
    v_mfma_f32_16x16x4_f32 v[216:219], v20, v96, v[216:219]
    v_cvt_f32_u32 v14, v14
    v_mul_f32 v14, 0.015625, v14
    v_mfma_f32_16x16x4_f32 v[220:223], v20, v100, v[220:223]
    v_cos_f32 v16, v14
    v_sin_f32 v15, v14
    v_mfma_f32_16x16x4_f32 v[184:187], v21, v128, v[184:187]
    s_nop 0
    v_sub_f32 v17, 0, v15
    v_mfma_f32_16x16x4_f32 v[188:191], v21, v132, v[188:191]
    v_mov_b32 v18, v15
    v_mfma_f32_16x16x4_f32 v[216:219], v19, v128, v[216:219]
    v_mfma_f32_16x16x4_f32 v[220:223], v19, v132, v[220:223]
    s_nop 0
    v_mfma_f32_16x16x4_f32 v[160:163], v16, v97, v[160:163]
    v_add_u32 v14, 16, v1
    v_add_u32 v15, 1, v4
    v_mfma_f32_16x16x4_f32 v[164:167], v16, v101, v[164:167]
    v_mul_u32_u24 v14, v14, v15
    v_and_b32 v14, 63, v14
    v_mfma_f32_16x16x4_f32 v[192:195], v17, v97, v[192:195]
    v_cvt_f32_u32 v14, v14
    v_mul_f32 v14, 0.015625, v14
    v_mfma_f32_16x16x4_f32 v[196:199], v17, v101, v[196:199]
    v_cos_f32 v19, v14
    v_sin_f32 v15, v14
    v_mfma_f32_16x16x4_f32 v[160:163], v18, v129, v[160:163]
    s_nop 0
    v_sub_f32 v20, 0, v15
    v_mfma_f32_16x16x4_f32 v[164:167], v18, v133, v[164:167]
    v_mov_b32 v21, v15
    v_mfma_f32_16x16x4_f32 v[192:195], v16, v129, v[192:195]
    v_mfma_f32_16x16x4_f32 v[196:199], v16, v133, v[196:199]
    s_nop 0
    v_mfma_f32_16x16x4_f32 v[168:171], v19, v97, v[168:171]
    v_add_u32 v14, 32, v1
    v_add_u32 v15, 1, v4
    v_mfma_f32_16x16x4_f32 v[172:175], v19, v101, v[172:175]
    v_mul_u32_u24 v14, v14, v15
    v_and_b32 v14, 63, v14
    v_mfma_f32_16x16x4_f32 v[200:203], v20, v97, v[200:203]
    v_cvt_f32_u32 v14, v14
    v_mul_f32 v14, 0.015625, v14
    v_mfma_f32_16x16x4_f32 v[204:207], v20, v101, v[204:207]
    v_cos_f32 v16, v14
    v_sin_f32 v15, v14
    v_mfma_f32_16x16x4_f32 v[168:171], v21, v129, v[168:171]
    s_nop 0
    v_sub_f32 v17, 0, v15
    v_mfma_f32_16x16x4_f32 v[172:175], v21, v133, v[172:175]
    v_mov_b32 v18, v15
    v_mfma_f32_16x16x4_f32 v[200:203], v19, v129, v[200:203]
    v_mfma_f32_16x16x4_f32 v[204:207], v19, v133, v[204:207]
    s_nop 0
    v_mfma_f32_16x16x4_f32 v[176:179], v16, v97, v[176:179]
    v_add_u32 v14, 48, v1
    v_add_u32 v15, 1, v4
    v_mfma_f32_16x16x4_f32 v[180:183], v16, v101, v[180:183]
    v_mul_u32_u24 v14, v14, v15
    v_and_b32 v14, 63, v14
    v_mfma_f32_16x16x4_f32 v[208:211], v17, v97, v[208:211]
    v_cvt_f32_u32 v14, v14
    v_mul_f32 v14, 0.015625, v14
    v_mfma_f32_16x16x4_f32 v[212:215], v17, v101, v[212:215]
    v_cos_f32 v19, v14
    v_sin_f32 v15, v14
    v_mfma_f32_16x16x4_f32 v[176:179], v18, v129, v[176:179]
    s_nop 0
    v_sub_f32 v20, 0, v15
    v_mfma_f32_16x16x4_f32 v[180:183], v18, v133, v[180:183]
    v_mov_b32 v21, v15
    v_mfma_f32_16x16x4_f32 v[208:211], v16, v129, v[208:211]
    v_mfma_f32_16x16x4_f32 v[212:215], v16, v133, v[212:215]
    s_nop 0
    v_mfma_f32_16x16x4_f32 v[184:187], v19, v97, v[184:187]
    v_add_u32 v14, 0, v1
    v_add_u32 v15, 2, v4
    v_mfma_f32_16x16x4_f32 v[188:191], v19, v101, v[188:191]
    v_mul_u32_u24 v14, v14, v15
    v_and_b32 v14, 63, v14
    v_mfma_f32_16x16x4_f32 v[216:219], v20, v97, v[216:219]
    v_cvt_f32_u32 v14, v14
    v_mul_f32 v14, 0.015625, v14
    v_mfma_f32_16x16x4_f32 v[220:223], v20, v101, v[220:223]
    v_cos_f32 v16, v14
    v_sin_f32 v15, v14
    v_mfma_f32_16x16x4_f32 v[184:187], v21, v129, v[184:187]
    s_nop 0
    v_sub_f32 v17, 0, v15
    v_mfma_f32_16x16x4_f32 v[188:191], v21, v133, v[188:191]
    v_mov_b32 v18, v15
    v_mfma_f32_16x16x4_f32 v[216:219], v19, v129, v[216:219]
    v_mfma_f32_16x16x4_f32 v[220:223], v19, v133, v[220:223]
    s_nop 0
    v_mfma_f32_16x16x4_f32 v[160:163], v16, v98, v[160:163]
    v_add_u32 v14, 16, v1
    v_add_u32 v15, 2, v4
    v_mfma_f32_16x16x4_f32 v[164:167], v16, v102, v[164:167]
    v_mul_u32_u24 v14, v14, v15
    v_and_b32 v14, 63, v14
    v_mfma_f32_16x16x4_f32 v[192:195], v17, v98, v[192:195]
    v_cvt_f32_u32 v14, v14
    v_mul_f32 v14, 0.015625, v14
    v_mfma_f32_16x16x4_f32 v[196:199], v17, v102, v[196:199]
    v_cos_f32 v19, v14
    v_sin_f32 v15, v14
    v_mfma_f32_16x16x4_f32 v[160:163], v18, v130, v[160:163]
    s_nop 0
    v_sub_f32 v20, 0, v15
    v_mfma_f32_16x16x4_f32 v[164:167], v18, v134, v[164:167]
    v_mov_b32 v21, v15
    v_mfma_f32_16x16x4_f32 v[192:195], v16, v130, v[192:195]
    v_mfma_f32_16x16x4_f32 v[196:199], v16, v134, v[196:199]
    s_nop 0
    v_mfma_f32_16x16x4_f32 v[168:171], v19, v98, v[168:171]
    v_add_u32 v14, 32, v1
    v_add_u32 v15, 2, v4
    v_mfma_f32_16x16x4_f32 v[172:175], v19, v102, v[172:175]
    v_mul_u32_u24 v14, v14, v15
    v_and_b32 v14, 63, v14
    v_mfma_f32_16x16x4_f32 v[200:203], v20, v98, v[200:203]
    v_cvt_f32_u32 v14, v14
    v_mul_f32 v14, 0.015625, v14
    v_mfma_f32_16x16x4_f32 v[204:207], v20, v102, v[204:207]
    v_cos_f32 v16, v14
    v_sin_f32 v15, v14
    v_mfma_f32_16x16x4_f32 v[168:171], v21, v130, v[168:171]
    s_nop 0
    v_sub_f32 v17, 0, v15
    v_mfma_f32_16x16x4_f32 v[172:175], v21, v134, v[172:175]
    v_mov_b32 v18, v15
    v_mfma_f32_16x16x4_f32 v[200:203], v19, v130, v[200:203]
    v_mfma_f32_16x16x4_f32 v[204:207], v19, v134, v[204:207]
    s_nop 0
    v_mfma_f32_16x16x4_f32 v[176:179], v16, v98, v[176:179]
    v_add_u32 v14, 48, v1
    v_add_u32 v15, 2, v4
    v_mfma_f32_16x16x4_f32 v[180:183], v16, v102, v[180:183]
    v_mul_u32_u24 v14, v14, v15
    v_and_b32 v14, 63, v14
    v_mfma_f32_16x16x4_f32 v[208:211], v17, v98, v[208:211]
    v_cvt_f32_u32 v14, v14
    v_mul_f32 v14, 0.015625, v14
    v_mfma_f32_16x16x4_f32 v[212:215], v17, v102, v[212:215]
    v_cos_f32 v19, v14
    v_sin_f32 v15, v14
    v_mfma_f32_16x16x4_f32 v[176:179], v18, v130, v[176:179]
    s_nop 0
    v_sub_f32 v20, 0, v15
    v_mfma_f32_16x16x4_f32 v[180:183], v18, v134, v[180:183]
    v_mov_b32 v21, v15
    v_mfma_f32_16x16x4_f32 v[208:211], v16, v130, v[208:211]
    v_mfma_f32_16x16x4_f32 v[212:215], v16, v134, v[212:215]
    s_nop 0
    v_mfma_f32_16x16x4_f32 v[184:187], v19, v98, v[184:187]
    v_add_u32 v14, 0, v1
    v_add_u32 v15, 3, v4
    v_mfma_f32_16x16x4_f32 v[188:191], v19, v102, v[188:191]
    v_mul_u32_u24 v14, v14, v15
    v_and_b32 v14, 63, v14
    v_mfma_f32_16x16x4_f32 v[216:219], v20, v98, v[216:219]
    v_cvt_f32_u32 v14, v14
    v_mul_f32 v14, 0.015625, v14
    v_mfma_f32_16x16x4_f32 v[220:223], v20, v102, v[220:223]
    v_cos_f32 v16, v14
    v_sin_f32 v15, v14
    v_mfma_f32_16x16x4_f32 v[184:187], v21, v130, v[184:187]
    s_nop 0
    v_sub_f32 v17, 0, v15
    v_mfma_f32_16x16x4_f32 v[188:191], v21, v134, v[188:191]
    v_mov_b32 v18, v15
    v_mfma_f32_16x16x4_f32 v[216:219], v19, v130, v[216:219]
    v_mfma_f32_16x16x4_f32 v[220:223], v19, v134, v[220:223]
    s_nop 0
    v_mfma_f32_16x16x4_f32 v[160:163], v16, v99, v[160:163]
    v_add_u32 v14, 16, v1
    v_add_u32 v15, 3, v4
    v_mfma_f32_16x16x4_f32 v[164:167], v16, v103, v[164:167]
    v_mul_u32_u24 v14, v14, v15
    v_and_b32 v14, 63, v14
    v_mfma_f32_16x16x4_f32 v[192:195], v17, v99, v[192:195]
    v_cvt_f32_u32 v14, v14
    v_mul_f32 v14, 0.015625, v14
    v_mfma_f32_16x16x4_f32 v[196:199], v17, v103, v[196:199]
    v_cos_f32 v19, v14
    v_sin_f32 v15, v14
    v_mfma_f32_16x16x4_f32 v[160:163], v18, v131, v[160:163]
    s_nop 0
    v_sub_f32 v20, 0, v15
    v_mfma_f32_16x16x4_f32 v[164:167], v18, v135, v[164:167]
    v_mov_b32 v21, v15
    v_mfma_f32_16x16x4_f32 v[192:195], v16, v131, v[192:195]
    v_mfma_f32_16x16x4_f32 v[196:199], v16, v135, v[196:199]
    s_nop 0
    v_mfma_f32_16x16x4_f32 v[168:171], v19, v99, v[168:171]
    v_add_u32 v14, 32, v1
    v_add_u32 v15, 3, v4
    v_mfma_f32_16x16x4_f32 v[172:175], v19, v103, v[172:175]
    v_mul_u32_u24 v14, v14, v15
    v_and_b32 v14, 63, v14
    v_mfma_f32_16x16x4_f32 v[200:203], v20, v99, v[200:203]
    v_cvt_f32_u32 v14, v14
    v_mul_f32 v14, 0.015625, v14
    v_mfma_f32_16x16x4_f32 v[204:207], v20, v103, v[204:207]
    v_cos_f32 v16, v14
    v_sin_f32 v15, v14
    v_mfma_f32_16x16x4_f32 v[168:171], v21, v131, v[168:171]
    s_nop 0
    v_sub_f32 v17, 0, v15
    v_mfma_f32_16x16x4_f32 v[172:175], v21, v135, v[172:175]
    v_mov_b32 v18, v15
    v_mfma_f32_16x16x4_f32 v[200:203], v19, v131, v[200:203]
    v_mfma_f32_16x16x4_f32 v[204:207], v19, v135, v[204:207]
    s_nop 0
    v_mfma_f32_16x16x4_f32 v[176:179], v16, v99, v[176:179]
    v_add_u32 v14, 48, v1
    v_add_u32 v15, 3, v4
    v_mfma_f32_16x16x4_f32 v[180:183], v16, v103, v[180:183]
    v_mul_u32_u24 v14, v14, v15
    v_and_b32 v14, 63, v14
    v_mfma_f32_16x16x4_f32 v[208:211], v17, v99, v[208:211]
    v_cvt_f32_u32 v14, v14
    v_mul_f32 v14, 0.015625, v14
    v_mfma_f32_16x16x4_f32 v[212:215], v17, v103, v[212:215]
    v_cos_f32 v19, v14
    v_sin_f32 v15, v14
    v_mfma_f32_16x16x4_f32 v[176:179], v18, v131, v[176:179]
    s_nop 0
    v_sub_f32 v20, 0, v15
    v_mfma_f32_16x16x4_f32 v[180:183], v18, v135, v[180:183]
    v_mov_b32 v21, v15
    v_mfma_f32_16x16x4_f32 v[208:211], v16, v131, v[208:211]
    v_mfma_f32_16x16x4_f32 v[212:215], v16, v135, v[212:215]
    s_nop 0
    v_mfma_f32_16x16x4_f32 v[184:187], v19, v99, v[184:187]
    v_add_u32 v14, 0, v1
    v_add_u32 v15, 16, v4
    v_mfma_f32_16x16x4_f32 v[188:191], v19, v103, v[188:191]
    v_mul_u32_u24 v14, v14, v15
    v_and_b32 v14, 63, v14
    v_mfma_f32_16x16x4_f32 v[216:219], v20, v99, v[216:219]
    v_cvt_f32_u32 v14, v14
    v_mul_f32 v14, 0.015625, v14
    v_mfma_f32_16x16x4_f32 v[220:223], v20, v103, v[220:223]
    v_cos_f32 v16, v14
    v_sin_f32 v15, v14
    v_mfma_f32_16x16x4_f32 v[184:187], v21, v131, v[184:187]
    s_nop 0
    v_sub_f32 v17, 0, v15
    v_mfma_f32_16x16x4_f32 v[188:191], v21, v135, v[188:191]
    v_mov_b32 v18, v15
    v_mfma_f32_16x16x4_f32 v[216:219], v19, v131, v[216:219]
    v_mfma_f32_16x16x4_f32 v[220:223], v19, v135, v[220:223]
    s_nop 0
    v_mfma_f32_16x16x4_f32 v[160:163], v16, v104, v[160:163]
    v_add_u32 v14, 16, v1
    v_add_u32 v15, 16, v4
    v_mfma_f32_16x16x4_f32 v[164:167], v16, v108, v[164:167]
    v_mul_u32_u24 v14, v14, v15
    v_and_b32 v14, 63, v14
    v_mfma_f32_16x16x4_f32 v[192:195], v17, v104, v[192:195]
    v_cvt_f32_u32 v14, v14
    v_mul_f32 v14, 0.015625, v14
    v_mfma_f32_16x16x4_f32 v[196:199], v17, v108, v[196:199]
    v_cos_f32 v19, v14
    v_sin_f32 v15, v14
    v_mfma_f32_16x16x4_f32 v[160:163], v18, v136, v[160:163]
    s_nop 0
    v_sub_f32 v20, 0, v15
    v_mfma_f32_16x16x4_f32 v[164:167], v18, v140, v[164:167]
    v_mov_b32 v21, v15
    v_mfma_f32_16x16x4_f32 v[192:195], v16, v136, v[192:195]
    v_mfma_f32_16x16x4_f32 v[196:199], v16, v140, v[196:199]
    s_nop 0
    v_mfma_f32_16x16x4_f32 v[168:171], v19, v104, v[168:171]
    v_add_u32 v14, 32, v1
    v_add_u32 v15, 16, v4
    v_mfma_f32_16x16x4_f32 v[172:175], v19, v108, v[172:175]
    v_mul_u32_u24 v14, v14, v15
    v_and_b32 v14, 63, v14
    v_mfma_f32_16x16x4_f32 v[200:203], v20, v104, v[200:203]
    v_cvt_f32_u32 v14, v14
    v_mul_f32 v14, 0.015625, v14
    v_mfma_f32_16x16x4_f32 v[204:207], v20, v108, v[204:207]
    v_cos_f32 v16, v14
    v_sin_f32 v15, v14
    v_mfma_f32_16x16x4_f32 v[168:171], v21, v136, v[168:171]
    s_nop 0
    v_sub_f32 v17, 0, v15
    v_mfma_f32_16x16x4_f32 v[172:175], v21, v140, v[172:175]
    v_mov_b32 v18, v15
    v_mfma_f32_16x16x4_f32 v[200:203], v19, v136, v[200:203]
    v_mfma_f32_16x16x4_f32 v[204:207], v19, v140, v[204:207]
    s_nop 0
    v_mfma_f32_16x16x4_f32 v[176:179], v16, v104, v[176:179]
    v_add_u32 v14, 48, v1
    v_add_u32 v15, 16, v4
    v_mfma_f32_16x16x4_f32 v[180:183], v16, v108, v[180:183]
    v_mul_u32_u24 v14, v14, v15
    v_and_b32 v14, 63, v14
    v_mfma_f32_16x16x4_f32 v[208:211], v17, v104, v[208:211]
    v_cvt_f32_u32 v14, v14
    v_mul_f32 v14, 0.015625, v14
    v_mfma_f32_16x16x4_f32 v[212:215], v17, v108, v[212:215]
    v_cos_f32 v19, v14
    v_sin_f32 v15, v14
    v_mfma_f32_16x16x4_f32 v[176:179], v18, v136, v[176:179]
    s_nop 0
    v_sub_f32 v20, 0, v15
    v_mfma_f32_16x16x4_f32 v[180:183], v18, v140, v[180:183]
    v_mov_b32 v21, v15
    v_mfma_f32_16x16x4_f32 v[208:211], v16, v136, v[208:211]
    v_mfma_f32_16x16x4_f32 v[212:215], v16, v140, v[212:215]
    s_nop 0
    v_mfma_f32_16x16x4_f32 v[184:187], v19, v104, v[184:187]
    v_add_u32 v14, 0, v1
    v_add_u32 v15, 17, v4
    v_mfma_f32_16x16x4_f32 v[188:191], v19, v108, v[188:191]
    v_mul_u32_u24 v14, v14, v15
    v_and_b32 v14, 63, v14
    v_mfma_f32_16x16x4_f32 v[216:219], v20, v104, v[216:219]
    v_cvt_f32_u32 v14, v14
    v_mul_f32 v14, 0.015625, v14
    v_mfma_f32_16x16x4_f32 v[220:223], v20, v108, v[220:223]
    v_cos_f32 v16, v14
    v_sin_f32 v15, v14
    v_mfma_f32_16x16x4_f32 v[184:187], v21, v136, v[184:187]
    s_nop 0
    v_sub_f32 v17, 0, v15
    v_mfma_f32_16x16x4_f32 v[188:191], v21, v140, v[188:191]
    v_mov_b32 v18, v15
    v_mfma_f32_16x16x4_f32 v[216:219], v19, v136, v[216:219]
    v_mfma_f32_16x16x4_f32 v[220:223], v19, v140, v[220:223]
    s_nop 0
    v_mfma_f32_16x16x4_f32 v[160:163], v16, v105, v[160:163]
    v_add_u32 v14, 16, v1
    v_add_u32 v15, 17, v4
    v_mfma_f32_16x16x4_f32 v[164:167], v16, v109, v[164:167]
    v_mul_u32_u24 v14, v14, v15
    v_and_b32 v14, 63, v14
    v_mfma_f32_16x16x4_f32 v[192:195], v17, v105, v[192:195]
    v_cvt_f32_u32 v14, v14
    v_mul_f32 v14, 0.015625, v14
    v_mfma_f32_16x16x4_f32 v[196:199], v17, v109, v[196:199]
    v_cos_f32 v19, v14
    v_sin_f32 v15, v14
    v_mfma_f32_16x16x4_f32 v[160:163], v18, v137, v[160:163]
    s_nop 0
    v_sub_f32 v20, 0, v15
    v_mfma_f32_16x16x4_f32 v[164:167], v18, v141, v[164:167]
    v_mov_b32 v21, v15
    v_mfma_f32_16x16x4_f32 v[192:195], v16, v137, v[192:195]
    v_mfma_f32_16x16x4_f32 v[196:199], v16, v141, v[196:199]
    s_nop 0
    v_mfma_f32_16x16x4_f32 v[168:171], v19, v105, v[168:171]
    v_add_u32 v14, 32, v1
    v_add_u32 v15, 17, v4
    v_mfma_f32_16x16x4_f32 v[172:175], v19, v109, v[172:175]
    v_mul_u32_u24 v14, v14, v15
    v_and_b32 v14, 63, v14
    v_mfma_f32_16x16x4_f32 v[200:203], v20, v105, v[200:203]
    v_cvt_f32_u32 v14, v14
    v_mul_f32 v14, 0.015625, v14
    v_mfma_f32_16x16x4_f32 v[204:207], v20, v109, v[204:207]
    v_cos_f32 v16, v14
    v_sin_f32 v15, v14
    v_mfma_f32_16x16x4_f32 v[168:171], v21, v137, v[168:171]
    s_nop 0
    v_sub_f32 v17, 0, v15
    v_mfma_f32_16x16x4_f32 v[172:175], v21, v141, v[172:175]
    v_mov_b32 v18, v15
    v_mfma_f32_16x16x4_f32 v[200:203], v19, v137, v[200:203]
    v_mfma_f32_16x16x4_f32 v[204:207], v19, v141, v[204:207]
    s_nop 0
    v_mfma_f32_16x16x4_f32 v[176:179], v16, v105, v[176:179]
    v_add_u32 v14, 48, v1
    v_add_u32 v15, 17, v4
    v_mfma_f32_16x16x4_f32 v[180:183], v16, v109, v[180:183]
    v_mul_u32_u24 v14, v14, v15
    v_and_b32 v14, 63, v14
    v_mfma_f32_16x16x4_f32 v[208:211], v17, v105, v[208:211]
    v_cvt_f32_u32 v14, v14
    v_mul_f32 v14, 0.015625, v14
    v_mfma_f32_16x16x4_f32 v[212:215], v17, v109, v[212:215]
    v_cos_f32 v19, v14
    v_sin_f32 v15, v14
    v_mfma_f32_16x16x4_f32 v[176:179], v18, v137, v[176:179]
    s_nop 0
    v_sub_f32 v20, 0, v15
    v_mfma_f32_16x16x4_f32 v[180:183], v18, v141, v[180:183]
    v_mov_b32 v21, v15
    v_mfma_f32_16x16x4_f32 v[208:211], v16, v137, v[208:211]
    v_mfma_f32_16x16x4_f32 v[212:215], v16, v141, v[212:215]
    s_nop 0
    v_mfma_f32_16x16x4_f32 v[184:187], v19, v105, v[184:187]
    v_add_u32 v14, 0, v1
    v_add_u32 v15, 18, v4
    v_mfma_f32_16x16x4_f32 v[188:191], v19, v109, v[188:191]
    v_mul_u32_u24 v14, v14, v15
    v_and_b32 v14, 63, v14
    v_mfma_f32_16x16x4_f32 v[216:219], v20, v105, v[216:219]
    v_cvt_f32_u32 v14, v14
    v_mul_f32 v14, 0.015625, v14
    v_mfma_f32_16x16x4_f32 v[220:223], v20, v109, v[220:223]
    v_cos_f32 v16, v14
    v_sin_f32 v15, v14
    v_mfma_f32_16x16x4_f32 v[184:187], v21, v137, v[184:187]
    s_nop 0
    v_sub_f32 v17, 0, v15
    v_mfma_f32_16x16x4_f32 v[188:191], v21, v141, v[188:191]
    v_mov_b32 v18, v15
    v_mfma_f32_16x16x4_f32 v[216:219], v19, v137, v[216:219]
    v_mfma_f32_16x16x4_f32 v[220:223], v19, v141, v[220:223]
    s_nop 0
    v_mfma_f32_16x16x4_f32 v[160:163], v16, v106, v[160:163]
    v_add_u32 v14, 16, v1
    v_add_u32 v15, 18, v4
    v_mfma_f32_16x16x4_f32 v[164:167], v16, v110, v[164:167]
    v_mul_u32_u24 v14, v14, v15
    v_and_b32 v14, 63, v14
    v_mfma_f32_16x16x4_f32 v[192:195], v17, v106, v[192:195]
    v_cvt_f32_u32 v14, v14
    v_mul_f32 v14, 0.015625, v14
    v_mfma_f32_16x16x4_f32 v[196:199], v17, v110, v[196:199]
    v_cos_f32 v19, v14
    v_sin_f32 v15, v14
    v_mfma_f32_16x16x4_f32 v[160:163], v18, v138, v[160:163]
    s_nop 0
    v_sub_f32 v20, 0, v15
    v_mfma_f32_16x16x4_f32 v[164:167], v18, v142, v[164:167]
    v_mov_b32 v21, v15
    v_mfma_f32_16x16x4_f32 v[192:195], v16, v138, v[192:195]
    v_mfma_f32_16x16x4_f32 v[196:199], v16, v142, v[196:199]
    s_nop 0
    v_mfma_f32_16x16x4_f32 v[168:171], v19, v106, v[168:171]
    v_add_u32 v14, 32, v1
    v_add_u32 v15, 18, v4
    v_mfma_f32_16x16x4_f32 v[172:175], v19, v110, v[172:175]
    v_mul_u32_u24 v14, v14, v15
    v_and_b32 v14, 63, v14
    v_mfma_f32_16x16x4_f32 v[200:203], v20, v106, v[200:203]
    v_cvt_f32_u32 v14, v14
    v_mul_f32 v14, 0.015625, v14
    v_mfma_f32_16x16x4_f32 v[204:207], v20, v110, v[204:207]
    v_cos_f32 v16, v14
    v_sin_f32 v15, v14
    v_mfma_f32_16x16x4_f32 v[168:171], v21, v138, v[168:171]
    s_nop 0
    v_sub_f32 v17, 0, v15
    v_mfma_f32_16x16x4_f32 v[172:175], v21, v142, v[172:175]
    v_mov_b32 v18, v15
    v_mfma_f32_16x16x4_f32 v[200:203], v19, v138, v[200:203]
    v_mfma_f32_16x16x4_f32 v[204:207], v19, v142, v[204:207]
    s_nop 0
    v_mfma_f32_16x16x4_f32 v[176:179], v16, v106, v[176:179]
    v_add_u32 v14, 48, v1
    v_add_u32 v15, 18, v4
    v_mfma_f32_16x16x4_f32 v[180:183], v16, v110, v[180:183]
    v_mul_u32_u24 v14, v14, v15
    v_and_b32 v14, 63, v14
    v_mfma_f32_16x16x4_f32 v[208:211], v17, v106, v[208:211]
    v_cvt_f32_u32 v14, v14
    v_mul_f32 v14, 0.015625, v14
    v_mfma_f32_16x16x4_f32 v[212:215], v17, v110, v[212:215]
    v_cos_f32 v19, v14
    v_sin_f32 v15, v14
    v_mfma_f32_16x16x4_f32 v[176:179], v18, v138, v[176:179]
    s_nop 0
    v_sub_f32 v20, 0, v15
    v_mfma_f32_16x16x4_f32 v[180:183], v18, v142, v[180:183]
    v_mov_b32 v21, v15
    v_mfma_f32_16x16x4_f32 v[208:211], v16, v138, v[208:211]
    v_mfma_f32_16x16x4_f32 v[212:215], v16, v142, v[212:215]
    s_nop 0
    v_mfma_f32_16x16x4_f32 v[184:187], v19, v106, v[184:187]
    v_add_u32 v14, 0, v1
    v_add_u32 v15, 19, v4
    v_mfma_f32_16x16x4_f32 v[188:191], v19, v110, v[188:191]
    v_mul_u32_u24 v14, v14, v15
    v_and_b32 v14, 63, v14
    v_mfma_f32_16x16x4_f32 v[216:219], v20, v106, v[216:219]
    v_cvt_f32_u32 v14, v14
    v_mul_f32 v14, 0.015625, v14
    v_mfma_f32_16x16x4_f32 v[220:223], v20, v110, v[220:223]
    v_cos_f32 v16, v14
    v_sin_f32 v15, v14
    v_mfma_f32_16x16x4_f32 v[184:187], v21, v138, v[184:187]
    s_nop 0
    v_sub_f32 v17, 0, v15
    v_mfma_f32_16x16x4_f32 v[188:191], v21, v142, v[188:191]
    v_mov_b32 v18, v15
    v_mfma_f32_16x16x4_f32 v[216:219], v19, v138, v[216:219]
    v_mfma_f32_16x16x4_f32 v[220:223], v19, v142, v[220:223]
    s_nop 0
    v_mfma_f32_16x16x4_f32 v[160:163], v16, v107, v[160:163]
    v_add_u32 v14, 16, v1
    v_add_u32 v15, 19, v4
    v_mfma_f32_16x16x4_f32 v[164:167], v16, v111, v[164:167]
    v_mul_u32_u24 v14, v14, v15
    v_and_b32 v14, 63, v14
    v_mfma_f32_16x16x4_f32 v[192:195], v17, v107, v[192:195]
    v_cvt_f32_u32 v14, v14
    v_mul_f32 v14, 0.015625, v14
    v_mfma_f32_16x16x4_f32 v[196:199], v17, v111, v[196:199]
    v_cos_f32 v19, v14
    v_sin_f32 v15, v14
    v_mfma_f32_16x16x4_f32 v[160:163], v18, v139, v[160:163]
    s_nop 0
    v_sub_f32 v20, 0, v15
    v_mfma_f32_16x16x4_f32 v[164:167], v18, v143, v[164:167]
    v_mov_b32 v21, v15
    v_mfma_f32_16x16x4_f32 v[192:195], v16, v139, v[192:195]
    v_mfma_f32_16x16x4_f32 v[196:199], v16, v143, v[196:199]
    s_nop 0
    v_mfma_f32_16x16x4_f32 v[168:171], v19, v107, v[168:171]
    v_add_u32 v14, 32, v1
    v_add_u32 v15, 19, v4
    v_mfma_f32_16x16x4_f32 v[172:175], v19, v111, v[172:175]
    v_mul_u32_u24 v14, v14, v15
    v_and_b32 v14, 63, v14
    v_mfma_f32_16x16x4_f32 v[200:203], v20, v107, v[200:203]
    v_cvt_f32_u32 v14, v14
    v_mul_f32 v14, 0.015625, v14
    v_mfma_f32_16x16x4_f32 v[204:207], v20, v111, v[204:207]
    v_cos_f32 v16, v14
    v_sin_f32 v15, v14
    v_mfma_f32_16x16x4_f32 v[168:171], v21, v139, v[168:171]
    s_nop 0
    v_sub_f32 v17, 0, v15
    v_mfma_f32_16x16x4_f32 v[172:175], v21, v143, v[172:175]
    v_mov_b32 v18, v15
    v_mfma_f32_16x16x4_f32 v[200:203], v19, v139, v[200:203]
    v_mfma_f32_16x16x4_f32 v[204:207], v19, v143, v[204:207]
    s_nop 0
    v_mfma_f32_16x16x4_f32 v[176:179], v16, v107, v[176:179]
    v_add_u32 v14, 48, v1
    v_add_u32 v15, 19, v4
    v_mfma_f32_16x16x4_f32 v[180:183], v16, v111, v[180:183]
    v_mul_u32_u24 v14, v14, v15
    v_and_b32 v14, 63, v14
    v_mfma_f32_16x16x4_f32 v[208:211], v17, v107, v[208:211]
    v_cvt_f32_u32 v14, v14
    v_mul_f32 v14, 0.015625, v14
    v_mfma_f32_16x16x4_f32 v[212:215], v17, v111, v[212:215]
    v_cos_f32 v19, v14
    v_sin_f32 v15, v14
    v_mfma_f32_16x16x4_f32 v[176:179], v18, v139, v[176:179]
    s_nop 0
    v_sub_f32 v20, 0, v15
    v_mfma_f32_16x16x4_f32 v[180:183], v18, v143, v[180:183]
    v_mov_b32 v21, v15
    v_mfma_f32_16x16x4_f32 v[208:211], v16, v139, v[208:211]
    v_mfma_f32_16x16x4_f32 v[212:215], v16, v143, v[212:215]
    s_nop 0
    v_mfma_f32_16x16x4_f32 v[184:187], v19, v107, v[184:187]
    v_add_u32 v14, 0, v1
    v_add_u32 v15, 32, v4
    v_mfma_f32_16x16x4_f32 v[188:191], v19, v111, v[188:191]
    v_mul_u32_u24 v14, v14, v15
    v_and_b32 v14, 63, v14
    v_mfma_f32_16x16x4_f32 v[216:219], v20, v107, v[216:219]
    v_cvt_f32_u32 v14, v14
    v_mul_f32 v14, 0.015625, v14
    v_mfma_f32_16x16x4_f32 v[220:223], v20, v111, v[220:223]
    v_cos_f32 v16, v14
    v_sin_f32 v15, v14
    v_mfma_f32_16x16x4_f32 v[184:187], v21, v139, v[184:187]
    s_nop 0
    v_sub_f32 v17, 0, v15
    v_mfma_f32_16x16x4_f32 v[188:191], v21, v143, v[188:191]
    v_mov_b32 v18, v15
    v_mfma_f32_16x16x4_f32 v[216:219], v19, v139, v[216:219]
    v_mfma_f32_16x16x4_f32 v[220:223], v19, v143, v[220:223]
    s_nop 0
    v_mfma_f32_16x16x4_f32 v[160:163], v16, v112, v[160:163]
    v_add_u32 v14, 16, v1
    v_add_u32 v15, 32, v4
    v_mfma_f32_16x16x4_f32 v[164:167], v16, v116, v[164:167]
    v_mul_u32_u24 v14, v14, v15
    v_and_b32 v14, 63, v14
    v_mfma_f32_16x16x4_f32 v[192:195], v17, v112, v[192:195]
    v_cvt_f32_u32 v14, v14
    v_mul_f32 v14, 0.015625, v14
    v_mfma_f32_16x16x4_f32 v[196:199], v17, v116, v[196:199]
    v_cos_f32 v19, v14
    v_sin_f32 v15, v14
    v_mfma_f32_16x16x4_f32 v[160:163], v18, v144, v[160:163]
    s_nop 0
    v_sub_f32 v20, 0, v15
    v_mfma_f32_16x16x4_f32 v[164:167], v18, v148, v[164:167]
    v_mov_b32 v21, v15
    v_mfma_f32_16x16x4_f32 v[192:195], v16, v144, v[192:195]
    v_mfma_f32_16x16x4_f32 v[196:199], v16, v148, v[196:199]
    s_nop 0
    v_mfma_f32_16x16x4_f32 v[168:171], v19, v112, v[168:171]
    v_add_u32 v14, 32, v1
    v_add_u32 v15, 32, v4
    v_mfma_f32_16x16x4_f32 v[172:175], v19, v116, v[172:175]
    v_mul_u32_u24 v14, v14, v15
    v_and_b32 v14, 63, v14
    v_mfma_f32_16x16x4_f32 v[200:203], v20, v112, v[200:203]
    v_cvt_f32_u32 v14, v14
    v_mul_f32 v14, 0.015625, v14
    v_mfma_f32_16x16x4_f32 v[204:207], v20, v116, v[204:207]
    v_cos_f32 v16, v14
    v_sin_f32 v15, v14
    v_mfma_f32_16x16x4_f32 v[168:171], v21, v144, v[168:171]
    s_nop 0
    v_sub_f32 v17, 0, v15
    v_mfma_f32_16x16x4_f32 v[172:175], v21, v148, v[172:175]
    v_mov_b32 v18, v15
    v_mfma_f32_16x16x4_f32 v[200:203], v19, v144, v[200:203]
    v_mfma_f32_16x16x4_f32 v[204:207], v19, v148, v[204:207]
    s_nop 0
    v_mfma_f32_16x16x4_f32 v[176:179], v16, v112, v[176:179]
    v_add_u32 v14, 48, v1
    v_add_u32 v15, 32, v4
    v_mfma_f32_16x16x4_f32 v[180:183], v16, v116, v[180:183]
    v_mul_u32_u24 v14, v14, v15
    v_and_b32 v14, 63, v14
    v_mfma_f32_16x16x4_f32 v[208:211], v17, v112, v[208:211]
    v_cvt_f32_u32 v14, v14
    v_mul_f32 v14, 0.015625, v14
    v_mfma_f32_16x16x4_f32 v[212:215], v17, v116, v[212:215]
    v_cos_f32 v19, v14
    v_sin_f32 v15, v14
    v_mfma_f32_16x16x4_f32 v[176:179], v18, v144, v[176:179]
    s_nop 0
    v_sub_f32 v20, 0, v15
    v_mfma_f32_16x16x4_f32 v[180:183], v18, v148, v[180:183]
    v_mov_b32 v21, v15
    v_mfma_f32_16x16x4_f32 v[208:211], v16, v144, v[208:211]
    v_mfma_f32_16x16x4_f32 v[212:215], v16, v148, v[212:215]
    s_nop 0
    v_mfma_f32_16x16x4_f32 v[184:187], v19, v112, v[184:187]
    v_add_u32 v14, 0, v1
    v_add_u32 v15, 33, v4
    v_mfma_f32_16x16x4_f32 v[188:191], v19, v116, v[188:191]
    v_mul_u32_u24 v14, v14, v15
    v_and_b32 v14, 63, v14
    v_mfma_f32_16x16x4_f32 v[216:219], v20, v112, v[216:219]
    v_cvt_f32_u32 v14, v14
    v_mul_f32 v14, 0.015625, v14
    v_mfma_f32_16x16x4_f32 v[220:223], v20, v116, v[220:223]
    v_cos_f32 v16, v14
    v_sin_f32 v15, v14
    v_mfma_f32_16x16x4_f32 v[184:187], v21, v144, v[184:187]
    s_nop 0
    v_sub_f32 v17, 0, v15
    v_mfma_f32_16x16x4_f32 v[188:191], v21, v148, v[188:191]
    v_mov_b32 v18, v15
    v_mfma_f32_16x16x4_f32 v[216:219], v19, v144, v[216:219]
    v_mfma_f32_16x16x4_f32 v[220:223], v19, v148, v[220:223]
    s_nop 0
    v_mfma_f32_16x16x4_f32 v[160:163], v16, v113, v[160:163]
    v_add_u32 v14, 16, v1
    v_add_u32 v15, 33, v4
    v_mfma_f32_16x16x4_f32 v[164:167], v16, v117, v[164:167]
    v_mul_u32_u24 v14, v14, v15
    v_and_b32 v14, 63, v14
    v_mfma_f32_16x16x4_f32 v[192:195], v17, v113, v[192:195]
    v_cvt_f32_u32 v14, v14
    v_mul_f32 v14, 0.015625, v14
    v_mfma_f32_16x16x4_f32 v[196:199], v17, v117, v[196:199]
    v_cos_f32 v19, v14
    v_sin_f32 v15, v14
    v_mfma_f32_16x16x4_f32 v[160:163], v18, v145, v[160:163]
    s_nop 0
    v_sub_f32 v20, 0, v15
    v_mfma_f32_16x16x4_f32 v[164:167], v18, v149, v[164:167]
    v_mov_b32 v21, v15
    v_mfma_f32_16x16x4_f32 v[192:195], v16, v145, v[192:195]
    v_mfma_f32_16x16x4_f32 v[196:199], v16, v149, v[196:199]
    s_nop 0
    v_mfma_f32_16x16x4_f32 v[168:171], v19, v113, v[168:171]
    v_add_u32 v14, 32, v1
    v_add_u32 v15, 33, v4
    v_mfma_f32_16x16x4_f32 v[172:175], v19, v117, v[172:175]
    v_mul_u32_u24 v14, v14, v15
    v_and_b32 v14, 63, v14
    v_mfma_f32_16x16x4_f32 v[200:203], v20, v113, v[200:203]
    v_cvt_f32_u32 v14, v14
    v_mul_f32 v14, 0.015625, v14
    v_mfma_f32_16x16x4_f32 v[204:207], v20, v117, v[204:207]
    v_cos_f32 v16, v14
    v_sin_f32 v15, v14
    v_mfma_f32_16x16x4_f32 v[168:171], v21, v145, v[168:171]
    s_nop 0
    v_sub_f32 v17, 0, v15
    v_mfma_f32_16x16x4_f32 v[172:175], v21, v149, v[172:175]
    v_mov_b32 v18, v15
    v_mfma_f32_16x16x4_f32 v[200:203], v19, v145, v[200:203]
    v_mfma_f32_16x16x4_f32 v[204:207], v19, v149, v[204:207]
    s_nop 0
    v_mfma_f32_16x16x4_f32 v[176:179], v16, v113, v[176:179]
    v_add_u32 v14, 48, v1
    v_add_u32 v15, 33, v4
    v_mfma_f32_16x16x4_f32 v[180:183], v16, v117, v[180:183]
    v_mul_u32_u24 v14, v14, v15
    v_and_b32 v14, 63, v14
    v_mfma_f32_16x16x4_f32 v[208:211], v17, v113, v[208:211]
    v_cvt_f32_u32 v14, v14
    v_mul_f32 v14, 0.015625, v14
    v_mfma_f32_16x16x4_f32 v[212:215], v17, v117, v[212:215]
    v_cos_f32 v19, v14
    v_sin_f32 v15, v14
    v_mfma_f32_16x16x4_f32 v[176:179], v18, v145, v[176:179]
    s_nop 0
    v_sub_f32 v20, 0, v15
    v_mfma_f32_16x16x4_f32 v[180:183], v18, v149, v[180:183]
    v_mov_b32 v21, v15
    v_mfma_f32_16x16x4_f32 v[208:211], v16, v145, v[208:211]
    v_mfma_f32_16x16x4_f32 v[212:215], v16, v149, v[212:215]
    s_nop 0
    v_mfma_f32_16x16x4_f32 v[184:187], v19, v113, v[184:187]
    v_add_u32 v14, 0, v1
    v_add_u32 v15, 34, v4
    v_mfma_f32_16x16x4_f32 v[188:191], v19, v117, v[188:191]
    v_mul_u32_u24 v14, v14, v15
    v_and_b32 v14, 63, v14
    v_mfma_f32_16x16x4_f32 v[216:219], v20, v113, v[216:219]
    v_cvt_f32_u32 v14, v14
    v_mul_f32 v14, 0.015625, v14
    v_mfma_f32_16x16x4_f32 v[220:223], v20, v117, v[220:223]
    v_cos_f32 v16, v14
    v_sin_f32 v15, v14
    v_mfma_f32_16x16x4_f32 v[184:187], v21, v145, v[184:187]
    s_nop 0
    v_sub_f32 v17, 0, v15
    v_mfma_f32_16x16x4_f32 v[188:191], v21, v149, v[188:191]
    v_mov_b32 v18, v15
    v_mfma_f32_16x16x4_f32 v[216:219], v19, v145, v[216:219]
    v_mfma_f32_16x16x4_f32 v[220:223], v19, v149, v[220:223]
    s_nop 0
    v_mfma_f32_16x16x4_f32 v[160:163], v16, v114, v[160:163]
    v_add_u32 v14, 16, v1
    v_add_u32 v15, 34, v4
    v_mfma_f32_16x16x4_f32 v[164:167], v16, v118, v[164:167]
    v_mul_u32_u24 v14, v14, v15
    v_and_b32 v14, 63, v14
    v_mfma_f32_16x16x4_f32 v[192:195], v17, v114, v[192:195]
    v_cvt_f32_u32 v14, v14
    v_mul_f32 v14, 0.015625, v14
    v_mfma_f32_16x16x4_f32 v[196:199], v17, v118, v[196:199]
    v_cos_f32 v19, v14
    v_sin_f32 v15, v14
    v_mfma_f32_16x16x4_f32 v[160:163], v18, v146, v[160:163]
    s_nop 0
    v_sub_f32 v20, 0, v15
    v_mfma_f32_16x16x4_f32 v[164:167], v18, v150, v[164:167]
    v_mov_b32 v21, v15
    v_mfma_f32_16x16x4_f32 v[192:195], v16, v146, v[192:195]
    v_mfma_f32_16x16x4_f32 v[196:199], v16, v150, v[196:199]
    s_nop 0
    v_mfma_f32_16x16x4_f32 v[168:171], v19, v114, v[168:171]
    v_add_u32 v14, 32, v1
    v_add_u32 v15, 34, v4
    v_mfma_f32_16x16x4_f32 v[172:175], v19, v118, v[172:175]
    v_mul_u32_u24 v14, v14, v15
    v_and_b32 v14, 63, v14
    v_mfma_f32_16x16x4_f32 v[200:203], v20, v114, v[200:203]
    v_cvt_f32_u32 v14, v14
    v_mul_f32 v14, 0.015625, v14
    v_mfma_f32_16x16x4_f32 v[204:207], v20, v118, v[204:207]
    v_cos_f32 v16, v14
    v_sin_f32 v15, v14
    v_mfma_f32_16x16x4_f32 v[168:171], v21, v146, v[168:171]
    s_nop 0
    v_sub_f32 v17, 0, v15
    v_mfma_f32_16x16x4_f32 v[172:175], v21, v150, v[172:175]
    v_mov_b32 v18, v15
    v_mfma_f32_16x16x4_f32 v[200:203], v19, v146, v[200:203]
    v_mfma_f32_16x16x4_f32 v[204:207], v19, v150, v[204:207]
    s_nop 0
    v_mfma_f32_16x16x4_f32 v[176:179], v16, v114, v[176:179]
    v_add_u32 v14, 48, v1
    v_add_u32 v15, 34, v4
    v_mfma_f32_16x16x4_f32 v[180:183], v16, v118, v[180:183]
    v_mul_u32_u24 v14, v14, v15
    v_and_b32 v14, 63, v14
    v_mfma_f32_16x16x4_f32 v[208:211], v17, v114, v[208:211]
    v_cvt_f32_u32 v14, v14
    v_mul_f32 v14, 0.015625, v14
    v_mfma_f32_16x16x4_f32 v[212:215], v17, v118, v[212:215]
    v_cos_f32 v19, v14
    v_sin_f32 v15, v14
    v_mfma_f32_16x16x4_f32 v[176:179], v18, v146, v[176:179]
    s_nop 0
    v_sub_f32 v20, 0, v15
    v_mfma_f32_16x16x4_f32 v[180:183], v18, v150, v[180:183]
    v_mov_b32 v21, v15
    v_mfma_f32_16x16x4_f32 v[208:211], v16, v146, v[208:211]
    v_mfma_f32_16x16x4_f32 v[212:215], v16, v150, v[212:215]
    s_nop 0
    v_mfma_f32_16x16x4_f32 v[184:187], v19, v114, v[184:187]
    v_add_u32 v14, 0, v1
    v_add_u32 v15, 35, v4
    v_mfma_f32_16x16x4_f32 v[188:191], v19, v118, v[188:191]
    v_mul_u32_u24 v14, v14, v15
    v_and_b32 v14, 63, v14
    v_mfma_f32_16x16x4_f32 v[216:219], v20, v114, v[216:219]
    v_cvt_f32_u32 v14, v14
    v_mul_f32 v14, 0.015625, v14
    v_mfma_f32_16x16x4_f32 v[220:223], v20, v118, v[220:223]
    v_cos_f32 v16, v14
    v_sin_f32 v15, v14
    v_mfma_f32_16x16x4_f32 v[184:187], v21, v146, v[184:187]
    s_nop 0
    v_sub_f32 v17, 0, v15
    v_mfma_f32_16x16x4_f32 v[188:191], v21, v150, v[188:191]
    v_mov_b32 v18, v15
    v_mfma_f32_16x16x4_f32 v[216:219], v19, v146, v[216:219]
    v_mfma_f32_16x16x4_f32 v[220:223], v19, v150, v[220:223]
    s_nop 0
    v_mfma_f32_16x16x4_f32 v[160:163], v16, v115, v[160:163]
    v_add_u32 v14, 16, v1
    v_add_u32 v15, 35, v4
    v_mfma_f32_16x16x4_f32 v[164:167], v16, v119, v[164:167]
    v_mul_u32_u24 v14, v14, v15
    v_and_b32 v14, 63, v14
    v_mfma_f32_16x16x4_f32 v[192:195], v17, v115, v[192:195]
    v_cvt_f32_u32 v14, v14
    v_mul_f32 v14, 0.015625, v14
    v_mfma_f32_16x16x4_f32 v[196:199], v17, v119, v[196:199]
    v_cos_f32 v19, v14
    v_sin_f32 v15, v14
    v_mfma_f32_16x16x4_f32 v[160:163], v18, v147, v[160:163]
    s_nop 0
    v_sub_f32 v20, 0, v15
    v_mfma_f32_16x16x4_f32 v[164:167], v18, v151, v[164:167]
    v_mov_b32 v21, v15
    v_mfma_f32_16x16x4_f32 v[192:195], v16, v147, v[192:195]
    v_mfma_f32_16x16x4_f32 v[196:199], v16, v151, v[196:199]
    s_nop 0
    v_mfma_f32_16x16x4_f32 v[168:171], v19, v115, v[168:171]
    v_add_u32 v14, 32, v1
    v_add_u32 v15, 35, v4
    v_mfma_f32_16x16x4_f32 v[172:175], v19, v119, v[172:175]
    v_mul_u32_u24 v14, v14, v15
    v_and_b32 v14, 63, v14
    v_mfma_f32_16x16x4_f32 v[200:203], v20, v115, v[200:203]
    v_cvt_f32_u32 v14, v14
    v_mul_f32 v14, 0.015625, v14
    v_mfma_f32_16x16x4_f32 v[204:207], v20, v119, v[204:207]
    v_cos_f32 v16, v14
    v_sin_f32 v15, v14
    v_mfma_f32_16x16x4_f32 v[168:171], v21, v147, v[168:171]
    s_nop 0
    v_sub_f32 v17, 0, v15
    v_mfma_f32_16x16x4_f32 v[172:175], v21, v151, v[172:175]
    v_mov_b32 v18, v15
    v_mfma_f32_16x16x4_f32 v[200:203], v19, v147, v[200:203]
    v_mfma_f32_16x16x4_f32 v[204:207], v19, v151, v[204:207]
    s_nop 0
    v_mfma_f32_16x16x4_f32 v[176:179], v16, v115, v[176:179]
    v_add_u32 v14, 48, v1
    v_add_u32 v15, 35, v4
    v_mfma_f32_16x16x4_f32 v[180:183], v16, v119, v[180:183]
    v_mul_u32_u24 v14, v14, v15
    v_and_b32 v14, 63, v14
    v_mfma_f32_16x16x4_f32 v[208:211], v17, v115, v[208:211]
    v_cvt_f32_u32 v14, v14
    v_mul_f32 v14, 0.015625, v14
    v_mfma_f32_16x16x4_f32 v[212:215], v17, v119, v[212:215]
    v_cos_f32 v19, v14
    v_sin_f32 v15, v14
    v_mfma_f32_16x16x4_f32 v[176:179], v18, v147, v[176:179]
    s_nop 0
    v_sub_f32 v20, 0, v15
    v_mfma_f32_16x16x4_f32 v[180:183], v18, v151, v[180:183]
    v_mov_b32 v21, v15
    v_mfma_f32_16x16x4_f32 v[208:211], v16, v147, v[208:211]
    v_mfma_f32_16x16x4_f32 v[212:215], v16, v151, v[212:215]
    s_nop 0
    v_mfma_f32_16x16x4_f32 v[184:187], v19, v115, v[184:187]
    v_add_u32 v14, 0, v1
    v_add_u32 v15, 48, v4
    v_mfma_f32_16x16x4_f32 v[188:191], v19, v119, v[188:191]
    v_mul_u32_u24 v14, v14, v15
    v_and_b32 v14, 63, v14
    v_mfma_f32_16x16x4_f32 v[216:219], v20, v115, v[216:219]
    v_cvt_f32_u32 v14, v14
    v_mul_f32 v14, 0.015625, v14
    v_mfma_f32_16x16x4_f32 v[220:223], v20, v119, v[220:223]
    v_cos_f32 v16, v14
    v_sin_f32 v15, v14
    v_mfma_f32_16x16x4_f32 v[184:187], v21, v147, v[184:187]
    s_nop 0
    v_sub_f32 v17, 0, v15
    v_mfma_f32_16x16x4_f32 v[188:191], v21, v151, v[188:191]
    v_mov_b32 v18, v15
    v_mfma_f32_16x16x4_f32 v[216:219], v19, v147, v[216:219]
    v_mfma_f32_16x16x4_f32 v[220:223], v19, v151, v[220:223]
    s_nop 0
    v_mfma_f32_16x16x4_f32 v[160:163], v16, v120, v[160:163]
    v_add_u32 v14, 16, v1
    v_add_u32 v15, 48, v4
    v_mfma_f32_16x16x4_f32 v[164:167], v16, v124, v[164:167]
    v_mul_u32_u24 v14, v14, v15
    v_and_b32 v14, 63, v14
    v_mfma_f32_16x16x4_f32 v[192:195], v17, v120, v[192:195]
    v_cvt_f32_u32 v14, v14
    v_mul_f32 v14, 0.015625, v14
    v_mfma_f32_16x16x4_f32 v[196:199], v17, v124, v[196:199]
    v_cos_f32 v19, v14
    v_sin_f32 v15, v14
    v_mfma_f32_16x16x4_f32 v[160:163], v18, v152, v[160:163]
    s_nop 0
    v_sub_f32 v20, 0, v15
    v_mfma_f32_16x16x4_f32 v[164:167], v18, v156, v[164:167]
    v_mov_b32 v21, v15
    v_mfma_f32_16x16x4_f32 v[192:195], v16, v152, v[192:195]
    v_mfma_f32_16x16x4_f32 v[196:199], v16, v156, v[196:199]
    s_nop 0
    v_mfma_f32_16x16x4_f32 v[168:171], v19, v120, v[168:171]
    v_add_u32 v14, 32, v1
    v_add_u32 v15, 48, v4
    v_mfma_f32_16x16x4_f32 v[172:175], v19, v124, v[172:175]
    v_mul_u32_u24 v14, v14, v15
    v_and_b32 v14, 63, v14
    v_mfma_f32_16x16x4_f32 v[200:203], v20, v120, v[200:203]
    v_cvt_f32_u32 v14, v14
    v_mul_f32 v14, 0.015625, v14
    v_mfma_f32_16x16x4_f32 v[204:207], v20, v124, v[204:207]
    v_cos_f32 v16, v14
    v_sin_f32 v15, v14
    v_mfma_f32_16x16x4_f32 v[168:171], v21, v152, v[168:171]
    s_nop 0
    v_sub_f32 v17, 0, v15
    v_mfma_f32_16x16x4_f32 v[172:175], v21, v156, v[172:175]
    v_mov_b32 v18, v15
    v_mfma_f32_16x16x4_f32 v[200:203], v19, v152, v[200:203]
    v_mfma_f32_16x16x4_f32 v[204:207], v19, v156, v[204:207]
    s_nop 0
    v_mfma_f32_16x16x4_f32 v[176:179], v16, v120, v[176:179]
    v_add_u32 v14, 48, v1
    v_add_u32 v15, 48, v4
    v_mfma_f32_16x16x4_f32 v[180:183], v16, v124, v[180:183]
    v_mul_u32_u24 v14, v14, v15
    v_and_b32 v14, 63, v14
    v_mfma_f32_16x16x4_f32 v[208:211], v17, v120, v[208:211]
    v_cvt_f32_u32 v14, v14
    v_mul_f32 v14, 0.015625, v14
    v_mfma_f32_16x16x4_f32 v[212:215], v17, v124, v[212:215]
    v_cos_f32 v19, v14
    v_sin_f32 v15, v14
    v_mfma_f32_16x16x4_f32 v[176:179], v18, v152, v[176:179]
    s_nop 0
    v_sub_f32 v20, 0, v15
    v_mfma_f32_16x16x4_f32 v[180:183], v18, v156, v[180:183]
    v_mov_b32 v21, v15
    v_mfma_f32_16x16x4_f32 v[208:211], v16, v152, v[208:211]
    v_mfma_f32_16x16x4_f32 v[212:215], v16, v156, v[212:215]
    s_nop 0
    v_mfma_f32_16x16x4_f32 v[184:187], v19, v120, v[184:187]
    v_add_u32 v14, 0, v1
    v_add_u32 v15, 49, v4
    v_mfma_f32_16x16x4_f32 v[188:191], v19, v124, v[188:191]
    v_mul_u32_u24 v14, v14, v15
    v_and_b32 v14, 63, v14
    v_mfma_f32_16x16x4_f32 v[216:219], v20, v120, v[216:219]
    v_cvt_f32_u32 v14, v14
    v_mul_f32 v14, 0.015625, v14
    v_mfma_f32_16x16x4_f32 v[220:223], v20, v124, v[220:223]
    v_cos_f32 v16, v14
    v_sin_f32 v15, v14
    v_mfma_f32_16x16x4_f32 v[184:187], v21, v152, v[184:187]
    s_nop 0
    v_sub_f32 v17, 0, v15
    v_mfma_f32_16x16x4_f32 v[188:191], v21, v156, v[188:191]
    v_mov_b32 v18, v15
    v_mfma_f32_16x16x4_f32 v[216:219], v19, v152, v[216:219]
    v_mfma_f32_16x16x4_f32 v[220:223], v19, v156, v[220:223]
    s_nop 0
    v_mfma_f32_16x16x4_f32 v[160:163], v16, v121, v[160:163]
    v_add_u32 v14, 16, v1
    v_add_u32 v15, 49, v4
    v_mfma_f32_16x16x4_f32 v[164:167], v16, v125, v[164:167]
    v_mul_u32_u24 v14, v14, v15
    v_and_b32 v14, 63, v14
    v_mfma_f32_16x16x4_f32 v[192:195], v17, v121, v[192:195]
    v_cvt_f32_u32 v14, v14
    v_mul_f32 v14, 0.015625, v14
    v_mfma_f32_16x16x4_f32 v[196:199], v17, v125, v[196:199]
    v_cos_f32 v19, v14
    v_sin_f32 v15, v14
    v_mfma_f32_16x16x4_f32 v[160:163], v18, v153, v[160:163]
    s_nop 0
    v_sub_f32 v20, 0, v15
    v_mfma_f32_16x16x4_f32 v[164:167], v18, v157, v[164:167]
    v_mov_b32 v21, v15
    v_mfma_f32_16x16x4_f32 v[192:195], v16, v153, v[192:195]
    v_mfma_f32_16x16x4_f32 v[196:199], v16, v157, v[196:199]
    s_nop 0
    v_mfma_f32_16x16x4_f32 v[168:171], v19, v121, v[168:171]
    v_add_u32 v14, 32, v1
    v_add_u32 v15, 49, v4
    v_mfma_f32_16x16x4_f32 v[172:175], v19, v125, v[172:175]
    v_mul_u32_u24 v14, v14, v15
    v_and_b32 v14, 63, v14
    v_mfma_f32_16x16x4_f32 v[200:203], v20, v121, v[200:203]
    v_cvt_f32_u32 v14, v14
    v_mul_f32 v14, 0.015625, v14
    v_mfma_f32_16x16x4_f32 v[204:207], v20, v125, v[204:207]
    v_cos_f32 v16, v14
    v_sin_f32 v15, v14
    v_mfma_f32_16x16x4_f32 v[168:171], v21, v153, v[168:171]
    s_nop 0
    v_sub_f32 v17, 0, v15
    v_mfma_f32_16x16x4_f32 v[172:175], v21, v157, v[172:175]
    v_mov_b32 v18, v15
    v_mfma_f32_16x16x4_f32 v[200:203], v19, v153, v[200:203]
    v_mfma_f32_16x16x4_f32 v[204:207], v19, v157, v[204:207]
    s_nop 0
    v_mfma_f32_16x16x4_f32 v[176:179], v16, v121, v[176:179]
    v_add_u32 v14, 48, v1
    v_add_u32 v15, 49, v4
    v_mfma_f32_16x16x4_f32 v[180:183], v16, v125, v[180:183]
    v_mul_u32_u24 v14, v14, v15
    v_and_b32 v14, 63, v14
    v_mfma_f32_16x16x4_f32 v[208:211], v17, v121, v[208:211]
    v_cvt_f32_u32 v14, v14
    v_mul_f32 v14, 0.015625, v14
    v_mfma_f32_16x16x4_f32 v[212:215], v17, v125, v[212:215]
    v_cos_f32 v19, v14
    v_sin_f32 v15, v14
    v_mfma_f32_16x16x4_f32 v[176:179], v18, v153, v[176:179]
    s_nop 0
    v_sub_f32 v20, 0, v15
    v_mfma_f32_16x16x4_f32 v[180:183], v18, v157, v[180:183]
    v_mov_b32 v21, v15
    v_mfma_f32_16x16x4_f32 v[208:211], v16, v153, v[208:211]
    v_mfma_f32_16x16x4_f32 v[212:215], v16, v157, v[212:215]
    s_nop 0
    v_mfma_f32_16x16x4_f32 v[184:187], v19, v121, v[184:187]
    v_add_u32 v14, 0, v1
    v_add_u32 v15, 50, v4
    v_mfma_f32_16x16x4_f32 v[188:191], v19, v125, v[188:191]
    v_mul_u32_u24 v14, v14, v15
    v_and_b32 v14, 63, v14
    v_mfma_f32_16x16x4_f32 v[216:219], v20, v121, v[216:219]
    v_cvt_f32_u32 v14, v14
    v_mul_f32 v14, 0.015625, v14
    v_mfma_f32_16x16x4_f32 v[220:223], v20, v125, v[220:223]
    v_cos_f32 v16, v14
    v_sin_f32 v15, v14
    v_mfma_f32_16x16x4_f32 v[184:187], v21, v153, v[184:187]
    s_nop 0
    v_sub_f32 v17, 0, v15
    v_mfma_f32_16x16x4_f32 v[188:191], v21, v157, v[188:191]
    v_mov_b32 v18, v15
    v_mfma_f32_16x16x4_f32 v[216:219], v19, v153, v[216:219]
    v_mfma_f32_16x16x4_f32 v[220:223], v19, v157, v[220:223]
    s_nop 0
    v_mfma_f32_16x16x4_f32 v[160:163], v16, v122, v[160:163]
    v_add_u32 v14, 16, v1
    v_add_u32 v15, 50, v4
    v_mfma_f32_16x16x4_f32 v[164:167], v16, v126, v[164:167]
    v_mul_u32_u24 v14, v14, v15
    v_and_b32 v14, 63, v14
    v_mfma_f32_16x16x4_f32 v[192:195], v17, v122, v[192:195]
    v_cvt_f32_u32 v14, v14
    v_mul_f32 v14, 0.015625, v14
    v_mfma_f32_16x16x4_f32 v[196:199], v17, v126, v[196:199]
    v_cos_f32 v19, v14
    v_sin_f32 v15, v14
    v_mfma_f32_16x16x4_f32 v[160:163], v18, v154, v[160:163]
    s_nop 0
    v_sub_f32 v20, 0, v15
    v_mfma_f32_16x16x4_f32 v[164:167], v18, v158, v[164:167]
    v_mov_b32 v21, v15
    v_mfma_f32_16x16x4_f32 v[192:195], v16, v154, v[192:195]
    v_mfma_f32_16x16x4_f32 v[196:199], v16, v158, v[196:199]
    s_nop 0
    v_mfma_f32_16x16x4_f32 v[168:171], v19, v122, v[168:171]
    v_add_u32 v14, 32, v1
    v_add_u32 v15, 50, v4
    v_mfma_f32_16x16x4_f32 v[172:175], v19, v126, v[172:175]
    v_mul_u32_u24 v14, v14, v15
    v_and_b32 v14, 63, v14
    v_mfma_f32_16x16x4_f32 v[200:203], v20, v122, v[200:203]
    v_cvt_f32_u32 v14, v14
    v_mul_f32 v14, 0.015625, v14
    v_mfma_f32_16x16x4_f32 v[204:207], v20, v126, v[204:207]
    v_cos_f32 v16, v14
    v_sin_f32 v15, v14
    v_mfma_f32_16x16x4_f32 v[168:171], v21, v154, v[168:171]
    s_nop 0
    v_sub_f32 v17, 0, v15
    v_mfma_f32_16x16x4_f32 v[172:175], v21, v158, v[172:175]
    v_mov_b32 v18, v15
    v_mfma_f32_16x16x4_f32 v[200:203], v19, v154, v[200:203]
    v_mfma_f32_16x16x4_f32 v[204:207], v19, v158, v[204:207]
    s_nop 0
    v_mfma_f32_16x16x4_f32 v[176:179], v16, v122, v[176:179]
    v_add_u32 v14, 48, v1
    v_add_u32 v15, 50, v4
    v_mfma_f32_16x16x4_f32 v[180:183], v16, v126, v[180:183]
    v_mul_u32_u24 v14, v14, v15
    v_and_b32 v14, 63, v14
    v_mfma_f32_16x16x4_f32 v[208:211], v17, v122, v[208:211]
    v_cvt_f32_u32 v14, v14
    v_mul_f32 v14, 0.015625, v14
    v_mfma_f32_16x16x4_f32 v[212:215], v17, v126, v[212:215]
    v_cos_f32 v19, v14
    v_sin_f32 v15, v14
    v_mfma_f32_16x16x4_f32 v[176:179], v18, v154, v[176:179]
    s_nop 0
    v_sub_f32 v20, 0, v15
    v_mfma_f32_16x16x4_f32 v[180:183], v18, v158, v[180:183]
    v_mov_b32 v21, v15
    v_mfma_f32_16x16x4_f32 v[208:211], v16, v154, v[208:211]
    v_mfma_f32_16x16x4_f32 v[212:215], v16, v158, v[212:215]
    s_nop 0
    v_mfma_f32_16x16x4_f32 v[184:187], v19, v122, v[184:187]
    v_add_u32 v14, 0, v1
    v_add_u32 v15, 51, v4
    v_mfma_f32_16x16x4_f32 v[188:191], v19, v126, v[188:191]
    v_mul_u32_u24 v14, v14, v15
    v_and_b32 v14, 63, v14
    v_mfma_f32_16x16x4_f32 v[216:219], v20, v122, v[216:219]
    v_cvt_f32_u32 v14, v14
    v_mul_f32 v14, 0.015625, v14
    v_mfma_f32_16x16x4_f32 v[220:223], v20, v126, v[220:223]
    v_cos_f32 v16, v14
    v_sin_f32 v15, v14
    v_mfma_f32_16x16x4_f32 v[184:187], v21, v154, v[184:187]
    s_nop 0
    v_sub_f32 v17, 0, v15
    v_mfma_f32_16x16x4_f32 v[188:191], v21, v158, v[188:191]
    v_mov_b32 v18, v15
    v_mfma_f32_16x16x4_f32 v[216:219], v19, v154, v[216:219]
    v_mfma_f32_16x16x4_f32 v[220:223], v19, v158, v[220:223]
    s_nop 0
    v_mfma_f32_16x16x4_f32 v[160:163], v16, v123, v[160:163]
    v_add_u32 v14, 16, v1
    v_add_u32 v15, 51, v4
    v_mfma_f32_16x16x4_f32 v[164:167], v16, v127, v[164:167]
    v_mul_u32_u24 v14, v14, v15
    v_and_b32 v14, 63, v14
    v_mfma_f32_16x16x4_f32 v[192:195], v17, v123, v[192:195]
    v_cvt_f32_u32 v14, v14
    v_mul_f32 v14, 0.015625, v14
    v_mfma_f32_16x16x4_f32 v[196:199], v17, v127, v[196:199]
    v_cos_f32 v19, v14
    v_sin_f32 v15, v14
    v_mfma_f32_16x16x4_f32 v[160:163], v18, v155, v[160:163]
    s_nop 0
    v_sub_f32 v20, 0, v15
    v_mfma_f32_16x16x4_f32 v[164:167], v18, v159, v[164:167]
    v_mov_b32 v21, v15
    v_mfma_f32_16x16x4_f32 v[192:195], v16, v155, v[192:195]
    v_mfma_f32_16x16x4_f32 v[196:199], v16, v159, v[196:199]
    s_nop 0
    v_mfma_f32_16x16x4_f32 v[168:171], v19, v123, v[168:171]
    v_add_u32 v14, 32, v1
    v_add_u32 v15, 51, v4
    v_mfma_f32_16x16x4_f32 v[172:175], v19, v127, v[172:175]
    v_mul_u32_u24 v14, v14, v15
    v_and_b32 v14, 63, v14
    v_mfma_f32_16x16x4_f32 v[200:203], v20, v123, v[200:203]
    v_cvt_f32_u32 v14, v14
    v_mul_f32 v14, 0.015625, v14
    v_mfma_f32_16x16x4_f32 v[204:207], v20, v127, v[204:207]
    v_cos_f32 v16, v14
    v_sin_f32 v15, v14
    v_mfma_f32_16x16x4_f32 v[168:171], v21, v155, v[168:171]
    s_nop 0
    v_sub_f32 v17, 0, v15
    v_mfma_f32_16x16x4_f32 v[172:175], v21, v159, v[172:175]
    v_mov_b32 v18, v15
    v_mfma_f32_16x16x4_f32 v[200:203], v19, v155, v[200:203]
    v_mfma_f32_16x16x4_f32 v[204:207], v19, v159, v[204:207]
    s_nop 0
    v_mfma_f32_16x16x4_f32 v[176:179], v16, v123, v[176:179]
    v_add_u32 v14, 48, v1
    v_add_u32 v15, 51, v4
    v_mfma_f32_16x16x4_f32 v[180:183], v16, v127, v[180:183]
    v_mul_u32_u24 v14, v14, v15
    v_and_b32 v14, 63, v14
    v_mfma_f32_16x16x4_f32 v[208:211], v17, v123, v[208:211]
    v_cvt_f32_u32 v14, v14
    v_mul_f32 v14, 0.015625, v14
    v_mfma_f32_16x16x4_f32 v[212:215], v17, v127, v[212:215]
    v_cos_f32 v19, v14
    v_sin_f32 v15, v14
    v_mfma_f32_16x16x4_f32 v[176:179], v18, v155, v[176:179]
    s_nop 0
    v_sub_f32 v20, 0, v15
    v_mfma_f32_16x16x4_f32 v[180:183], v18, v159, v[180:183]
    v_mov_b32 v21, v15
    v_mfma_f32_16x16x4_f32 v[208:211], v16, v155, v[208:211]
    v_mfma_f32_16x16x4_f32 v[212:215], v16, v159, v[212:215]
    s_nop 0
    v_mfma_f32_16x16x4_f32 v[184:187], v19, v123, v[184:187]
    v_mfma_f32_16x16x4_f32 v[188:191], v19, v127, v[188:191]
    v_mfma_f32_16x16x4_f32 v[216:219], v20, v123, v[216:219]
    v_mfma_f32_16x16x4_f32 v[220:223], v20, v127, v[220:223]
    v_mfma_f32_16x16x4_f32 v[184:187], v21, v155, v[184:187]
    v_mfma_f32_16x16x4_f32 v[188:191], v21, v159, v[188:191]
    v_mfma_f32_16x16x4_f32 v[216:219], v19, v155, v[216:219]
    v_mfma_f32_16x16x4_f32 v[220:223], v19, v159, v[220:223]
    s_waitcnt vmcnt(0)
    s_nop 9
    v_lshlrev_b32 v32, 16, v32
    v_lshlrev_b32 v64, 16, v64
    v_mul_f32 v10, v160, v32
    v_mul_f32 v11, v192, v32
    v_fma_f32 v10, -v192, v64, v10
    v_fma_f32 v192, v160, v64, v11
    v_mov_b32 v160, v10
    v_lshlrev_b32 v33, 16, v33
    v_lshlrev_b32 v65, 16, v65
    v_mul_f32 v10, v161, v33
    v_mul_f32 v11, v193, v33
    v_fma_f32 v10, -v193, v65, v10
    v_fma_f32 v193, v161, v65, v11
    v_mov_b32 v161, v10
    v_lshlrev_b32 v34, 16, v34
    v_lshlrev_b32 v66, 16, v66
    v_mul_f32 v10, v162, v34
    v_mul_f32 v11, v194, v34
    v_fma_f32 v10, -v194, v66, v10
    v_fma_f32 v194, v162, v66, v11
    v_mov_b32 v162, v10
    v_lshlrev_b32 v35, 16, v35
    v_lshlrev_b32 v67, 16, v67
    v_mul_f32 v10, v163, v35
    v_mul_f32 v11, v195, v35
    v_fma_f32 v10, -v195, v67, v10
    v_fma_f32 v195, v163, v67, v11
    v_mov_b32 v163, v10
    v_lshlrev_b32 v36, 16, v36
    v_lshlrev_b32 v68, 16, v68
    v_mul_f32 v10, v164, v36
    v_mul_f32 v11, v196, v36
    v_fma_f32 v10, -v196, v68, v10
    v_fma_f32 v196, v164, v68, v11
    v_mov_b32 v164, v10
    v_lshlrev_b32 v37, 16, v37
    v_lshlrev_b32 v69, 16, v69
    v_mul_f32 v10, v165, v37
    v_mul_f32 v11, v197, v37
    v_fma_f32 v10, -v197, v69, v10
    v_fma_f32 v197, v165, v69, v11
    v_mov_b32 v165, v10
    v_lshlrev_b32 v38, 16, v38
    v_lshlrev_b32 v70, 16, v70
    v_mul_f32 v10, v166, v38
    v_mul_f32 v11, v198, v38
    v_fma_f32 v10, -v198, v70, v10
    v_fma_f32 v198, v166, v70, v11
    v_mov_b32 v166, v10
    v_lshlrev_b32 v39, 16, v39
    v_lshlrev_b32 v71, 16, v71
    v_mul_f32 v10, v167, v39
    v_mul_f32 v11, v199, v39
    v_fma_f32 v10, -v199, v71, v10
    v_fma_f32 v199, v167, v71, v11
    v_mov_b32 v167, v10
    v_lshlrev_b32 v40, 16, v40
    v_lshlrev_b32 v72, 16, v72
    v_mul_f32 v10, v168, v40
    v_mul_f32 v11, v200, v40
    v_fma_f32 v10, -v200, v72, v10
    v_fma_f32 v200, v168, v72, v11
    v_mov_b32 v168, v10
    v_lshlrev_b32 v41, 16, v41
    v_lshlrev_b32 v73, 16, v73
    v_mul_f32 v10, v169, v41
    v_mul_f32 v11, v201, v41
    v_fma_f32 v10, -v201, v73, v10
    v_fma_f32 v201, v169, v73, v11
    v_mov_b32 v169, v10
    v_lshlrev_b32 v42, 16, v42
    v_lshlrev_b32 v74, 16, v74
    v_mul_f32 v10, v170, v42
    v_mul_f32 v11, v202, v42
    v_fma_f32 v10, -v202, v74, v10
    v_fma_f32 v202, v170, v74, v11
    v_mov_b32 v170, v10
    v_lshlrev_b32 v43, 16, v43
    v_lshlrev_b32 v75, 16, v75
    v_mul_f32 v10, v171, v43
    v_mul_f32 v11, v203, v43
    v_fma_f32 v10, -v203, v75, v10
    v_fma_f32 v203, v171, v75, v11
    v_mov_b32 v171, v10
    v_lshlrev_b32 v44, 16, v44
    v_lshlrev_b32 v76, 16, v76
    v_mul_f32 v10, v172, v44
    v_mul_f32 v11, v204, v44
    v_fma_f32 v10, -v204, v76, v10
    v_fma_f32 v204, v172, v76, v11
    v_mov_b32 v172, v10
    v_lshlrev_b32 v45, 16, v45
    v_lshlrev_b32 v77, 16, v77
    v_mul_f32 v10, v173, v45
    v_mul_f32 v11, v205, v45
    v_fma_f32 v10, -v205, v77, v10
    v_fma_f32 v205, v173, v77, v11
    v_mov_b32 v173, v10
    v_lshlrev_b32 v46, 16, v46
    v_lshlrev_b32 v78, 16, v78
    v_mul_f32 v10, v174, v46
    v_mul_f32 v11, v206, v46
    v_fma_f32 v10, -v206, v78, v10
    v_fma_f32 v206, v174, v78, v11
    v_mov_b32 v174, v10
    v_lshlrev_b32 v47, 16, v47
    v_lshlrev_b32 v79, 16, v79
    v_mul_f32 v10, v175, v47
    v_mul_f32 v11, v207, v47
    v_fma_f32 v10, -v207, v79, v10
    v_fma_f32 v207, v175, v79, v11
    v_mov_b32 v175, v10
    v_lshlrev_b32 v48, 16, v48
    v_lshlrev_b32 v80, 16, v80
    v_mul_f32 v10, v176, v48
    v_mul_f32 v11, v208, v48
    v_fma_f32 v10, -v208, v80, v10
    v_fma_f32 v208, v176, v80, v11
    v_mov_b32 v176, v10
    v_lshlrev_b32 v49, 16, v49
    v_lshlrev_b32 v81, 16, v81
    v_mul_f32 v10, v177, v49
    v_mul_f32 v11, v209, v49
    v_fma_f32 v10, -v209, v81, v10
    v_fma_f32 v209, v177, v81, v11
    v_mov_b32 v177, v10
    v_lshlrev_b32 v50, 16, v50
    v_lshlrev_b32 v82, 16, v82
    v_mul_f32 v10, v178, v50
    v_mul_f32 v11, v210, v50
    v_fma_f32 v10, -v210, v82, v10
    v_fma_f32 v210, v178, v82, v11
    v_mov_b32 v178, v10
    v_lshlrev_b32 v51, 16, v51
    v_lshlrev_b32 v83, 16, v83
    v_mul_f32 v10, v179, v51
    v_mul_f32 v11, v211, v51
    v_fma_f32 v10, -v211, v83, v10
    v_fma_f32 v211, v179, v83, v11
    v_mov_b32 v179, v10
    v_lshlrev_b32 v52, 16, v52
    v_lshlrev_b32 v84, 16, v84
    v_mul_f32 v10, v180, v52
    v_mul_f32 v11, v212, v52
    v_fma_f32 v10, -v212, v84, v10
    v_fma_f32 v212, v180, v84, v11
    v_mov_b32 v180, v10
    v_lshlrev_b32 v53, 16, v53
    v_lshlrev_b32 v85, 16, v85
    v_mul_f32 v10, v181, v53
    v_mul_f32 v11, v213, v53
    v_fma_f32 v10, -v213, v85, v10
    v_fma_f32 v213, v181, v85, v11
    v_mov_b32 v181, v10
    v_lshlrev_b32 v54, 16, v54
    v_lshlrev_b32 v86, 16, v86
    v_mul_f32 v10, v182, v54
    v_mul_f32 v11, v214, v54
    v_fma_f32 v10, -v214, v86, v10
    v_fma_f32 v214, v182, v86, v11
    v_mov_b32 v182, v10
    v_lshlrev_b32 v55, 16, v55
    v_lshlrev_b32 v87, 16, v87
    v_mul_f32 v10, v183, v55
    v_mul_f32 v11, v215, v55
    v_fma_f32 v10, -v215, v87, v10
    v_fma_f32 v215, v183, v87, v11
    v_mov_b32 v183, v10
    v_lshlrev_b32 v56, 16, v56
    v_lshlrev_b32 v88, 16, v88
    v_mul_f32 v10, v184, v56
    v_mul_f32 v11, v216, v56
    v_fma_f32 v10, -v216, v88, v10
    v_fma_f32 v216, v184, v88, v11
    v_mov_b32 v184, v10
    v_lshlrev_b32 v57, 16, v57
    v_lshlrev_b32 v89, 16, v89
    v_mul_f32 v10, v185, v57
    v_mul_f32 v11, v217, v57
    v_fma_f32 v10, -v217, v89, v10
    v_fma_f32 v217, v185, v89, v11
    v_mov_b32 v185, v10
    v_lshlrev_b32 v58, 16, v58
    v_lshlrev_b32 v90, 16, v90
    v_mul_f32 v10, v186, v58
    v_mul_f32 v11, v218, v58
    v_fma_f32 v10, -v218, v90, v10
    v_fma_f32 v218, v186, v90, v11
    v_mov_b32 v186, v10
    v_lshlrev_b32 v59, 16, v59
    v_lshlrev_b32 v91, 16, v91
    v_mul_f32 v10, v187, v59
    v_mul_f32 v11, v219, v59
    v_fma_f32 v10, -v219, v91, v10
    v_fma_f32 v219, v187, v91, v11
    v_mov_b32 v187, v10
    v_lshlrev_b32 v60, 16, v60
    v_lshlrev_b32 v92, 16, v92
    v_mul_f32 v10, v188, v60
    v_mul_f32 v11, v220, v60
    v_fma_f32 v10, -v220, v92, v10
    v_fma_f32 v220, v188, v92, v11
    v_mov_b32 v188, v10
    v_lshlrev_b32 v61, 16, v61
    v_lshlrev_b32 v93, 16, v93
    v_mul_f32 v10, v189, v61
    v_mul_f32 v11, v221, v61
    v_fma_f32 v10, -v221, v93, v10
    v_fma_f32 v221, v189, v93, v11
    v_mov_b32 v189, v10
    v_lshlrev_b32 v62, 16, v62
    v_lshlrev_b32 v94, 16, v94
    v_mul_f32 v10, v190, v62
    v_mul_f32 v11, v222, v62
    v_fma_f32 v10, -v222, v94, v10
    v_fma_f32 v222, v190, v94, v11
    v_mov_b32 v190, v10
    v_lshlrev_b32 v63, 16, v63
    v_lshlrev_b32 v95, 16, v95
    v_mul_f32 v10, v191, v63
    v_mul_f32 v11, v223, v63
    v_fma_f32 v10, -v223, v95, v10
    v_fma_f32 v223, v191, v95, v11
    v_mov_b32 v191, v10
    v_mov_b32 v96, 0
    v_mov_b32 v97, 0
    v_mov_b32 v98, 0
    v_mov_b32 v99, 0
    v_mov_b32 v100, 0
    v_mov_b32 v101, 0
    v_mov_b32 v102, 0
    v_mov_b32 v103, 0
    v_mov_b32 v104, 0
    v_mov_b32 v105, 0
    v_mov_b32 v106, 0
    v_mov_b32 v107, 0
    v_mov_b32 v108, 0
    v_mov_b32 v109, 0
    v_mov_b32 v110, 0
    v_mov_b32 v111, 0
    v_mov_b32 v112, 0
    v_mov_b32 v113, 0
    v_mov_b32 v114, 0
    v_mov_b32 v115, 0
    v_mov_b32 v116, 0
    v_mov_b32 v117, 0
    v_mov_b32 v118, 0
    v_mov_b32 v119, 0
    v_mov_b32 v120, 0
    v_mov_b32 v121, 0
    v_mov_b32 v122, 0
    v_mov_b32 v123, 0
    v_mov_b32 v124, 0
    v_mov_b32 v125, 0
    v_mov_b32 v126, 0
    v_mov_b32 v127, 0
    v_mov_b32 v128, 0
    v_mov_b32 v129, 0
    v_mov_b32 v130, 0
    v_mov_b32 v131, 0
    v_mov_b32 v132, 0
    v_mov_b32 v133, 0
    v_mov_b32 v134, 0
    v_mov_b32 v135, 0
    v_mov_b32 v136, 0
    v_mov_b32 v137, 0
    v_mov_b32 v138, 0
    v_mov_b32 v139, 0
    v_mov_b32 v140, 0
    v_mov_b32 v141, 0
    v_mov_b32 v142, 0
    v_mov_b32 v143, 0
    v_mov_b32 v144, 0
    v_mov_b32 v145, 0
    v_mov_b32 v146, 0
    v_mov_b32 v147, 0
    v_mov_b32 v148, 0
    v_mov_b32 v149, 0
    v_mov_b32 v150, 0
    v_mov_b32 v151, 0
    v_mov_b32 v152, 0
    v_mov_b32 v153, 0
    v_mov_b32 v154, 0
    v_mov_b32 v155, 0
    v_mov_b32 v156, 0
    v_mov_b32 v157, 0
    v_mov_b32 v158, 0
    v_mov_b32 v159, 0
    v_add_u32 v14, 0, v4
    v_add_u32 v15, 0, v1
    v_mul_u32_u24 v14, v14, v15
    v_and_b32 v14, 63, v14
    v_cvt_f32_u32 v14, v14
    v_mul_f32 v14, 0.015625, v14
    v_cos_f32 v16, v14
    v_sin_f32 v15, v14
    s_nop 0
    v_mov_b32 v17, v15
    v_sub_f32 v18, 0, v15
    s_nop 0
    v_mfma_f32_16x16x4_f32 v[96:99], v160, v16, v[96:99]
    v_add_u32 v14, 0, v4
    v_add_u32 v15, 16, v1
    v_mfma_f32_16x16x4_f32 v[112:115], v164, v16, v[112:115]
    v_mul_u32_u24 v14, v14, v15
    v_and_b32 v14, 63, v14
    v_mfma_f32_16x16x4_f32 v[128:131], v160, v17, v[128:131]
    v_cvt_f32_u32 v14, v14
    v_mul_f32 v14, 0.015625, v14
    v_mfma_f32_16x16x4_f32 v[144:147], v164, v17, v[144:147]
    v_cos_f32 v19, v14
    v_sin_f32 v15, v14
    v_mfma_f32_16x16x4_f32 v[96:99], v192, v18, v[96:99]
    s_nop 0
    v_mov_b32 v20, v15
    v_mfma_f32_16x16x4_f32 v[112:115], v196, v18, v[112:115]
    v_sub_f32 v21, 0, v15
    v_mfma_f32_16x16x4_f32 v[128:131], v192, v16, v[128:131]
    v_mfma_f32_16x16x4_f32 v[144:147], v196, v16, v[144:147]
    s_nop 0
    v_mfma_f32_16x16x4_f32 v[100:103], v160, v19, v[100:103]
    v_add_u32 v14, 0, v4
    v_add_u32 v15, 32, v1
    v_mfma_f32_16x16x4_f32 v[116:119], v164, v19, v[116:119]
    v_mul_u32_u24 v14, v14, v15
    v_and_b32 v14, 63, v14
    v_mfma_f32_16x16x4_f32 v[132:135], v160, v20, v[132:135]
    v_cvt_f32_u32 v14, v14
    v_mul_f32 v14, 0.015625, v14
    v_mfma_f32_16x16x4_f32 v[148:151], v164, v20, v[148:151]
    v_cos_f32 v16, v14
    v_sin_f32 v15, v14
    v_mfma_f32_16x16x4_f32 v[100:103], v192, v21, v[100:103]
    s_nop 0
    v_mov_b32 v17, v15
    v_mfma_f32_16x16x4_f32 v[116:119], v196, v21, v[116:119]
    v_sub_f32 v18, 0, v15
    v_mfma_f32_16x16x4_f32 v[132:135], v192, v19, v[132:135]
    v_mfma_f32_16x16x4_f32 v[148:151], v196, v19, v[148:151]
    s_nop 0
    v_mfma_f32_16x16x4_f32 v[104:107], v160, v16, v[104:107]
    v_add_u32 v14, 0, v4
    v_add_u32 v15, 48, v1
    v_mfma_f32_16x16x4_f32 v[120:123], v164, v16, v[120:123]
    v_mul_u32_u24 v14, v14, v15
    v_and_b32 v14, 63, v14
    v_mfma_f32_16x16x4_f32 v[136:139], v160, v17, v[136:139]
    v_cvt_f32_u32 v14, v14
    v_mul_f32 v14, 0.015625, v14
    v_mfma_f32_16x16x4_f32 v[152:155], v164, v17, v[152:155]
    v_cos_f32 v19, v14
    v_sin_f32 v15, v14
    v_mfma_f32_16x16x4_f32 v[104:107], v192, v18, v[104:107]
    s_nop 0
    v_mov_b32 v20, v15
    v_mfma_f32_16x16x4_f32 v[120:123], v196, v18, v[120:123]
    v_sub_f32 v21, 0, v15
    v_mfma_f32_16x16x4_f32 v[136:139], v192, v16, v[136:139]
    v_mfma_f32_16x16x4_f32 v[152:155], v196, v16, v[152:155]
    s_nop 0
    v_mfma_f32_16x16x4_f32 v[108:111], v160, v19, v[108:111]
    v_add_u32 v14, 1, v4
    v_add_u32 v15, 0, v1
    v_mfma_f32_16x16x4_f32 v[124:127], v164, v19, v[124:127]
    v_mul_u32_u24 v14, v14, v15
    v_and_b32 v14, 63, v14
    v_mfma_f32_16x16x4_f32 v[140:143], v160, v20, v[140:143]
    v_cvt_f32_u32 v14, v14
    v_mul_f32 v14, 0.015625, v14
    v_mfma_f32_16x16x4_f32 v[156:159], v164, v20, v[156:159]
    v_cos_f32 v16, v14
    v_sin_f32 v15, v14
    v_mfma_f32_16x16x4_f32 v[108:111], v192, v21, v[108:111]
    s_nop 0
    v_mov_b32 v17, v15
    v_mfma_f32_16x16x4_f32 v[124:127], v196, v21, v[124:127]
    v_sub_f32 v18, 0, v15
    v_mfma_f32_16x16x4_f32 v[140:143], v192, v19, v[140:143]
    v_mfma_f32_16x16x4_f32 v[156:159], v196, v19, v[156:159]
    s_nop 0
    v_mfma_f32_16x16x4_f32 v[96:99], v161, v16, v[96:99]
    v_add_u32 v14, 1, v4
    v_add_u32 v15, 16, v1
    v_mfma_f32_16x16x4_f32 v[112:115], v165, v16, v[112:115]
    v_mul_u32_u24 v14, v14, v15
    v_and_b32 v14, 63, v14
    v_mfma_f32_16x16x4_f32 v[128:131], v161, v17, v[128:131]
    v_cvt_f32_u32 v14, v14
    v_mul_f32 v14, 0.015625, v14
    v_mfma_f32_16x16x4_f32 v[144:147], v165, v17, v[144:147]
    v_cos_f32 v19, v14
    v_sin_f32 v15, v14
    v_mfma_f32_16x16x4_f32 v[96:99], v193, v18, v[96:99]
    s_nop 0
    v_mov_b32 v20, v15
    v_mfma_f32_16x16x4_f32 v[112:115], v197, v18, v[112:115]
    v_sub_f32 v21, 0, v15
    v_mfma_f32_16x16x4_f32 v[128:131], v193, v16, v[128:131]
    v_mfma_f32_16x16x4_f32 v[144:147], v197, v16, v[144:147]
    s_nop 0
    v_mfma_f32_16x16x4_f32 v[100:103], v161, v19, v[100:103]
    v_add_u32 v14, 1, v4
    v_add_u32 v15, 32, v1
    v_mfma_f32_16x16x4_f32 v[116:119], v165, v19, v[116:119]
    v_mul_u32_u24 v14, v14, v15
    v_and_b32 v14, 63, v14
    v_mfma_f32_16x16x4_f32 v[132:135], v161, v20, v[132:135]
    v_cvt_f32_u32 v14, v14
    v_mul_f32 v14, 0.015625, v14
    v_mfma_f32_16x16x4_f32 v[148:151], v165, v20, v[148:151]
    v_cos_f32 v16, v14
    v_sin_f32 v15, v14
    v_mfma_f32_16x16x4_f32 v[100:103], v193, v21, v[100:103]
    s_nop 0
    v_mov_b32 v17, v15
    v_mfma_f32_16x16x4_f32 v[116:119], v197, v21, v[116:119]
    v_sub_f32 v18, 0, v15
    v_mfma_f32_16x16x4_f32 v[132:135], v193, v19, v[132:135]
    v_mfma_f32_16x16x4_f32 v[148:151], v197, v19, v[148:151]
    s_nop 0
    v_mfma_f32_16x16x4_f32 v[104:107], v161, v16, v[104:107]
    v_add_u32 v14, 1, v4
    v_add_u32 v15, 48, v1
    v_mfma_f32_16x16x4_f32 v[120:123], v165, v16, v[120:123]
    v_mul_u32_u24 v14, v14, v15
    v_and_b32 v14, 63, v14
    v_mfma_f32_16x16x4_f32 v[136:139], v161, v17, v[136:139]
    v_cvt_f32_u32 v14, v14
    v_mul_f32 v14, 0.015625, v14
    v_mfma_f32_16x16x4_f32 v[152:155], v165, v17, v[152:155]
    v_cos_f32 v19, v14
    v_sin_f32 v15, v14
    v_mfma_f32_16x16x4_f32 v[104:107], v193, v18, v[104:107]
    s_nop 0
    v_mov_b32 v20, v15
    v_mfma_f32_16x16x4_f32 v[120:123], v197, v18, v[120:123]
    v_sub_f32 v21, 0, v15
    v_mfma_f32_16x16x4_f32 v[136:139], v193, v16, v[136:139]
    v_mfma_f32_16x16x4_f32 v[152:155], v197, v16, v[152:155]
    s_nop 0
    v_mfma_f32_16x16x4_f32 v[108:111], v161, v19, v[108:111]
    v_add_u32 v14, 2, v4
    v_add_u32 v15, 0, v1
    v_mfma_f32_16x16x4_f32 v[124:127], v165, v19, v[124:127]
    v_mul_u32_u24 v14, v14, v15
    v_and_b32 v14, 63, v14
    v_mfma_f32_16x16x4_f32 v[140:143], v161, v20, v[140:143]
    v_cvt_f32_u32 v14, v14
    v_mul_f32 v14, 0.015625, v14
    v_mfma_f32_16x16x4_f32 v[156:159], v165, v20, v[156:159]
    v_cos_f32 v16, v14
    v_sin_f32 v15, v14
    v_mfma_f32_16x16x4_f32 v[108:111], v193, v21, v[108:111]
    s_nop 0
    v_mov_b32 v17, v15
    v_mfma_f32_16x16x4_f32 v[124:127], v197, v21, v[124:127]
    v_sub_f32 v18, 0, v15
    v_mfma_f32_16x16x4_f32 v[140:143], v193, v19, v[140:143]
    v_mfma_f32_16x16x4_f32 v[156:159], v197, v19, v[156:159]
    s_nop 0
    v_mfma_f32_16x16x4_f32 v[96:99], v162, v16, v[96:99]
    v_add_u32 v14, 2, v4
    v_add_u32 v15, 16, v1
    v_mfma_f32_16x16x4_f32 v[112:115], v166, v16, v[112:115]
    v_mul_u32_u24 v14, v14, v15
    v_and_b32 v14, 63, v14
    v_mfma_f32_16x16x4_f32 v[128:131], v162, v17, v[128:131]
    v_cvt_f32_u32 v14, v14
    v_mul_f32 v14, 0.015625, v14
    v_mfma_f32_16x16x4_f32 v[144:147], v166, v17, v[144:147]
    v_cos_f32 v19, v14
    v_sin_f32 v15, v14
    v_mfma_f32_16x16x4_f32 v[96:99], v194, v18, v[96:99]
    s_nop 0
    v_mov_b32 v20, v15
    v_mfma_f32_16x16x4_f32 v[112:115], v198, v18, v[112:115]
    v_sub_f32 v21, 0, v15
    v_mfma_f32_16x16x4_f32 v[128:131], v194, v16, v[128:131]
    v_mfma_f32_16x16x4_f32 v[144:147], v198, v16, v[144:147]
    s_nop 0
    v_mfma_f32_16x16x4_f32 v[100:103], v162, v19, v[100:103]
    v_add_u32 v14, 2, v4
    v_add_u32 v15, 32, v1
    v_mfma_f32_16x16x4_f32 v[116:119], v166, v19, v[116:119]
    v_mul_u32_u24 v14, v14, v15
    v_and_b32 v14, 63, v14
    v_mfma_f32_16x16x4_f32 v[132:135], v162, v20, v[132:135]
    v_cvt_f32_u32 v14, v14
    v_mul_f32 v14, 0.015625, v14
    v_mfma_f32_16x16x4_f32 v[148:151], v166, v20, v[148:151]
    v_cos_f32 v16, v14
    v_sin_f32 v15, v14
    v_mfma_f32_16x16x4_f32 v[100:103], v194, v21, v[100:103]
    s_nop 0
    v_mov_b32 v17, v15
    v_mfma_f32_16x16x4_f32 v[116:119], v198, v21, v[116:119]
    v_sub_f32 v18, 0, v15
    v_mfma_f32_16x16x4_f32 v[132:135], v194, v19, v[132:135]
    v_mfma_f32_16x16x4_f32 v[148:151], v198, v19, v[148:151]
    s_nop 0
    v_mfma_f32_16x16x4_f32 v[104:107], v162, v16, v[104:107]
    v_add_u32 v14, 2, v4
    v_add_u32 v15, 48, v1
    v_mfma_f32_16x16x4_f32 v[120:123], v166, v16, v[120:123]
    v_mul_u32_u24 v14, v14, v15
    v_and_b32 v14, 63, v14
    v_mfma_f32_16x16x4_f32 v[136:139], v162, v17, v[136:139]
    v_cvt_f32_u32 v14, v14
    v_mul_f32 v14, 0.015625, v14
    v_mfma_f32_16x16x4_f32 v[152:155], v166, v17, v[152:155]
    v_cos_f32 v19, v14
    v_sin_f32 v15, v14
    v_mfma_f32_16x16x4_f32 v[104:107], v194, v18, v[104:107]
    s_nop 0
    v_mov_b32 v20, v15
    v_mfma_f32_16x16x4_f32 v[120:123], v198, v18, v[120:123]
    v_sub_f32 v21, 0, v15
    v_mfma_f32_16x16x4_f32 v[136:139], v194, v16, v[136:139]
    v_mfma_f32_16x16x4_f32 v[152:155], v198, v16, v[152:155]
    s_nop 0
    v_mfma_f32_16x16x4_f32 v[108:111], v162, v19, v[108:111]
    v_add_u32 v14, 3, v4
    v_add_u32 v15, 0, v1
    v_mfma_f32_16x16x4_f32 v[124:127], v166, v19, v[124:127]
    v_mul_u32_u24 v14, v14, v15
    v_and_b32 v14, 63, v14
    v_mfma_f32_16x16x4_f32 v[140:143], v162, v20, v[140:143]
    v_cvt_f32_u32 v14, v14
    v_mul_f32 v14, 0.015625, v14
    v_mfma_f32_16x16x4_f32 v[156:159], v166, v20, v[156:159]
    v_cos_f32 v16, v14
    v_sin_f32 v15, v14
    v_mfma_f32_16x16x4_f32 v[108:111], v194, v21, v[108:111]
    s_nop 0
    v_mov_b32 v17, v15
    v_mfma_f32_16x16x4_f32 v[124:127], v198, v21, v[124:127]
    v_sub_f32 v18, 0, v15
    v_mfma_f32_16x16x4_f32 v[140:143], v194, v19, v[140:143]
    v_mfma_f32_16x16x4_f32 v[156:159], v198, v19, v[156:159]
    s_nop 0
    v_mfma_f32_16x16x4_f32 v[96:99], v163, v16, v[96:99]
    v_add_u32 v14, 3, v4
    v_add_u32 v15, 16, v1
    v_mfma_f32_16x16x4_f32 v[112:115], v167, v16, v[112:115]
    v_mul_u32_u24 v14, v14, v15
    v_and_b32 v14, 63, v14
    v_mfma_f32_16x16x4_f32 v[128:131], v163, v17, v[128:131]
    v_cvt_f32_u32 v14, v14
    v_mul_f32 v14, 0.015625, v14
    v_mfma_f32_16x16x4_f32 v[144:147], v167, v17, v[144:147]
    v_cos_f32 v19, v14
    v_sin_f32 v15, v14
    v_mfma_f32_16x16x4_f32 v[96:99], v195, v18, v[96:99]
    s_nop 0
    v_mov_b32 v20, v15
    v_mfma_f32_16x16x4_f32 v[112:115], v199, v18, v[112:115]
    v_sub_f32 v21, 0, v15
    v_mfma_f32_16x16x4_f32 v[128:131], v195, v16, v[128:131]
    v_mfma_f32_16x16x4_f32 v[144:147], v199, v16, v[144:147]
    s_nop 0
    v_mfma_f32_16x16x4_f32 v[100:103], v163, v19, v[100:103]
    v_add_u32 v14, 3, v4
    v_add_u32 v15, 32, v1
    v_mfma_f32_16x16x4_f32 v[116:119], v167, v19, v[116:119]
    v_mul_u32_u24 v14, v14, v15
    v_and_b32 v14, 63, v14
    v_mfma_f32_16x16x4_f32 v[132:135], v163, v20, v[132:135]
    v_cvt_f32_u32 v14, v14
    v_mul_f32 v14, 0.015625, v14
    v_mfma_f32_16x16x4_f32 v[148:151], v167, v20, v[148:151]
    v_cos_f32 v16, v14
    v_sin_f32 v15, v14
    v_mfma_f32_16x16x4_f32 v[100:103], v195, v21, v[100:103]
    s_nop 0
    v_mov_b32 v17, v15
    v_mfma_f32_16x16x4_f32 v[116:119], v199, v21, v[116:119]
    v_sub_f32 v18, 0, v15
    v_mfma_f32_16x16x4_f32 v[132:135], v195, v19, v[132:135]
    v_mfma_f32_16x16x4_f32 v[148:151], v199, v19, v[148:151]
    s_nop 0
    v_mfma_f32_16x16x4_f32 v[104:107], v163, v16, v[104:107]
    v_add_u32 v14, 3, v4
    v_add_u32 v15, 48, v1
    v_mfma_f32_16x16x4_f32 v[120:123], v167, v16, v[120:123]
    v_mul_u32_u24 v14, v14, v15
    v_and_b32 v14, 63, v14
    v_mfma_f32_16x16x4_f32 v[136:139], v163, v17, v[136:139]
    v_cvt_f32_u32 v14, v14
    v_mul_f32 v14, 0.015625, v14
    v_mfma_f32_16x16x4_f32 v[152:155], v167, v17, v[152:155]
    v_cos_f32 v19, v14
    v_sin_f32 v15, v14
    v_mfma_f32_16x16x4_f32 v[104:107], v195, v18, v[104:107]
    s_nop 0
    v_mov_b32 v20, v15
    v_mfma_f32_16x16x4_f32 v[120:123], v199, v18, v[120:123]
    v_sub_f32 v21, 0, v15
    v_mfma_f32_16x16x4_f32 v[136:139], v195, v16, v[136:139]
    v_mfma_f32_16x16x4_f32 v[152:155], v199, v16, v[152:155]
    s_nop 0
    v_mfma_f32_16x16x4_f32 v[108:111], v163, v19, v[108:111]
    v_add_u32 v14, 16, v4
    v_add_u32 v15, 0, v1
    v_mfma_f32_16x16x4_f32 v[124:127], v167, v19, v[124:127]
    v_mul_u32_u24 v14, v14, v15
    v_and_b32 v14, 63, v14
    v_mfma_f32_16x16x4_f32 v[140:143], v163, v20, v[140:143]
    v_cvt_f32_u32 v14, v14
    v_mul_f32 v14, 0.015625, v14
    v_mfma_f32_16x16x4_f32 v[156:159], v167, v20, v[156:159]
    v_cos_f32 v16, v14
    v_sin_f32 v15, v14
    v_mfma_f32_16x16x4_f32 v[108:111], v195, v21, v[108:111]
    s_nop 0
    v_mov_b32 v17, v15
    v_mfma_f32_16x16x4_f32 v[124:127], v199, v21, v[124:127]
    v_sub_f32 v18, 0, v15
    v_mfma_f32_16x16x4_f32 v[140:143], v195, v19, v[140:143]
    v_mfma_f32_16x16x4_f32 v[156:159], v199, v19, v[156:159]
    s_nop 0
    v_mfma_f32_16x16x4_f32 v[96:99], v168, v16, v[96:99]
    v_add_u32 v14, 16, v4
    v_add_u32 v15, 16, v1
    v_mfma_f32_16x16x4_f32 v[112:115], v172, v16, v[112:115]
    v_mul_u32_u24 v14, v14, v15
    v_and_b32 v14, 63, v14
    v_mfma_f32_16x16x4_f32 v[128:131], v168, v17, v[128:131]
    v_cvt_f32_u32 v14, v14
    v_mul_f32 v14, 0.015625, v14
    v_mfma_f32_16x16x4_f32 v[144:147], v172, v17, v[144:147]
    v_cos_f32 v19, v14
    v_sin_f32 v15, v14
    v_mfma_f32_16x16x4_f32 v[96:99], v200, v18, v[96:99]
    s_nop 0
    v_mov_b32 v20, v15
    v_mfma_f32_16x16x4_f32 v[112:115], v204, v18, v[112:115]
    v_sub_f32 v21, 0, v15
    v_mfma_f32_16x16x4_f32 v[128:131], v200, v16, v[128:131]
    v_mfma_f32_16x16x4_f32 v[144:147], v204, v16, v[144:147]
    s_nop 0
    v_mfma_f32_16x16x4_f32 v[100:103], v168, v19, v[100:103]
    v_add_u32 v14, 16, v4
    v_add_u32 v15, 32, v1
    v_mfma_f32_16x16x4_f32 v[116:119], v172, v19, v[116:119]
    v_mul_u32_u24 v14, v14, v15
    v_and_b32 v14, 63, v14
    v_mfma_f32_16x16x4_f32 v[132:135], v168, v20, v[132:135]
    v_cvt_f32_u32 v14, v14
    v_mul_f32 v14, 0.015625, v14
    v_mfma_f32_16x16x4_f32 v[148:151], v172, v20, v[148:151]
    v_cos_f32 v16, v14
    v_sin_f32 v15, v14
    v_mfma_f32_16x16x4_f32 v[100:103], v200, v21, v[100:103]
    s_nop 0
    v_mov_b32 v17, v15
    v_mfma_f32_16x16x4_f32 v[116:119], v204, v21, v[116:119]
    v_sub_f32 v18, 0, v15
    v_mfma_f32_16x16x4_f32 v[132:135], v200, v19, v[132:135]
    v_mfma_f32_16x16x4_f32 v[148:151], v204, v19, v[148:151]
    s_nop 0
    v_mfma_f32_16x16x4_f32 v[104:107], v168, v16, v[104:107]
    v_add_u32 v14, 16, v4
    v_add_u32 v15, 48, v1
    v_mfma_f32_16x16x4_f32 v[120:123], v172, v16, v[120:123]
    v_mul_u32_u24 v14, v14, v15
    v_and_b32 v14, 63, v14
    v_mfma_f32_16x16x4_f32 v[136:139], v168, v17, v[136:139]
    v_cvt_f32_u32 v14, v14
    v_mul_f32 v14, 0.015625, v14
    v_mfma_f32_16x16x4_f32 v[152:155], v172, v17, v[152:155]
    v_cos_f32 v19, v14
    v_sin_f32 v15, v14
    v_mfma_f32_16x16x4_f32 v[104:107], v200, v18, v[104:107]
    s_nop 0
    v_mov_b32 v20, v15
    v_mfma_f32_16x16x4_f32 v[120:123], v204, v18, v[120:123]
    v_sub_f32 v21, 0, v15
    v_mfma_f32_16x16x4_f32 v[136:139], v200, v16, v[136:139]
    v_mfma_f32_16x16x4_f32 v[152:155], v204, v16, v[152:155]
    s_nop 0
    v_mfma_f32_16x16x4_f32 v[108:111], v168, v19, v[108:111]
    v_add_u32 v14, 17, v4
    v_add_u32 v15, 0, v1
    v_mfma_f32_16x16x4_f32 v[124:127], v172, v19, v[124:127]
    v_mul_u32_u24 v14, v14, v15
    v_and_b32 v14, 63, v14
    v_mfma_f32_16x16x4_f32 v[140:143], v168, v20, v[140:143]
    v_cvt_f32_u32 v14, v14
    v_mul_f32 v14, 0.015625, v14
    v_mfma_f32_16x16x4_f32 v[156:159], v172, v20, v[156:159]
    v_cos_f32 v16, v14
    v_sin_f32 v15, v14
    v_mfma_f32_16x16x4_f32 v[108:111], v200, v21, v[108:111]
    s_nop 0
    v_mov_b32 v17, v15
    v_mfma_f32_16x16x4_f32 v[124:127], v204, v21, v[124:127]
    v_sub_f32 v18, 0, v15
    v_mfma_f32_16x16x4_f32 v[140:143], v200, v19, v[140:143]
    v_mfma_f32_16x16x4_f32 v[156:159], v204, v19, v[156:159]
    s_nop 0
    v_mfma_f32_16x16x4_f32 v[96:99], v169, v16, v[96:99]
    v_add_u32 v14, 17, v4
    v_add_u32 v15, 16, v1
    v_mfma_f32_16x16x4_f32 v[112:115], v173, v16, v[112:115]
    v_mul_u32_u24 v14, v14, v15
    v_and_b32 v14, 63, v14
    v_mfma_f32_16x16x4_f32 v[128:131], v169, v17, v[128:131]
    v_cvt_f32_u32 v14, v14
    v_mul_f32 v14, 0.015625, v14
    v_mfma_f32_16x16x4_f32 v[144:147], v173, v17, v[144:147]
    v_cos_f32 v19, v14
    v_sin_f32 v15, v14
    v_mfma_f32_16x16x4_f32 v[96:99], v201, v18, v[96:99]
    s_nop 0
    v_mov_b32 v20, v15
    v_mfma_f32_16x16x4_f32 v[112:115], v205, v18, v[112:115]
    v_sub_f32 v21, 0, v15
    v_mfma_f32_16x16x4_f32 v[128:131], v201, v16, v[128:131]
    v_mfma_f32_16x16x4_f32 v[144:147], v205, v16, v[144:147]
    s_nop 0
    v_mfma_f32_16x16x4_f32 v[100:103], v169, v19, v[100:103]
    v_add_u32 v14, 17, v4
    v_add_u32 v15, 32, v1
    v_mfma_f32_16x16x4_f32 v[116:119], v173, v19, v[116:119]
    v_mul_u32_u24 v14, v14, v15
    v_and_b32 v14, 63, v14
    v_mfma_f32_16x16x4_f32 v[132:135], v169, v20, v[132:135]
    v_cvt_f32_u32 v14, v14
    v_mul_f32 v14, 0.015625, v14
    v_mfma_f32_16x16x4_f32 v[148:151], v173, v20, v[148:151]
    v_cos_f32 v16, v14
    v_sin_f32 v15, v14
    v_mfma_f32_16x16x4_f32 v[100:103], v201, v21, v[100:103]
    s_nop 0
    v_mov_b32 v17, v15
    v_mfma_f32_16x16x4_f32 v[116:119], v205, v21, v[116:119]
    v_sub_f32 v18, 0, v15
    v_mfma_f32_16x16x4_f32 v[132:135], v201, v19, v[132:135]
    v_mfma_f32_16x16x4_f32 v[148:151], v205, v19, v[148:151]
    s_nop 0
    v_mfma_f32_16x16x4_f32 v[104:107], v169, v16, v[104:107]
    v_add_u32 v14, 17, v4
    v_add_u32 v15, 48, v1
    v_mfma_f32_16x16x4_f32 v[120:123], v173, v16, v[120:123]
    v_mul_u32_u24 v14, v14, v15
    v_and_b32 v14, 63, v14
    v_mfma_f32_16x16x4_f32 v[136:139], v169, v17, v[136:139]
    v_cvt_f32_u32 v14, v14
    v_mul_f32 v14, 0.015625, v14
    v_mfma_f32_16x16x4_f32 v[152:155], v173, v17, v[152:155]
    v_cos_f32 v19, v14
    v_sin_f32 v15, v14
    v_mfma_f32_16x16x4_f32 v[104:107], v201, v18, v[104:107]
    s_nop 0
    v_mov_b32 v20, v15
    v_mfma_f32_16x16x4_f32 v[120:123], v205, v18, v[120:123]
    v_sub_f32 v21, 0, v15
    v_mfma_f32_16x16x4_f32 v[136:139], v201, v16, v[136:139]
    v_mfma_f32_16x16x4_f32 v[152:155], v205, v16, v[152:155]
    s_nop 0
    v_mfma_f32_16x16x4_f32 v[108:111], v169, v19, v[108:111]
    v_add_u32 v14, 18, v4
    v_add_u32 v15, 0, v1
    v_mfma_f32_16x16x4_f32 v[124:127], v173, v19, v[124:127]
    v_mul_u32_u24 v14, v14, v15
    v_and_b32 v14, 63, v14
    v_mfma_f32_16x16x4_f32 v[140:143], v169, v20, v[140:143]
    v_cvt_f32_u32 v14, v14
    v_mul_f32 v14, 0.015625, v14
    v_mfma_f32_16x16x4_f32 v[156:159], v173, v20, v[156:159]
    v_cos_f32 v16, v14
    v_sin_f32 v15, v14
    v_mfma_f32_16x16x4_f32 v[108:111], v201, v21, v[108:111]
    s_nop 0
    v_mov_b32 v17, v15
    v_mfma_f32_16x16x4_f32 v[124:127], v205, v21, v[124:127]
    v_sub_f32 v18, 0, v15
    v_mfma_f32_16x16x4_f32 v[140:143], v201, v19, v[140:143]
    v_mfma_f32_16x16x4_f32 v[156:159], v205, v19, v[156:159]
    s_nop 0
    v_mfma_f32_16x16x4_f32 v[96:99], v170, v16, v[96:99]
    v_add_u32 v14, 18, v4
    v_add_u32 v15, 16, v1
    v_mfma_f32_16x16x4_f32 v[112:115], v174, v16, v[112:115]
    v_mul_u32_u24 v14, v14, v15
    v_and_b32 v14, 63, v14
    v_mfma_f32_16x16x4_f32 v[128:131], v170, v17, v[128:131]
    v_cvt_f32_u32 v14, v14
    v_mul_f32 v14, 0.015625, v14
    v_mfma_f32_16x16x4_f32 v[144:147], v174, v17, v[144:147]
    v_cos_f32 v19, v14
    v_sin_f32 v15, v14
    v_mfma_f32_16x16x4_f32 v[96:99], v202, v18, v[96:99]
    s_nop 0
    v_mov_b32 v20, v15
    v_mfma_f32_16x16x4_f32 v[112:115], v206, v18, v[112:115]
    v_sub_f32 v21, 0, v15
    v_mfma_f32_16x16x4_f32 v[128:131], v202, v16, v[128:131]
    v_mfma_f32_16x16x4_f32 v[144:147], v206, v16, v[144:147]
    s_nop 0
    v_mfma_f32_16x16x4_f32 v[100:103], v170, v19, v[100:103]
    v_add_u32 v14, 18, v4
    v_add_u32 v15, 32, v1
    v_mfma_f32_16x16x4_f32 v[116:119], v174, v19, v[116:119]
    v_mul_u32_u24 v14, v14, v15
    v_and_b32 v14, 63, v14
    v_mfma_f32_16x16x4_f32 v[132:135], v170, v20, v[132:135]
    v_cvt_f32_u32 v14, v14
    v_mul_f32 v14, 0.015625, v14
    v_mfma_f32_16x16x4_f32 v[148:151], v174, v20, v[148:151]
    v_cos_f32 v16, v14
    v_sin_f32 v15, v14
    v_mfma_f32_16x16x4_f32 v[100:103], v202, v21, v[100:103]
    s_nop 0
    v_mov_b32 v17, v15
    v_mfma_f32_16x16x4_f32 v[116:119], v206, v21, v[116:119]
    v_sub_f32 v18, 0, v15
    v_mfma_f32_16x16x4_f32 v[132:135], v202, v19, v[132:135]
    v_mfma_f32_16x16x4_f32 v[148:151], v206, v19, v[148:151]
    s_nop 0
    v_mfma_f32_16x16x4_f32 v[104:107], v170, v16, v[104:107]
    v_add_u32 v14, 18, v4
    v_add_u32 v15, 48, v1
    v_mfma_f32_16x16x4_f32 v[120:123], v174, v16, v[120:123]
    v_mul_u32_u24 v14, v14, v15
    v_and_b32 v14, 63, v14
    v_mfma_f32_16x16x4_f32 v[136:139], v170, v17, v[136:139]
    v_cvt_f32_u32 v14, v14
    v_mul_f32 v14, 0.015625, v14
    v_mfma_f32_16x16x4_f32 v[152:155], v174, v17, v[152:155]
    v_cos_f32 v19, v14
    v_sin_f32 v15, v14
    v_mfma_f32_16x16x4_f32 v[104:107], v202, v18, v[104:107]
    s_nop 0
    v_mov_b32 v20, v15
    v_mfma_f32_16x16x4_f32 v[120:123], v206, v18, v[120:123]
    v_sub_f32 v21, 0, v15
    v_mfma_f32_16x16x4_f32 v[136:139], v202, v16, v[136:139]
    v_mfma_f32_16x16x4_f32 v[152:155], v206, v16, v[152:155]
    s_nop 0
    v_mfma_f32_16x16x4_f32 v[108:111], v170, v19, v[108:111]
    v_add_u32 v14, 19, v4
    v_add_u32 v15, 0, v1
    v_mfma_f32_16x16x4_f32 v[124:127], v174, v19, v[124:127]
    v_mul_u32_u24 v14, v14, v15
    v_and_b32 v14, 63, v14
    v_mfma_f32_16x16x4_f32 v[140:143], v170, v20, v[140:143]
    v_cvt_f32_u32 v14, v14
    v_mul_f32 v14, 0.015625, v14
    v_mfma_f32_16x16x4_f32 v[156:159], v174, v20, v[156:159]
    v_cos_f32 v16, v14
    v_sin_f32 v15, v14
    v_mfma_f32_16x16x4_f32 v[108:111], v202, v21, v[108:111]
    s_nop 0
    v_mov_b32 v17, v15
    v_mfma_f32_16x16x4_f32 v[124:127], v206, v21, v[124:127]
    v_sub_f32 v18, 0, v15
    v_mfma_f32_16x16x4_f32 v[140:143], v202, v19, v[140:143]
    v_mfma_f32_16x16x4_f32 v[156:159], v206, v19, v[156:159]
    s_nop 0
    v_mfma_f32_16x16x4_f32 v[96:99], v171, v16, v[96:99]
    v_add_u32 v14, 19, v4
    v_add_u32 v15, 16, v1
    v_mfma_f32_16x16x4_f32 v[112:115], v175, v16, v[112:115]
    v_mul_u32_u24 v14, v14, v15
    v_and_b32 v14, 63, v14
    v_mfma_f32_16x16x4_f32 v[128:131], v171, v17, v[128:131]
    v_cvt_f32_u32 v14, v14
    v_mul_f32 v14, 0.015625, v14
    v_mfma_f32_16x16x4_f32 v[144:147], v175, v17, v[144:147]
    v_cos_f32 v19, v14
    v_sin_f32 v15, v14
    v_mfma_f32_16x16x4_f32 v[96:99], v203, v18, v[96:99]
    s_nop 0
    v_mov_b32 v20, v15
    v_mfma_f32_16x16x4_f32 v[112:115], v207, v18, v[112:115]
    v_sub_f32 v21, 0, v15
    v_mfma_f32_16x16x4_f32 v[128:131], v203, v16, v[128:131]
    v_mfma_f32_16x16x4_f32 v[144:147], v207, v16, v[144:147]
    s_nop 0
    v_mfma_f32_16x16x4_f32 v[100:103], v171, v19, v[100:103]
    v_add_u32 v14, 19, v4
    v_add_u32 v15, 32, v1
    v_mfma_f32_16x16x4_f32 v[116:119], v175, v19, v[116:119]
    v_mul_u32_u24 v14, v14, v15
    v_and_b32 v14, 63, v14
    v_mfma_f32_16x16x4_f32 v[132:135], v171, v20, v[132:135]
    v_cvt_f32_u32 v14, v14
    v_mul_f32 v14, 0.015625, v14
    v_mfma_f32_16x16x4_f32 v[148:151], v175, v20, v[148:151]
    v_cos_f32 v16, v14
    v_sin_f32 v15, v14
    v_mfma_f32_16x16x4_f32 v[100:103], v203, v21, v[100:103]
    s_nop 0
    v_mov_b32 v17, v15
    v_mfma_f32_16x16x4_f32 v[116:119], v207, v21, v[116:119]
    v_sub_f32 v18, 0, v15
    v_mfma_f32_16x16x4_f32 v[132:135], v203, v19, v[132:135]
    v_mfma_f32_16x16x4_f32 v[148:151], v207, v19, v[148:151]
    s_nop 0
    v_mfma_f32_16x16x4_f32 v[104:107], v171, v16, v[104:107]
    v_add_u32 v14, 19, v4
    v_add_u32 v15, 48, v1
    v_mfma_f32_16x16x4_f32 v[120:123], v175, v16, v[120:123]
    v_mul_u32_u24 v14, v14, v15
    v_and_b32 v14, 63, v14
    v_mfma_f32_16x16x4_f32 v[136:139], v171, v17, v[136:139]
    v_cvt_f32_u32 v14, v14
    v_mul_f32 v14, 0.015625, v14
    v_mfma_f32_16x16x4_f32 v[152:155], v175, v17, v[152:155]
    v_cos_f32 v19, v14
    v_sin_f32 v15, v14
    v_mfma_f32_16x16x4_f32 v[104:107], v203, v18, v[104:107]
    s_nop 0
    v_mov_b32 v20, v15
    v_mfma_f32_16x16x4_f32 v[120:123], v207, v18, v[120:123]
    v_sub_f32 v21, 0, v15
    v_mfma_f32_16x16x4_f32 v[136:139], v203, v16, v[136:139]
    v_mfma_f32_16x16x4_f32 v[152:155], v207, v16, v[152:155]
    s_nop 0
    v_mfma_f32_16x16x4_f32 v[108:111], v171, v19, v[108:111]
    v_add_u32 v14, 32, v4
    v_add_u32 v15, 0, v1
    v_mfma_f32_16x16x4_f32 v[124:127], v175, v19, v[124:127]
    v_mul_u32_u24 v14, v14, v15
    v_and_b32 v14, 63, v14
    v_mfma_f32_16x16x4_f32 v[140:143], v171, v20, v[140:143]
    v_cvt_f32_u32 v14, v14
    v_mul_f32 v14, 0.015625, v14
    v_mfma_f32_16x16x4_f32 v[156:159], v175, v20, v[156:159]
    v_cos_f32 v16, v14
    v_sin_f32 v15, v14
    v_mfma_f32_16x16x4_f32 v[108:111], v203, v21, v[108:111]
    s_nop 0
    v_mov_b32 v17, v15
    v_mfma_f32_16x16x4_f32 v[124:127], v207, v21, v[124:127]
    v_sub_f32 v18, 0, v15
    v_mfma_f32_16x16x4_f32 v[140:143], v203, v19, v[140:143]
    v_mfma_f32_16x16x4_f32 v[156:159], v207, v19, v[156:159]
    s_nop 0
    v_mfma_f32_16x16x4_f32 v[96:99], v176, v16, v[96:99]
    v_add_u32 v14, 32, v4
    v_add_u32 v15, 16, v1
    v_mfma_f32_16x16x4_f32 v[112:115], v180, v16, v[112:115]
    v_mul_u32_u24 v14, v14, v15
    v_and_b32 v14, 63, v14
    v_mfma_f32_16x16x4_f32 v[128:131], v176, v17, v[128:131]
    v_cvt_f32_u32 v14, v14
    v_mul_f32 v14, 0.015625, v14
    v_mfma_f32_16x16x4_f32 v[144:147], v180, v17, v[144:147]
    v_cos_f32 v19, v14
    v_sin_f32 v15, v14
    v_mfma_f32_16x16x4_f32 v[96:99], v208, v18, v[96:99]
    s_nop 0
    v_mov_b32 v20, v15
    v_mfma_f32_16x16x4_f32 v[112:115], v212, v18, v[112:115]
    v_sub_f32 v21, 0, v15
    v_mfma_f32_16x16x4_f32 v[128:131], v208, v16, v[128:131]
    v_mfma_f32_16x16x4_f32 v[144:147], v212, v16, v[144:147]
    s_nop 0
    v_mfma_f32_16x16x4_f32 v[100:103], v176, v19, v[100:103]
    v_add_u32 v14, 32, v4
    v_add_u32 v15, 32, v1
    v_mfma_f32_16x16x4_f32 v[116:119], v180, v19, v[116:119]
    v_mul_u32_u24 v14, v14, v15
    v_and_b32 v14, 63, v14
    v_mfma_f32_16x16x4_f32 v[132:135], v176, v20, v[132:135]
    v_cvt_f32_u32 v14, v14
    v_mul_f32 v14, 0.015625, v14
    v_mfma_f32_16x16x4_f32 v[148:151], v180, v20, v[148:151]
    v_cos_f32 v16, v14
    v_sin_f32 v15, v14
    v_mfma_f32_16x16x4_f32 v[100:103], v208, v21, v[100:103]
    s_nop 0
    v_mov_b32 v17, v15
    v_mfma_f32_16x16x4_f32 v[116:119], v212, v21, v[116:119]
    v_sub_f32 v18, 0, v15
    v_mfma_f32_16x16x4_f32 v[132:135], v208, v19, v[132:135]
    v_mfma_f32_16x16x4_f32 v[148:151], v212, v19, v[148:151]
    s_nop 0
    v_mfma_f32_16x16x4_f32 v[104:107], v176, v16, v[104:107]
    v_add_u32 v14, 32, v4
    v_add_u32 v15, 48, v1
    v_mfma_f32_16x16x4_f32 v[120:123], v180, v16, v[120:123]
    v_mul_u32_u24 v14, v14, v15
    v_and_b32 v14, 63, v14
    v_mfma_f32_16x16x4_f32 v[136:139], v176, v17, v[136:139]
    v_cvt_f32_u32 v14, v14
    v_mul_f32 v14, 0.015625, v14
    v_mfma_f32_16x16x4_f32 v[152:155], v180, v17, v[152:155]
    v_cos_f32 v19, v14
    v_sin_f32 v15, v14
    v_mfma_f32_16x16x4_f32 v[104:107], v208, v18, v[104:107]
    s_nop 0
    v_mov_b32 v20, v15
    v_mfma_f32_16x16x4_f32 v[120:123], v212, v18, v[120:123]
    v_sub_f32 v21, 0, v15
    v_mfma_f32_16x16x4_f32 v[136:139], v208, v16, v[136:139]
    v_mfma_f32_16x16x4_f32 v[152:155], v212, v16, v[152:155]
    s_nop 0
    v_mfma_f32_16x16x4_f32 v[108:111], v176, v19, v[108:111]
    v_add_u32 v14, 33, v4
    v_add_u32 v15, 0, v1
    v_mfma_f32_16x16x4_f32 v[124:127], v180, v19, v[124:127]
    v_mul_u32_u24 v14, v14, v15
    v_and_b32 v14, 63, v14
    v_mfma_f32_16x16x4_f32 v[140:143], v176, v20, v[140:143]
    v_cvt_f32_u32 v14, v14
    v_mul_f32 v14, 0.015625, v14
    v_mfma_f32_16x16x4_f32 v[156:159], v180, v20, v[156:159]
    v_cos_f32 v16, v14
    v_sin_f32 v15, v14
    v_mfma_f32_16x16x4_f32 v[108:111], v208, v21, v[108:111]
    s_nop 0
    v_mov_b32 v17, v15
    v_mfma_f32_16x16x4_f32 v[124:127], v212, v21, v[124:127]
    v_sub_f32 v18, 0, v15
    v_mfma_f32_16x16x4_f32 v[140:143], v208, v19, v[140:143]
    v_mfma_f32_16x16x4_f32 v[156:159], v212, v19, v[156:159]
    s_nop 0
    v_mfma_f32_16x16x4_f32 v[96:99], v177, v16, v[96:99]
    v_add_u32 v14, 33, v4
    v_add_u32 v15, 16, v1
    v_mfma_f32_16x16x4_f32 v[112:115], v181, v16, v[112:115]
    v_mul_u32_u24 v14, v14, v15
    v_and_b32 v14, 63, v14
    v_mfma_f32_16x16x4_f32 v[128:131], v177, v17, v[128:131]
    v_cvt_f32_u32 v14, v14
    v_mul_f32 v14, 0.015625, v14
    v_mfma_f32_16x16x4_f32 v[144:147], v181, v17, v[144:147]
    v_cos_f32 v19, v14
    v_sin_f32 v15, v14
    v_mfma_f32_16x16x4_f32 v[96:99], v209, v18, v[96:99]
    s_nop 0
    v_mov_b32 v20, v15
    v_mfma_f32_16x16x4_f32 v[112:115], v213, v18, v[112:115]
    v_sub_f32 v21, 0, v15
    v_mfma_f32_16x16x4_f32 v[128:131], v209, v16, v[128:131]
    v_mfma_f32_16x16x4_f32 v[144:147], v213, v16, v[144:147]
    s_nop 0
    v_mfma_f32_16x16x4_f32 v[100:103], v177, v19, v[100:103]
    v_add_u32 v14, 33, v4
    v_add_u32 v15, 32, v1
    v_mfma_f32_16x16x4_f32 v[116:119], v181, v19, v[116:119]
    v_mul_u32_u24 v14, v14, v15
    v_and_b32 v14, 63, v14
    v_mfma_f32_16x16x4_f32 v[132:135], v177, v20, v[132:135]
    v_cvt_f32_u32 v14, v14
    v_mul_f32 v14, 0.015625, v14
    v_mfma_f32_16x16x4_f32 v[148:151], v181, v20, v[148:151]
    v_cos_f32 v16, v14
    v_sin_f32 v15, v14
    v_mfma_f32_16x16x4_f32 v[100:103], v209, v21, v[100:103]
    s_nop 0
    v_mov_b32 v17, v15
    v_mfma_f32_16x16x4_f32 v[116:119], v213, v21, v[116:119]
    v_sub_f32 v18, 0, v15
    v_mfma_f32_16x16x4_f32 v[132:135], v209, v19, v[132:135]
    v_mfma_f32_16x16x4_f32 v[148:151], v213, v19, v[148:151]
    s_nop 0
    v_mfma_f32_16x16x4_f32 v[104:107], v177, v16, v[104:107]
    v_add_u32 v14, 33, v4
    v_add_u32 v15, 48, v1
    v_mfma_f32_16x16x4_f32 v[120:123], v181, v16, v[120:123]
    v_mul_u32_u24 v14, v14, v15
    v_and_b32 v14, 63, v14
    v_mfma_f32_16x16x4_f32 v[136:139], v177, v17, v[136:139]
    v_cvt_f32_u32 v14, v14
    v_mul_f32 v14, 0.015625, v14
    v_mfma_f32_16x16x4_f32 v[152:155], v181, v17, v[152:155]
    v_cos_f32 v19, v14
    v_sin_f32 v15, v14
    v_mfma_f32_16x16x4_f32 v[104:107], v209, v18, v[104:107]
    s_nop 0
    v_mov_b32 v20, v15
    v_mfma_f32_16x16x4_f32 v[120:123], v213, v18, v[120:123]
    v_sub_f32 v21, 0, v15
    v_mfma_f32_16x16x4_f32 v[136:139], v209, v16, v[136:139]
    v_mfma_f32_16x16x4_f32 v[152:155], v213, v16, v[152:155]
    s_nop 0
    v_mfma_f32_16x16x4_f32 v[108:111], v177, v19, v[108:111]
    v_add_u32 v14, 34, v4
    v_add_u32 v15, 0, v1
    v_mfma_f32_16x16x4_f32 v[124:127], v181, v19, v[124:127]
    v_mul_u32_u24 v14, v14, v15
    v_and_b32 v14, 63, v14
    v_mfma_f32_16x16x4_f32 v[140:143], v177, v20, v[140:143]
    v_cvt_f32_u32 v14, v14
    v_mul_f32 v14, 0.015625, v14
    v_mfma_f32_16x16x4_f32 v[156:159], v181, v20, v[156:159]
    v_cos_f32 v16, v14
    v_sin_f32 v15, v14
    v_mfma_f32_16x16x4_f32 v[108:111], v209, v21, v[108:111]
    s_nop 0
    v_mov_b32 v17, v15
    v_mfma_f32_16x16x4_f32 v[124:127], v213, v21, v[124:127]
    v_sub_f32 v18, 0, v15
    v_mfma_f32_16x16x4_f32 v[140:143], v209, v19, v[140:143]
    v_mfma_f32_16x16x4_f32 v[156:159], v213, v19, v[156:159]
    s_nop 0
    v_mfma_f32_16x16x4_f32 v[96:99], v178, v16, v[96:99]
    v_add_u32 v14, 34, v4
    v_add_u32 v15, 16, v1
    v_mfma_f32_16x16x4_f32 v[112:115], v182, v16, v[112:115]
    v_mul_u32_u24 v14, v14, v15
    v_and_b32 v14, 63, v14
    v_mfma_f32_16x16x4_f32 v[128:131], v178, v17, v[128:131]
    v_cvt_f32_u32 v14, v14
    v_mul_f32 v14, 0.015625, v14
    v_mfma_f32_16x16x4_f32 v[144:147], v182, v17, v[144:147]
    v_cos_f32 v19, v14
    v_sin_f32 v15, v14
    v_mfma_f32_16x16x4_f32 v[96:99], v210, v18, v[96:99]
    s_nop 0
    v_mov_b32 v20, v15
    v_mfma_f32_16x16x4_f32 v[112:115], v214, v18, v[112:115]
    v_sub_f32 v21, 0, v15
    v_mfma_f32_16x16x4_f32 v[128:131], v210, v16, v[128:131]
    v_mfma_f32_16x16x4_f32 v[144:147], v214, v16, v[144:147]
    s_nop 0
    v_mfma_f32_16x16x4_f32 v[100:103], v178, v19, v[100:103]
    v_add_u32 v14, 34, v4
    v_add_u32 v15, 32, v1
    v_mfma_f32_16x16x4_f32 v[116:119], v182, v19, v[116:119]
    v_mul_u32_u24 v14, v14, v15
    v_and_b32 v14, 63, v14
    v_mfma_f32_16x16x4_f32 v[132:135], v178, v20, v[132:135]
    v_cvt_f32_u32 v14, v14
    v_mul_f32 v14, 0.015625, v14
    v_mfma_f32_16x16x4_f32 v[148:151], v182, v20, v[148:151]
    v_cos_f32 v16, v14
    v_sin_f32 v15, v14
    v_mfma_f32_16x16x4_f32 v[100:103], v210, v21, v[100:103]
    s_nop 0
    v_mov_b32 v17, v15
    v_mfma_f32_16x16x4_f32 v[116:119], v214, v21, v[116:119]
    v_sub_f32 v18, 0, v15
    v_mfma_f32_16x16x4_f32 v[132:135], v210, v19, v[132:135]
    v_mfma_f32_16x16x4_f32 v[148:151], v214, v19, v[148:151]
    s_nop 0
    v_mfma_f32_16x16x4_f32 v[104:107], v178, v16, v[104:107]
    v_add_u32 v14, 34, v4
    v_add_u32 v15, 48, v1
    v_mfma_f32_16x16x4_f32 v[120:123], v182, v16, v[120:123]
    v_mul_u32_u24 v14, v14, v15
    v_and_b32 v14, 63, v14
    v_mfma_f32_16x16x4_f32 v[136:139], v178, v17, v[136:139]
    v_cvt_f32_u32 v14, v14
    v_mul_f32 v14, 0.015625, v14
    v_mfma_f32_16x16x4_f32 v[152:155], v182, v17, v[152:155]
    v_cos_f32 v19, v14
    v_sin_f32 v15, v14
    v_mfma_f32_16x16x4_f32 v[104:107], v210, v18, v[104:107]
    s_nop 0
    v_mov_b32 v20, v15
    v_mfma_f32_16x16x4_f32 v[120:123], v214, v18, v[120:123]
    v_sub_f32 v21, 0, v15
    v_mfma_f32_16x16x4_f32 v[136:139], v210, v16, v[136:139]
    v_mfma_f32_16x16x4_f32 v[152:155], v214, v16, v[152:155]
    s_nop 0
    v_mfma_f32_16x16x4_f32 v[108:111], v178, v19, v[108:111]
    v_add_u32 v14, 35, v4
    v_add_u32 v15, 0, v1
    v_mfma_f32_16x16x4_f32 v[124:127], v182, v19, v[124:127]
    v_mul_u32_u24 v14, v14, v15
    v_and_b32 v14, 63, v14
    v_mfma_f32_16x16x4_f32 v[140:143], v178, v20, v[140:143]
    v_cvt_f32_u32 v14, v14
    v_mul_f32 v14, 0.015625, v14
    v_mfma_f32_16x16x4_f32 v[156:159], v182, v20, v[156:159]
    v_cos_f32 v16, v14
    v_sin_f32 v15, v14
    v_mfma_f32_16x16x4_f32 v[108:111], v210, v21, v[108:111]
    s_nop 0
    v_mov_b32 v17, v15
    v_mfma_f32_16x16x4_f32 v[124:127], v214, v21, v[124:127]
    v_sub_f32 v18, 0, v15
    v_mfma_f32_16x16x4_f32 v[140:143], v210, v19, v[140:143]
    v_mfma_f32_16x16x4_f32 v[156:159], v214, v19, v[156:159]
    s_nop 0
    v_mfma_f32_16x16x4_f32 v[96:99], v179, v16, v[96:99]
    v_add_u32 v14, 35, v4
    v_add_u32 v15, 16, v1
    v_mfma_f32_16x16x4_f32 v[112:115], v183, v16, v[112:115]
    v_mul_u32_u24 v14, v14, v15
    v_and_b32 v14, 63, v14
    v_mfma_f32_16x16x4_f32 v[128:131], v179, v17, v[128:131]
    v_cvt_f32_u32 v14, v14
    v_mul_f32 v14, 0.015625, v14
    v_mfma_f32_16x16x4_f32 v[144:147], v183, v17, v[144:147]
    v_cos_f32 v19, v14
    v_sin_f32 v15, v14
    v_mfma_f32_16x16x4_f32 v[96:99], v211, v18, v[96:99]
    s_nop 0
    v_mov_b32 v20, v15
    v_mfma_f32_16x16x4_f32 v[112:115], v215, v18, v[112:115]
    v_sub_f32 v21, 0, v15
    v_mfma_f32_16x16x4_f32 v[128:131], v211, v16, v[128:131]
    v_mfma_f32_16x16x4_f32 v[144:147], v215, v16, v[144:147]
    s_nop 0
    v_mfma_f32_16x16x4_f32 v[100:103], v179, v19, v[100:103]
    v_add_u32 v14, 35, v4
    v_add_u32 v15, 32, v1
    v_mfma_f32_16x16x4_f32 v[116:119], v183, v19, v[116:119]
    v_mul_u32_u24 v14, v14, v15
    v_and_b32 v14, 63, v14
    v_mfma_f32_16x16x4_f32 v[132:135], v179, v20, v[132:135]
    v_cvt_f32_u32 v14, v14
    v_mul_f32 v14, 0.015625, v14
    v_mfma_f32_16x16x4_f32 v[148:151], v183, v20, v[148:151]
    v_cos_f32 v16, v14
    v_sin_f32 v15, v14
    v_mfma_f32_16x16x4_f32 v[100:103], v211, v21, v[100:103]
    s_nop 0
    v_mov_b32 v17, v15
    v_mfma_f32_16x16x4_f32 v[116:119], v215, v21, v[116:119]
    v_sub_f32 v18, 0, v15
    v_mfma_f32_16x16x4_f32 v[132:135], v211, v19, v[132:135]
    v_mfma_f32_16x16x4_f32 v[148:151], v215, v19, v[148:151]
    s_nop 0
    v_mfma_f32_16x16x4_f32 v[104:107], v179, v16, v[104:107]
    v_add_u32 v14, 35, v4
    v_add_u32 v15, 48, v1
    v_mfma_f32_16x16x4_f32 v[120:123], v183, v16, v[120:123]
    v_mul_u32_u24 v14, v14, v15
    v_and_b32 v14, 63, v14
    v_mfma_f32_16x16x4_f32 v[136:139], v179, v17, v[136:139]
    v_cvt_f32_u32 v14, v14
    v_mul_f32 v14, 0.015625, v14
    v_mfma_f32_16x16x4_f32 v[152:155], v183, v17, v[152:155]
    v_cos_f32 v19, v14
    v_sin_f32 v15, v14
    v_mfma_f32_16x16x4_f32 v[104:107], v211, v18, v[104:107]
    s_nop 0
    v_mov_b32 v20, v15
    v_mfma_f32_16x16x4_f32 v[120:123], v215, v18, v[120:123]
    v_sub_f32 v21, 0, v15
    v_mfma_f32_16x16x4_f32 v[136:139], v211, v16, v[136:139]
    v_mfma_f32_16x16x4_f32 v[152:155], v215, v16, v[152:155]
    s_nop 0
    v_mfma_f32_16x16x4_f32 v[108:111], v179, v19, v[108:111]
    v_add_u32 v14, 48, v4
    v_add_u32 v15, 0, v1
    v_mfma_f32_16x16x4_f32 v[124:127], v183, v19, v[124:127]
    v_mul_u32_u24 v14, v14, v15
    v_and_b32 v14, 63, v14
    v_mfma_f32_16x16x4_f32 v[140:143], v179, v20, v[140:143]
    v_cvt_f32_u32 v14, v14
    v_mul_f32 v14, 0.015625, v14
    v_mfma_f32_16x16x4_f32 v[156:159], v183, v20, v[156:159]
    v_cos_f32 v16, v14
    v_sin_f32 v15, v14
    v_mfma_f32_16x16x4_f32 v[108:111], v211, v21, v[108:111]
    s_nop 0
    v_mov_b32 v17, v15
    v_mfma_f32_16x16x4_f32 v[124:127], v215, v21, v[124:127]
    v_sub_f32 v18, 0, v15
    v_mfma_f32_16x16x4_f32 v[140:143], v211, v19, v[140:143]
    v_mfma_f32_16x16x4_f32 v[156:159], v215, v19, v[156:159]
    s_nop 0
    v_mfma_f32_16x16x4_f32 v[96:99], v184, v16, v[96:99]
    v_add_u32 v14, 48, v4
    v_add_u32 v15, 16, v1
    v_mfma_f32_16x16x4_f32 v[112:115], v188, v16, v[112:115]
    v_mul_u32_u24 v14, v14, v15
    v_and_b32 v14, 63, v14
    v_mfma_f32_16x16x4_f32 v[128:131], v184, v17, v[128:131]
    v_cvt_f32_u32 v14, v14
    v_mul_f32 v14, 0.015625, v14
    v_mfma_f32_16x16x4_f32 v[144:147], v188, v17, v[144:147]
    v_cos_f32 v19, v14
    v_sin_f32 v15, v14
    v_mfma_f32_16x16x4_f32 v[96:99], v216, v18, v[96:99]
    s_nop 0
    v_mov_b32 v20, v15
    v_mfma_f32_16x16x4_f32 v[112:115], v220, v18, v[112:115]
    v_sub_f32 v21, 0, v15
    v_mfma_f32_16x16x4_f32 v[128:131], v216, v16, v[128:131]
    v_mfma_f32_16x16x4_f32 v[144:147], v220, v16, v[144:147]
    s_nop 0
    v_mfma_f32_16x16x4_f32 v[100:103], v184, v19, v[100:103]
    v_add_u32 v14, 48, v4
    v_add_u32 v15, 32, v1
    v_mfma_f32_16x16x4_f32 v[116:119], v188, v19, v[116:119]
    v_mul_u32_u24 v14, v14, v15
    v_and_b32 v14, 63, v14
    v_mfma_f32_16x16x4_f32 v[132:135], v184, v20, v[132:135]
    v_cvt_f32_u32 v14, v14
    v_mul_f32 v14, 0.015625, v14
    v_mfma_f32_16x16x4_f32 v[148:151], v188, v20, v[148:151]
    v_cos_f32 v16, v14
    v_sin_f32 v15, v14
    v_mfma_f32_16x16x4_f32 v[100:103], v216, v21, v[100:103]
    s_nop 0
    v_mov_b32 v17, v15
    v_mfma_f32_16x16x4_f32 v[116:119], v220, v21, v[116:119]
    v_sub_f32 v18, 0, v15
    v_mfma_f32_16x16x4_f32 v[132:135], v216, v19, v[132:135]
    v_mfma_f32_16x16x4_f32 v[148:151], v220, v19, v[148:151]
    s_nop 0
    v_mfma_f32_16x16x4_f32 v[104:107], v184, v16, v[104:107]
    v_add_u32 v14, 48, v4
    v_add_u32 v15, 48, v1
    v_mfma_f32_16x16x4_f32 v[120:123], v188, v16, v[120:123]
    v_mul_u32_u24 v14, v14, v15
    v_and_b32 v14, 63, v14
    v_mfma_f32_16x16x4_f32 v[136:139], v184, v17, v[136:139]
    v_cvt_f32_u32 v14, v14
    v_mul_f32 v14, 0.015625, v14
    v_mfma_f32_16x16x4_f32 v[152:155], v188, v17, v[152:155]
    v_cos_f32 v19, v14
    v_sin_f32 v15, v14
    v_mfma_f32_16x16x4_f32 v[104:107], v216, v18, v[104:107]
    s_nop 0
    v_mov_b32 v20, v15
    v_mfma_f32_16x16x4_f32 v[120:123], v220, v18, v[120:123]
    v_sub_f32 v21, 0, v15
    v_mfma_f32_16x16x4_f32 v[136:139], v216, v16, v[136:139]
    v_mfma_f32_16x16x4_f32 v[152:155], v220, v16, v[152:155]
    s_nop 0
    v_mfma_f32_16x16x4_f32 v[108:111], v184, v19, v[108:111]
    v_add_u32 v14, 49, v4
    v_add_u32 v15, 0, v1
    v_mfma_f32_16x16x4_f32 v[124:127], v188, v19, v[124:127]
    v_mul_u32_u24 v14, v14, v15
    v_and_b32 v14, 63, v14
    v_mfma_f32_16x16x4_f32 v[140:143], v184, v20, v[140:143]
    v_cvt_f32_u32 v14, v14
    v_mul_f32 v14, 0.015625, v14
    v_mfma_f32_16x16x4_f32 v[156:159], v188, v20, v[156:159]
    v_cos_f32 v16, v14
    v_sin_f32 v15, v14
    v_mfma_f32_16x16x4_f32 v[108:111], v216, v21, v[108:111]
    s_nop 0
    v_mov_b32 v17, v15
    v_mfma_f32_16x16x4_f32 v[124:127], v220, v21, v[124:127]
    v_sub_f32 v18, 0, v15
    v_mfma_f32_16x16x4_f32 v[140:143], v216, v19, v[140:143]
    v_mfma_f32_16x16x4_f32 v[156:159], v220, v19, v[156:159]
    s_nop 0
    v_mfma_f32_16x16x4_f32 v[96:99], v185, v16, v[96:99]
    v_add_u32 v14, 49, v4
    v_add_u32 v15, 16, v1
    v_mfma_f32_16x16x4_f32 v[112:115], v189, v16, v[112:115]
    v_mul_u32_u24 v14, v14, v15
    v_and_b32 v14, 63, v14
    v_mfma_f32_16x16x4_f32 v[128:131], v185, v17, v[128:131]
    v_cvt_f32_u32 v14, v14
    v_mul_f32 v14, 0.015625, v14
    v_mfma_f32_16x16x4_f32 v[144:147], v189, v17, v[144:147]
    v_cos_f32 v19, v14
    v_sin_f32 v15, v14
    v_mfma_f32_16x16x4_f32 v[96:99], v217, v18, v[96:99]
    s_nop 0
    v_mov_b32 v20, v15
    v_mfma_f32_16x16x4_f32 v[112:115], v221, v18, v[112:115]
    v_sub_f32 v21, 0, v15
    v_mfma_f32_16x16x4_f32 v[128:131], v217, v16, v[128:131]
    v_mfma_f32_16x16x4_f32 v[144:147], v221, v16, v[144:147]
    s_nop 0
    v_mfma_f32_16x16x4_f32 v[100:103], v185, v19, v[100:103]
    v_add_u32 v14, 49, v4
    v_add_u32 v15, 32, v1
    v_mfma_f32_16x16x4_f32 v[116:119], v189, v19, v[116:119]
    v_mul_u32_u24 v14, v14, v15
    v_and_b32 v14, 63, v14
    v_mfma_f32_16x16x4_f32 v[132:135], v185, v20, v[132:135]
    v_cvt_f32_u32 v14, v14
    v_mul_f32 v14, 0.015625, v14
    v_mfma_f32_16x16x4_f32 v[148:151], v189, v20, v[148:151]
    v_cos_f32 v16, v14
    v_sin_f32 v15, v14
    v_mfma_f32_16x16x4_f32 v[100:103], v217, v21, v[100:103]
    s_nop 0
    v_mov_b32 v17, v15
    v_mfma_f32_16x16x4_f32 v[116:119], v221, v21, v[116:119]
    v_sub_f32 v18, 0, v15
    v_mfma_f32_16x16x4_f32 v[132:135], v217, v19, v[132:135]
    v_mfma_f32_16x16x4_f32 v[148:151], v221, v19, v[148:151]
    s_nop 0
    v_mfma_f32_16x16x4_f32 v[104:107], v185, v16, v[104:107]
    v_add_u32 v14, 49, v4
    v_add_u32 v15, 48, v1
    v_mfma_f32_16x16x4_f32 v[120:123], v189, v16, v[120:123]
    v_mul_u32_u24 v14, v14, v15
    v_and_b32 v14, 63, v14
    v_mfma_f32_16x16x4_f32 v[136:139], v185, v17, v[136:139]
    v_cvt_f32_u32 v14, v14
    v_mul_f32 v14, 0.015625, v14
    v_mfma_f32_16x16x4_f32 v[152:155], v189, v17, v[152:155]
    v_cos_f32 v19, v14
    v_sin_f32 v15, v14
    v_mfma_f32_16x16x4_f32 v[104:107], v217, v18, v[104:107]
    s_nop 0
    v_mov_b32 v20, v15
    v_mfma_f32_16x16x4_f32 v[120:123], v221, v18, v[120:123]
    v_sub_f32 v21, 0, v15
    v_mfma_f32_16x16x4_f32 v[136:139], v217, v16, v[136:139]
    v_mfma_f32_16x16x4_f32 v[152:155], v221, v16, v[152:155]
    s_nop 0
    v_mfma_f32_16x16x4_f32 v[108:111], v185, v19, v[108:111]
    v_add_u32 v14, 50, v4
    v_add_u32 v15, 0, v1
    v_mfma_f32_16x16x4_f32 v[124:127], v189, v19, v[124:127]
    v_mul_u32_u24 v14, v14, v15
    v_and_b32 v14, 63, v14
    v_mfma_f32_16x16x4_f32 v[140:143], v185, v20, v[140:143]
    v_cvt_f32_u32 v14, v14
    v_mul_f32 v14, 0.015625, v14
    v_mfma_f32_16x16x4_f32 v[156:159], v189, v20, v[156:159]
    v_cos_f32 v16, v14
    v_sin_f32 v15, v14
    v_mfma_f32_16x16x4_f32 v[108:111], v217, v21, v[108:111]
    s_nop 0
    v_mov_b32 v17, v15
    v_mfma_f32_16x16x4_f32 v[124:127], v221, v21, v[124:127]
    v_sub_f32 v18, 0, v15
    v_mfma_f32_16x16x4_f32 v[140:143], v217, v19, v[140:143]
    v_mfma_f32_16x16x4_f32 v[156:159], v221, v19, v[156:159]
    s_nop 0
    v_mfma_f32_16x16x4_f32 v[96:99], v186, v16, v[96:99]
    v_add_u32 v14, 50, v4
    v_add_u32 v15, 16, v1
    v_mfma_f32_16x16x4_f32 v[112:115], v190, v16, v[112:115]
    v_mul_u32_u24 v14, v14, v15
    v_and_b32 v14, 63, v14
    v_mfma_f32_16x16x4_f32 v[128:131], v186, v17, v[128:131]
    v_cvt_f32_u32 v14, v14
    v_mul_f32 v14, 0.015625, v14
    v_mfma_f32_16x16x4_f32 v[144:147], v190, v17, v[144:147]
    v_cos_f32 v19, v14
    v_sin_f32 v15, v14
    v_mfma_f32_16x16x4_f32 v[96:99], v218, v18, v[96:99]
    s_nop 0
    v_mov_b32 v20, v15
    v_mfma_f32_16x16x4_f32 v[112:115], v222, v18, v[112:115]
    v_sub_f32 v21, 0, v15
    v_mfma_f32_16x16x4_f32 v[128:131], v218, v16, v[128:131]
    v_mfma_f32_16x16x4_f32 v[144:147], v222, v16, v[144:147]
    s_nop 0
    v_mfma_f32_16x16x4_f32 v[100:103], v186, v19, v[100:103]
    v_add_u32 v14, 50, v4
    v_add_u32 v15, 32, v1
    v_mfma_f32_16x16x4_f32 v[116:119], v190, v19, v[116:119]
    v_mul_u32_u24 v14, v14, v15
    v_and_b32 v14, 63, v14
    v_mfma_f32_16x16x4_f32 v[132:135], v186, v20, v[132:135]
    v_cvt_f32_u32 v14, v14
    v_mul_f32 v14, 0.015625, v14
    v_mfma_f32_16x16x4_f32 v[148:151], v190, v20, v[148:151]
    v_cos_f32 v16, v14
    v_sin_f32 v15, v14
    v_mfma_f32_16x16x4_f32 v[100:103], v218, v21, v[100:103]
    s_nop 0
    v_mov_b32 v17, v15
    v_mfma_f32_16x16x4_f32 v[116:119], v222, v21, v[116:119]
    v_sub_f32 v18, 0, v15
    v_mfma_f32_16x16x4_f32 v[132:135], v218, v19, v[132:135]
    v_mfma_f32_16x16x4_f32 v[148:151], v222, v19, v[148:151]
    s_nop 0
    v_mfma_f32_16x16x4_f32 v[104:107], v186, v16, v[104:107]
    v_add_u32 v14, 50, v4
    v_add_u32 v15, 48, v1
    v_mfma_f32_16x16x4_f32 v[120:123], v190, v16, v[120:123]
    v_mul_u32_u24 v14, v14, v15
    v_and_b32 v14, 63, v14
    v_mfma_f32_16x16x4_f32 v[136:139], v186, v17, v[136:139]
    v_cvt_f32_u32 v14, v14
    v_mul_f32 v14, 0.015625, v14
    v_mfma_f32_16x16x4_f32 v[152:155], v190, v17, v[152:155]
    v_cos_f32 v19, v14
    v_sin_f32 v15, v14
    v_mfma_f32_16x16x4_f32 v[104:107], v218, v18, v[104:107]
    s_nop 0
    v_mov_b32 v20, v15
    v_mfma_f32_16x16x4_f32 v[120:123], v222, v18, v[120:123]
    v_sub_f32 v21, 0, v15
    v_mfma_f32_16x16x4_f32 v[136:139], v218, v16, v[136:139]
    v_mfma_f32_16x16x4_f32 v[152:155], v222, v16, v[152:155]
    s_nop 0
    v_mfma_f32_16x16x4_f32 v[108:111], v186, v19, v[108:111]
    v_add_u32 v14, 51, v4
    v_add_u32 v15, 0, v1
    v_mfma_f32_16x16x4_f32 v[124:127], v190, v19, v[124:127]
    v_mul_u32_u24 v14, v14, v15
    v_and_b32 v14, 63, v14
    v_mfma_f32_16x16x4_f32 v[140:143], v186, v20, v[140:143]
    v_cvt_f32_u32 v14, v14
    v_mul_f32 v14, 0.015625, v14
    v_mfma_f32_16x16x4_f32 v[156:159], v190, v20, v[156:159]
    v_cos_f32 v16, v14
    v_sin_f32 v15, v14
    v_mfma_f32_16x16x4_f32 v[108:111], v218, v21, v[108:111]
    s_nop 0
    v_mov_b32 v17, v15
    v_mfma_f32_16x16x4_f32 v[124:127], v222, v21, v[124:127]
    v_sub_f32 v18, 0, v15
    v_mfma_f32_16x16x4_f32 v[140:143], v218, v19, v[140:143]
    v_mfma_f32_16x16x4_f32 v[156:159], v222, v19, v[156:159]
    s_nop 0
    v_mfma_f32_16x16x4_f32 v[96:99], v187, v16, v[96:99]
    v_add_u32 v14, 51, v4
    v_add_u32 v15, 16, v1
    v_mfma_f32_16x16x4_f32 v[112:115], v191, v16, v[112:115]
    v_mul_u32_u24 v14, v14, v15
    v_and_b32 v14, 63, v14
    v_mfma_f32_16x16x4_f32 v[128:131], v187, v17, v[128:131]
    v_cvt_f32_u32 v14, v14
    v_mul_f32 v14, 0.015625, v14
    v_mfma_f32_16x16x4_f32 v[144:147], v191, v17, v[144:147]
    v_cos_f32 v19, v14
    v_sin_f32 v15, v14
    v_mfma_f32_16x16x4_f32 v[96:99], v219, v18, v[96:99]
    s_nop 0
    v_mov_b32 v20, v15
    v_mfma_f32_16x16x4_f32 v[112:115], v223, v18, v[112:115]
    v_sub_f32 v21, 0, v15
    v_mfma_f32_16x16x4_f32 v[128:131], v219, v16, v[128:131]
    v_mfma_f32_16x16x4_f32 v[144:147], v223, v16, v[144:147]
    s_nop 0
    v_mfma_f32_16x16x4_f32 v[100:103], v187, v19, v[100:103]
    v_add_u32 v14, 51, v4
    v_add_u32 v15, 32, v1
    v_mfma_f32_16x16x4_f32 v[116:119], v191, v19, v[116:119]
    v_mul_u32_u24 v14, v14, v15
    v_and_b32 v14, 63, v14
    v_mfma_f32_16x16x4_f32 v[132:135], v187, v20, v[132:135]
    v_cvt_f32_u32 v14, v14
    v_mul_f32 v14, 0.015625, v14
    v_mfma_f32_16x16x4_f32 v[148:151], v191, v20, v[148:151]
    v_cos_f32 v16, v14
    v_sin_f32 v15, v14
    v_mfma_f32_16x16x4_f32 v[100:103], v219, v21, v[100:103]
    s_nop 0
    v_mov_b32 v17, v15
    v_mfma_f32_16x16x4_f32 v[116:119], v223, v21, v[116:119]
    v_sub_f32 v18, 0, v15
    v_mfma_f32_16x16x4_f32 v[132:135], v219, v19, v[132:135]
    v_mfma_f32_16x16x4_f32 v[148:151], v223, v19, v[148:151]
    s_nop 0
    v_mfma_f32_16x16x4_f32 v[104:107], v187, v16, v[104:107]
    v_add_u32 v14, 51, v4
    v_add_u32 v15, 48, v1
    v_mfma_f32_16x16x4_f32 v[120:123], v191, v16, v[120:123]
    v_mul_u32_u24 v14, v14, v15
    v_and_b32 v14, 63, v14
    v_mfma_f32_16x16x4_f32 v[136:139], v187, v17, v[136:139]
    v_cvt_f32_u32 v14, v14
    v_mul_f32 v14, 0.015625, v14
    v_mfma_f32_16x16x4_f32 v[152:155], v191, v17, v[152:155]
    v_cos_f32 v19, v14
    v_sin_f32 v15, v14
    v_mfma_f32_16x16x4_f32 v[104:107], v219, v18, v[104:107]
    s_nop 0
    v_mov_b32 v20, v15
    v_mfma_f32_16x16x4_f32 v[120:123], v223, v18, v[120:123]
    v_sub_f32 v21, 0, v15
    v_mfma_f32_16x16x4_f32 v[136:139], v219, v16, v[136:139]
    v_mfma_f32_16x16x4_f32 v[152:155], v223, v16, v[152:155]
    s_nop 0
    v_mfma_f32_16x16x4_f32 v[108:111], v187, v19, v[108:111]
    v_mfma_f32_16x16x4_f32 v[124:127], v191, v19, v[124:127]
    v_mfma_f32_16x16x4_f32 v[140:143], v187, v20, v[140:143]
    v_mfma_f32_16x16x4_f32 v[156:159], v191, v20, v[156:159]
    v_mfma_f32_16x16x4_f32 v[108:111], v219, v21, v[108:111]
    v_mfma_f32_16x16x4_f32 v[124:127], v223, v21, v[124:127]
    v_mfma_f32_16x16x4_f32 v[140:143], v219, v19, v[140:143]
    v_mfma_f32_16x16x4_f32 v[156:159], v223, v19, v[156:159]
    s_nop 9
    v_add_u32 v14, 0, v4
    v_add_u32 v15, 0, v1
    v_mul_u32_u24 v14, v14, v15
    v_cvt_f32_u32 v14, v14
    v_mul_f32 v14, 0.00048828125, v14
    v_cos_f32 v8, v14
    v_sin_f32 v9, v14
    s_nop 0
    v_mul_f32 v10, v96, v8
    v_mul_f32 v11, v128, v8
    v_fma_f32 v10, -v128, v9, v10
    v_fma_f32 v128, v96, v9, v11
    v_mov_b32 v96, v10
    v_add_u32 v14, 1, v4
    v_add_u32 v15, 0, v1
    v_mul_u32_u24 v14, v14, v15
    v_cvt_f32_u32 v14, v14
    v_mul_f32 v14, 0.00048828125, v14
    v_cos_f32 v8, v14
    v_sin_f32 v9, v14
    s_nop 0
    v_mul_f32 v10, v97, v8
    v_mul_f32 v11, v129, v8
    v_fma_f32 v10, -v129, v9, v10
    v_fma_f32 v129, v97, v9, v11
    v_mov_b32 v97, v10
    v_add_u32 v14, 2, v4
    v_add_u32 v15, 0, v1
    v_mul_u32_u24 v14, v14, v15
    v_cvt_f32_u32 v14, v14
    v_mul_f32 v14, 0.00048828125, v14
    v_cos_f32 v8, v14
    v_sin_f32 v9, v14
    s_nop 0
    v_mul_f32 v10, v98, v8
    v_mul_f32 v11, v130, v8
    v_fma_f32 v10, -v130, v9, v10
    v_fma_f32 v130, v98, v9, v11
    v_mov_b32 v98, v10
    v_add_u32 v14, 3, v4
    v_add_u32 v15, 0, v1
    v_mul_u32_u24 v14, v14, v15
    v_cvt_f32_u32 v14, v14
    v_mul_f32 v14, 0.00048828125, v14
    v_cos_f32 v8, v14
    v_sin_f32 v9, v14
    s_nop 0
    v_mul_f32 v10, v99, v8
    v_mul_f32 v11, v131, v8
    v_fma_f32 v10, -v131, v9, v10
    v_fma_f32 v131, v99, v9, v11
    v_mov_b32 v99, v10
    v_add_u32 v14, 0, v4
    v_add_u32 v15, 16, v1
    v_mul_u32_u24 v14, v14, v15
    v_cvt_f32_u32 v14, v14
    v_mul_f32 v14, 0.00048828125, v14
    v_cos_f32 v8, v14
    v_sin_f32 v9, v14
    s_nop 0
    v_mul_f32 v10, v100, v8
    v_mul_f32 v11, v132, v8
    v_fma_f32 v10, -v132, v9, v10
    v_fma_f32 v132, v100, v9, v11
    v_mov_b32 v100, v10
    v_add_u32 v14, 1, v4
    v_add_u32 v15, 16, v1
    v_mul_u32_u24 v14, v14, v15
    v_cvt_f32_u32 v14, v14
    v_mul_f32 v14, 0.00048828125, v14
    v_cos_f32 v8, v14
    v_sin_f32 v9, v14
    s_nop 0
    v_mul_f32 v10, v101, v8
    v_mul_f32 v11, v133, v8
    v_fma_f32 v10, -v133, v9, v10
    v_fma_f32 v133, v101, v9, v11
    v_mov_b32 v101, v10
    v_add_u32 v14, 2, v4
    v_add_u32 v15, 16, v1
    v_mul_u32_u24 v14, v14, v15
    v_cvt_f32_u32 v14, v14
    v_mul_f32 v14, 0.00048828125, v14
    v_cos_f32 v8, v14
    v_sin_f32 v9, v14
    s_nop 0
    v_mul_f32 v10, v102, v8
    v_mul_f32 v11, v134, v8
    v_fma_f32 v10, -v134, v9, v10
    v_fma_f32 v134, v102, v9, v11
    v_mov_b32 v102, v10
    v_add_u32 v14, 3, v4
    v_add_u32 v15, 16, v1
    v_mul_u32_u24 v14, v14, v15
    v_cvt_f32_u32 v14, v14
    v_mul_f32 v14, 0.00048828125, v14
    v_cos_f32 v8, v14
    v_sin_f32 v9, v14
    s_nop 0
    v_mul_f32 v10, v103, v8
    v_mul_f32 v11, v135, v8
    v_fma_f32 v10, -v135, v9, v10
    v_fma_f32 v135, v103, v9, v11
    v_mov_b32 v103, v10
    v_add_u32 v14, 0, v4
    v_add_u32 v15, 32, v1
    v_mul_u32_u24 v14, v14, v15
    v_cvt_f32_u32 v14, v14
    v_mul_f32 v14, 0.00048828125, v14
    v_cos_f32 v8, v14
    v_sin_f32 v9, v14
    s_nop 0
    v_mul_f32 v10, v104, v8
    v_mul_f32 v11, v136, v8
    v_fma_f32 v10, -v136, v9, v10
    v_fma_f32 v136, v104, v9, v11
    v_mov_b32 v104, v10
    v_add_u32 v14, 1, v4
    v_add_u32 v15, 32, v1
    v_mul_u32_u24 v14, v14, v15
    v_cvt_f32_u32 v14, v14
    v_mul_f32 v14, 0.00048828125, v14
    v_cos_f32 v8, v14
    v_sin_f32 v9, v14
    s_nop 0
    v_mul_f32 v10, v105, v8
    v_mul_f32 v11, v137, v8
    v_fma_f32 v10, -v137, v9, v10
    v_fma_f32 v137, v105, v9, v11
    v_mov_b32 v105, v10
    v_add_u32 v14, 2, v4
    v_add_u32 v15, 32, v1
    v_mul_u32_u24 v14, v14, v15
    v_cvt_f32_u32 v14, v14
    v_mul_f32 v14, 0.00048828125, v14
    v_cos_f32 v8, v14
    v_sin_f32 v9, v14
    s_nop 0
    v_mul_f32 v10, v106, v8
    v_mul_f32 v11, v138, v8
    v_fma_f32 v10, -v138, v9, v10
    v_fma_f32 v138, v106, v9, v11
    v_mov_b32 v106, v10
    v_add_u32 v14, 3, v4
    v_add_u32 v15, 32, v1
    v_mul_u32_u24 v14, v14, v15
    v_cvt_f32_u32 v14, v14
    v_mul_f32 v14, 0.00048828125, v14
    v_cos_f32 v8, v14
    v_sin_f32 v9, v14
    s_nop 0
    v_mul_f32 v10, v107, v8
    v_mul_f32 v11, v139, v8
    v_fma_f32 v10, -v139, v9, v10
    v_fma_f32 v139, v107, v9, v11
    v_mov_b32 v107, v10
    v_add_u32 v14, 0, v4
    v_add_u32 v15, 48, v1
    v_mul_u32_u24 v14, v14, v15
    v_cvt_f32_u32 v14, v14
    v_mul_f32 v14, 0.00048828125, v14
    v_cos_f32 v8, v14
    v_sin_f32 v9, v14
    s_nop 0
    v_mul_f32 v10, v108, v8
    v_mul_f32 v11, v140, v8
    v_fma_f32 v10, -v140, v9, v10
    v_fma_f32 v140, v108, v9, v11
    v_mov_b32 v108, v10
    v_add_u32 v14, 1, v4
    v_add_u32 v15, 48, v1
    v_mul_u32_u24 v14, v14, v15
    v_cvt_f32_u32 v14, v14
    v_mul_f32 v14, 0.00048828125, v14
    v_cos_f32 v8, v14
    v_sin_f32 v9, v14
    s_nop 0
    v_mul_f32 v10, v109, v8
    v_mul_f32 v11, v141, v8
    v_fma_f32 v10, -v141, v9, v10
    v_fma_f32 v141, v109, v9, v11
    v_mov_b32 v109, v10
    v_add_u32 v14, 2, v4
    v_add_u32 v15, 48, v1
    v_mul_u32_u24 v14, v14, v15
    v_cvt_f32_u32 v14, v14
    v_mul_f32 v14, 0.00048828125, v14
    v_cos_f32 v8, v14
    v_sin_f32 v9, v14
    s_nop 0
    v_mul_f32 v10, v110, v8
    v_mul_f32 v11, v142, v8
    v_fma_f32 v10, -v142, v9, v10
    v_fma_f32 v142, v110, v9, v11
    v_mov_b32 v110, v10
    v_add_u32 v14, 3, v4
    v_add_u32 v15, 48, v1
    v_mul_u32_u24 v14, v14, v15
    v_cvt_f32_u32 v14, v14
    v_mul_f32 v14, 0.00048828125, v14
    v_cos_f32 v8, v14
    v_sin_f32 v9, v14
    s_nop 0
    v_mul_f32 v10, v111, v8
    v_mul_f32 v11, v143, v8
    v_fma_f32 v10, -v143, v9, v10
    v_fma_f32 v143, v111, v9, v11
    v_mov_b32 v111, v10
    v_add_u32 v14, 16, v4
    v_add_u32 v15, 0, v1
    v_mul_u32_u24 v14, v14, v15
    v_cvt_f32_u32 v14, v14
    v_mul_f32 v14, 0.00048828125, v14
    v_cos_f32 v8, v14
    v_sin_f32 v9, v14
    s_nop 0
    v_mul_f32 v10, v112, v8
    v_mul_f32 v11, v144, v8
    v_fma_f32 v10, -v144, v9, v10
    v_fma_f32 v144, v112, v9, v11
    v_mov_b32 v112, v10
    v_add_u32 v14, 17, v4
    v_add_u32 v15, 0, v1
    v_mul_u32_u24 v14, v14, v15
    v_cvt_f32_u32 v14, v14
    v_mul_f32 v14, 0.00048828125, v14
    v_cos_f32 v8, v14
    v_sin_f32 v9, v14
    s_nop 0
    v_mul_f32 v10, v113, v8
    v_mul_f32 v11, v145, v8
    v_fma_f32 v10, -v145, v9, v10
    v_fma_f32 v145, v113, v9, v11
    v_mov_b32 v113, v10
    v_add_u32 v14, 18, v4
    v_add_u32 v15, 0, v1
    v_mul_u32_u24 v14, v14, v15
    v_cvt_f32_u32 v14, v14
    v_mul_f32 v14, 0.00048828125, v14
    v_cos_f32 v8, v14
    v_sin_f32 v9, v14
    s_nop 0
    v_mul_f32 v10, v114, v8
    v_mul_f32 v11, v146, v8
    v_fma_f32 v10, -v146, v9, v10
    v_fma_f32 v146, v114, v9, v11
    v_mov_b32 v114, v10
    v_add_u32 v14, 19, v4
    v_add_u32 v15, 0, v1
    v_mul_u32_u24 v14, v14, v15
    v_cvt_f32_u32 v14, v14
    v_mul_f32 v14, 0.00048828125, v14
    v_cos_f32 v8, v14
    v_sin_f32 v9, v14
    s_nop 0
    v_mul_f32 v10, v115, v8
    v_mul_f32 v11, v147, v8
    v_fma_f32 v10, -v147, v9, v10
    v_fma_f32 v147, v115, v9, v11
    v_mov_b32 v115, v10
    v_add_u32 v14, 16, v4
    v_add_u32 v15, 16, v1
    v_mul_u32_u24 v14, v14, v15
    v_cvt_f32_u32 v14, v14
    v_mul_f32 v14, 0.00048828125, v14
    v_cos_f32 v8, v14
    v_sin_f32 v9, v14
    s_nop 0
    v_mul_f32 v10, v116, v8
    v_mul_f32 v11, v148, v8
    v_fma_f32 v10, -v148, v9, v10
    v_fma_f32 v148, v116, v9, v11
    v_mov_b32 v116, v10
    v_add_u32 v14, 17, v4
    v_add_u32 v15, 16, v1
    v_mul_u32_u24 v14, v14, v15
    v_cvt_f32_u32 v14, v14
    v_mul_f32 v14, 0.00048828125, v14
    v_cos_f32 v8, v14
    v_sin_f32 v9, v14
    s_nop 0
    v_mul_f32 v10, v117, v8
    v_mul_f32 v11, v149, v8
    v_fma_f32 v10, -v149, v9, v10
    v_fma_f32 v149, v117, v9, v11
    v_mov_b32 v117, v10
    v_add_u32 v14, 18, v4
    v_add_u32 v15, 16, v1
    v_mul_u32_u24 v14, v14, v15
    v_cvt_f32_u32 v14, v14
    v_mul_f32 v14, 0.00048828125, v14
    v_cos_f32 v8, v14
    v_sin_f32 v9, v14
    s_nop 0
    v_mul_f32 v10, v118, v8
    v_mul_f32 v11, v150, v8
    v_fma_f32 v10, -v150, v9, v10
    v_fma_f32 v150, v118, v9, v11
    v_mov_b32 v118, v10
    v_add_u32 v14, 19, v4
    v_add_u32 v15, 16, v1
    v_mul_u32_u24 v14, v14, v15
    v_cvt_f32_u32 v14, v14
    v_mul_f32 v14, 0.00048828125, v14
    v_cos_f32 v8, v14
    v_sin_f32 v9, v14
    s_nop 0
    v_mul_f32 v10, v119, v8
    v_mul_f32 v11, v151, v8
    v_fma_f32 v10, -v151, v9, v10
    v_fma_f32 v151, v119, v9, v11
    v_mov_b32 v119, v10
    v_add_u32 v14, 16, v4
    v_add_u32 v15, 32, v1
    v_mul_u32_u24 v14, v14, v15
    v_cvt_f32_u32 v14, v14
    v_mul_f32 v14, 0.00048828125, v14
    v_cos_f32 v8, v14
    v_sin_f32 v9, v14
    s_nop 0
    v_mul_f32 v10, v120, v8
    v_mul_f32 v11, v152, v8
    v_fma_f32 v10, -v152, v9, v10
    v_fma_f32 v152, v120, v9, v11
    v_mov_b32 v120, v10
    v_add_u32 v14, 17, v4
    v_add_u32 v15, 32, v1
    v_mul_u32_u24 v14, v14, v15
    v_cvt_f32_u32 v14, v14
    v_mul_f32 v14, 0.00048828125, v14
    v_cos_f32 v8, v14
    v_sin_f32 v9, v14
    s_nop 0
    v_mul_f32 v10, v121, v8
    v_mul_f32 v11, v153, v8
    v_fma_f32 v10, -v153, v9, v10
    v_fma_f32 v153, v121, v9, v11
    v_mov_b32 v121, v10
    v_add_u32 v14, 18, v4
    v_add_u32 v15, 32, v1
    v_mul_u32_u24 v14, v14, v15
    v_cvt_f32_u32 v14, v14
    v_mul_f32 v14, 0.00048828125, v14
    v_cos_f32 v8, v14
    v_sin_f32 v9, v14
    s_nop 0
    v_mul_f32 v10, v122, v8
    v_mul_f32 v11, v154, v8
    v_fma_f32 v10, -v154, v9, v10
    v_fma_f32 v154, v122, v9, v11
    v_mov_b32 v122, v10
    v_add_u32 v14, 19, v4
    v_add_u32 v15, 32, v1
    v_mul_u32_u24 v14, v14, v15
    v_cvt_f32_u32 v14, v14
    v_mul_f32 v14, 0.00048828125, v14
    v_cos_f32 v8, v14
    v_sin_f32 v9, v14
    s_nop 0
    v_mul_f32 v10, v123, v8
    v_mul_f32 v11, v155, v8
    v_fma_f32 v10, -v155, v9, v10
    v_fma_f32 v155, v123, v9, v11
    v_mov_b32 v123, v10
    v_add_u32 v14, 16, v4
    v_add_u32 v15, 48, v1
    v_mul_u32_u24 v14, v14, v15
    v_cvt_f32_u32 v14, v14
    v_mul_f32 v14, 0.00048828125, v14
    v_cos_f32 v8, v14
    v_sin_f32 v9, v14
    s_nop 0
    v_mul_f32 v10, v124, v8
    v_mul_f32 v11, v156, v8
    v_fma_f32 v10, -v156, v9, v10
    v_fma_f32 v156, v124, v9, v11
    v_mov_b32 v124, v10
    v_add_u32 v14, 17, v4
    v_add_u32 v15, 48, v1
    v_mul_u32_u24 v14, v14, v15
    v_cvt_f32_u32 v14, v14
    v_mul_f32 v14, 0.00048828125, v14
    v_cos_f32 v8, v14
    v_sin_f32 v9, v14
    s_nop 0
    v_mul_f32 v10, v125, v8
    v_mul_f32 v11, v157, v8
    v_fma_f32 v10, -v157, v9, v10
    v_fma_f32 v157, v125, v9, v11
    v_mov_b32 v125, v10
    v_add_u32 v14, 18, v4
    v_add_u32 v15, 48, v1
    v_mul_u32_u24 v14, v14, v15
    v_cvt_f32_u32 v14, v14
    v_mul_f32 v14, 0.00048828125, v14
    v_cos_f32 v8, v14
    v_sin_f32 v9, v14
    s_nop 0
    v_mul_f32 v10, v126, v8
    v_mul_f32 v11, v158, v8
    v_fma_f32 v10, -v158, v9, v10
    v_fma_f32 v158, v126, v9, v11
    v_mov_b32 v126, v10
    v_add_u32 v14, 19, v4
    v_add_u32 v15, 48, v1
    v_mul_u32_u24 v14, v14, v15
    v_cvt_f32_u32 v14, v14
    v_mul_f32 v14, 0.00048828125, v14
    v_cos_f32 v8, v14
    v_sin_f32 v9, v14
    s_nop 0
    v_mul_f32 v10, v127, v8
    v_mul_f32 v11, v159, v8
    v_fma_f32 v10, -v159, v9, v10
    v_fma_f32 v159, v127, v9, v11
    v_mov_b32 v127, v10
    v_mov_b32 v160, 0
    v_mov_b32 v161, 0
    v_mov_b32 v162, 0
    v_mov_b32 v163, 0
    v_mov_b32 v164, 0
    v_mov_b32 v165, 0
    v_mov_b32 v166, 0
    v_mov_b32 v167, 0
    v_mov_b32 v168, 0
    v_mov_b32 v169, 0
    v_mov_b32 v170, 0
    v_mov_b32 v171, 0
    v_mov_b32 v172, 0
    v_mov_b32 v173, 0
    v_mov_b32 v174, 0
    v_mov_b32 v175, 0
    v_mov_b32 v176, 0
    v_mov_b32 v177, 0
    v_mov_b32 v178, 0
    v_mov_b32 v179, 0
    v_mov_b32 v180, 0
    v_mov_b32 v181, 0
    v_mov_b32 v182, 0
    v_mov_b32 v183, 0
    v_mov_b32 v184, 0
    v_mov_b32 v185, 0
    v_mov_b32 v186, 0
    v_mov_b32 v187, 0
    v_mov_b32 v188, 0
    v_mov_b32 v189, 0
    v_mov_b32 v190, 0
    v_mov_b32 v191, 0
    v_mov_b32 v192, 0
    v_mov_b32 v193, 0
    v_mov_b32 v194, 0
    v_mov_b32 v195, 0
    v_mov_b32 v196, 0
    v_mov_b32 v197, 0
    v_mov_b32 v198, 0
    v_mov_b32 v199, 0
    v_mov_b32 v200, 0
    v_mov_b32 v201, 0
    v_mov_b32 v202, 0
    v_mov_b32 v203, 0
    v_mov_b32 v204, 0
    v_mov_b32 v205, 0
    v_mov_b32 v206, 0
    v_mov_b32 v207, 0
    v_mov_b32 v208, 0
    v_mov_b32 v209, 0
    v_mov_b32 v210, 0
    v_mov_b32 v211, 0
    v_mov_b32 v212, 0
    v_mov_b32 v213, 0
    v_mov_b32 v214, 0
    v_mov_b32 v215, 0
    v_mov_b32 v216, 0
    v_mov_b32 v217, 0
    v_mov_b32 v218, 0
    v_mov_b32 v219, 0
    v_mov_b32 v220, 0
    v_mov_b32 v221, 0
    v_mov_b32 v222, 0
    v_mov_b32 v223, 0
    v_add_u32 v14, 0, v1
    v_add_u32 v15, 0, v4
    v_mul_u32_u24 v14, v14, v15
    v_and_b32 v14, 31, v14
    v_cvt_f32_u32 v14, v14
    v_mul_f32 v14, 0.03125, v14
    v_cos_f32 v16, v14
    v_sin_f32 v15, v14
    s_nop 0
    v_mov_b32 v17, v15
    v_sub_f32 v18, 0, v15
    s_nop 0
    v_mfma_f32_16x16x4_f32 v[160:163], v16, v96, v[160:163]
    v_add_u32 v14, 16, v1
    v_add_u32 v15, 0, v4
    v_mfma_f32_16x16x4_f32 v[164:167], v16, v100, v[164:167]
    v_mul_u32_u24 v14, v14, v15
    v_and_b32 v14, 31, v14
    v_mfma_f32_16x16x4_f32 v[168:171], v16, v104, v[168:171]
    v_cvt_f32_u32 v14, v14
    v_mul_f32 v14, 0.03125, v14
    v_mfma_f32_16x16x4_f32 v[172:175], v16, v108, v[172:175]
    v_cos_f32 v19, v14
    v_sin_f32 v15, v14
    v_mfma_f32_16x16x4_f32 v[192:195], v17, v96, v[192:195]
    s_nop 0
    v_mov_b32 v20, v15
    v_mfma_f32_16x16x4_f32 v[196:199], v17, v100, v[196:199]
    v_sub_f32 v21, 0, v15
    v_mfma_f32_16x16x4_f32 v[200:203], v17, v104, v[200:203]
    v_mfma_f32_16x16x4_f32 v[204:207], v17, v108, v[204:207]
    v_mfma_f32_16x16x4_f32 v[160:163], v18, v128, v[160:163]
    v_mfma_f32_16x16x4_f32 v[164:167], v18, v132, v[164:167]
    v_mfma_f32_16x16x4_f32 v[168:171], v18, v136, v[168:171]
    v_mfma_f32_16x16x4_f32 v[172:175], v18, v140, v[172:175]
    v_mfma_f32_16x16x4_f32 v[192:195], v16, v128, v[192:195]
    v_mfma_f32_16x16x4_f32 v[196:199], v16, v132, v[196:199]
    v_mfma_f32_16x16x4_f32 v[200:203], v16, v136, v[200:203]
    v_mfma_f32_16x16x4_f32 v[204:207], v16, v140, v[204:207]
    s_nop 0
    v_mfma_f32_16x16x4_f32 v[176:179], v19, v96, v[176:179]
    v_add_u32 v14, 0, v1
    v_add_u32 v15, 1, v4
    v_mfma_f32_16x16x4_f32 v[180:183], v19, v100, v[180:183]
    v_mul_u32_u24 v14, v14, v15
    v_and_b32 v14, 31, v14
    v_mfma_f32_16x16x4_f32 v[184:187], v19, v104, v[184:187]
    v_cvt_f32_u32 v14, v14
    v_mul_f32 v14, 0.03125, v14
    v_mfma_f32_16x16x4_f32 v[188:191], v19, v108, v[188:191]
    v_cos_f32 v16, v14
    v_sin_f32 v15, v14
    v_mfma_f32_16x16x4_f32 v[208:211], v20, v96, v[208:211]
    s_nop 0
    v_mov_b32 v17, v15
    v_mfma_f32_16x16x4_f32 v[212:215], v20, v100, v[212:215]
    v_sub_f32 v18, 0, v15
    v_mfma_f32_16x16x4_f32 v[216:219], v20, v104, v[216:219]
    v_mfma_f32_16x16x4_f32 v[220:223], v20, v108, v[220:223]
    v_mfma_f32_16x16x4_f32 v[176:179], v21, v128, v[176:179]
    v_mfma_f32_16x16x4_f32 v[180:183], v21, v132, v[180:183]
    v_mfma_f32_16x16x4_f32 v[184:187], v21, v136, v[184:187]
    v_mfma_f32_16x16x4_f32 v[188:191], v21, v140, v[188:191]
    v_mfma_f32_16x16x4_f32 v[208:211], v19, v128, v[208:211]
    v_mfma_f32_16x16x4_f32 v[212:215], v19, v132, v[212:215]
    v_mfma_f32_16x16x4_f32 v[216:219], v19, v136, v[216:219]
    v_mfma_f32_16x16x4_f32 v[220:223], v19, v140, v[220:223]
    s_nop 0
    v_mfma_f32_16x16x4_f32 v[160:163], v16, v97, v[160:163]
    v_add_u32 v14, 16, v1
    v_add_u32 v15, 1, v4
    v_mfma_f32_16x16x4_f32 v[164:167], v16, v101, v[164:167]
    v_mul_u32_u24 v14, v14, v15
    v_and_b32 v14, 31, v14
    v_mfma_f32_16x16x4_f32 v[168:171], v16, v105, v[168:171]
    v_cvt_f32_u32 v14, v14
    v_mul_f32 v14, 0.03125, v14
    v_mfma_f32_16x16x4_f32 v[172:175], v16, v109, v[172:175]
    v_cos_f32 v19, v14
    v_sin_f32 v15, v14
    v_mfma_f32_16x16x4_f32 v[192:195], v17, v97, v[192:195]
    s_nop 0
    v_mov_b32 v20, v15
    v_mfma_f32_16x16x4_f32 v[196:199], v17, v101, v[196:199]
    v_sub_f32 v21, 0, v15
    v_mfma_f32_16x16x4_f32 v[200:203], v17, v105, v[200:203]
    v_mfma_f32_16x16x4_f32 v[204:207], v17, v109, v[204:207]
    v_mfma_f32_16x16x4_f32 v[160:163], v18, v129, v[160:163]
    v_mfma_f32_16x16x4_f32 v[164:167], v18, v133, v[164:167]
    v_mfma_f32_16x16x4_f32 v[168:171], v18, v137, v[168:171]
    v_mfma_f32_16x16x4_f32 v[172:175], v18, v141, v[172:175]
    v_mfma_f32_16x16x4_f32 v[192:195], v16, v129, v[192:195]
    v_mfma_f32_16x16x4_f32 v[196:199], v16, v133, v[196:199]
    v_mfma_f32_16x16x4_f32 v[200:203], v16, v137, v[200:203]
    v_mfma_f32_16x16x4_f32 v[204:207], v16, v141, v[204:207]
    s_nop 0
    v_mfma_f32_16x16x4_f32 v[176:179], v19, v97, v[176:179]
    v_add_u32 v14, 0, v1
    v_add_u32 v15, 2, v4
    v_mfma_f32_16x16x4_f32 v[180:183], v19, v101, v[180:183]
    v_mul_u32_u24 v14, v14, v15
    v_and_b32 v14, 31, v14
    v_mfma_f32_16x16x4_f32 v[184:187], v19, v105, v[184:187]
    v_cvt_f32_u32 v14, v14
    v_mul_f32 v14, 0.03125, v14
    v_mfma_f32_16x16x4_f32 v[188:191], v19, v109, v[188:191]
    v_cos_f32 v16, v14
    v_sin_f32 v15, v14
    v_mfma_f32_16x16x4_f32 v[208:211], v20, v97, v[208:211]
    s_nop 0
    v_mov_b32 v17, v15
    v_mfma_f32_16x16x4_f32 v[212:215], v20, v101, v[212:215]
    v_sub_f32 v18, 0, v15
    v_mfma_f32_16x16x4_f32 v[216:219], v20, v105, v[216:219]
    v_mfma_f32_16x16x4_f32 v[220:223], v20, v109, v[220:223]
    v_mfma_f32_16x16x4_f32 v[176:179], v21, v129, v[176:179]
    v_mfma_f32_16x16x4_f32 v[180:183], v21, v133, v[180:183]
    v_mfma_f32_16x16x4_f32 v[184:187], v21, v137, v[184:187]
    v_mfma_f32_16x16x4_f32 v[188:191], v21, v141, v[188:191]
    v_mfma_f32_16x16x4_f32 v[208:211], v19, v129, v[208:211]
    v_mfma_f32_16x16x4_f32 v[212:215], v19, v133, v[212:215]
    v_mfma_f32_16x16x4_f32 v[216:219], v19, v137, v[216:219]
    v_mfma_f32_16x16x4_f32 v[220:223], v19, v141, v[220:223]
    s_nop 0
    v_mfma_f32_16x16x4_f32 v[160:163], v16, v98, v[160:163]
    v_add_u32 v14, 16, v1
    v_add_u32 v15, 2, v4
    v_mfma_f32_16x16x4_f32 v[164:167], v16, v102, v[164:167]
    v_mul_u32_u24 v14, v14, v15
    v_and_b32 v14, 31, v14
    v_mfma_f32_16x16x4_f32 v[168:171], v16, v106, v[168:171]
    v_cvt_f32_u32 v14, v14
    v_mul_f32 v14, 0.03125, v14
    v_mfma_f32_16x16x4_f32 v[172:175], v16, v110, v[172:175]
    v_cos_f32 v19, v14
    v_sin_f32 v15, v14
    v_mfma_f32_16x16x4_f32 v[192:195], v17, v98, v[192:195]
    s_nop 0
    v_mov_b32 v20, v15
    v_mfma_f32_16x16x4_f32 v[196:199], v17, v102, v[196:199]
    v_sub_f32 v21, 0, v15
    v_mfma_f32_16x16x4_f32 v[200:203], v17, v106, v[200:203]
    v_mfma_f32_16x16x4_f32 v[204:207], v17, v110, v[204:207]
    v_mfma_f32_16x16x4_f32 v[160:163], v18, v130, v[160:163]
    v_mfma_f32_16x16x4_f32 v[164:167], v18, v134, v[164:167]
    v_mfma_f32_16x16x4_f32 v[168:171], v18, v138, v[168:171]
    v_mfma_f32_16x16x4_f32 v[172:175], v18, v142, v[172:175]
    v_mfma_f32_16x16x4_f32 v[192:195], v16, v130, v[192:195]
    v_mfma_f32_16x16x4_f32 v[196:199], v16, v134, v[196:199]
    v_mfma_f32_16x16x4_f32 v[200:203], v16, v138, v[200:203]
    v_mfma_f32_16x16x4_f32 v[204:207], v16, v142, v[204:207]
    s_nop 0
    v_mfma_f32_16x16x4_f32 v[176:179], v19, v98, v[176:179]
    v_add_u32 v14, 0, v1
    v_add_u32 v15, 3, v4
    v_mfma_f32_16x16x4_f32 v[180:183], v19, v102, v[180:183]
    v_mul_u32_u24 v14, v14, v15
    v_and_b32 v14, 31, v14
    v_mfma_f32_16x16x4_f32 v[184:187], v19, v106, v[184:187]
    v_cvt_f32_u32 v14, v14
    v_mul_f32 v14, 0.03125, v14
    v_mfma_f32_16x16x4_f32 v[188:191], v19, v110, v[188:191]
    v_cos_f32 v16, v14
    v_sin_f32 v15, v14
    v_mfma_f32_16x16x4_f32 v[208:211], v20, v98, v[208:211]
    s_nop 0
    v_mov_b32 v17, v15
    v_mfma_f32_16x16x4_f32 v[212:215], v20, v102, v[212:215]
    v_sub_f32 v18, 0, v15
    v_mfma_f32_16x16x4_f32 v[216:219], v20, v106, v[216:219]
    v_mfma_f32_16x16x4_f32 v[220:223], v20, v110, v[220:223]
    v_mfma_f32_16x16x4_f32 v[176:179], v21, v130, v[176:179]
    v_mfma_f32_16x16x4_f32 v[180:183], v21, v134, v[180:183]
    v_mfma_f32_16x16x4_f32 v[184:187], v21, v138, v[184:187]
    v_mfma_f32_16x16x4_f32 v[188:191], v21, v142, v[188:191]
    v_mfma_f32_16x16x4_f32 v[208:211], v19, v130, v[208:211]
    v_mfma_f32_16x16x4_f32 v[212:215], v19, v134, v[212:215]
    v_mfma_f32_16x16x4_f32 v[216:219], v19, v138, v[216:219]
    v_mfma_f32_16x16x4_f32 v[220:223], v19, v142, v[220:223]
    s_nop 0
    v_mfma_f32_16x16x4_f32 v[160:163], v16, v99, v[160:163]
    v_add_u32 v14, 16, v1
    v_add_u32 v15, 3, v4
    v_mfma_f32_16x16x4_f32 v[164:167], v16, v103, v[164:167]
    v_mul_u32_u24 v14, v14, v15
    v_and_b32 v14, 31, v14
    v_mfma_f32_16x16x4_f32 v[168:171], v16, v107, v[168:171]
    v_cvt_f32_u32 v14, v14
    v_mul_f32 v14, 0.03125, v14
    v_mfma_f32_16x16x4_f32 v[172:175], v16, v111, v[172:175]
    v_cos_f32 v19, v14
    v_sin_f32 v15, v14
    v_mfma_f32_16x16x4_f32 v[192:195], v17, v99, v[192:195]
    s_nop 0
    v_mov_b32 v20, v15
    v_mfma_f32_16x16x4_f32 v[196:199], v17, v103, v[196:199]
    v_sub_f32 v21, 0, v15
    v_mfma_f32_16x16x4_f32 v[200:203], v17, v107, v[200:203]
    v_mfma_f32_16x16x4_f32 v[204:207], v17, v111, v[204:207]
    v_mfma_f32_16x16x4_f32 v[160:163], v18, v131, v[160:163]
    v_mfma_f32_16x16x4_f32 v[164:167], v18, v135, v[164:167]
    v_mfma_f32_16x16x4_f32 v[168:171], v18, v139, v[168:171]
    v_mfma_f32_16x16x4_f32 v[172:175], v18, v143, v[172:175]
    v_mfma_f32_16x16x4_f32 v[192:195], v16, v131, v[192:195]
    v_mfma_f32_16x16x4_f32 v[196:199], v16, v135, v[196:199]
    v_mfma_f32_16x16x4_f32 v[200:203], v16, v139, v[200:203]
    v_mfma_f32_16x16x4_f32 v[204:207], v16, v143, v[204:207]
    s_nop 0
    v_mfma_f32_16x16x4_f32 v[176:179], v19, v99, v[176:179]
    v_add_u32 v14, 0, v1
    v_add_u32 v15, 16, v4
    v_mfma_f32_16x16x4_f32 v[180:183], v19, v103, v[180:183]
    v_mul_u32_u24 v14, v14, v15
    v_and_b32 v14, 31, v14
    v_mfma_f32_16x16x4_f32 v[184:187], v19, v107, v[184:187]
    v_cvt_f32_u32 v14, v14
    v_mul_f32 v14, 0.03125, v14
    v_mfma_f32_16x16x4_f32 v[188:191], v19, v111, v[188:191]
    v_cos_f32 v16, v14
    v_sin_f32 v15, v14
    v_mfma_f32_16x16x4_f32 v[208:211], v20, v99, v[208:211]
    s_nop 0
    v_mov_b32 v17, v15
    v_mfma_f32_16x16x4_f32 v[212:215], v20, v103, v[212:215]
    v_sub_f32 v18, 0, v15
    v_mfma_f32_16x16x4_f32 v[216:219], v20, v107, v[216:219]
    v_mfma_f32_16x16x4_f32 v[220:223], v20, v111, v[220:223]
    v_mfma_f32_16x16x4_f32 v[176:179], v21, v131, v[176:179]
    v_mfma_f32_16x16x4_f32 v[180:183], v21, v135, v[180:183]
    v_mfma_f32_16x16x4_f32 v[184:187], v21, v139, v[184:187]
    v_mfma_f32_16x16x4_f32 v[188:191], v21, v143, v[188:191]
    v_mfma_f32_16x16x4_f32 v[208:211], v19, v131, v[208:211]
    v_mfma_f32_16x16x4_f32 v[212:215], v19, v135, v[212:215]
    v_mfma_f32_16x16x4_f32 v[216:219], v19, v139, v[216:219]
    v_mfma_f32_16x16x4_f32 v[220:223], v19, v143, v[220:223]
    s_nop 0
    v_mfma_f32_16x16x4_f32 v[160:163], v16, v112, v[160:163]
    v_add_u32 v14, 16, v1
    v_add_u32 v15, 16, v4
    v_mfma_f32_16x16x4_f32 v[164:167], v16, v116, v[164:167]
    v_mul_u32_u24 v14, v14, v15
    v_and_b32 v14, 31, v14
    v_mfma_f32_16x16x4_f32 v[168:171], v16, v120, v[168:171]
    v_cvt_f32_u32 v14, v14
    v_mul_f32 v14, 0.03125, v14
    v_mfma_f32_16x16x4_f32 v[172:175], v16, v124, v[172:175]
    v_cos_f32 v19, v14
    v_sin_f32 v15, v14
    v_mfma_f32_16x16x4_f32 v[192:195], v17, v112, v[192:195]
    s_nop 0
    v_mov_b32 v20, v15
    v_mfma_f32_16x16x4_f32 v[196:199], v17, v116, v[196:199]
    v_sub_f32 v21, 0, v15
    v_mfma_f32_16x16x4_f32 v[200:203], v17, v120, v[200:203]
    v_mfma_f32_16x16x4_f32 v[204:207], v17, v124, v[204:207]
    v_mfma_f32_16x16x4_f32 v[160:163], v18, v144, v[160:163]
    v_mfma_f32_16x16x4_f32 v[164:167], v18, v148, v[164:167]
    v_mfma_f32_16x16x4_f32 v[168:171], v18, v152, v[168:171]
    v_mfma_f32_16x16x4_f32 v[172:175], v18, v156, v[172:175]
    v_mfma_f32_16x16x4_f32 v[192:195], v16, v144, v[192:195]
    v_mfma_f32_16x16x4_f32 v[196:199], v16, v148, v[196:199]
    v_mfma_f32_16x16x4_f32 v[200:203], v16, v152, v[200:203]
    v_mfma_f32_16x16x4_f32 v[204:207], v16, v156, v[204:207]
    s_nop 0
    v_mfma_f32_16x16x4_f32 v[176:179], v19, v112, v[176:179]
    v_add_u32 v14, 0, v1
    v_add_u32 v15, 17, v4
    v_mfma_f32_16x16x4_f32 v[180:183], v19, v116, v[180:183]
    v_mul_u32_u24 v14, v14, v15
    v_and_b32 v14, 31, v14
    v_mfma_f32_16x16x4_f32 v[184:187], v19, v120, v[184:187]
    v_cvt_f32_u32 v14, v14
    v_mul_f32 v14, 0.03125, v14
    v_mfma_f32_16x16x4_f32 v[188:191], v19, v124, v[188:191]
    v_cos_f32 v16, v14
    v_sin_f32 v15, v14
    v_mfma_f32_16x16x4_f32 v[208:211], v20, v112, v[208:211]
    s_nop 0
    v_mov_b32 v17, v15
    v_mfma_f32_16x16x4_f32 v[212:215], v20, v116, v[212:215]
    v_sub_f32 v18, 0, v15
    v_mfma_f32_16x16x4_f32 v[216:219], v20, v120, v[216:219]
    v_mfma_f32_16x16x4_f32 v[220:223], v20, v124, v[220:223]
    v_mfma_f32_16x16x4_f32 v[176:179], v21, v144, v[176:179]
    v_mfma_f32_16x16x4_f32 v[180:183], v21, v148, v[180:183]
    v_mfma_f32_16x16x4_f32 v[184:187], v21, v152, v[184:187]
    v_mfma_f32_16x16x4_f32 v[188:191], v21, v156, v[188:191]
    v_mfma_f32_16x16x4_f32 v[208:211], v19, v144, v[208:211]
    v_mfma_f32_16x16x4_f32 v[212:215], v19, v148, v[212:215]
    v_mfma_f32_16x16x4_f32 v[216:219], v19, v152, v[216:219]
    v_mfma_f32_16x16x4_f32 v[220:223], v19, v156, v[220:223]
    s_nop 0
    v_mfma_f32_16x16x4_f32 v[160:163], v16, v113, v[160:163]
    v_add_u32 v14, 16, v1
    v_add_u32 v15, 17, v4
    v_mfma_f32_16x16x4_f32 v[164:167], v16, v117, v[164:167]
    v_mul_u32_u24 v14, v14, v15
    v_and_b32 v14, 31, v14
    v_mfma_f32_16x16x4_f32 v[168:171], v16, v121, v[168:171]
    v_cvt_f32_u32 v14, v14
    v_mul_f32 v14, 0.03125, v14
    v_mfma_f32_16x16x4_f32 v[172:175], v16, v125, v[172:175]
    v_cos_f32 v19, v14
    v_sin_f32 v15, v14
    v_mfma_f32_16x16x4_f32 v[192:195], v17, v113, v[192:195]
    s_nop 0
    v_mov_b32 v20, v15
    v_mfma_f32_16x16x4_f32 v[196:199], v17, v117, v[196:199]
    v_sub_f32 v21, 0, v15
    v_mfma_f32_16x16x4_f32 v[200:203], v17, v121, v[200:203]
    v_mfma_f32_16x16x4_f32 v[204:207], v17, v125, v[204:207]
    v_mfma_f32_16x16x4_f32 v[160:163], v18, v145, v[160:163]
    v_mfma_f32_16x16x4_f32 v[164:167], v18, v149, v[164:167]
    v_mfma_f32_16x16x4_f32 v[168:171], v18, v153, v[168:171]
    v_mfma_f32_16x16x4_f32 v[172:175], v18, v157, v[172:175]
    v_mfma_f32_16x16x4_f32 v[192:195], v16, v145, v[192:195]
    v_mfma_f32_16x16x4_f32 v[196:199], v16, v149, v[196:199]
    v_mfma_f32_16x16x4_f32 v[200:203], v16, v153, v[200:203]
    v_mfma_f32_16x16x4_f32 v[204:207], v16, v157, v[204:207]
    s_nop 0
    v_mfma_f32_16x16x4_f32 v[176:179], v19, v113, v[176:179]
    v_add_u32 v14, 0, v1
    v_add_u32 v15, 18, v4
    v_mfma_f32_16x16x4_f32 v[180:183], v19, v117, v[180:183]
    v_mul_u32_u24 v14, v14, v15
    v_and_b32 v14, 31, v14
    v_mfma_f32_16x16x4_f32 v[184:187], v19, v121, v[184:187]
    v_cvt_f32_u32 v14, v14
    v_mul_f32 v14, 0.03125, v14
    v_mfma_f32_16x16x4_f32 v[188:191], v19, v125, v[188:191]
    v_cos_f32 v16, v14
    v_sin_f32 v15, v14
    v_mfma_f32_16x16x4_f32 v[208:211], v20, v113, v[208:211]
    s_nop 0
    v_mov_b32 v17, v15
    v_mfma_f32_16x16x4_f32 v[212:215], v20, v117, v[212:215]
    v_sub_f32 v18, 0, v15
    v_mfma_f32_16x16x4_f32 v[216:219], v20, v121, v[216:219]
    v_mfma_f32_16x16x4_f32 v[220:223], v20, v125, v[220:223]
    v_mfma_f32_16x16x4_f32 v[176:179], v21, v145, v[176:179]
    v_mfma_f32_16x16x4_f32 v[180:183], v21, v149, v[180:183]
    v_mfma_f32_16x16x4_f32 v[184:187], v21, v153, v[184:187]
    v_mfma_f32_16x16x4_f32 v[188:191], v21, v157, v[188:191]
    v_mfma_f32_16x16x4_f32 v[208:211], v19, v145, v[208:211]
    v_mfma_f32_16x16x4_f32 v[212:215], v19, v149, v[212:215]
    v_mfma_f32_16x16x4_f32 v[216:219], v19, v153, v[216:219]
    v_mfma_f32_16x16x4_f32 v[220:223], v19, v157, v[220:223]
    s_nop 0
    v_mfma_f32_16x16x4_f32 v[160:163], v16, v114, v[160:163]
    v_add_u32 v14, 16, v1
    v_add_u32 v15, 18, v4
    v_mfma_f32_16x16x4_f32 v[164:167], v16, v118, v[164:167]
    v_mul_u32_u24 v14, v14, v15
    v_and_b32 v14, 31, v14
    v_mfma_f32_16x16x4_f32 v[168:171], v16, v122, v[168:171]
    v_cvt_f32_u32 v14, v14
    v_mul_f32 v14, 0.03125, v14
    v_mfma_f32_16x16x4_f32 v[172:175], v16, v126, v[172:175]
    v_cos_f32 v19, v14
    v_sin_f32 v15, v14
    v_mfma_f32_16x16x4_f32 v[192:195], v17, v114, v[192:195]
    s_nop 0
    v_mov_b32 v20, v15
    v_mfma_f32_16x16x4_f32 v[196:199], v17, v118, v[196:199]
    v_sub_f32 v21, 0, v15
    v_mfma_f32_16x16x4_f32 v[200:203], v17, v122, v[200:203]
    v_mfma_f32_16x16x4_f32 v[204:207], v17, v126, v[204:207]
    v_mfma_f32_16x16x4_f32 v[160:163], v18, v146, v[160:163]
    v_mfma_f32_16x16x4_f32 v[164:167], v18, v150, v[164:167]
    v_mfma_f32_16x16x4_f32 v[168:171], v18, v154, v[168:171]
    v_mfma_f32_16x16x4_f32 v[172:175], v18, v158, v[172:175]
    v_mfma_f32_16x16x4_f32 v[192:195], v16, v146, v[192:195]
    v_mfma_f32_16x16x4_f32 v[196:199], v16, v150, v[196:199]
    v_mfma_f32_16x16x4_f32 v[200:203], v16, v154, v[200:203]
    v_mfma_f32_16x16x4_f32 v[204:207], v16, v158, v[204:207]
    s_nop 0
    v_mfma_f32_16x16x4_f32 v[176:179], v19, v114, v[176:179]
    v_add_u32 v14, 0, v1
    v_add_u32 v15, 19, v4
    v_mfma_f32_16x16x4_f32 v[180:183], v19, v118, v[180:183]
    v_mul_u32_u24 v14, v14, v15
    v_and_b32 v14, 31, v14
    v_mfma_f32_16x16x4_f32 v[184:187], v19, v122, v[184:187]
    v_cvt_f32_u32 v14, v14
    v_mul_f32 v14, 0.03125, v14
    v_mfma_f32_16x16x4_f32 v[188:191], v19, v126, v[188:191]
    v_cos_f32 v16, v14
    v_sin_f32 v15, v14
    v_mfma_f32_16x16x4_f32 v[208:211], v20, v114, v[208:211]
    s_nop 0
    v_mov_b32 v17, v15
    v_mfma_f32_16x16x4_f32 v[212:215], v20, v118, v[212:215]
    v_sub_f32 v18, 0, v15
    v_mfma_f32_16x16x4_f32 v[216:219], v20, v122, v[216:219]
    v_mfma_f32_16x16x4_f32 v[220:223], v20, v126, v[220:223]
    v_mfma_f32_16x16x4_f32 v[176:179], v21, v146, v[176:179]
    v_mfma_f32_16x16x4_f32 v[180:183], v21, v150, v[180:183]
    v_mfma_f32_16x16x4_f32 v[184:187], v21, v154, v[184:187]
    v_mfma_f32_16x16x4_f32 v[188:191], v21, v158, v[188:191]
    v_mfma_f32_16x16x4_f32 v[208:211], v19, v146, v[208:211]
    v_mfma_f32_16x16x4_f32 v[212:215], v19, v150, v[212:215]
    v_mfma_f32_16x16x4_f32 v[216:219], v19, v154, v[216:219]
    v_mfma_f32_16x16x4_f32 v[220:223], v19, v158, v[220:223]
    s_nop 0
    v_mfma_f32_16x16x4_f32 v[160:163], v16, v115, v[160:163]
    v_add_u32 v14, 16, v1
    v_add_u32 v15, 19, v4
    v_mfma_f32_16x16x4_f32 v[164:167], v16, v119, v[164:167]
    v_mul_u32_u24 v14, v14, v15
    v_and_b32 v14, 31, v14
    v_mfma_f32_16x16x4_f32 v[168:171], v16, v123, v[168:171]
    v_cvt_f32_u32 v14, v14
    v_mul_f32 v14, 0.03125, v14
    v_mfma_f32_16x16x4_f32 v[172:175], v16, v127, v[172:175]
    v_cos_f32 v19, v14
    v_sin_f32 v15, v14
    v_mfma_f32_16x16x4_f32 v[192:195], v17, v115, v[192:195]
    s_nop 0
    v_mov_b32 v20, v15
    v_mfma_f32_16x16x4_f32 v[196:199], v17, v119, v[196:199]
    v_sub_f32 v21, 0, v15
    v_mfma_f32_16x16x4_f32 v[200:203], v17, v123, v[200:203]
    v_mfma_f32_16x16x4_f32 v[204:207], v17, v127, v[204:207]
    v_mfma_f32_16x16x4_f32 v[160:163], v18, v147, v[160:163]
    v_mfma_f32_16x16x4_f32 v[164:167], v18, v151, v[164:167]
    v_mfma_f32_16x16x4_f32 v[168:171], v18, v155, v[168:171]
    v_mfma_f32_16x16x4_f32 v[172:175], v18, v159, v[172:175]
    v_mfma_f32_16x16x4_f32 v[192:195], v16, v147, v[192:195]
    v_mfma_f32_16x16x4_f32 v[196:199], v16, v151, v[196:199]
    v_mfma_f32_16x16x4_f32 v[200:203], v16, v155, v[200:203]
    v_mfma_f32_16x16x4_f32 v[204:207], v16, v159, v[204:207]
    s_nop 0
    v_mfma_f32_16x16x4_f32 v[176:179], v19, v115, v[176:179]
    v_mfma_f32_16x16x4_f32 v[180:183], v19, v119, v[180:183]
    v_mfma_f32_16x16x4_f32 v[184:187], v19, v123, v[184:187]
    v_mfma_f32_16x16x4_f32 v[188:191], v19, v127, v[188:191]
    v_mfma_f32_16x16x4_f32 v[208:211], v20, v115, v[208:211]
    v_mfma_f32_16x16x4_f32 v[212:215], v20, v119, v[212:215]
    v_mfma_f32_16x16x4_f32 v[216:219], v20, v123, v[216:219]
    v_mfma_f32_16x16x4_f32 v[220:223], v20, v127, v[220:223]
    v_mfma_f32_16x16x4_f32 v[176:179], v21, v147, v[176:179]
    v_mfma_f32_16x16x4_f32 v[180:183], v21, v151, v[180:183]
    v_mfma_f32_16x16x4_f32 v[184:187], v21, v155, v[184:187]
    v_mfma_f32_16x16x4_f32 v[188:191], v21, v159, v[188:191]
    v_mfma_f32_16x16x4_f32 v[208:211], v19, v147, v[208:211]
    v_mfma_f32_16x16x4_f32 v[212:215], v19, v151, v[212:215]
    v_mfma_f32_16x16x4_f32 v[216:219], v19, v155, v[216:219]
    v_mfma_f32_16x16x4_f32 v[220:223], v19, v159, v[220:223]
    s_nop 9
Lf2_st:
    v_lshlrev_b32 v6, 6, v4
    v_add_u32 v6, v6, v1
    v_lshlrev_b32 v6, 3, v6
    v_lshrrev_b32 v7, 6, v0
    v_lshl_add_u32 v6, v7, 1, v6
    v_cvt_pk_bf16_f32 v8, v160, v192
    v_lshlrev_b32 v12, 16, v8
    v_and_b32 v13, 0xffff0000, v8
    v_sub_f32 v12, v160, v12
    v_sub_f32 v13, v192, v13
    v_cvt_pk_bf16_f32 v9, v12, v13
    ds_write_b16 v6, v8 offset:0
    ds_write_b16_d16_hi v6, v8 offset:16384
    ds_write_b16 v6, v9 offset:32768
    ds_write_b16_d16_hi v6, v9 offset:49152
    v_cvt_pk_bf16_f32 v10, v161, v193
    v_lshlrev_b32 v12, 16, v10
    v_and_b32 v13, 0xffff0000, v10
    v_sub_f32 v12, v161, v12
    v_sub_f32 v13, v193, v13
    v_cvt_pk_bf16_f32 v11, v12, v13
    ds_write_b16 v6, v10 offset:512
    ds_write_b16_d16_hi v6, v10 offset:16896
    ds_write_b16 v6, v11 offset:33280
    ds_write_b16_d16_hi v6, v11 offset:49664
    v_cvt_pk_bf16_f32 v8, v162, v194
    v_lshlrev_b32 v12, 16, v8
    v_and_b32 v13, 0xffff0000, v8
    v_sub_f32 v12, v162, v12
    v_sub_f32 v13, v194, v13
    v_cvt_pk_bf16_f32 v9, v12, v13
    ds_write_b16 v6, v8 offset:1024
    ds_write_b16_d16_hi v6, v8 offset:17408
    ds_write_b16 v6, v9 offset:33792
    ds_write_b16_d16_hi v6, v9 offset:50176
    v_cvt_pk_bf16_f32 v10, v163, v195
    v_lshlrev_b32 v12, 16, v10
    v_and_b32 v13, 0xffff0000, v10
    v_sub_f32 v12, v163, v12
    v_sub_f32 v13, v195, v13
    v_cvt_pk_bf16_f32 v11, v12, v13
    ds_write_b16 v6, v10 offset:1536
    ds_write_b16_d16_hi v6, v10 offset:17920
    ds_write_b16 v6, v11 offset:34304
    ds_write_b16_d16_hi v6, v11 offset:50688
    v_cvt_pk_bf16_f32 v8, v164, v196
    v_lshlrev_b32 v12, 16, v8
    v_and_b32 v13, 0xffff0000, v8
    v_sub_f32 v12, v164, v12
    v_sub_f32 v13, v196, v13
    v_cvt_pk_bf16_f32 v9, v12, v13
    ds_write_b16 v6, v8 offset:128
    ds_write_b16_d16_hi v6, v8 offset:16512
    ds_write_b16 v6, v9 offset:32896
    ds_write_b16_d16_hi v6, v9 offset:49280
    v_cvt_pk_bf16_f32 v10, v165, v197
    v_lshlrev_b32 v12, 16, v10
    v_and_b32 v13, 0xffff0000, v10
    v_sub_f32 v12, v165, v12
    v_sub_f32 v13, v197, v13
    v_cvt_pk_bf16_f32 v11, v12, v13
    ds_write_b16 v6, v10 offset:640
    ds_write_b16_d16_hi v6, v10 offset:17024
    ds_write_b16 v6, v11 offset:33408
    ds_write_b16_d16_hi v6, v11 offset:49792
    v_cvt_pk_bf16_f32 v8, v166, v198
    v_lshlrev_b32 v12, 16, v8
    v_and_b32 v13, 0xffff0000, v8
    v_sub_f32 v12, v166, v12
    v_sub_f32 v13, v198, v13
    v_cvt_pk_bf16_f32 v9, v12, v13
    ds_write_b16 v6, v8 offset:1152
    ds_write_b16_d16_hi v6, v8 offset:17536
    ds_write_b16 v6, v9 offset:33920
    ds_write_b16_d16_hi v6, v9 offset:50304
    v_cvt_pk_bf16_f32 v10, v167, v199
    v_lshlrev_b32 v12, 16, v10
    v_and_b32 v13, 0xffff0000, v10
    v_sub_f32 v12, v167, v12
    v_sub_f32 v13, v199, v13
    v_cvt_pk_bf16_f32 v11, v12, v13
    ds_write_b16 v6, v10 offset:1664
    ds_write_b16_d16_hi v6, v10 offset:18048
    ds_write_b16 v6, v11 offset:34432
    ds_write_b16_d16_hi v6, v11 offset:50816
    v_cvt_pk_bf16_f32 v8, v168, v200
    v_lshlrev_b32 v12, 16, v8
    v_and_b32 v13, 0xffff0000, v8
    v_sub_f32 v12, v168, v12
    v_sub_f32 v13, v200, v13
    v_cvt_pk_bf16_f32 v9, v12, v13
    ds_write_b16 v6, v8 offset:256
    ds_write_b16_d16_hi v6, v8 offset:16640
    ds_write_b16 v6, v9 offset:33024
    ds_write_b16_d16_hi v6, v9 offset:49408
    v_cvt_pk_bf16_f32 v10, v169, v201
    v_lshlrev_b32 v12, 16, v10
    v_and_b32 v13, 0xffff0000, v10
    v_sub_f32 v12, v169, v12
    v_sub_f32 v13, v201, v13
    v_cvt_pk_bf16_f32 v11, v12, v13
    ds_write_b16 v6, v10 offset:768
    ds_write_b16_d16_hi v6, v10 offset:17152
    ds_write_b16 v6, v11 offset:33536
    ds_write_b16_d16_hi v6, v11 offset:49920
    v_cvt_pk_bf16_f32 v8, v170, v202
    v_lshlrev_b32 v12, 16, v8
    v_and_b32 v13, 0xffff0000, v8
    v_sub_f32 v12, v170, v12
    v_sub_f32 v13, v202, v13
    v_cvt_pk_bf16_f32 v9, v12, v13
    ds_write_b16 v6, v8 offset:1280
    ds_write_b16_d16_hi v6, v8 offset:17664
    ds_write_b16 v6, v9 offset:34048
    ds_write_b16_d16_hi v6, v9 offset:50432
    v_cvt_pk_bf16_f32 v10, v171, v203
    v_lshlrev_b32 v12, 16, v10
    v_and_b32 v13, 0xffff0000, v10
    v_sub_f32 v12, v171, v12
    v_sub_f32 v13, v203, v13
    v_cvt_pk_bf16_f32 v11, v12, v13
    ds_write_b16 v6, v10 offset:1792
    ds_write_b16_d16_hi v6, v10 offset:18176
    ds_write_b16 v6, v11 offset:34560
    ds_write_b16_d16_hi v6, v11 offset:50944
    v_cvt_pk_bf16_f32 v8, v172, v204
    v_lshlrev_b32 v12, 16, v8
    v_and_b32 v13, 0xffff0000, v8
    v_sub_f32 v12, v172, v12
    v_sub_f32 v13, v204, v13
    v_cvt_pk_bf16_f32 v9, v12, v13
    ds_write_b16 v6, v8 offset:384
    ds_write_b16_d16_hi v6, v8 offset:16768
    ds_write_b16 v6, v9 offset:33152
    ds_write_b16_d16_hi v6, v9 offset:49536
    v_cvt_pk_bf16_f32 v10, v173, v205
    v_lshlrev_b32 v12, 16, v10
    v_and_b32 v13, 0xffff0000, v10
    v_sub_f32 v12, v173, v12
    v_sub_f32 v13, v205, v13
    v_cvt_pk_bf16_f32 v11, v12, v13
    ds_write_b16 v6, v10 offset:896
    ds_write_b16_d16_hi v6, v10 offset:17280
    ds_write_b16 v6, v11 offset:33664
    ds_write_b16_d16_hi v6, v11 offset:50048
    v_cvt_pk_bf16_f32 v8, v174, v206
    v_lshlrev_b32 v12, 16, v8
    v_and_b32 v13, 0xffff0000, v8
    v_sub_f32 v12, v174, v12
    v_sub_f32 v13, v206, v13
    v_cvt_pk_bf16_f32 v9, v12, v13
    ds_write_b16 v6, v8 offset:1408
    ds_write_b16_d16_hi v6, v8 offset:17792
    ds_write_b16 v6, v9 offset:34176
    ds_write_b16_d16_hi v6, v9 offset:50560
    v_cvt_pk_bf16_f32 v10, v175, v207
    v_lshlrev_b32 v12, 16, v10
    v_and_b32 v13, 0xffff0000, v10
    v_sub_f32 v12, v175, v12
    v_sub_f32 v13, v207, v13
    v_cvt_pk_bf16_f32 v11, v12, v13
    ds_write_b16 v6, v10 offset:1920
    ds_write_b16_d16_hi v6, v10 offset:18304
    ds_write_b16 v6, v11 offset:34688
    ds_write_b16_d16_hi v6, v11 offset:51072
    v_cvt_pk_bf16_f32 v8, v176, v208
    v_lshlrev_b32 v12, 16, v8
    v_and_b32 v13, 0xffff0000, v8
    v_sub_f32 v12, v176, v12
    v_sub_f32 v13, v208, v13
    v_cvt_pk_bf16_f32 v9, v12, v13
    ds_write_b16 v6, v8 offset:8192
    ds_write_b16_d16_hi v6, v8 offset:24576
    ds_write_b16 v6, v9 offset:40960
    ds_write_b16_d16_hi v6, v9 offset:57344
    v_cvt_pk_bf16_f32 v10, v177, v209
    v_lshlrev_b32 v12, 16, v10
    v_and_b32 v13, 0xffff0000, v10
    v_sub_f32 v12, v177, v12
    v_sub_f32 v13, v209, v13
    v_cvt_pk_bf16_f32 v11, v12, v13
    ds_write_b16 v6, v10 offset:8704
    ds_write_b16_d16_hi v6, v10 offset:25088
    ds_write_b16 v6, v11 offset:41472
    ds_write_b16_d16_hi v6, v11 offset:57856
    v_cvt_pk_bf16_f32 v8, v178, v210
    v_lshlrev_b32 v12, 16, v8
    v_and_b32 v13, 0xffff0000, v8
    v_sub_f32 v12, v178, v12
    v_sub_f32 v13, v210, v13
    v_cvt_pk_bf16_f32 v9, v12, v13
    ds_write_b16 v6, v8 offset:9216
    ds_write_b16_d16_hi v6, v8 offset:25600
    ds_write_b16 v6, v9 offset:41984
    ds_write_b16_d16_hi v6, v9 offset:58368
    v_cvt_pk_bf16_f32 v10, v179, v211
    v_lshlrev_b32 v12, 16, v10
    v_and_b32 v13, 0xffff0000, v10
    v_sub_f32 v12, v179, v12
    v_sub_f32 v13, v211, v13
    v_cvt_pk_bf16_f32 v11, v12, v13
    ds_write_b16 v6, v10 offset:9728
    ds_write_b16_d16_hi v6, v10 offset:26112
    ds_write_b16 v6, v11 offset:42496
    ds_write_b16_d16_hi v6, v11 offset:58880
    v_cvt_pk_bf16_f32 v8, v180, v212
    v_lshlrev_b32 v12, 16, v8
    v_and_b32 v13, 0xffff0000, v8
    v_sub_f32 v12, v180, v12
    v_sub_f32 v13, v212, v13
    v_cvt_pk_bf16_f32 v9, v12, v13
    ds_write_b16 v6, v8 offset:8320
    ds_write_b16_d16_hi v6, v8 offset:24704
    ds_write_b16 v6, v9 offset:41088
    ds_write_b16_d16_hi v6, v9 offset:57472
    v_cvt_pk_bf16_f32 v10, v181, v213
    v_lshlrev_b32 v12, 16, v10
    v_and_b32 v13, 0xffff0000, v10
    v_sub_f32 v12, v181, v12
    v_sub_f32 v13, v213, v13
    v_cvt_pk_bf16_f32 v11, v12, v13
    ds_write_b16 v6, v10 offset:8832
    ds_write_b16_d16_hi v6, v10 offset:25216
    ds_write_b16 v6, v11 offset:41600
    ds_write_b16_d16_hi v6, v11 offset:57984
    v_cvt_pk_bf16_f32 v8, v182, v214
    v_lshlrev_b32 v12, 16, v8
    v_and_b32 v13, 0xffff0000, v8
    v_sub_f32 v12, v182, v12
    v_sub_f32 v13, v214, v13
    v_cvt_pk_bf16_f32 v9, v12, v13
    ds_write_b16 v6, v8 offset:9344
    ds_write_b16_d16_hi v6, v8 offset:25728
    ds_write_b16 v6, v9 offset:42112
    ds_write_b16_d16_hi v6, v9 offset:58496
    v_cvt_pk_bf16_f32 v10, v183, v215
    v_lshlrev_b32 v12, 16, v10
    v_and_b32 v13, 0xffff0000, v10
    v_sub_f32 v12, v183, v12
    v_sub_f32 v13, v215, v13
    v_cvt_pk_bf16_f32 v11, v12, v13
    ds_write_b16 v6, v10 offset:9856
    ds_write_b16_d16_hi v6, v10 offset:26240
    ds_write_b16 v6, v11 offset:42624
    ds_write_b16_d16_hi v6, v11 offset:59008
    v_cvt_pk_bf16_f32 v8, v184, v216
    v_lshlrev_b32 v12, 16, v8
    v_and_b32 v13, 0xffff0000, v8
    v_sub_f32 v12, v184, v12
    v_sub_f32 v13, v216, v13
    v_cvt_pk_bf16_f32 v9, v12, v13
    ds_write_b16 v6, v8 offset:8448
    ds_write_b16_d16_hi v6, v8 offset:24832
    ds_write_b16 v6, v9 offset:41216
    ds_write_b16_d16_hi v6, v9 offset:57600
    v_cvt_pk_bf16_f32 v10, v185, v217
    v_lshlrev_b32 v12, 16, v10
    v_and_b32 v13, 0xffff0000, v10
    v_sub_f32 v12, v185, v12
    v_sub_f32 v13, v217, v13
    v_cvt_pk_bf16_f32 v11, v12, v13
    ds_write_b16 v6, v10 offset:8960
    ds_write_b16_d16_hi v6, v10 offset:25344
    ds_write_b16 v6, v11 offset:41728
    ds_write_b16_d16_hi v6, v11 offset:58112
    v_cvt_pk_bf16_f32 v8, v186, v218
    v_lshlrev_b32 v12, 16, v8
    v_and_b32 v13, 0xffff0000, v8
    v_sub_f32 v12, v186, v12
    v_sub_f32 v13, v218, v13
    v_cvt_pk_bf16_f32 v9, v12, v13
    ds_write_b16 v6, v8 offset:9472
    ds_write_b16_d16_hi v6, v8 offset:25856
    ds_write_b16 v6, v9 offset:42240
    ds_write_b16_d16_hi v6, v9 offset:58624
    v_cvt_pk_bf16_f32 v10, v187, v219
    v_lshlrev_b32 v12, 16, v10
    v_and_b32 v13, 0xffff0000, v10
    v_sub_f32 v12, v187, v12
    v_sub_f32 v13, v219, v13
    v_cvt_pk_bf16_f32 v11, v12, v13
    ds_write_b16 v6, v10 offset:9984
    ds_write_b16_d16_hi v6, v10 offset:26368
    ds_write_b16 v6, v11 offset:42752
    ds_write_b16_d16_hi v6, v11 offset:59136
    v_cvt_pk_bf16_f32 v8, v188, v220
    v_lshlrev_b32 v12, 16, v8
    v_and_b32 v13, 0xffff0000, v8
    v_sub_f32 v12, v188, v12
    v_sub_f32 v13, v220, v13
    v_cvt_pk_bf16_f32 v9, v12, v13
    ds_write_b16 v6, v8 offset:8576
    ds_write_b16_d16_hi v6, v8 offset:24960
    ds_write_b16 v6, v9 offset:41344
    ds_write_b16_d16_hi v6, v9 offset:57728
    v_cvt_pk_bf16_f32 v10, v189, v221
    v_lshlrev_b32 v12, 16, v10
    v_and_b32 v13, 0xffff0000, v10
    v_sub_f32 v12, v189, v12
    v_sub_f32 v13, v221, v13
    v_cvt_pk_bf16_f32 v11, v12, v13
    ds_write_b16 v6, v10 offset:9088
    ds_write_b16_d16_hi v6, v10 offset:25472
    ds_write_b16 v6, v11 offset:41856
    ds_write_b16_d16_hi v6, v11 offset:58240
    v_cvt_pk_bf16_f32 v8, v190, v222
    v_lshlrev_b32 v12, 16, v8
    v_and_b32 v13, 0xffff0000, v8
    v_sub_f32 v12, v190, v12
    v_sub_f32 v13, v222, v13
    v_cvt_pk_bf16_f32 v9, v12, v13
    ds_write_b16 v6, v8 offset:9600
    ds_write_b16_d16_hi v6, v8 offset:25984
    ds_write_b16 v6, v9 offset:42368
    ds_write_b16_d16_hi v6, v9 offset:58752
    v_cvt_pk_bf16_f32 v10, v191, v223
    v_lshlrev_b32 v12, 16, v10
    v_and_b32 v13, 0xffff0000, v10
    v_sub_f32 v12, v191, v12
    v_sub_f32 v13, v223, v13
    v_cvt_pk_bf16_f32 v11, v12, v13
    ds_write_b16 v6, v10 offset:10112
    ds_write_b16_d16_hi v6, v10 offset:26496
    ds_write_b16 v6, v11 offset:42880
    ds_write_b16_d16_hi v6, v11 offset:59264
    s_waitcnt lgkmcnt(0)
    s_barrier
    v_lshlrev_b32 v6, 3, v0
    v_mul_u32_u24 v7, 1536, v0
    s_lshl_b32 s24, s2, 3
    v_add_u32 v7, s24, v7
    ds_read_b64 v[32:33], v6 offset:0
    ds_read_b64 v[34:35], v6 offset:2048
    ds_read_b64 v[36:37], v6 offset:4096
    ds_read_b64 v[38:39], v6 offset:6144
    ds_read_b64 v[40:41], v6 offset:8192
    ds_read_b64 v[42:43], v6 offset:10240
    ds_read_b64 v[44:45], v6 offset:12288
    ds_read_b64 v[46:47], v6 offset:14336
    ds_read_b64 v[48:49], v6 offset:16384
    ds_read_b64 v[50:51], v6 offset:18432
    ds_read_b64 v[52:53], v6 offset:20480
    ds_read_b64 v[54:55], v6 offset:22528
    ds_read_b64 v[56:57], v6 offset:24576
    ds_read_b64 v[58:59], v6 offset:26624
    ds_read_b64 v[60:61], v6 offset:28672
    ds_read_b64 v[62:63], v6 offset:30720
    ds_read_b64 v[64:65], v6 offset:32768
    ds_read_b64 v[66:67], v6 offset:34816
    ds_read_b64 v[68:69], v6 offset:36864
    ds_read_b64 v[70:71], v6 offset:38912
    ds_read_b64 v[72:73], v6 offset:40960
    ds_read_b64 v[74:75], v6 offset:43008
    ds_read_b64 v[76:77], v6 offset:45056
    ds_read_b64 v[78:79], v6 offset:47104
    ds_read_b64 v[80:81], v6 offset:49152
    ds_read_b64 v[82:83], v6 offset:51200
    ds_read_b64 v[84:85], v6 offset:53248
    ds_read_b64 v[86:87], v6 offset:55296
    ds_read_b64 v[88:89], v6 offset:57344
    ds_read_b64 v[90:91], v6 offset:59392
    ds_read_b64 v[92:93], v6 offset:61440
    ds_read_b64 v[94:95], v6 offset:63488
    s_mov_b32 s24, 0x9600000
    s_waitcnt lgkmcnt(15)
    buffer_store_dwordx2 v[32:33], v7, s[8:11], s24 offen
    s_mov_b32 s24, 0x9660000
    s_waitcnt lgkmcnt(15)
    buffer_store_dwordx2 v[34:35], v7, s[8:11], s24 offen
    s_mov_b32 s24, 0x96c0000
    s_waitcnt lgkmcnt(15)
    buffer_store_dwordx2 v[36:37], v7, s[8:11], s24 offen
    s_mov_b32 s24, 0x9720000
    s_waitcnt lgkmcnt(15)
    buffer_store_dwordx2 v[38:39], v7, s[8:11], s24 offen
    s_mov_b32 s24, 0x9780000
    s_waitcnt lgkmcnt(15)
    buffer_store_dwordx2 v[40:41], v7, s[8:11], s24 offen
    s_mov_b32 s24, 0x97e0000
    s_waitcnt lgkmcnt(15)
    buffer_store_dwordx2 v[42:43], v7, s[8:11], s24 offen
    s_mov_b32 s24, 0x9840000
    s_waitcnt lgkmcnt(15)
    buffer_store_dwordx2 v[44:45], v7, s[8:11], s24 offen
    s_mov_b32 s24, 0x98a0000
    s_waitcnt lgkmcnt(15)
    buffer_store_dwordx2 v[46:47], v7, s[8:11], s24 offen
    s_mov_b32 s24, 0x9600300
    s_waitcnt lgkmcnt(15)
    buffer_store_dwordx2 v[48:49], v7, s[8:11], s24 offen
    s_mov_b32 s24, 0x9660300
    s_waitcnt lgkmcnt(15)
    buffer_store_dwordx2 v[50:51], v7, s[8:11], s24 offen
    s_mov_b32 s24, 0x96c0300
    s_waitcnt lgkmcnt(15)
    buffer_store_dwordx2 v[52:53], v7, s[8:11], s24 offen
    s_mov_b32 s24, 0x9720300
    s_waitcnt lgkmcnt(15)
    buffer_store_dwordx2 v[54:55], v7, s[8:11], s24 offen
    s_mov_b32 s24, 0x9780300
    s_waitcnt lgkmcnt(15)
    buffer_store_dwordx2 v[56:57], v7, s[8:11], s24 offen
    s_mov_b32 s24, 0x97e0300
    s_waitcnt lgkmcnt(15)
    buffer_store_dwordx2 v[58:59], v7, s[8:11], s24 offen
    s_mov_b32 s24, 0x9840300
    s_waitcnt lgkmcnt(15)
    buffer_store_dwordx2 v[60:61], v7, s[8:11], s24 offen
    s_mov_b32 s24, 0x98a0300
    s_waitcnt lgkmcnt(15)
    buffer_store_dwordx2 v[62:63], v7, s[8:11], s24 offen
    s_mov_b32 s24, 0x9900000
    s_waitcnt lgkmcnt(15)
    buffer_store_dwordx2 v[64:65], v7, s[8:11], s24 offen
    s_mov_b32 s24, 0x9960000
    s_waitcnt lgkmcnt(14)
    buffer_store_dwordx2 v[66:67], v7, s[8:11], s24 offen
    s_mov_b32 s24, 0x99c0000
    s_waitcnt lgkmcnt(13)
    buffer_store_dwordx2 v[68:69], v7, s[8:11], s24 offen
    s_mov_b32 s24, 0x9a20000
    s_waitcnt lgkmcnt(12)
    buffer_store_dwordx2 v[70:71], v7, s[8:11], s24 offen
    s_mov_b32 s24, 0x9a80000
    s_waitcnt lgkmcnt(11)
    buffer_store_dwordx2 v[72:73], v7, s[8:11], s24 offen
    s_mov_b32 s24, 0x9ae0000
    s_waitcnt lgkmcnt(10)
    buffer_store_dwordx2 v[74:75], v7, s[8:11], s24 offen
    s_mov_b32 s24, 0x9b40000
    s_waitcnt lgkmcnt(9)
    buffer_store_dwordx2 v[76:77], v7, s[8:11], s24 offen
    s_mov_b32 s24, 0x9ba0000
    s_waitcnt lgkmcnt(8)
    buffer_store_dwordx2 v[78:79], v7, s[8:11], s24 offen
    s_mov_b32 s24, 0x9900300
    s_waitcnt lgkmcnt(7)
    buffer_store_dwordx2 v[80:81], v7, s[8:11], s24 offen
    s_mov_b32 s24, 0x9960300
    s_waitcnt lgkmcnt(6)
    buffer_store_dwordx2 v[82:83], v7, s[8:11], s24 offen
    s_mov_b32 s24, 0x99c0300
    s_waitcnt lgkmcnt(5)
    buffer_store_dwordx2 v[84:85], v7, s[8:11], s24 offen
    s_mov_b32 s24, 0x9a20300
    s_waitcnt lgkmcnt(4)
    buffer_store_dwordx2 v[86:87], v7, s[8:11], s24 offen
    s_mov_b32 s24, 0x9a80300
    s_waitcnt lgkmcnt(3)
    buffer_store_dwordx2 v[88:89], v7, s[8:11], s24 offen
    s_mov_b32 s24, 0x9ae0300
    s_waitcnt lgkmcnt(2)
    buffer_store_dwordx2 v[90:91], v7, s[8:11], s24 offen
    s_mov_b32 s24, 0x9b40300
    s_waitcnt lgkmcnt(1)
    buffer_store_dwordx2 v[92:93], v7, s[8:11], s24 offen
    s_mov_b32 s24, 0x9ba0300
    s_waitcnt lgkmcnt(0)
    buffer_store_dwordx2 v[94:95], v7, s[8:11], s24 offen
Lf2_rel:
    s_mov_b32 s26, 0x9f00800
    s_and_b32 s27, s23, 3
    s_waitcnt vmcnt(0)
    s_barrier
    s_cmp_lg_u32 s27, 0
    s_cbranch_scc1 Lrel_10
    s_mov_b64 exec, 1
    buffer_wbl2 sc1
    s_waitcnt vmcnt(0)
    v_mov_b32 v6, 1
    v_mov_b32 v7, 0
    buffer_atomic_add v6, v7, s[8:11], s26 offen sc1
    s_waitcnt vmcnt(0)
    s_mov_b64 exec, -1
Lrel_10:
Lf2_end:
    s_endpgm
Lg_entry128:
    s_load_dwordx2 s[4:5], s[0:1], 104
    s_load_dwordx2 s[6:7], s[0:1], 0
    s_waitcnt lgkmcnt(0)
    s_mov_b32 s8, s4
    s_and_b32 s9, s5, 0xffff
    s_mov_b32 s10, 0x10000000
    s_mov_b32 s11, 0x00020000
    s_mov_b32 s12, s6
    s_and_b32 s13, s7, 0xffff
    s_mov_b32 s14, 0x280000
    s_mov_b32 s15, 0x00020000
    v_and_b32 v1, 63, v0
    v_lshrrev_b32 v2, 6, v0
    v_and_b32 v3, 15, v0
    v_bfe_u32 v4, v0, 4, 2
    v_lshrrev_b32 v5, 3, v0
    v_and_b32 v6, 7, v0
    v_lshlrev_b32 v6, 4, v6
    v_add_u32 v7, 0, v5
    v_mul_u32_u24 v7, 1280, v7
    v_add_u32 v7, v7, v6
    v_add_u32 v8, 32, v5
    v_mul_u32_u24 v8, 1280, v8
    v_add_u32 v8, v8, v6
    v_add_u32 v9, 64, v5
    v_mul_u32_u24 v9, 1280, v9
    v_add_u32 v9, v9, v6
    v_add_u32 v10, 96, v5
    v_mul_u32_u24 v10, 1280, v10
    v_add_u32 v10, v10, v6
    v_add_u32 v11, 0, v5
    v_mul_u32_u24 v11, 1280, v11
    v_add_u32 v11, v11, v6
    v_add_u32 v12, 32, v5
    v_mul_u32_u24 v12, 1280, v12
    v_add_u32 v12, v12, v6
    v_add_u32 v13, 64, v5
    v_mul_u32_u24 v13, 1280, v13
    v_add_u32 v13, v13, v6
    v_add_u32 v14, 96, v5
    v_mul_u32_u24 v14, 1280, v14
    v_add_u32 v14, v14, v6
    v_lshrrev_b32 v5, 3, v0
    v_and_b32 v6, 7, v0
    v_and_b32 v15, 7, v5
    v_xor_b32 v15, v15, v6
    v_lshlrev_b32 v15, 4, v15
    v_lshl_add_u32 v15, v5, 7, v15
    v_and_b32 v5, 7, v3
    v_xor_b32 v5, v5, v4
    v_lshlrev_b32 v5, 4, v5
    v_lshl_add_u32 v5, v3, 7, v5
    v_and_b32 v6, 1, v2
    v_mul_u32_u24 v6, 8192, v6
    v_add_u32 v16, v5, v6
    v_xor_b32 v17, 64, v16
    v_lshrrev_b32 v6, 1, v2
    v_mul_u32_u24 v6, 8192, v6
    v_add_u32 v18, v5, v6
    v_add_u32 v18, 16384, v18
    v_xor_b32 v19, 64, v18
    v_mov_b32 v148, 0
    v_mov_b32 v149, 0
    v_mov_b32 v150, 0
    v_mov_b32 v151, 0
    v_mov_b32 v152, 0
    v_mov_b32 v153, 0
    v_mov_b32 v154, 0
    v_mov_b32 v155, 0
    v_mov_b32 v156, 0
    v_mov_b32 v157, 0
    v_mov_b32 v158, 0
    v_mov_b32 v159, 0
    v_mov_b32 v160, 0
    v_mov_b32 v161, 0
    v_mov_b32 v162, 0
    v_mov_b32 v163, 0
    v_mov_b32 v164, 0
    v_mov_b32 v165, 0
    v_mov_b32 v166, 0
    v_mov_b32 v167, 0
    v_mov_b32 v168, 0
    v_mov_b32 v169, 0
    v_mov_b32 v170, 0
    v_mov_b32 v171, 0
    v_mov_b32 v172, 0
    v_mov_b32 v173, 0
    v_mov_b32 v174, 0
    v_mov_b32 v175, 0
    v_mov_b32 v176, 0
    v_mov_b32 v177, 0
    v_mov_b32 v178, 0
    v_mov_b32 v179, 0
    v_mov_b32 v180, 0
    v_mov_b32 v181, 0
    v_mov_b32 v182, 0
    v_mov_b32 v183, 0
    v_mov_b32 v184, 0
    v_mov_b32 v185, 0
    v_mov_b32 v186, 0
    v_mov_b32 v187, 0
    v_mov_b32 v188, 0
    v_mov_b32 v189, 0
    v_mov_b32 v190, 0
    v_mov_b32 v191, 0
    v_mov_b32 v192, 0
    v_mov_b32 v193, 0
    v_mov_b32 v194, 0
    v_mov_b32 v195, 0
    v_mov_b32 v196, 0
    v_mov_b32 v197, 0
    v_mov_b32 v198, 0
    v_mov_b32 v199, 0
    v_mov_b32 v200, 0
    v_mov_b32 v201, 0
    v_mov_b32 v202, 0
    v_mov_b32 v203, 0
    v_mov_b32 v204, 0
    v_mov_b32 v205, 0
    v_mov_b32 v206, 0
    v_mov_b32 v207, 0
    v_mov_b32 v208, 0
    v_mov_b32 v209, 0
    v_mov_b32 v210, 0
    v_mov_b32 v211, 0
    s_mul_i32 s18, s16, 163840
    s_add_u32 s18, s18, 0x0
    s_mul_i32 s19, s17, 163840
    s_cmp_lt_u32 s16, 64
    s_cselect_b32 s20, s8, s12
    s_cselect_b32 s24, s12, s8
    s_cselect_b32 s21, s9, s13
    s_cselect_b32 s25, s13, s9
    s_cselect_b32 s22, s10, s14
    s_cselect_b32 s26, s14, s10
    s_cselect_b32 s23, s11, s15
    s_cselect_b32 s27, s15, s11
    s_cselect_b32 s28, s18, s19
    s_cselect_b32 s29, s19, s18
    s_mul_i32 s30, s17, 2129920
    s_lshl_b32 s31, s16, 8
    s_add_u32 s30, s30, s31
    s_add_u32 s30, s30, 0x1500000
    s_sub_u32 s31, s16, 64
    s_mul_i32 s31, s31, 540672
    s_lshl_b32 s32, s17, 8
    s_add_u32 s31, s31, s32
    s_add_u32 s31, s31, 0x3600000
    s_cmp_lt_u32 s16, 64
    s_cselect_b32 s30, s30, s31
    s_mov_b32 s33, 4224
    s_cselect_b32 s33, 16640, s33
    v_lshrrev_b32 v5, 1, v2
    v_lshlrev_b32 v5, 6, v5
    v_add_u32 v5, v5, v3
    v_mul_lo_u32 v212, s33, v5
    v_and_b32 v5, 1, v2
    v_lshlrev_b32 v5, 7, v5
    v_lshl_add_u32 v5, v4, 3, v5
    v_add_u32 v212, v212, v5
    s_lshl_b32 s34, s33, 4
    buffer_load_dwordx4 v[20:23], v7, s[20:23], s28 offen
    buffer_load_dwordx4 v[24:27], v8, s[20:23], s28 offen
    buffer_load_dwordx4 v[28:31], v9, s[20:23], s28 offen
    buffer_load_dwordx4 v[32:35], v10, s[20:23], s28 offen
    buffer_load_dwordx4 v[36:39], v11, s[24:27], s29 offen
    buffer_load_dwordx4 v[40:43], v12, s[24:27], s29 offen
    buffer_load_dwordx4 v[44:47], v13, s[24:27], s29 offen
    buffer_load_dwordx4 v[48:51], v14, s[24:27], s29 offen
    s_add_u32 s28, s28, 128
    s_add_u32 s29, s29, 128
    buffer_load_dwordx4 v[52:55], v7, s[20:23], s28 offen
    buffer_load_dwordx4 v[56:59], v8, s[20:23], s28 offen
    buffer_load_dwordx4 v[60:63], v9, s[20:23], s28 offen
    buffer_load_dwordx4 v[64:67], v10, s[20:23], s28 offen
    buffer_load_dwordx4 v[68:71], v11, s[24:27], s29 offen
    buffer_load_dwordx4 v[72:75], v12, s[24:27], s29 offen
    buffer_load_dwordx4 v[76:79], v13, s[24:27], s29 offen
    buffer_load_dwordx4 v[80:83], v14, s[24:27], s29 offen
    s_add_u32 s28, s28, 128
    s_add_u32 s29, s29, 128
    s_waitcnt vmcnt(8)
    ds_write_b128 v15, v[20:23] offset:0
    ds_write_b128 v15, v[24:27] offset:4096
    ds_write_b128 v15, v[28:31] offset:8192
    ds_write_b128 v15, v[32:35] offset:12288
    ds_write_b128 v15, v[36:39] offset:16384
    ds_write_b128 v15, v[40:43] offset:20480
    ds_write_b128 v15, v[44:47] offset:24576
    ds_write_b128 v15, v[48:51] offset:28672
    s_waitcnt lgkmcnt(0)
    s_barrier
    s_mov_b32 s35, 5
Lg_11:
    buffer_load_dwordx4 v[20:23], v7, s[20:23], s28 offen
    buffer_load_dwordx4 v[24:27], v8, s[20:23], s28 offen
    buffer_load_dwordx4 v[28:31], v9, s[20:23], s28 offen
    buffer_load_dwordx4 v[32:35], v10, s[20:23], s28 offen
    buffer_load_dwordx4 v[36:39], v11, s[24:27], s29 offen
    buffer_load_dwordx4 v[40:43], v12, s[24:27], s29 offen
    buffer_load_dwordx4 v[44:47], v13, s[24:27], s29 offen
    buffer_load_dwordx4 v[48:51], v14, s[24:27], s29 offen
    s_add_u32 s28, s28, 128
    s_add_u32 s29, s29, 128
    v_xor_b32 v15, 32768, v15
    ds_read_b128 v[84:87], v16 offset:0
    ds_read_b128 v[88:91], v16 offset:2048
    ds_read_b128 v[92:95], v16 offset:4096
    ds_read_b128 v[96:99], v16 offset:6144
    ds_read_b128 v[116:119], v18 offset:0
    ds_read_b128 v[120:123], v18 offset:2048
    ds_read_b128 v[124:127], v18 offset:4096
    ds_read_b128 v[128:131], v18 offset:6144
    ds_read_b128 v[100:103], v17 offset:0
    ds_read_b128 v[104:107], v17 offset:2048
    ds_read_b128 v[108:111], v17 offset:4096
    ds_read_b128 v[112:115], v17 offset:6144
    ds_read_b128 v[132:135], v19 offset:0
    ds_read_b128 v[136:139], v19 offset:2048
    ds_read_b128 v[140:143], v19 offset:4096
    ds_read_b128 v[144:147], v19 offset:6144
    s_waitcnt lgkmcnt(8)
    v_mfma_f32_16x16x32_bf16 v[148:151], v[84:87], v[116:119], v[148:151]
    v_mfma_f32_16x16x32_bf16 v[152:155], v[84:87], v[120:123], v[152:155]
    v_mfma_f32_16x16x32_bf16 v[156:159], v[84:87], v[124:127], v[156:159]
    v_mfma_f32_16x16x32_bf16 v[160:163], v[84:87], v[128:131], v[160:163]
    v_mfma_f32_16x16x32_bf16 v[164:167], v[88:91], v[116:119], v[164:167]
    v_mfma_f32_16x16x32_bf16 v[168:171], v[88:91], v[120:123], v[168:171]
    v_mfma_f32_16x16x32_bf16 v[172:175], v[88:91], v[124:127], v[172:175]
    v_mfma_f32_16x16x32_bf16 v[176:179], v[88:91], v[128:131], v[176:179]
    v_mfma_f32_16x16x32_bf16 v[180:183], v[92:95], v[116:119], v[180:183]
    v_mfma_f32_16x16x32_bf16 v[184:187], v[92:95], v[120:123], v[184:187]
    v_mfma_f32_16x16x32_bf16 v[188:191], v[92:95], v[124:127], v[188:191]
    v_mfma_f32_16x16x32_bf16 v[192:195], v[92:95], v[128:131], v[192:195]
    v_mfma_f32_16x16x32_bf16 v[196:199], v[96:99], v[116:119], v[196:199]
    v_mfma_f32_16x16x32_bf16 v[200:203], v[96:99], v[120:123], v[200:203]
    v_mfma_f32_16x16x32_bf16 v[204:207], v[96:99], v[124:127], v[204:207]
    v_mfma_f32_16x16x32_bf16 v[208:211], v[96:99], v[128:131], v[208:211]
    s_waitcnt lgkmcnt(0)
    v_mfma_f32_16x16x32_bf16 v[148:151], v[100:103], v[132:135], v[148:151]
    v_mfma_f32_16x16x32_bf16 v[152:155], v[100:103], v[136:139], v[152:155]
    v_mfma_f32_16x16x32_bf16 v[156:159], v[100:103], v[140:143], v[156:159]
    v_mfma_f32_16x16x32_bf16 v[160:163], v[100:103], v[144:147], v[160:163]
    v_mfma_f32_16x16x32_bf16 v[164:167], v[104:107], v[132:135], v[164:167]
    v_mfma_f32_16x16x32_bf16 v[168:171], v[104:107], v[136:139], v[168:171]
    v_mfma_f32_16x16x32_bf16 v[172:175], v[104:107], v[140:143], v[172:175]
    v_mfma_f32_16x16x32_bf16 v[176:179], v[104:107], v[144:147], v[176:179]
    v_mfma_f32_16x16x32_bf16 v[180:183], v[108:111], v[132:135], v[180:183]
    v_mfma_f32_16x16x32_bf16 v[184:187], v[108:111], v[136:139], v[184:187]
    v_mfma_f32_16x16x32_bf16 v[188:191], v[108:111], v[140:143], v[188:191]
    v_mfma_f32_16x16x32_bf16 v[192:195], v[108:111], v[144:147], v[192:195]
    v_mfma_f32_16x16x32_bf16 v[196:199], v[112:115], v[132:135], v[196:199]
    v_mfma_f32_16x16x32_bf16 v[200:203], v[112:115], v[136:139], v[200:203]
    v_mfma_f32_16x16x32_bf16 v[204:207], v[112:115], v[140:143], v[204:207]
    v_mfma_f32_16x16x32_bf16 v[208:211], v[112:115], v[144:147], v[208:211]
    s_waitcnt vmcnt(8)
    ds_write_b128 v15, v[52:55] offset:0
    ds_write_b128 v15, v[56:59] offset:4096
    ds_write_b128 v15, v[60:63] offset:8192
    ds_write_b128 v15, v[64:67] offset:12288
    ds_write_b128 v15, v[68:71] offset:16384
    ds_write_b128 v15, v[72:75] offset:20480
    ds_write_b128 v15, v[76:79] offset:24576
    ds_write_b128 v15, v[80:83] offset:28672
    v_xor_b32 v16, 32768, v16
    v_xor_b32 v17, 32768, v17
    v_xor_b32 v18, 32768, v18
    v_xor_b32 v19, 32768, v19
    s_waitcnt lgkmcnt(0)
    s_barrier
    buffer_load_dwordx4 v[52:55], v7, s[20:23], s28 offen
    buffer_load_dwordx4 v[56:59], v8, s[20:23], s28 offen
    buffer_load_dwordx4 v[60:63], v9, s[20:23], s28 offen
    buffer_load_dwordx4 v[64:67], v10, s[20:23], s28 offen
    buffer_load_dwordx4 v[68:71], v11, s[24:27], s29 offen
    buffer_load_dwordx4 v[72:75], v12, s[24:27], s29 offen
    buffer_load_dwordx4 v[76:79], v13, s[24:27], s29 offen
    buffer_load_dwordx4 v[80:83], v14, s[24:27], s29 offen
    s_add_u32 s28, s28, 128
    s_add_u32 s29, s29, 128
    v_xor_b32 v15, 32768, v15
    ds_read_b128 v[84:87], v16 offset:0
    ds_read_b128 v[88:91], v16 offset:2048
    ds_read_b128 v[92:95], v16 offset:4096
    ds_read_b128 v[96:99], v16 offset:6144
    ds_read_b128 v[116:119], v18 offset:0
    ds_read_b128 v[120:123], v18 offset:2048
    ds_read_b128 v[124:127], v18 offset:4096
    ds_read_b128 v[128:131], v18 offset:6144
    ds_read_b128 v[100:103], v17 offset:0
    ds_read_b128 v[104:107], v17 offset:2048
    ds_read_b128 v[108:111], v17 offset:4096
    ds_read_b128 v[112:115], v17 offset:6144
    ds_read_b128 v[132:135], v19 offset:0
    ds_read_b128 v[136:139], v19 offset:2048
    ds_read_b128 v[140:143], v19 offset:4096
    ds_read_b128 v[144:147], v19 offset:6144
    s_waitcnt lgkmcnt(8)
    v_mfma_f32_16x16x32_bf16 v[148:151], v[84:87], v[116:119], v[148:151]
    v_mfma_f32_16x16x32_bf16 v[152:155], v[84:87], v[120:123], v[152:155]
    v_mfma_f32_16x16x32_bf16 v[156:159], v[84:87], v[124:127], v[156:159]
    v_mfma_f32_16x16x32_bf16 v[160:163], v[84:87], v[128:131], v[160:163]
    v_mfma_f32_16x16x32_bf16 v[164:167], v[88:91], v[116:119], v[164:167]
    v_mfma_f32_16x16x32_bf16 v[168:171], v[88:91], v[120:123], v[168:171]
    v_mfma_f32_16x16x32_bf16 v[172:175], v[88:91], v[124:127], v[172:175]
    v_mfma_f32_16x16x32_bf16 v[176:179], v[88:91], v[128:131], v[176:179]
    v_mfma_f32_16x16x32_bf16 v[180:183], v[92:95], v[116:119], v[180:183]
    v_mfma_f32_16x16x32_bf16 v[184:187], v[92:95], v[120:123], v[184:187]
    v_mfma_f32_16x16x32_bf16 v[188:191], v[92:95], v[124:127], v[188:191]
    v_mfma_f32_16x16x32_bf16 v[192:195], v[92:95], v[128:131], v[192:195]
    v_mfma_f32_16x16x32_bf16 v[196:199], v[96:99], v[116:119], v[196:199]
    v_mfma_f32_16x16x32_bf16 v[200:203], v[96:99], v[120:123], v[200:203]
    v_mfma_f32_16x16x32_bf16 v[204:207], v[96:99], v[124:127], v[204:207]
    v_mfma_f32_16x16x32_bf16 v[208:211], v[96:99], v[128:131], v[208:211]
    s_waitcnt lgkmcnt(0)
    v_mfma_f32_16x16x32_bf16 v[148:151], v[100:103], v[132:135], v[148:151]
    v_mfma_f32_16x16x32_bf16 v[152:155], v[100:103], v[136:139], v[152:155]
    v_mfma_f32_16x16x32_bf16 v[156:159], v[100:103], v[140:143], v[156:159]
    v_mfma_f32_16x16x32_bf16 v[160:163], v[100:103], v[144:147], v[160:163]
    v_mfma_f32_16x16x32_bf16 v[164:167], v[104:107], v[132:135], v[164:167]
    v_mfma_f32_16x16x32_bf16 v[168:171], v[104:107], v[136:139], v[168:171]
    v_mfma_f32_16x16x32_bf16 v[172:175], v[104:107], v[140:143], v[172:175]
    v_mfma_f32_16x16x32_bf16 v[176:179], v[104:107], v[144:147], v[176:179]
    v_mfma_f32_16x16x32_bf16 v[180:183], v[108:111], v[132:135], v[180:183]
    v_mfma_f32_16x16x32_bf16 v[184:187], v[108:111], v[136:139], v[184:187]
    v_mfma_f32_16x16x32_bf16 v[188:191], v[108:111], v[140:143], v[188:191]
    v_mfma_f32_16x16x32_bf16 v[192:195], v[108:111], v[144:147], v[192:195]
    v_mfma_f32_16x16x32_bf16 v[196:199], v[112:115], v[132:135], v[196:199]
    v_mfma_f32_16x16x32_bf16 v[200:203], v[112:115], v[136:139], v[200:203]
    v_mfma_f32_16x16x32_bf16 v[204:207], v[112:115], v[140:143], v[204:207]
    v_mfma_f32_16x16x32_bf16 v[208:211], v[112:115], v[144:147], v[208:211]
    s_waitcnt vmcnt(8)
    ds_write_b128 v15, v[20:23] offset:0
    ds_write_b128 v15, v[24:27] offset:4096
    ds_write_b128 v15, v[28:31] offset:8192
    ds_write_b128 v15, v[32:35] offset:12288
    ds_write_b128 v15, v[36:39] offset:16384
    ds_write_b128 v15, v[40:43] offset:20480
    ds_write_b128 v15, v[44:47] offset:24576
    ds_write_b128 v15, v[48:51] offset:28672
    v_xor_b32 v16, 32768, v16
    v_xor_b32 v17, 32768, v17
    v_xor_b32 v18, 32768, v18
    v_xor_b32 v19, 32768, v19
    s_waitcnt lgkmcnt(0)
    s_barrier
    s_sub_u32 s35, s35, 1
    s_cmp_lg_u32 s35, 0
    s_cbranch_scc1 Lg_11
    s_waitcnt vmcnt(0)
    s_nop 9
    v_and_b32 v5, 7, v3
    v_lshrrev_b32 v6, 1, v4
    v_xor_b32 v5, v5, v6
    v_lshlrev_b32 v5, 4, v5
    v_and_b32 v6, 1, v4
    v_lshl_add_u32 v5, v6, 3, v5
    v_mul_u32_u24 v6, 128, v3
    v_add_u32 v5, v5, v6
    v_mul_u32_u24 v6, 8192, v2
    v_add_u32 v212, v5, v6
    v_lshrrev_b32 v5, 3, v1
    v_add_u32 v213, 0, v5
    v_and_b32 v214, 7, v213
    v_and_b32 v218, 7, v1
    v_xor_b32 v214, v214, v218
    v_lshlrev_b32 v214, 4, v214
    v_mul_u32_u24 v213, 128, v213
    v_add_u32 v214, v214, v213
    v_add_u32 v214, v214, v6
    v_lshrrev_b32 v213, 1, v2
    v_mul_u32_u24 v213, 64, v213
    v_add_u32 v213, v213, v5
    v_mul_lo_u32 v213, s33, v213
    v_and_b32 v218, 7, v1
    v_lshl_add_u32 v218, v218, 4, v213
    v_and_b32 v213, 1, v2
    v_mul_u32_u24 v213, 128, v213
    v_add_u32 v218, v218, v213
    s_mul_i32 s34, s33, 8
    v_xor_b32 v213, 0, v212
    v_cvt_pk_bf16_f32 v20, v148, v149
    v_cvt_pk_bf16_f32 v21, v150, v151
    ds_write_b64 v213, v[20:21] offset:0
    v_cvt_pk_bf16_f32 v22, v152, v153
    v_cvt_pk_bf16_f32 v23, v154, v155
    ds_write_b64 v213, v[22:23] offset:2048
    v_cvt_pk_bf16_f32 v24, v156, v157
    v_cvt_pk_bf16_f32 v25, v158, v159
    ds_write_b64 v213, v[24:25] offset:4096
    v_cvt_pk_bf16_f32 v26, v160, v161
    v_cvt_pk_bf16_f32 v27, v162, v163
    ds_write_b64 v213, v[26:27] offset:6144
    v_xor_b32 v213, 32, v212
    v_cvt_pk_bf16_f32 v28, v164, v165
    v_cvt_pk_bf16_f32 v29, v166, v167
    ds_write_b64 v213, v[28:29] offset:0
    v_cvt_pk_bf16_f32 v30, v168, v169
    v_cvt_pk_bf16_f32 v31, v170, v171
    ds_write_b64 v213, v[30:31] offset:2048
    v_cvt_pk_bf16_f32 v32, v172, v173
    v_cvt_pk_bf16_f32 v33, v174, v175
    ds_write_b64 v213, v[32:33] offset:4096
    v_cvt_pk_bf16_f32 v34, v176, v177
    v_cvt_pk_bf16_f32 v35, v178, v179
    ds_write_b64 v213, v[34:35] offset:6144
    v_xor_b32 v213, 64, v212
    v_cvt_pk_bf16_f32 v20, v180, v181
    v_cvt_pk_bf16_f32 v21, v182, v183
    ds_write_b64 v213, v[20:21] offset:0
    v_cvt_pk_bf16_f32 v22, v184, v185
    v_cvt_pk_bf16_f32 v23, v186, v187
    ds_write_b64 v213, v[22:23] offset:2048
    v_cvt_pk_bf16_f32 v24, v188, v189
    v_cvt_pk_bf16_f32 v25, v190, v191
    ds_write_b64 v213, v[24:25] offset:4096
    v_cvt_pk_bf16_f32 v26, v192, v193
    v_cvt_pk_bf16_f32 v27, v194, v195
    ds_write_b64 v213, v[26:27] offset:6144
    v_xor_b32 v213, 96, v212
    v_cvt_pk_bf16_f32 v28, v196, v197
    v_cvt_pk_bf16_f32 v29, v198, v199
    ds_write_b64 v213, v[28:29] offset:0
    v_cvt_pk_bf16_f32 v30, v200, v201
    v_cvt_pk_bf16_f32 v31, v202, v203
    ds_write_b64 v213, v[30:31] offset:2048
    v_cvt_pk_bf16_f32 v32, v204, v205
    v_cvt_pk_bf16_f32 v33, v206, v207
    ds_write_b64 v213, v[32:33] offset:4096
    v_cvt_pk_bf16_f32 v34, v208, v209
    v_cvt_pk_bf16_f32 v35, v210, v211
    ds_write_b64 v213, v[34:35] offset:6144
    s_waitcnt lgkmcnt(0)
    ds_read_b128 v[84:87], v214 offset:0
    ds_read_b128 v[88:91], v214 offset:1024
    ds_read_b128 v[92:95], v214 offset:2048
    ds_read_b128 v[96:99], v214 offset:3072
    ds_read_b128 v[100:103], v214 offset:4096
    ds_read_b128 v[104:107], v214 offset:5120
    ds_read_b128 v[108:111], v214 offset:6144
    ds_read_b128 v[112:115], v214 offset:7168
    s_waitcnt lgkmcnt(7)
    buffer_store_dwordx4 v[84:87], v218, s[8:11], s30 offen sc1
    s_add_u32 s30, s30, s34
    s_waitcnt lgkmcnt(6)
    buffer_store_dwordx4 v[88:91], v218, s[8:11], s30 offen sc1
    s_add_u32 s30, s30, s34
    s_waitcnt lgkmcnt(5)
    buffer_store_dwordx4 v[92:95], v218, s[8:11], s30 offen sc1
    s_add_u32 s30, s30, s34
    s_waitcnt lgkmcnt(4)
    buffer_store_dwordx4 v[96:99], v218, s[8:11], s30 offen sc1
    s_add_u32 s30, s30, s34
    s_waitcnt lgkmcnt(3)
    buffer_store_dwordx4 v[100:103], v218, s[8:11], s30 offen sc1
    s_add_u32 s30, s30, s34
    s_waitcnt lgkmcnt(2)
    buffer_store_dwordx4 v[104:107], v218, s[8:11], s30 offen sc1
    s_add_u32 s30, s30, s34
    s_waitcnt lgkmcnt(1)
    buffer_store_dwordx4 v[108:111], v218, s[8:11], s30 offen sc1
    s_add_u32 s30, s30, s34
    s_waitcnt lgkmcnt(0)
    buffer_store_dwordx4 v[112:115], v218, s[8:11], s30 offen sc1
    s_add_u32 s30, s30, s34
    s_nop 1
    s_nop 0
    v_readfirstlane_b32 s36, v2
    s_nop 2
    s_waitcnt vmcnt(0)
    s_barrier
    s_cmp_lg_u32 s36, 0
    s_cbranch_scc1 Lrel_12
    s_mov_b64 exec, 1
    v_mov_b32 v5, 1
    v_mov_b32 v6, 0
    buffer_atomic_add v5, v6, s[8:11], s37 offen sc1
    s_waitcnt vmcnt(0)
    s_mov_b64 exec, -1
Lrel_12:
Lq_end128:
    s_endpgm
Lg_entry256:
    s_load_dwordx2 s[4:5], s[0:1], 104
    s_load_dwordx2 s[6:7], s[0:1], 0
    s_waitcnt lgkmcnt(0)
    s_mov_b32 s8, s4
    s_and_b32 s9, s5, 0xffff
    s_mov_b32 s10, 0x10000000
    s_mov_b32 s11, 0x00020000
    s_mov_b32 s12, s6
    s_and_b32 s13, s7, 0xffff
    s_mov_b32 s14, 0x280000
    s_mov_b32 s15, 0x00020000
    v_and_b32 v1, 63, v0
    v_lshrrev_b32 v2, 6, v0
    v_and_b32 v3, 15, v0
    v_bfe_u32 v4, v0, 4, 2
    v_lshrrev_b32 v5, 3, v0
    v_and_b32 v6, 7, v0
    v_lshlrev_b32 v6, 4, v6
    v_add_u32 v7, 0, v5
    v_mul_u32_u24 v7, 1280, v7
    v_add_u32 v7, v7, v6
    v_add_u32 v8, 32, v5
    v_mul_u32_u24 v8, 1280, v8
    v_add_u32 v8, v8, v6
    v_add_u32 v9, 64, v5
    v_mul_u32_u24 v9, 1280, v9
    v_add_u32 v9, v9, v6
    v_add_u32 v10, 96, v5
    v_mul_u32_u24 v10, 1280, v10
    v_add_u32 v10, v10, v6
    v_add_u32 v11, 128, v5
    v_mul_u32_u24 v11, 1280, v11
    v_add_u32 v11, v11, v6
    v_add_u32 v12, 160, v5
    v_mul_u32_u24 v12, 1280, v12
    v_add_u32 v12, v12, v6
    v_add_u32 v13, 192, v5
    v_mul_u32_u24 v13, 1280, v13
    v_add_u32 v13, v13, v6
    v_add_u32 v14, 224, v5
    v_mul_u32_u24 v14, 1280, v14
    v_add_u32 v14, v14, v6
    v_add_u32 v15, 0, v5
    v_mul_u32_u24 v15, 1280, v15
    v_add_u32 v15, v15, v6
    v_add_u32 v16, 32, v5
    v_mul_u32_u24 v16, 1280, v16
    v_add_u32 v16, v16, v6
    v_add_u32 v17, 64, v5
    v_mul_u32_u24 v17, 1280, v17
    v_add_u32 v17, v17, v6
    v_add_u32 v18, 96, v5
    v_mul_u32_u24 v18, 1280, v18
    v_add_u32 v18, v18, v6
    v_add_u32 v19, 128, v5
    v_mul_u32_u24 v19, 1280, v19
    v_add_u32 v19, v19, v6
    v_add_u32 v20, 160, v5
    v_mul_u32_u24 v20, 1280, v20
    v_add_u32 v20, v20, v6
    v_add_u32 v21, 192, v5
    v_mul_u32_u24 v21, 1280, v21
    v_add_u32 v21, v21, v6
    v_add_u32 v22, 224, v5
    v_mul_u32_u24 v22, 1280, v22
    v_add_u32 v22, v22, v6
    v_lshrrev_b32 v5, 3, v0
    v_and_b32 v6, 7, v0
    v_and_b32 v23, 7, v5
    v_xor_b32 v23, v23, v6
    v_lshlrev_b32 v23, 4, v23
    v_lshl_add_u32 v23, v5, 7, v23
    v_and_b32 v5, 7, v3
    v_xor_b32 v5, v5, v4
    v_lshlrev_b32 v5, 4, v5
    v_lshl_add_u32 v5, v3, 7, v5
    v_and_b32 v6, 1, v2
    v_mul_u32_u24 v6, 16384, v6
    v_add_u32 v24, v5, v6
    v_xor_b32 v25, 64, v24
    v_lshrrev_b32 v6, 1, v2
    v_mul_u32_u24 v6, 16384, v6
    v_add_u32 v26, v5, v6
    v_add_u32 v26, 32768, v26
    v_xor_b32 v27, 64, v26
    v_accvgpr_write_b32 a0, 0
    v_accvgpr_write_b32 a1, 0
    v_accvgpr_write_b32 a2, 0
    v_accvgpr_write_b32 a3, 0
    v_accvgpr_write_b32 a4, 0
    v_accvgpr_write_b32 a5, 0
    v_accvgpr_write_b32 a6, 0
    v_accvgpr_write_b32 a7, 0
    v_accvgpr_write_b32 a8, 0
    v_accvgpr_write_b32 a9, 0
    v_accvgpr_write_b32 a10, 0
    v_accvgpr_write_b32 a11, 0
    v_accvgpr_write_b32 a12, 0
    v_accvgpr_write_b32 a13, 0
    v_accvgpr_write_b32 a14, 0
    v_accvgpr_write_b32 a15, 0
    v_accvgpr_write_b32 a16, 0
    v_accvgpr_write_b32 a17, 0
    v_accvgpr_write_b32 a18, 0
    v_accvgpr_write_b32 a19, 0
    v_accvgpr_write_b32 a20, 0
    v_accvgpr_write_b32 a21, 0
    v_accvgpr_write_b32 a22, 0
    v_accvgpr_write_b32 a23, 0
    v_accvgpr_write_b32 a24, 0
    v_accvgpr_write_b32 a25, 0
    v_accvgpr_write_b32 a26, 0
    v_accvgpr_write_b32 a27, 0
    v_accvgpr_write_b32 a28, 0
    v_accvgpr_write_b32 a29, 0
    v_accvgpr_write_b32 a30, 0
    v_accvgpr_write_b32 a31, 0
    v_accvgpr_write_b32 a32, 0
    v_accvgpr_write_b32 a33, 0
    v_accvgpr_write_b32 a34, 0
    v_accvgpr_write_b32 a35, 0
    v_accvgpr_write_b32 a36, 0
    v_accvgpr_write_b32 a37, 0
    v_accvgpr_write_b32 a38, 0
    v_accvgpr_write_b32 a39, 0
    v_accvgpr_write_b32 a40, 0
    v_accvgpr_write_b32 a41, 0
    v_accvgpr_write_b32 a42, 0
    v_accvgpr_write_b32 a43, 0
    v_accvgpr_write_b32 a44, 0
    v_accvgpr_write_b32 a45, 0
    v_accvgpr_write_b32 a46, 0
    v_accvgpr_write_b32 a47, 0
    v_accvgpr_write_b32 a48, 0
    v_accvgpr_write_b32 a49, 0
    v_accvgpr_write_b32 a50, 0
    v_accvgpr_write_b32 a51, 0
    v_accvgpr_write_b32 a52, 0
    v_accvgpr_write_b32 a53, 0
    v_accvgpr_write_b32 a54, 0
    v_accvgpr_write_b32 a55, 0
    v_accvgpr_write_b32 a56, 0
    v_accvgpr_write_b32 a57, 0
    v_accvgpr_write_b32 a58, 0
    v_accvgpr_write_b32 a59, 0
    v_accvgpr_write_b32 a60, 0
    v_accvgpr_write_b32 a61, 0
    v_accvgpr_write_b32 a62, 0
    v_accvgpr_write_b32 a63, 0
    v_accvgpr_write_b32 a64, 0
    v_accvgpr_write_b32 a65, 0
    v_accvgpr_write_b32 a66, 0
    v_accvgpr_write_b32 a67, 0
    v_accvgpr_write_b32 a68, 0
    v_accvgpr_write_b32 a69, 0
    v_accvgpr_write_b32 a70, 0
    v_accvgpr_write_b32 a71, 0
    v_accvgpr_write_b32 a72, 0
    v_accvgpr_write_b32 a73, 0
    v_accvgpr_write_b32 a74, 0
    v_accvgpr_write_b32 a75, 0
    v_accvgpr_write_b32 a76, 0
    v_accvgpr_write_b32 a77, 0
    v_accvgpr_write_b32 a78, 0
    v_accvgpr_write_b32 a79, 0
    v_accvgpr_write_b32 a80, 0
    v_accvgpr_write_b32 a81, 0
    v_accvgpr_write_b32 a82, 0
    v_accvgpr_write_b32 a83, 0
    v_accvgpr_write_b32 a84, 0
    v_accvgpr_write_b32 a85, 0
    v_accvgpr_write_b32 a86, 0
    v_accvgpr_write_b32 a87, 0
    v_accvgpr_write_b32 a88, 0
    v_accvgpr_write_b32 a89, 0
    v_accvgpr_write_b32 a90, 0
    v_accvgpr_write_b32 a91, 0
    v_accvgpr_write_b32 a92, 0
    v_accvgpr_write_b32 a93, 0
    v_accvgpr_write_b32 a94, 0
    v_accvgpr_write_b32 a95, 0
    v_accvgpr_write_b32 a96, 0
    v_accvgpr_write_b32 a97, 0
    v_accvgpr_write_b32 a98, 0
    v_accvgpr_write_b32 a99, 0
    v_accvgpr_write_b32 a100, 0
    v_accvgpr_write_b32 a101, 0
    v_accvgpr_write_b32 a102, 0
    v_accvgpr_write_b32 a103, 0
    v_accvgpr_write_b32 a104, 0
    v_accvgpr_write_b32 a105, 0
    v_accvgpr_write_b32 a106, 0
    v_accvgpr_write_b32 a107, 0
    v_accvgpr_write_b32 a108, 0
    v_accvgpr_write_b32 a109, 0
    v_accvgpr_write_b32 a110, 0
    v_accvgpr_write_b32 a111, 0
    v_accvgpr_write_b32 a112, 0
    v_accvgpr_write_b32 a113, 0
    v_accvgpr_write_b32 a114, 0
    v_accvgpr_write_b32 a115, 0
    v_accvgpr_write_b32 a116, 0
    v_accvgpr_write_b32 a117, 0
    v_accvgpr_write_b32 a118, 0
    v_accvgpr_write_b32 a119, 0
    v_accvgpr_write_b32 a120, 0
    v_accvgpr_write_b32 a121, 0
    v_accvgpr_write_b32 a122, 0
    v_accvgpr_write_b32 a123, 0
    v_accvgpr_write_b32 a124, 0
    v_accvgpr_write_b32 a125, 0
    v_accvgpr_write_b32 a126, 0
    v_accvgpr_write_b32 a127, 0
    v_accvgpr_write_b32 a128, 0
    v_accvgpr_write_b32 a129, 0
    v_accvgpr_write_b32 a130, 0
    v_accvgpr_write_b32 a131, 0
    v_accvgpr_write_b32 a132, 0
    v_accvgpr_write_b32 a133, 0
    v_accvgpr_write_b32 a134, 0
    v_accvgpr_write_b32 a135, 0
    v_accvgpr_write_b32 a136, 0
    v_accvgpr_write_b32 a137, 0
    v_accvgpr_write_b32 a138, 0
    v_accvgpr_write_b32 a139, 0
    v_accvgpr_write_b32 a140, 0
    v_accvgpr_write_b32 a141, 0
    v_accvgpr_write_b32 a142, 0
    v_accvgpr_write_b32 a143, 0
    v_accvgpr_write_b32 a144, 0
    v_accvgpr_write_b32 a145, 0
    v_accvgpr_write_b32 a146, 0
    v_accvgpr_write_b32 a147, 0
    v_accvgpr_write_b32 a148, 0
    v_accvgpr_write_b32 a149, 0
    v_accvgpr_write_b32 a150, 0
    v_accvgpr_write_b32 a151, 0
    v_accvgpr_write_b32 a152, 0
    v_accvgpr_write_b32 a153, 0
    v_accvgpr_write_b32 a154, 0
    v_accvgpr_write_b32 a155, 0
    v_accvgpr_write_b32 a156, 0
    v_accvgpr_write_b32 a157, 0
    v_accvgpr_write_b32 a158, 0
    v_accvgpr_write_b32 a159, 0
    v_accvgpr_write_b32 a160, 0
    v_accvgpr_write_b32 a161, 0
    v_accvgpr_write_b32 a162, 0
    v_accvgpr_write_b32 a163, 0
    v_accvgpr_write_b32 a164, 0
    v_accvgpr_write_b32 a165, 0
    v_accvgpr_write_b32 a166, 0
    v_accvgpr_write_b32 a167, 0
    v_accvgpr_write_b32 a168, 0
    v_accvgpr_write_b32 a169, 0
    v_accvgpr_write_b32 a170, 0
    v_accvgpr_write_b32 a171, 0
    v_accvgpr_write_b32 a172, 0
    v_accvgpr_write_b32 a173, 0
    v_accvgpr_write_b32 a174, 0
    v_accvgpr_write_b32 a175, 0
    v_accvgpr_write_b32 a176, 0
    v_accvgpr_write_b32 a177, 0
    v_accvgpr_write_b32 a178, 0
    v_accvgpr_write_b32 a179, 0
    v_accvgpr_write_b32 a180, 0
    v_accvgpr_write_b32 a181, 0
    v_accvgpr_write_b32 a182, 0
    v_accvgpr_write_b32 a183, 0
    v_accvgpr_write_b32 a184, 0
    v_accvgpr_write_b32 a185, 0
    v_accvgpr_write_b32 a186, 0
    v_accvgpr_write_b32 a187, 0
    v_accvgpr_write_b32 a188, 0
    v_accvgpr_write_b32 a189, 0
    v_accvgpr_write_b32 a190, 0
    v_accvgpr_write_b32 a191, 0
    v_accvgpr_write_b32 a192, 0
    v_accvgpr_write_b32 a193, 0
    v_accvgpr_write_b32 a194, 0
    v_accvgpr_write_b32 a195, 0
    v_accvgpr_write_b32 a196, 0
    v_accvgpr_write_b32 a197, 0
    v_accvgpr_write_b32 a198, 0
    v_accvgpr_write_b32 a199, 0
    v_accvgpr_write_b32 a200, 0
    v_accvgpr_write_b32 a201, 0
    v_accvgpr_write_b32 a202, 0
    v_accvgpr_write_b32 a203, 0
    v_accvgpr_write_b32 a204, 0
    v_accvgpr_write_b32 a205, 0
    v_accvgpr_write_b32 a206, 0
    v_accvgpr_write_b32 a207, 0
    v_accvgpr_write_b32 a208, 0
    v_accvgpr_write_b32 a209, 0
    v_accvgpr_write_b32 a210, 0
    v_accvgpr_write_b32 a211, 0
    v_accvgpr_write_b32 a212, 0
    v_accvgpr_write_b32 a213, 0
    v_accvgpr_write_b32 a214, 0
    v_accvgpr_write_b32 a215, 0
    v_accvgpr_write_b32 a216, 0
    v_accvgpr_write_b32 a217, 0
    v_accvgpr_write_b32 a218, 0
    v_accvgpr_write_b32 a219, 0
    v_accvgpr_write_b32 a220, 0
    v_accvgpr_write_b32 a221, 0
    v_accvgpr_write_b32 a222, 0
    v_accvgpr_write_b32 a223, 0
    v_accvgpr_write_b32 a224, 0
    v_accvgpr_write_b32 a225, 0
    v_accvgpr_write_b32 a226, 0
    v_accvgpr_write_b32 a227, 0
    v_accvgpr_write_b32 a228, 0
    v_accvgpr_write_b32 a229, 0
    v_accvgpr_write_b32 a230, 0
    v_accvgpr_write_b32 a231, 0
    v_accvgpr_write_b32 a232, 0
    v_accvgpr_write_b32 a233, 0
    v_accvgpr_write_b32 a234, 0
    v_accvgpr_write_b32 a235, 0
    v_accvgpr_write_b32 a236, 0
    v_accvgpr_write_b32 a237, 0
    v_accvgpr_write_b32 a238, 0
    v_accvgpr_write_b32 a239, 0
    v_accvgpr_write_b32 a240, 0
    v_accvgpr_write_b32 a241, 0
    v_accvgpr_write_b32 a242, 0
    v_accvgpr_write_b32 a243, 0
    v_accvgpr_write_b32 a244, 0
    v_accvgpr_write_b32 a245, 0
    v_accvgpr_write_b32 a246, 0
    v_accvgpr_write_b32 a247, 0
    v_accvgpr_write_b32 a248, 0
    v_accvgpr_write_b32 a249, 0
    v_accvgpr_write_b32 a250, 0
    v_accvgpr_write_b32 a251, 0
    v_accvgpr_write_b32 a252, 0
    v_accvgpr_write_b32 a253, 0
    v_accvgpr_write_b32 a254, 0
    v_accvgpr_write_b32 a255, 0
    s_mul_i32 s18, s16, 327680
    s_add_u32 s18, s18, 0x0
    s_mul_i32 s19, s17, 327680
    s_cmp_lt_u32 s16, 32
    s_cselect_b32 s20, s8, s12
    s_cselect_b32 s24, s12, s8
    s_cselect_b32 s21, s9, s13
    s_cselect_b32 s25, s13, s9
    s_cselect_b32 s22, s10, s14
    s_cselect_b32 s26, s14, s10
    s_cselect_b32 s23, s11, s15
    s_cselect_b32 s27, s15, s11
    s_cselect_b32 s28, s18, s19
    s_cselect_b32 s29, s19, s18
    s_mul_i32 s30, s17, 4259840
    s_lshl_b32 s31, s16, 9
    s_add_u32 s30, s30, s31
    s_add_u32 s30, s30, 0x1500000
    s_sub_u32 s31, s16, 32
    s_mul_i32 s31, s31, 1081344
    s_lshl_b32 s32, s17, 9
    s_add_u32 s31, s31, s32
    s_add_u32 s31, s31, 0x3600000
    s_cmp_lt_u32 s16, 32
    s_cselect_b32 s30, s30, s31
    s_mov_b32 s33, 4224
    s_cselect_b32 s33, 16640, s33
    v_lshrrev_b32 v5, 1, v2
    v_lshlrev_b32 v5, 7, v5
    v_add_u32 v5, v5, v3
    v_mul_lo_u32 v220, s33, v5
    v_and_b32 v5, 1, v2
    v_lshlrev_b32 v5, 8, v5
    v_lshl_add_u32 v5, v4, 3, v5
    v_add_u32 v220, v220, v5
    s_lshl_b32 s34, s33, 4
    buffer_load_dwordx4 v[28:31], v7, s[20:23], s28 offen
    buffer_load_dwordx4 v[32:35], v8, s[20:23], s28 offen
    buffer_load_dwordx4 v[36:39], v9, s[20:23], s28 offen
    buffer_load_dwordx4 v[40:43], v10, s[20:23], s28 offen
    buffer_load_dwordx4 v[44:47], v11, s[20:23], s28 offen
    buffer_load_dwordx4 v[48:51], v12, s[20:23], s28 offen
    buffer_load_dwordx4 v[52:55], v13, s[20:23], s28 offen
    buffer_load_dwordx4 v[56:59], v14, s[20:23], s28 offen
    buffer_load_dwordx4 v[60:63], v15, s[24:27], s29 offen
    buffer_load_dwordx4 v[64:67], v16, s[24:27], s29 offen
    buffer_load_dwordx4 v[68:71], v17, s[24:27], s29 offen
    buffer_load_dwordx4 v[72:75], v18, s[24:27], s29 offen
    buffer_load_dwordx4 v[76:79], v19, s[24:27], s29 offen
    buffer_load_dwordx4 v[80:83], v20, s[24:27], s29 offen
    buffer_load_dwordx4 v[84:87], v21, s[24:27], s29 offen
    buffer_load_dwordx4 v[88:91], v22, s[24:27], s29 offen
    s_add_u32 s28, s28, 128
    s_add_u32 s29, s29, 128
    s_waitcnt vmcnt(0)
    ds_write_b128 v23, v[28:31] offset:0
    ds_write_b128 v23, v[32:35] offset:4096
    ds_write_b128 v23, v[36:39] offset:8192
    ds_write_b128 v23, v[40:43] offset:12288
    ds_write_b128 v23, v[44:47] offset:16384
    ds_write_b128 v23, v[48:51] offset:20480
    ds_write_b128 v23, v[52:55] offset:24576
    ds_write_b128 v23, v[56:59] offset:28672
    ds_write_b128 v23, v[60:63] offset:32768
    ds_write_b128 v23, v[64:67] offset:36864
    ds_write_b128 v23, v[68:71] offset:40960
    ds_write_b128 v23, v[72:75] offset:45056
    ds_write_b128 v23, v[76:79] offset:49152
    ds_write_b128 v23, v[80:83] offset:53248
    ds_write_b128 v23, v[84:87] offset:57344
    ds_write_b128 v23, v[88:91] offset:61440
    s_waitcnt lgkmcnt(0)
    s_barrier
    s_mov_b32 s35, 10
Lg_13:
    buffer_load_dwordx4 v[28:31], v7, s[20:23], s28 offen
    buffer_load_dwordx4 v[32:35], v8, s[20:23], s28 offen
    buffer_load_dwordx4 v[36:39], v9, s[20:23], s28 offen
    buffer_load_dwordx4 v[40:43], v10, s[20:23], s28 offen
    buffer_load_dwordx4 v[44:47], v11, s[20:23], s28 offen
    buffer_load_dwordx4 v[48:51], v12, s[20:23], s28 offen
    buffer_load_dwordx4 v[52:55], v13, s[20:23], s28 offen
    buffer_load_dwordx4 v[56:59], v14, s[20:23], s28 offen
    buffer_load_dwordx4 v[60:63], v15, s[24:27], s29 offen
    buffer_load_dwordx4 v[64:67], v16, s[24:27], s29 offen
    buffer_load_dwordx4 v[68:71], v17, s[24:27], s29 offen
    buffer_load_dwordx4 v[72:75], v18, s[24:27], s29 offen
    buffer_load_dwordx4 v[76:79], v19, s[24:27], s29 offen
    buffer_load_dwordx4 v[80:83], v20, s[24:27], s29 offen
    buffer_load_dwordx4 v[84:87], v21, s[24:27], s29 offen
    buffer_load_dwordx4 v[88:91], v22, s[24:27], s29 offen
    s_add_u32 s28, s28, 128
    s_add_u32 s29, s29, 128
    v_xor_b32 v23, 65536, v23
    ds_read_b128 v[92:95], v24 offset:0
    ds_read_b128 v[96:99], v24 offset:2048
    ds_read_b128 v[100:103], v24 offset:4096
    ds_read_b128 v[104:107], v24 offset:6144
    ds_read_b128 v[108:111], v24 offset:8192
    ds_read_b128 v[112:115], v24 offset:10240
    ds_read_b128 v[116:119], v24 offset:12288
    ds_read_b128 v[120:123], v24 offset:14336
    ds_read_b128 v[156:159], v26 offset:0
    ds_read_b128 v[160:163], v26 offset:2048
    ds_read_b128 v[164:167], v26 offset:4096
    ds_read_b128 v[168:171], v26 offset:6144
    ds_read_b128 v[172:175], v26 offset:8192
    ds_read_b128 v[176:179], v26 offset:10240
    ds_read_b128 v[180:183], v26 offset:12288
    ds_read_b128 v[184:187], v26 offset:14336
    ds_read_b128 v[124:127], v25 offset:0
    ds_read_b128 v[128:131], v25 offset:2048
    ds_read_b128 v[132:135], v25 offset:4096
    ds_read_b128 v[136:139], v25 offset:6144
    ds_read_b128 v[140:143], v25 offset:8192
    ds_read_b128 v[144:147], v25 offset:10240
    ds_read_b128 v[148:151], v25 offset:12288
    ds_read_b128 v[152:155], v25 offset:14336
    ds_read_b128 v[188:191], v27 offset:0
    ds_read_b128 v[192:195], v27 offset:2048
    ds_read_b128 v[196:199], v27 offset:4096
    ds_read_b128 v[200:203], v27 offset:6144
    ds_read_b128 v[204:207], v27 offset:8192
    ds_read_b128 v[208:211], v27 offset:10240
    ds_read_b128 v[212:215], v27 offset:12288
    ds_read_b128 v[216:219], v27 offset:14336
    s_waitcnt lgkmcnt(15)
    v_mfma_f32_16x16x32_bf16 a[0:3], v[92:95], v[156:159], a[0:3]
    v_mfma_f32_16x16x32_bf16 a[4:7], v[92:95], v[160:163], a[4:7]
    v_mfma_f32_16x16x32_bf16 a[8:11], v[92:95], v[164:167], a[8:11]
    v_mfma_f32_16x16x32_bf16 a[12:15], v[92:95], v[168:171], a[12:15]
    v_mfma_f32_16x16x32_bf16 a[16:19], v[92:95], v[172:175], a[16:19]
    v_mfma_f32_16x16x32_bf16 a[20:23], v[92:95], v[176:179], a[20:23]
    v_mfma_f32_16x16x32_bf16 a[24:27], v[92:95], v[180:183], a[24:27]
    v_mfma_f32_16x16x32_bf16 a[28:31], v[92:95], v[184:187], a[28:31]
    v_mfma_f32_16x16x32_bf16 a[32:35], v[96:99], v[156:159], a[32:35]
    v_mfma_f32_16x16x32_bf16 a[36:39], v[96:99], v[160:163], a[36:39]
    v_mfma_f32_16x16x32_bf16 a[40:43], v[96:99], v[164:167], a[40:43]
    v_mfma_f32_16x16x32_bf16 a[44:47], v[96:99], v[168:171], a[44:47]
    v_mfma_f32_16x16x32_bf16 a[48:51], v[96:99], v[172:175], a[48:51]
    v_mfma_f32_16x16x32_bf16 a[52:55], v[96:99], v[176:179], a[52:55]
    v_mfma_f32_16x16x32_bf16 a[56:59], v[96:99], v[180:183], a[56:59]
    v_mfma_f32_16x16x32_bf16 a[60:63], v[96:99], v[184:187], a[60:63]
    v_mfma_f32_16x16x32_bf16 a[64:67], v[100:103], v[156:159], a[64:67]
    v_mfma_f32_16x16x32_bf16 a[68:71], v[100:103], v[160:163], a[68:71]
    v_mfma_f32_16x16x32_bf16 a[72:75], v[100:103], v[164:167], a[72:75]
    v_mfma_f32_16x16x32_bf16 a[76:79], v[100:103], v[168:171], a[76:79]
    v_mfma_f32_16x16x32_bf16 a[80:83], v[100:103], v[172:175], a[80:83]
    v_mfma_f32_16x16x32_bf16 a[84:87], v[100:103], v[176:179], a[84:87]
    v_mfma_f32_16x16x32_bf16 a[88:91], v[100:103], v[180:183], a[88:91]
    v_mfma_f32_16x16x32_bf16 a[92:95], v[100:103], v[184:187], a[92:95]
    v_mfma_f32_16x16x32_bf16 a[96:99], v[104:107], v[156:159], a[96:99]
    v_mfma_f32_16x16x32_bf16 a[100:103], v[104:107], v[160:163], a[100:103]
    v_mfma_f32_16x16x32_bf16 a[104:107], v[104:107], v[164:167], a[104:107]
    v_mfma_f32_16x16x32_bf16 a[108:111], v[104:107], v[168:171], a[108:111]
    v_mfma_f32_16x16x32_bf16 a[112:115], v[104:107], v[172:175], a[112:115]
    v_mfma_f32_16x16x32_bf16 a[116:119], v[104:107], v[176:179], a[116:119]
    v_mfma_f32_16x16x32_bf16 a[120:123], v[104:107], v[180:183], a[120:123]
    v_mfma_f32_16x16x32_bf16 a[124:127], v[104:107], v[184:187], a[124:127]
    v_mfma_f32_16x16x32_bf16 a[128:131], v[108:111], v[156:159], a[128:131]
    v_mfma_f32_16x16x32_bf16 a[132:135], v[108:111], v[160:163], a[132:135]
    v_mfma_f32_16x16x32_bf16 a[136:139], v[108:111], v[164:167], a[136:139]
    v_mfma_f32_16x16x32_bf16 a[140:143], v[108:111], v[168:171], a[140:143]
    v_mfma_f32_16x16x32_bf16 a[144:147], v[108:111], v[172:175], a[144:147]
    v_mfma_f32_16x16x32_bf16 a[148:151], v[108:111], v[176:179], a[148:151]
    v_mfma_f32_16x16x32_bf16 a[152:155], v[108:111], v[180:183], a[152:155]
    v_mfma_f32_16x16x32_bf16 a[156:159], v[108:111], v[184:187], a[156:159]
    v_mfma_f32_16x16x32_bf16 a[160:163], v[112:115], v[156:159], a[160:163]
    v_mfma_f32_16x16x32_bf16 a[164:167], v[112:115], v[160:163], a[164:167]
    v_mfma_f32_16x16x32_bf16 a[168:171], v[112:115], v[164:167], a[168:171]
    v_mfma_f32_16x16x32_bf16 a[172:175], v[112:115], v[168:171], a[172:175]
    v_mfma_f32_16x16x32_bf16 a[176:179], v[112:115], v[172:175], a[176:179]
    v_mfma_f32_16x16x32_bf16 a[180:183], v[112:115], v[176:179], a[180:183]
    v_mfma_f32_16x16x32_bf16 a[184:187], v[112:115], v[180:183], a[184:187]
    v_mfma_f32_16x16x32_bf16 a[188:191], v[112:115], v[184:187], a[188:191]
    v_mfma_f32_16x16x32_bf16 a[192:195], v[116:119], v[156:159], a[192:195]
    v_mfma_f32_16x16x32_bf16 a[196:199], v[116:119], v[160:163], a[196:199]
    v_mfma_f32_16x16x32_bf16 a[200:203], v[116:119], v[164:167], a[200:203]
    v_mfma_f32_16x16x32_bf16 a[204:207], v[116:119], v[168:171], a[204:207]
    v_mfma_f32_16x16x32_bf16 a[208:211], v[116:119], v[172:175], a[208:211]
    v_mfma_f32_16x16x32_bf16 a[212:215], v[116:119], v[176:179], a[212:215]
    v_mfma_f32_16x16x32_bf16 a[216:219], v[116:119], v[180:183], a[216:219]
    v_mfma_f32_16x16x32_bf16 a[220:223], v[116:119], v[184:187], a[220:223]
    v_mfma_f32_16x16x32_bf16 a[224:227], v[120:123], v[156:159], a[224:227]
    v_mfma_f32_16x16x32_bf16 a[228:231], v[120:123], v[160:163], a[228:231]
    v_mfma_f32_16x16x32_bf16 a[232:235], v[120:123], v[164:167], a[232:235]
    v_mfma_f32_16x16x32_bf16 a[236:239], v[120:123], v[168:171], a[236:239]
    v_mfma_f32_16x16x32_bf16 a[240:243], v[120:123], v[172:175], a[240:243]
    v_mfma_f32_16x16x32_bf16 a[244:247], v[120:123], v[176:179], a[244:247]
    v_mfma_f32_16x16x32_bf16 a[248:251], v[120:123], v[180:183], a[248:251]
    v_mfma_f32_16x16x32_bf16 a[252:255], v[120:123], v[184:187], a[252:255]
    s_waitcnt lgkmcnt(0)
    v_mfma_f32_16x16x32_bf16 a[0:3], v[124:127], v[188:191], a[0:3]
    v_mfma_f32_16x16x32_bf16 a[4:7], v[124:127], v[192:195], a[4:7]
    v_mfma_f32_16x16x32_bf16 a[8:11], v[124:127], v[196:199], a[8:11]
    v_mfma_f32_16x16x32_bf16 a[12:15], v[124:127], v[200:203], a[12:15]
    v_mfma_f32_16x16x32_bf16 a[16:19], v[124:127], v[204:207], a[16:19]
    v_mfma_f32_16x16x32_bf16 a[20:23], v[124:127], v[208:211], a[20:23]
    v_mfma_f32_16x16x32_bf16 a[24:27], v[124:127], v[212:215], a[24:27]
    v_mfma_f32_16x16x32_bf16 a[28:31], v[124:127], v[216:219], a[28:31]
    v_mfma_f32_16x16x32_bf16 a[32:35], v[128:131], v[188:191], a[32:35]
    v_mfma_f32_16x16x32_bf16 a[36:39], v[128:131], v[192:195], a[36:39]
    v_mfma_f32_16x16x32_bf16 a[40:43], v[128:131], v[196:199], a[40:43]
    v_mfma_f32_16x16x32_bf16 a[44:47], v[128:131], v[200:203], a[44:47]
    v_mfma_f32_16x16x32_bf16 a[48:51], v[128:131], v[204:207], a[48:51]
    v_mfma_f32_16x16x32_bf16 a[52:55], v[128:131], v[208:211], a[52:55]
    v_mfma_f32_16x16x32_bf16 a[56:59], v[128:131], v[212:215], a[56:59]
    v_mfma_f32_16x16x32_bf16 a[60:63], v[128:131], v[216:219], a[60:63]
    v_mfma_f32_16x16x32_bf16 a[64:67], v[132:135], v[188:191], a[64:67]
    v_mfma_f32_16x16x32_bf16 a[68:71], v[132:135], v[192:195], a[68:71]
    v_mfma_f32_16x16x32_bf16 a[72:75], v[132:135], v[196:199], a[72:75]
    v_mfma_f32_16x16x32_bf16 a[76:79], v[132:135], v[200:203], a[76:79]
    v_mfma_f32_16x16x32_bf16 a[80:83], v[132:135], v[204:207], a[80:83]
    v_mfma_f32_16x16x32_bf16 a[84:87], v[132:135], v[208:211], a[84:87]
    v_mfma_f32_16x16x32_bf16 a[88:91], v[132:135], v[212:215], a[88:91]
    v_mfma_f32_16x16x32_bf16 a[92:95], v[132:135], v[216:219], a[92:95]
    v_mfma_f32_16x16x32_bf16 a[96:99], v[136:139], v[188:191], a[96:99]
    v_mfma_f32_16x16x32_bf16 a[100:103], v[136:139], v[192:195], a[100:103]
    v_mfma_f32_16x16x32_bf16 a[104:107], v[136:139], v[196:199], a[104:107]
    v_mfma_f32_16x16x32_bf16 a[108:111], v[136:139], v[200:203], a[108:111]
    v_mfma_f32_16x16x32_bf16 a[112:115], v[136:139], v[204:207], a[112:115]
    v_mfma_f32_16x16x32_bf16 a[116:119], v[136:139], v[208:211], a[116:119]
    v_mfma_f32_16x16x32_bf16 a[120:123], v[136:139], v[212:215], a[120:123]
    v_mfma_f32_16x16x32_bf16 a[124:127], v[136:139], v[216:219], a[124:127]
    v_mfma_f32_16x16x32_bf16 a[128:131], v[140:143], v[188:191], a[128:131]
    v_mfma_f32_16x16x32_bf16 a[132:135], v[140:143], v[192:195], a[132:135]
    v_mfma_f32_16x16x32_bf16 a[136:139], v[140:143], v[196:199], a[136:139]
    v_mfma_f32_16x16x32_bf16 a[140:143], v[140:143], v[200:203], a[140:143]
    v_mfma_f32_16x16x32_bf16 a[144:147], v[140:143], v[204:207], a[144:147]
    v_mfma_f32_16x16x32_bf16 a[148:151], v[140:143], v[208:211], a[148:151]
    v_mfma_f32_16x16x32_bf16 a[152:155], v[140:143], v[212:215], a[152:155]
    v_mfma_f32_16x16x32_bf16 a[156:159], v[140:143], v[216:219], a[156:159]
    v_mfma_f32_16x16x32_bf16 a[160:163], v[144:147], v[188:191], a[160:163]
    v_mfma_f32_16x16x32_bf16 a[164:167], v[144:147], v[192:195], a[164:167]
    v_mfma_f32_16x16x32_bf16 a[168:171], v[144:147], v[196:199], a[168:171]
    v_mfma_f32_16x16x32_bf16 a[172:175], v[144:147], v[200:203], a[172:175]
    v_mfma_f32_16x16x32_bf16 a[176:179], v[144:147], v[204:207], a[176:179]
    v_mfma_f32_16x16x32_bf16 a[180:183], v[144:147], v[208:211], a[180:183]
    v_mfma_f32_16x16x32_bf16 a[184:187], v[144:147], v[212:215], a[184:187]
    v_mfma_f32_16x16x32_bf16 a[188:191], v[144:147], v[216:219], a[188:191]
    v_mfma_f32_16x16x32_bf16 a[192:195], v[148:151], v[188:191], a[192:195]
    v_mfma_f32_16x16x32_bf16 a[196:199], v[148:151], v[192:195], a[196:199]
    v_mfma_f32_16x16x32_bf16 a[200:203], v[148:151], v[196:199], a[200:203]
    v_mfma_f32_16x16x32_bf16 a[204:207], v[148:151], v[200:203], a[204:207]
    v_mfma_f32_16x16x32_bf16 a[208:211], v[148:151], v[204:207], a[208:211]
    v_mfma_f32_16x16x32_bf16 a[212:215], v[148:151], v[208:211], a[212:215]
    v_mfma_f32_16x16x32_bf16 a[216:219], v[148:151], v[212:215], a[216:219]
    v_mfma_f32_16x16x32_bf16 a[220:223], v[148:151], v[216:219], a[220:223]
    v_mfma_f32_16x16x32_bf16 a[224:227], v[152:155], v[188:191], a[224:227]
    v_mfma_f32_16x16x32_bf16 a[228:231], v[152:155], v[192:195], a[228:231]
    v_mfma_f32_16x16x32_bf16 a[232:235], v[152:155], v[196:199], a[232:235]
    v_mfma_f32_16x16x32_bf16 a[236:239], v[152:155], v[200:203], a[236:239]
    v_mfma_f32_16x16x32_bf16 a[240:243], v[152:155], v[204:207], a[240:243]
    v_mfma_f32_16x16x32_bf16 a[244:247], v[152:155], v[208:211], a[244:247]
    v_mfma_f32_16x16x32_bf16 a[248:251], v[152:155], v[212:215], a[248:251]
    v_mfma_f32_16x16x32_bf16 a[252:255], v[152:155], v[216:219], a[252:255]
    s_waitcnt vmcnt(0)
    ds_write_b128 v23, v[28:31] offset:0
    ds_write_b128 v23, v[32:35] offset:4096
    ds_write_b128 v23, v[36:39] offset:8192
    ds_write_b128 v23, v[40:43] offset:12288
    ds_write_b128 v23, v[44:47] offset:16384
    ds_write_b128 v23, v[48:51] offset:20480
    ds_write_b128 v23, v[52:55] offset:24576
    ds_write_b128 v23, v[56:59] offset:28672
    ds_write_b128 v23, v[60:63] offset:32768
    ds_write_b128 v23, v[64:67] offset:36864
    ds_write_b128 v23, v[68:71] offset:40960
    ds_write_b128 v23, v[72:75] offset:45056
    ds_write_b128 v23, v[76:79] offset:49152
    ds_write_b128 v23, v[80:83] offset:53248
    ds_write_b128 v23, v[84:87] offset:57344
    ds_write_b128 v23, v[88:91] offset:61440
    v_xor_b32 v24, 65536, v24
    v_xor_b32 v25, 65536, v25
    v_xor_b32 v26, 65536, v26
    v_xor_b32 v27, 65536, v27
    s_waitcnt lgkmcnt(0)
    s_barrier
    s_sub_u32 s35, s35, 1
    s_cmp_lg_u32 s35, 0
    s_cbranch_scc1 Lg_13
    s_waitcnt vmcnt(0)
    s_nop 9
    v_and_b32 v5, 15, v3
    v_lshrrev_b32 v6, 1, v4
    v_xor_b32 v5, v5, v6
    v_lshlrev_b32 v5, 4, v5
    v_and_b32 v6, 1, v4
    v_lshl_add_u32 v5, v6, 3, v5
    v_mul_u32_u24 v6, 256, v3
    v_add_u32 v5, v5, v6
    v_mul_u32_u24 v6, 32768, v2
    v_add_u32 v220, v5, v6
    v_lshrrev_b32 v5, 4, v1
    v_add_u32 v221, 0, v5
    v_and_b32 v222, 15, v221
    v_and_b32 v226, 15, v1
    v_xor_b32 v222, v222, v226
    v_lshlrev_b32 v222, 4, v222
    v_mul_u32_u24 v221, 256, v221
    v_add_u32 v222, v222, v221
    v_add_u32 v222, v222, v6
    v_add_u32 v221, 4, v5
    v_and_b32 v223, 15, v221
    v_and_b32 v226, 15, v1
    v_xor_b32 v223, v223, v226
    v_lshlrev_b32 v223, 4, v223
    v_mul_u32_u24 v221, 256, v221
    v_add_u32 v223, v223, v221
    v_add_u32 v223, v223, v6
    v_add_u32 v221, 8, v5
    v_and_b32 v224, 15, v221
    v_and_b32 v226, 15, v1
    v_xor_b32 v224, v224, v226
    v_lshlrev_b32 v224, 4, v224
    v_mul_u32_u24 v221, 256, v221
    v_add_u32 v224, v224, v221
    v_add_u32 v224, v224, v6
    v_add_u32 v221, 12, v5
    v_and_b32 v225, 15, v221
    v_and_b32 v226, 15, v1
    v_xor_b32 v225, v225, v226
    v_lshlrev_b32 v225, 4, v225
    v_mul_u32_u24 v221, 256, v221
    v_add_u32 v225, v225, v221
    v_add_u32 v225, v225, v6
    v_lshrrev_b32 v221, 1, v2
    v_mul_u32_u24 v221, 128, v221
    v_add_u32 v221, v221, v5
    v_mul_lo_u32 v221, s33, v221
    v_and_b32 v226, 15, v1
    v_lshl_add_u32 v226, v226, 4, v221
    v_and_b32 v221, 1, v2
    v_mul_u32_u24 v221, 256, v221
    v_add_u32 v226, v226, v221
    s_mul_i32 s34, s33, 4
    v_xor_b32 v221, 0, v220
    v_accvgpr_read_b32 v44, a0
    v_accvgpr_read_b32 v45, a1
    v_accvgpr_read_b32 v46, a2
    v_accvgpr_read_b32 v47, a3
    v_cvt_pk_bf16_f32 v28, v44, v45
    v_cvt_pk_bf16_f32 v29, v46, v47
    ds_write_b64 v221, v[28:29] offset:0
    v_accvgpr_read_b32 v48, a4
    v_accvgpr_read_b32 v49, a5
    v_accvgpr_read_b32 v50, a6
    v_accvgpr_read_b32 v51, a7
    v_cvt_pk_bf16_f32 v30, v48, v49
    v_cvt_pk_bf16_f32 v31, v50, v51
    ds_write_b64 v221, v[30:31] offset:4096
    v_accvgpr_read_b32 v52, a8
    v_accvgpr_read_b32 v53, a9
    v_accvgpr_read_b32 v54, a10
    v_accvgpr_read_b32 v55, a11
    v_cvt_pk_bf16_f32 v32, v52, v53
    v_cvt_pk_bf16_f32 v33, v54, v55
    ds_write_b64 v221, v[32:33] offset:8192
    v_accvgpr_read_b32 v56, a12
    v_accvgpr_read_b32 v57, a13
    v_accvgpr_read_b32 v58, a14
    v_accvgpr_read_b32 v59, a15
    v_cvt_pk_bf16_f32 v34, v56, v57
    v_cvt_pk_bf16_f32 v35, v58, v59
    ds_write_b64 v221, v[34:35] offset:12288
    v_accvgpr_read_b32 v44, a16
    v_accvgpr_read_b32 v45, a17
    v_accvgpr_read_b32 v46, a18
    v_accvgpr_read_b32 v47, a19
    v_cvt_pk_bf16_f32 v36, v44, v45
    v_cvt_pk_bf16_f32 v37, v46, v47
    ds_write_b64 v221, v[36:37] offset:16384
    v_accvgpr_read_b32 v48, a20
    v_accvgpr_read_b32 v49, a21
    v_accvgpr_read_b32 v50, a22
    v_accvgpr_read_b32 v51, a23
    v_cvt_pk_bf16_f32 v38, v48, v49
    v_cvt_pk_bf16_f32 v39, v50, v51
    ds_write_b64 v221, v[38:39] offset:20480
    v_accvgpr_read_b32 v52, a24
    v_accvgpr_read_b32 v53, a25
    v_accvgpr_read_b32 v54, a26
    v_accvgpr_read_b32 v55, a27
    v_cvt_pk_bf16_f32 v40, v52, v53
    v_cvt_pk_bf16_f32 v41, v54, v55
    ds_write_b64 v221, v[40:41] offset:24576
    v_accvgpr_read_b32 v56, a28
    v_accvgpr_read_b32 v57, a29
    v_accvgpr_read_b32 v58, a30
    v_accvgpr_read_b32 v59, a31
    v_cvt_pk_bf16_f32 v42, v56, v57
    v_cvt_pk_bf16_f32 v43, v58, v59
    ds_write_b64 v221, v[42:43] offset:28672
    v_xor_b32 v221, 32, v220
    v_accvgpr_read_b32 v44, a32
    v_accvgpr_read_b32 v45, a33
    v_accvgpr_read_b32 v46, a34
    v_accvgpr_read_b32 v47, a35
    v_cvt_pk_bf16_f32 v28, v44, v45
    v_cvt_pk_bf16_f32 v29, v46, v47
    ds_write_b64 v221, v[28:29] offset:0
    v_accvgpr_read_b32 v48, a36
    v_accvgpr_read_b32 v49, a37
    v_accvgpr_read_b32 v50, a38
    v_accvgpr_read_b32 v51, a39
    v_cvt_pk_bf16_f32 v30, v48, v49
    v_cvt_pk_bf16_f32 v31, v50, v51
    ds_write_b64 v221, v[30:31] offset:4096
    v_accvgpr_read_b32 v52, a40
    v_accvgpr_read_b32 v53, a41
    v_accvgpr_read_b32 v54, a42
    v_accvgpr_read_b32 v55, a43
    v_cvt_pk_bf16_f32 v32, v52, v53
    v_cvt_pk_bf16_f32 v33, v54, v55
    ds_write_b64 v221, v[32:33] offset:8192
    v_accvgpr_read_b32 v56, a44
    v_accvgpr_read_b32 v57, a45
    v_accvgpr_read_b32 v58, a46
    v_accvgpr_read_b32 v59, a47
    v_cvt_pk_bf16_f32 v34, v56, v57
    v_cvt_pk_bf16_f32 v35, v58, v59
    ds_write_b64 v221, v[34:35] offset:12288
    v_accvgpr_read_b32 v44, a48
    v_accvgpr_read_b32 v45, a49
    v_accvgpr_read_b32 v46, a50
    v_accvgpr_read_b32 v47, a51
    v_cvt_pk_bf16_f32 v36, v44, v45
    v_cvt_pk_bf16_f32 v37, v46, v47
    ds_write_b64 v221, v[36:37] offset:16384
    v_accvgpr_read_b32 v48, a52
    v_accvgpr_read_b32 v49, a53
    v_accvgpr_read_b32 v50, a54
    v_accvgpr_read_b32 v51, a55
    v_cvt_pk_bf16_f32 v38, v48, v49
    v_cvt_pk_bf16_f32 v39, v50, v51
    ds_write_b64 v221, v[38:39] offset:20480
    v_accvgpr_read_b32 v52, a56
    v_accvgpr_read_b32 v53, a57
    v_accvgpr_read_b32 v54, a58
    v_accvgpr_read_b32 v55, a59
    v_cvt_pk_bf16_f32 v40, v52, v53
    v_cvt_pk_bf16_f32 v41, v54, v55
    ds_write_b64 v221, v[40:41] offset:24576
    v_accvgpr_read_b32 v56, a60
    v_accvgpr_read_b32 v57, a61
    v_accvgpr_read_b32 v58, a62
    v_accvgpr_read_b32 v59, a63
    v_cvt_pk_bf16_f32 v42, v56, v57
    v_cvt_pk_bf16_f32 v43, v58, v59
    ds_write_b64 v221, v[42:43] offset:28672
    v_xor_b32 v221, 64, v220
    v_accvgpr_read_b32 v44, a64
    v_accvgpr_read_b32 v45, a65
    v_accvgpr_read_b32 v46, a66
    v_accvgpr_read_b32 v47, a67
    v_cvt_pk_bf16_f32 v28, v44, v45
    v_cvt_pk_bf16_f32 v29, v46, v47
    ds_write_b64 v221, v[28:29] offset:0
    v_accvgpr_read_b32 v48, a68
    v_accvgpr_read_b32 v49, a69
    v_accvgpr_read_b32 v50, a70
    v_accvgpr_read_b32 v51, a71
    v_cvt_pk_bf16_f32 v30, v48, v49
    v_cvt_pk_bf16_f32 v31, v50, v51
    ds_write_b64 v221, v[30:31] offset:4096
    v_accvgpr_read_b32 v52, a72
    v_accvgpr_read_b32 v53, a73
    v_accvgpr_read_b32 v54, a74
    v_accvgpr_read_b32 v55, a75
    v_cvt_pk_bf16_f32 v32, v52, v53
    v_cvt_pk_bf16_f32 v33, v54, v55
    ds_write_b64 v221, v[32:33] offset:8192
    v_accvgpr_read_b32 v56, a76
    v_accvgpr_read_b32 v57, a77
    v_accvgpr_read_b32 v58, a78
    v_accvgpr_read_b32 v59, a79
    v_cvt_pk_bf16_f32 v34, v56, v57
    v_cvt_pk_bf16_f32 v35, v58, v59
    ds_write_b64 v221, v[34:35] offset:12288
    v_accvgpr_read_b32 v44, a80
    v_accvgpr_read_b32 v45, a81
    v_accvgpr_read_b32 v46, a82
    v_accvgpr_read_b32 v47, a83
    v_cvt_pk_bf16_f32 v36, v44, v45
    v_cvt_pk_bf16_f32 v37, v46, v47
    ds_write_b64 v221, v[36:37] offset:16384
    v_accvgpr_read_b32 v48, a84
    v_accvgpr_read_b32 v49, a85
    v_accvgpr_read_b32 v50, a86
    v_accvgpr_read_b32 v51, a87
    v_cvt_pk_bf16_f32 v38, v48, v49
    v_cvt_pk_bf16_f32 v39, v50, v51
    ds_write_b64 v221, v[38:39] offset:20480
    v_accvgpr_read_b32 v52, a88
    v_accvgpr_read_b32 v53, a89
    v_accvgpr_read_b32 v54, a90
    v_accvgpr_read_b32 v55, a91
    v_cvt_pk_bf16_f32 v40, v52, v53
    v_cvt_pk_bf16_f32 v41, v54, v55
    ds_write_b64 v221, v[40:41] offset:24576
    v_accvgpr_read_b32 v56, a92
    v_accvgpr_read_b32 v57, a93
    v_accvgpr_read_b32 v58, a94
    v_accvgpr_read_b32 v59, a95
    v_cvt_pk_bf16_f32 v42, v56, v57
    v_cvt_pk_bf16_f32 v43, v58, v59
    ds_write_b64 v221, v[42:43] offset:28672
    v_xor_b32 v221, 96, v220
    v_accvgpr_read_b32 v44, a96
    v_accvgpr_read_b32 v45, a97
    v_accvgpr_read_b32 v46, a98
    v_accvgpr_read_b32 v47, a99
    v_cvt_pk_bf16_f32 v28, v44, v45
    v_cvt_pk_bf16_f32 v29, v46, v47
    ds_write_b64 v221, v[28:29] offset:0
    v_accvgpr_read_b32 v48, a100
    v_accvgpr_read_b32 v49, a101
    v_accvgpr_read_b32 v50, a102
    v_accvgpr_read_b32 v51, a103
    v_cvt_pk_bf16_f32 v30, v48, v49
    v_cvt_pk_bf16_f32 v31, v50, v51
    ds_write_b64 v221, v[30:31] offset:4096
    v_accvgpr_read_b32 v52, a104
    v_accvgpr_read_b32 v53, a105
    v_accvgpr_read_b32 v54, a106
    v_accvgpr_read_b32 v55, a107
    v_cvt_pk_bf16_f32 v32, v52, v53
    v_cvt_pk_bf16_f32 v33, v54, v55
    ds_write_b64 v221, v[32:33] offset:8192
    v_accvgpr_read_b32 v56, a108
    v_accvgpr_read_b32 v57, a109
    v_accvgpr_read_b32 v58, a110
    v_accvgpr_read_b32 v59, a111
    v_cvt_pk_bf16_f32 v34, v56, v57
    v_cvt_pk_bf16_f32 v35, v58, v59
    ds_write_b64 v221, v[34:35] offset:12288
    v_accvgpr_read_b32 v44, a112
    v_accvgpr_read_b32 v45, a113
    v_accvgpr_read_b32 v46, a114
    v_accvgpr_read_b32 v47, a115
    v_cvt_pk_bf16_f32 v36, v44, v45
    v_cvt_pk_bf16_f32 v37, v46, v47
    ds_write_b64 v221, v[36:37] offset:16384
    v_accvgpr_read_b32 v48, a116
    v_accvgpr_read_b32 v49, a117
    v_accvgpr_read_b32 v50, a118
    v_accvgpr_read_b32 v51, a119
    v_cvt_pk_bf16_f32 v38, v48, v49
    v_cvt_pk_bf16_f32 v39, v50, v51
    ds_write_b64 v221, v[38:39] offset:20480
    v_accvgpr_read_b32 v52, a120
    v_accvgpr_read_b32 v53, a121
    v_accvgpr_read_b32 v54, a122
    v_accvgpr_read_b32 v55, a123
    v_cvt_pk_bf16_f32 v40, v52, v53
    v_cvt_pk_bf16_f32 v41, v54, v55
    ds_write_b64 v221, v[40:41] offset:24576
    v_accvgpr_read_b32 v56, a124
    v_accvgpr_read_b32 v57, a125
    v_accvgpr_read_b32 v58, a126
    v_accvgpr_read_b32 v59, a127
    v_cvt_pk_bf16_f32 v42, v56, v57
    v_cvt_pk_bf16_f32 v43, v58, v59
    ds_write_b64 v221, v[42:43] offset:28672
    v_xor_b32 v221, 128, v220
    v_accvgpr_read_b32 v44, a128
    v_accvgpr_read_b32 v45, a129
    v_accvgpr_read_b32 v46, a130
    v_accvgpr_read_b32 v47, a131
    v_cvt_pk_bf16_f32 v28, v44, v45
    v_cvt_pk_bf16_f32 v29, v46, v47
    ds_write_b64 v221, v[28:29] offset:0
    v_accvgpr_read_b32 v48, a132
    v_accvgpr_read_b32 v49, a133
    v_accvgpr_read_b32 v50, a134
    v_accvgpr_read_b32 v51, a135
    v_cvt_pk_bf16_f32 v30, v48, v49
    v_cvt_pk_bf16_f32 v31, v50, v51
    ds_write_b64 v221, v[30:31] offset:4096
    v_accvgpr_read_b32 v52, a136
    v_accvgpr_read_b32 v53, a137
    v_accvgpr_read_b32 v54, a138
    v_accvgpr_read_b32 v55, a139
    v_cvt_pk_bf16_f32 v32, v52, v53
    v_cvt_pk_bf16_f32 v33, v54, v55
    ds_write_b64 v221, v[32:33] offset:8192
    v_accvgpr_read_b32 v56, a140
    v_accvgpr_read_b32 v57, a141
    v_accvgpr_read_b32 v58, a142
    v_accvgpr_read_b32 v59, a143
    v_cvt_pk_bf16_f32 v34, v56, v57
    v_cvt_pk_bf16_f32 v35, v58, v59
    ds_write_b64 v221, v[34:35] offset:12288
    v_accvgpr_read_b32 v44, a144
    v_accvgpr_read_b32 v45, a145
    v_accvgpr_read_b32 v46, a146
    v_accvgpr_read_b32 v47, a147
    v_cvt_pk_bf16_f32 v36, v44, v45
    v_cvt_pk_bf16_f32 v37, v46, v47
    ds_write_b64 v221, v[36:37] offset:16384
    v_accvgpr_read_b32 v48, a148
    v_accvgpr_read_b32 v49, a149
    v_accvgpr_read_b32 v50, a150
    v_accvgpr_read_b32 v51, a151
    v_cvt_pk_bf16_f32 v38, v48, v49
    v_cvt_pk_bf16_f32 v39, v50, v51
    ds_write_b64 v221, v[38:39] offset:20480
    v_accvgpr_read_b32 v52, a152
    v_accvgpr_read_b32 v53, a153
    v_accvgpr_read_b32 v54, a154
    v_accvgpr_read_b32 v55, a155
    v_cvt_pk_bf16_f32 v40, v52, v53
    v_cvt_pk_bf16_f32 v41, v54, v55
    ds_write_b64 v221, v[40:41] offset:24576
    v_accvgpr_read_b32 v56, a156
    v_accvgpr_read_b32 v57, a157
    v_accvgpr_read_b32 v58, a158
    v_accvgpr_read_b32 v59, a159
    v_cvt_pk_bf16_f32 v42, v56, v57
    v_cvt_pk_bf16_f32 v43, v58, v59
    ds_write_b64 v221, v[42:43] offset:28672
    v_xor_b32 v221, 160, v220
    v_accvgpr_read_b32 v44, a160
    v_accvgpr_read_b32 v45, a161
    v_accvgpr_read_b32 v46, a162
    v_accvgpr_read_b32 v47, a163
    v_cvt_pk_bf16_f32 v28, v44, v45
    v_cvt_pk_bf16_f32 v29, v46, v47
    ds_write_b64 v221, v[28:29] offset:0
    v_accvgpr_read_b32 v48, a164
    v_accvgpr_read_b32 v49, a165
    v_accvgpr_read_b32 v50, a166
    v_accvgpr_read_b32 v51, a167
    v_cvt_pk_bf16_f32 v30, v48, v49
    v_cvt_pk_bf16_f32 v31, v50, v51
    ds_write_b64 v221, v[30:31] offset:4096
    v_accvgpr_read_b32 v52, a168
    v_accvgpr_read_b32 v53, a169
    v_accvgpr_read_b32 v54, a170
    v_accvgpr_read_b32 v55, a171
    v_cvt_pk_bf16_f32 v32, v52, v53
    v_cvt_pk_bf16_f32 v33, v54, v55
    ds_write_b64 v221, v[32:33] offset:8192
    v_accvgpr_read_b32 v56, a172
    v_accvgpr_read_b32 v57, a173
    v_accvgpr_read_b32 v58, a174
    v_accvgpr_read_b32 v59, a175
    v_cvt_pk_bf16_f32 v34, v56, v57
    v_cvt_pk_bf16_f32 v35, v58, v59
    ds_write_b64 v221, v[34:35] offset:12288
    v_accvgpr_read_b32 v44, a176
    v_accvgpr_read_b32 v45, a177
    v_accvgpr_read_b32 v46, a178
    v_accvgpr_read_b32 v47, a179
    v_cvt_pk_bf16_f32 v36, v44, v45
    v_cvt_pk_bf16_f32 v37, v46, v47
    ds_write_b64 v221, v[36:37] offset:16384
    v_accvgpr_read_b32 v48, a180
    v_accvgpr_read_b32 v49, a181
    v_accvgpr_read_b32 v50, a182
    v_accvgpr_read_b32 v51, a183
    v_cvt_pk_bf16_f32 v38, v48, v49
    v_cvt_pk_bf16_f32 v39, v50, v51
    ds_write_b64 v221, v[38:39] offset:20480
    v_accvgpr_read_b32 v52, a184
    v_accvgpr_read_b32 v53, a185
    v_accvgpr_read_b32 v54, a186
    v_accvgpr_read_b32 v55, a187
    v_cvt_pk_bf16_f32 v40, v52, v53
    v_cvt_pk_bf16_f32 v41, v54, v55
    ds_write_b64 v221, v[40:41] offset:24576
    v_accvgpr_read_b32 v56, a188
    v_accvgpr_read_b32 v57, a189
    v_accvgpr_read_b32 v58, a190
    v_accvgpr_read_b32 v59, a191
    v_cvt_pk_bf16_f32 v42, v56, v57
    v_cvt_pk_bf16_f32 v43, v58, v59
    ds_write_b64 v221, v[42:43] offset:28672
    v_xor_b32 v221, 192, v220
    v_accvgpr_read_b32 v44, a192
    v_accvgpr_read_b32 v45, a193
    v_accvgpr_read_b32 v46, a194
    v_accvgpr_read_b32 v47, a195
    v_cvt_pk_bf16_f32 v28, v44, v45
    v_cvt_pk_bf16_f32 v29, v46, v47
    ds_write_b64 v221, v[28:29] offset:0
    v_accvgpr_read_b32 v48, a196
    v_accvgpr_read_b32 v49, a197
    v_accvgpr_read_b32 v50, a198
    v_accvgpr_read_b32 v51, a199
    v_cvt_pk_bf16_f32 v30, v48, v49
    v_cvt_pk_bf16_f32 v31, v50, v51
    ds_write_b64 v221, v[30:31] offset:4096
    v_accvgpr_read_b32 v52, a200
    v_accvgpr_read_b32 v53, a201
    v_accvgpr_read_b32 v54, a202
    v_accvgpr_read_b32 v55, a203
    v_cvt_pk_bf16_f32 v32, v52, v53
    v_cvt_pk_bf16_f32 v33, v54, v55
    ds_write_b64 v221, v[32:33] offset:8192
    v_accvgpr_read_b32 v56, a204
    v_accvgpr_read_b32 v57, a205
    v_accvgpr_read_b32 v58, a206
    v_accvgpr_read_b32 v59, a207
    v_cvt_pk_bf16_f32 v34, v56, v57
    v_cvt_pk_bf16_f32 v35, v58, v59
    ds_write_b64 v221, v[34:35] offset:12288
    v_accvgpr_read_b32 v44, a208
    v_accvgpr_read_b32 v45, a209
    v_accvgpr_read_b32 v46, a210
    v_accvgpr_read_b32 v47, a211
    v_cvt_pk_bf16_f32 v36, v44, v45
    v_cvt_pk_bf16_f32 v37, v46, v47
    ds_write_b64 v221, v[36:37] offset:16384
    v_accvgpr_read_b32 v48, a212
    v_accvgpr_read_b32 v49, a213
    v_accvgpr_read_b32 v50, a214
    v_accvgpr_read_b32 v51, a215
    v_cvt_pk_bf16_f32 v38, v48, v49
    v_cvt_pk_bf16_f32 v39, v50, v51
    ds_write_b64 v221, v[38:39] offset:20480
    v_accvgpr_read_b32 v52, a216
    v_accvgpr_read_b32 v53, a217
    v_accvgpr_read_b32 v54, a218
    v_accvgpr_read_b32 v55, a219
    v_cvt_pk_bf16_f32 v40, v52, v53
    v_cvt_pk_bf16_f32 v41, v54, v55
    ds_write_b64 v221, v[40:41] offset:24576
    v_accvgpr_read_b32 v56, a220
    v_accvgpr_read_b32 v57, a221
    v_accvgpr_read_b32 v58, a222
    v_accvgpr_read_b32 v59, a223
    v_cvt_pk_bf16_f32 v42, v56, v57
    v_cvt_pk_bf16_f32 v43, v58, v59
    ds_write_b64 v221, v[42:43] offset:28672
    v_xor_b32 v221, 224, v220
    v_accvgpr_read_b32 v44, a224
    v_accvgpr_read_b32 v45, a225
    v_accvgpr_read_b32 v46, a226
    v_accvgpr_read_b32 v47, a227
    v_cvt_pk_bf16_f32 v28, v44, v45
    v_cvt_pk_bf16_f32 v29, v46, v47
    ds_write_b64 v221, v[28:29] offset:0
    v_accvgpr_read_b32 v48, a228
    v_accvgpr_read_b32 v49, a229
    v_accvgpr_read_b32 v50, a230
    v_accvgpr_read_b32 v51, a231
    v_cvt_pk_bf16_f32 v30, v48, v49
    v_cvt_pk_bf16_f32 v31, v50, v51
    ds_write_b64 v221, v[30:31] offset:4096
    v_accvgpr_read_b32 v52, a232
    v_accvgpr_read_b32 v53, a233
    v_accvgpr_read_b32 v54, a234
    v_accvgpr_read_b32 v55, a235
    v_cvt_pk_bf16_f32 v32, v52, v53
    v_cvt_pk_bf16_f32 v33, v54, v55
    ds_write_b64 v221, v[32:33] offset:8192
    v_accvgpr_read_b32 v56, a236
    v_accvgpr_read_b32 v57, a237
    v_accvgpr_read_b32 v58, a238
    v_accvgpr_read_b32 v59, a239
    v_cvt_pk_bf16_f32 v34, v56, v57
    v_cvt_pk_bf16_f32 v35, v58, v59
    ds_write_b64 v221, v[34:35] offset:12288
    v_accvgpr_read_b32 v44, a240
    v_accvgpr_read_b32 v45, a241
    v_accvgpr_read_b32 v46, a242
    v_accvgpr_read_b32 v47, a243
    v_cvt_pk_bf16_f32 v36, v44, v45
    v_cvt_pk_bf16_f32 v37, v46, v47
    ds_write_b64 v221, v[36:37] offset:16384
    v_accvgpr_read_b32 v48, a244
    v_accvgpr_read_b32 v49, a245
    v_accvgpr_read_b32 v50, a246
    v_accvgpr_read_b32 v51, a247
    v_cvt_pk_bf16_f32 v38, v48, v49
    v_cvt_pk_bf16_f32 v39, v50, v51
    ds_write_b64 v221, v[38:39] offset:20480
    v_accvgpr_read_b32 v52, a248
    v_accvgpr_read_b32 v53, a249
    v_accvgpr_read_b32 v54, a250
    v_accvgpr_read_b32 v55, a251
    v_cvt_pk_bf16_f32 v40, v52, v53
    v_cvt_pk_bf16_f32 v41, v54, v55
    ds_write_b64 v221, v[40:41] offset:24576
    v_accvgpr_read_b32 v56, a252
    v_accvgpr_read_b32 v57, a253
    v_accvgpr_read_b32 v58, a254
    v_accvgpr_read_b32 v59, a255
    v_cvt_pk_bf16_f32 v42, v56, v57
    v_cvt_pk_bf16_f32 v43, v58, v59
    ds_write_b64 v221, v[42:43] offset:28672
    s_waitcnt lgkmcnt(0)
    ds_read_b128 v[92:95], v222 offset:0
    ds_read_b128 v[96:99], v223 offset:0
    ds_read_b128 v[100:103], v224 offset:0
    ds_read_b128 v[104:107], v225 offset:0
    ds_read_b128 v[108:111], v222 offset:4096
    ds_read_b128 v[112:115], v223 offset:4096
    ds_read_b128 v[116:119], v224 offset:4096
    ds_read_b128 v[120:123], v225 offset:4096
    s_waitcnt lgkmcnt(7)
    buffer_store_dwordx4 v[92:95], v226, s[8:11], s30 offen sc1
    s_add_u32 s30, s30, s34
    s_waitcnt lgkmcnt(6)
    buffer_store_dwordx4 v[96:99], v226, s[8:11], s30 offen sc1
    s_add_u32 s30, s30, s34
    s_waitcnt lgkmcnt(5)
    buffer_store_dwordx4 v[100:103], v226, s[8:11], s30 offen sc1
    s_add_u32 s30, s30, s34
    s_waitcnt lgkmcnt(4)
    buffer_store_dwordx4 v[104:107], v226, s[8:11], s30 offen sc1
    s_add_u32 s30, s30, s34
    s_waitcnt lgkmcnt(3)
    buffer_store_dwordx4 v[108:111], v226, s[8:11], s30 offen sc1
    s_add_u32 s30, s30, s34
    s_waitcnt lgkmcnt(2)
    buffer_store_dwordx4 v[112:115], v226, s[8:11], s30 offen sc1
    s_add_u32 s30, s30, s34
    s_waitcnt lgkmcnt(1)
    buffer_store_dwordx4 v[116:119], v226, s[8:11], s30 offen sc1
    s_add_u32 s30, s30, s34
    s_waitcnt lgkmcnt(0)
    buffer_store_dwordx4 v[120:123], v226, s[8:11], s30 offen sc1
    s_add_u32 s30, s30, s34
    s_nop 1
    ds_read_b128 v[92:95], v222 offset:8192
    ds_read_b128 v[96:99], v223 offset:8192
    ds_read_b128 v[100:103], v224 offset:8192
    ds_read_b128 v[104:107], v225 offset:8192
    ds_read_b128 v[108:111], v222 offset:12288
    ds_read_b128 v[112:115], v223 offset:12288
    ds_read_b128 v[116:119], v224 offset:12288
    ds_read_b128 v[120:123], v225 offset:12288
    s_waitcnt lgkmcnt(7)
    buffer_store_dwordx4 v[92:95], v226, s[8:11], s30 offen sc1
    s_add_u32 s30, s30, s34
    s_waitcnt lgkmcnt(6)
    buffer_store_dwordx4 v[96:99], v226, s[8:11], s30 offen sc1
    s_add_u32 s30, s30, s34
    s_waitcnt lgkmcnt(5)
    buffer_store_dwordx4 v[100:103], v226, s[8:11], s30 offen sc1
    s_add_u32 s30, s30, s34
    s_waitcnt lgkmcnt(4)
    buffer_store_dwordx4 v[104:107], v226, s[8:11], s30 offen sc1
    s_add_u32 s30, s30, s34
    s_waitcnt lgkmcnt(3)
    buffer_store_dwordx4 v[108:111], v226, s[8:11], s30 offen sc1
    s_add_u32 s30, s30, s34
    s_waitcnt lgkmcnt(2)
    buffer_store_dwordx4 v[112:115], v226, s[8:11], s30 offen sc1
    s_add_u32 s30, s30, s34
    s_waitcnt lgkmcnt(1)
    buffer_store_dwordx4 v[116:119], v226, s[8:11], s30 offen sc1
    s_add_u32 s30, s30, s34
    s_waitcnt lgkmcnt(0)
    buffer_store_dwordx4 v[120:123], v226, s[8:11], s30 offen sc1
    s_add_u32 s30, s30, s34
    s_nop 1
    ds_read_b128 v[92:95], v222 offset:16384
    ds_read_b128 v[96:99], v223 offset:16384
    ds_read_b128 v[100:103], v224 offset:16384
    ds_read_b128 v[104:107], v225 offset:16384
    ds_read_b128 v[108:111], v222 offset:20480
    ds_read_b128 v[112:115], v223 offset:20480
    ds_read_b128 v[116:119], v224 offset:20480
    ds_read_b128 v[120:123], v225 offset:20480
    s_waitcnt lgkmcnt(7)
    buffer_store_dwordx4 v[92:95], v226, s[8:11], s30 offen sc1
    s_add_u32 s30, s30, s34
    s_waitcnt lgkmcnt(6)
    buffer_store_dwordx4 v[96:99], v226, s[8:11], s30 offen sc1
    s_add_u32 s30, s30, s34
    s_waitcnt lgkmcnt(5)
    buffer_store_dwordx4 v[100:103], v226, s[8:11], s30 offen sc1
    s_add_u32 s30, s30, s34
    s_waitcnt lgkmcnt(4)
    buffer_store_dwordx4 v[104:107], v226, s[8:11], s30 offen sc1
    s_add_u32 s30, s30, s34
    s_waitcnt lgkmcnt(3)
    buffer_store_dwordx4 v[108:111], v226, s[8:11], s30 offen sc1
    s_add_u32 s30, s30, s34
    s_waitcnt lgkmcnt(2)
    buffer_store_dwordx4 v[112:115], v226, s[8:11], s30 offen sc1
    s_add_u32 s30, s30, s34
    s_waitcnt lgkmcnt(1)
    buffer_store_dwordx4 v[116:119], v226, s[8:11], s30 offen sc1
    s_add_u32 s30, s30, s34
    s_waitcnt lgkmcnt(0)
    buffer_store_dwordx4 v[120:123], v226, s[8:11], s30 offen sc1
    s_add_u32 s30, s30, s34
    s_nop 1
    ds_read_b128 v[92:95], v222 offset:24576
    ds_read_b128 v[96:99], v223 offset:24576
    ds_read_b128 v[100:103], v224 offset:24576
    ds_read_b128 v[104:107], v225 offset:24576
    ds_read_b128 v[108:111], v222 offset:28672
    ds_read_b128 v[112:115], v223 offset:28672
    ds_read_b128 v[116:119], v224 offset:28672
    ds_read_b128 v[120:123], v225 offset:28672
    s_waitcnt lgkmcnt(7)
    buffer_store_dwordx4 v[92:95], v226, s[8:11], s30 offen sc1
    s_add_u32 s30, s30, s34
    s_waitcnt lgkmcnt(6)
    buffer_store_dwordx4 v[96:99], v226, s[8:11], s30 offen sc1
    s_add_u32 s30, s30, s34
    s_waitcnt lgkmcnt(5)
    buffer_store_dwordx4 v[100:103], v226, s[8:11], s30 offen sc1
    s_add_u32 s30, s30, s34
    s_waitcnt lgkmcnt(4)
    buffer_store_dwordx4 v[104:107], v226, s[8:11], s30 offen sc1
    s_add_u32 s30, s30, s34
    s_waitcnt lgkmcnt(3)
    buffer_store_dwordx4 v[108:111], v226, s[8:11], s30 offen sc1
    s_add_u32 s30, s30, s34
    s_waitcnt lgkmcnt(2)
    buffer_store_dwordx4 v[112:115], v226, s[8:11], s30 offen sc1
    s_add_u32 s30, s30, s34
    s_waitcnt lgkmcnt(1)
    buffer_store_dwordx4 v[116:119], v226, s[8:11], s30 offen sc1
    s_add_u32 s30, s30, s34
    s_waitcnt lgkmcnt(0)
    buffer_store_dwordx4 v[120:123], v226, s[8:11], s30 offen sc1
    s_add_u32 s30, s30, s34
    s_nop 1
    s_nop 0
    v_readfirstlane_b32 s36, v2
    s_nop 2
    s_waitcnt vmcnt(0)
    s_barrier
    s_cmp_lg_u32 s36, 0
    s_cbranch_scc1 Lrel_14
    s_mov_b64 exec, 1
    v_mov_b32 v5, 2
    v_mov_b32 v6, 0
    buffer_atomic_add v5, v6, s[8:11], s37 offen sc1
    buffer_atomic_add v5, v6, s[8:11], s37 offen offset:128 sc1
    s_waitcnt vmcnt(0)
    s_mov_b64 exec, -1
Lrel_14:
Lq_end256:
    s_endpgm
Lg_entry64:
    s_load_dwordx2 s[4:5], s[0:1], 104
    s_load_dwordx2 s[6:7], s[0:1], 0
    s_waitcnt lgkmcnt(0)
    s_mov_b32 s8, s4
    s_and_b32 s9, s5, 0xffff
    s_mov_b32 s10, 0x10000000
    s_mov_b32 s11, 0x00020000
    s_mov_b32 s12, s6
    s_and_b32 s13, s7, 0xffff
    s_mov_b32 s14, 0x280000
    s_mov_b32 s15, 0x00020000
    v_and_b32 v1, 63, v0
    v_lshrrev_b32 v2, 6, v0
    v_and_b32 v3, 15, v0
    v_bfe_u32 v4, v0, 4, 2
    v_lshrrev_b32 v5, 3, v0
    v_and_b32 v6, 7, v0
    v_lshlrev_b32 v6, 4, v6
    v_add_u32 v7, 0, v5
    v_mul_u32_u24 v7, 1280, v7
    v_add_u32 v7, v7, v6
    v_add_u32 v8, 32, v5
    v_mul_u32_u24 v8, 1280, v8
    v_add_u32 v8, v8, v6
    v_add_u32 v9, 0, v5
    v_mul_u32_u24 v9, 1280, v9
    v_add_u32 v9, v9, v6
    v_add_u32 v10, 32, v5
    v_mul_u32_u24 v10, 1280, v10
    v_add_u32 v10, v10, v6
    v_lshrrev_b32 v5, 3, v0
    v_and_b32 v6, 7, v0
    v_and_b32 v11, 7, v5
    v_xor_b32 v11, v11, v6
    v_lshlrev_b32 v11, 4, v11
    v_lshl_add_u32 v11, v5, 7, v11
    v_and_b32 v5, 7, v3
    v_xor_b32 v5, v5, v4
    v_lshlrev_b32 v5, 4, v5
    v_lshl_add_u32 v5, v3, 7, v5
    v_and_b32 v6, 1, v2
    v_mul_u32_u24 v6, 4096, v6
    v_add_u32 v12, v5, v6
    v_xor_b32 v13, 64, v12
    v_lshrrev_b32 v6, 1, v2
    v_mul_u32_u24 v6, 4096, v6
    v_add_u32 v14, v5, v6
    v_add_u32 v14, 8192, v14
    v_xor_b32 v15, 64, v14
    v_mov_b32 v80, 0
    v_mov_b32 v81, 0
    v_mov_b32 v82, 0
    v_mov_b32 v83, 0
    v_mov_b32 v84, 0
    v_mov_b32 v85, 0
    v_mov_b32 v86, 0
    v_mov_b32 v87, 0
    v_mov_b32 v88, 0
    v_mov_b32 v89, 0
    v_mov_b32 v90, 0
    v_mov_b32 v91, 0
    v_mov_b32 v92, 0
    v_mov_b32 v93, 0
    v_mov_b32 v94, 0
    v_mov_b32 v95, 0
    s_mul_i32 s18, s16, 81920
    s_add_u32 s18, s18, 0x0
    s_mul_i32 s19, s17, 81920
    s_cmp_lt_u32 s16, 128
    s_cselect_b32 s20, s8, s12
    s_cselect_b32 s24, s12, s8
    s_cselect_b32 s21, s9, s13
    s_cselect_b32 s25, s13, s9
    s_cselect_b32 s22, s10, s14
    s_cselect_b32 s26, s14, s10
    s_cselect_b32 s23, s11, s15
    s_cselect_b32 s27, s15, s11
    s_cselect_b32 s28, s18, s19
    s_cselect_b32 s29, s19, s18
    s_mul_i32 s30, s17, 1064960
    s_lshl_b32 s31, s16, 7
    s_add_u32 s30, s30, s31
    s_add_u32 s30, s30, 0x1500000
    s_sub_u32 s31, s16, 128
    s_mul_i32 s31, s31, 270336
    s_lshl_b32 s32, s17, 7
    s_add_u32 s31, s31, s32
    s_add_u32 s31, s31, 0x3600000
    s_cmp_lt_u32 s16, 128
    s_cselect_b32 s30, s30, s31
    s_mov_b32 s33, 4224
    s_cselect_b32 s33, 16640, s33
    v_lshrrev_b32 v5, 1, v2
    v_lshlrev_b32 v5, 5, v5
    v_add_u32 v5, v5, v3
    v_mul_lo_u32 v96, s33, v5
    v_and_b32 v5, 1, v2
    v_lshlrev_b32 v5, 6, v5
    v_lshl_add_u32 v5, v4, 3, v5
    v_add_u32 v96, v96, v5
    s_lshl_b32 s34, s33, 4
    buffer_load_dwordx4 v[16:19], v7, s[20:23], s28 offen
    buffer_load_dwordx4 v[20:23], v8, s[20:23], s28 offen
    buffer_load_dwordx4 v[24:27], v9, s[24:27], s29 offen
    buffer_load_dwordx4 v[28:31], v10, s[24:27], s29 offen
    s_add_u32 s28, s28, 128
    s_add_u32 s29, s29, 128
    buffer_load_dwordx4 v[32:35], v7, s[20:23], s28 offen
    buffer_load_dwordx4 v[36:39], v8, s[20:23], s28 offen
    buffer_load_dwordx4 v[40:43], v9, s[24:27], s29 offen
    buffer_load_dwordx4 v[44:47], v10, s[24:27], s29 offen
    s_add_u32 s28, s28, 128
    s_add_u32 s29, s29, 128
    s_waitcnt vmcnt(4)
    ds_write_b128 v11, v[16:19] offset:0
    ds_write_b128 v11, v[20:23] offset:4096
    ds_write_b128 v11, v[24:27] offset:8192
    ds_write_b128 v11, v[28:31] offset:12288
    s_waitcnt lgkmcnt(0)
    s_barrier
    s_mov_b32 s35, 5
Lg_15:
    buffer_load_dwordx4 v[16:19], v7, s[20:23], s28 offen
    buffer_load_dwordx4 v[20:23], v8, s[20:23], s28 offen
    buffer_load_dwordx4 v[24:27], v9, s[24:27], s29 offen
    buffer_load_dwordx4 v[28:31], v10, s[24:27], s29 offen
    s_add_u32 s28, s28, 128
    s_add_u32 s29, s29, 128
    v_xor_b32 v11, 16384, v11
    ds_read_b128 v[48:51], v12 offset:0
    ds_read_b128 v[52:55], v12 offset:2048
    ds_read_b128 v[64:67], v14 offset:0
    ds_read_b128 v[68:71], v14 offset:2048
    ds_read_b128 v[56:59], v13 offset:0
    ds_read_b128 v[60:63], v13 offset:2048
    ds_read_b128 v[72:75], v15 offset:0
    ds_read_b128 v[76:79], v15 offset:2048
    s_waitcnt lgkmcnt(4)
    v_mfma_f32_16x16x32_bf16 v[80:83], v[48:51], v[64:67], v[80:83]
    v_mfma_f32_16x16x32_bf16 v[84:87], v[48:51], v[68:71], v[84:87]
    v_mfma_f32_16x16x32_bf16 v[88:91], v[52:55], v[64:67], v[88:91]
    v_mfma_f32_16x16x32_bf16 v[92:95], v[52:55], v[68:71], v[92:95]
    s_waitcnt lgkmcnt(0)
    v_mfma_f32_16x16x32_bf16 v[80:83], v[56:59], v[72:75], v[80:83]
    v_mfma_f32_16x16x32_bf16 v[84:87], v[56:59], v[76:79], v[84:87]
    v_mfma_f32_16x16x32_bf16 v[88:91], v[60:63], v[72:75], v[88:91]
    v_mfma_f32_16x16x32_bf16 v[92:95], v[60:63], v[76:79], v[92:95]
    s_waitcnt vmcnt(4)
    ds_write_b128 v11, v[32:35] offset:0
    ds_write_b128 v11, v[36:39] offset:4096
    ds_write_b128 v11, v[40:43] offset:8192
    ds_write_b128 v11, v[44:47] offset:12288
    v_xor_b32 v12, 16384, v12
    v_xor_b32 v13, 16384, v13
    v_xor_b32 v14, 16384, v14
    v_xor_b32 v15, 16384, v15
    s_waitcnt lgkmcnt(0)
    s_barrier
    buffer_load_dwordx4 v[32:35], v7, s[20:23], s28 offen
    buffer_load_dwordx4 v[36:39], v8, s[20:23], s28 offen
    buffer_load_dwordx4 v[40:43], v9, s[24:27], s29 offen
    buffer_load_dwordx4 v[44:47], v10, s[24:27], s29 offen
    s_add_u32 s28, s28, 128
    s_add_u32 s29, s29, 128
    v_xor_b32 v11, 16384, v11
    ds_read_b128 v[48:51], v12 offset:0
    ds_read_b128 v[52:55], v12 offset:2048
    ds_read_b128 v[64:67], v14 offset:0
    ds_read_b128 v[68:71], v14 offset:2048
    ds_read_b128 v[56:59], v13 offset:0
    ds_read_b128 v[60:63], v13 offset:2048
    ds_read_b128 v[72:75], v15 offset:0
    ds_read_b128 v[76:79], v15 offset:2048
    s_waitcnt lgkmcnt(4)
    v_mfma_f32_16x16x32_bf16 v[80:83], v[48:51], v[64:67], v[80:83]
    v_mfma_f32_16x16x32_bf16 v[84:87], v[48:51], v[68:71], v[84:87]
    v_mfma_f32_16x16x32_bf16 v[88:91], v[52:55], v[64:67], v[88:91]
    v_mfma_f32_16x16x32_bf16 v[92:95], v[52:55], v[68:71], v[92:95]
    s_waitcnt lgkmcnt(0)
    v_mfma_f32_16x16x32_bf16 v[80:83], v[56:59], v[72:75], v[80:83]
    v_mfma_f32_16x16x32_bf16 v[84:87], v[56:59], v[76:79], v[84:87]
    v_mfma_f32_16x16x32_bf16 v[88:91], v[60:63], v[72:75], v[88:91]
    v_mfma_f32_16x16x32_bf16 v[92:95], v[60:63], v[76:79], v[92:95]
    s_waitcnt vmcnt(4)
    ds_write_b128 v11, v[16:19] offset:0
    ds_write_b128 v11, v[20:23] offset:4096
    ds_write_b128 v11, v[24:27] offset:8192
    ds_write_b128 v11, v[28:31] offset:12288
    v_xor_b32 v12, 16384, v12
    v_xor_b32 v13, 16384, v13
    v_xor_b32 v14, 16384, v14
    v_xor_b32 v15, 16384, v15
    s_waitcnt lgkmcnt(0)
    s_barrier
    s_sub_u32 s35, s35, 1
    s_cmp_lg_u32 s35, 0
    s_cbranch_scc1 Lg_15
    s_waitcnt vmcnt(0)
    s_nop 9
    v_and_b32 v5, 3, v3
    v_lshrrev_b32 v6, 1, v4
    v_xor_b32 v5, v5, v6
    v_lshlrev_b32 v5, 4, v5
    v_and_b32 v6, 1, v4
    v_lshl_add_u32 v5, v6, 3, v5
    v_mul_u32_u24 v6, 64, v3
    v_add_u32 v5, v5, v6
    v_mul_u32_u24 v6, 2048, v2
    v_add_u32 v96, v5, v6
    v_lshrrev_b32 v5, 2, v1
    v_add_u32 v97, 0, v5
    v_and_b32 v98, 3, v97
    v_and_b32 v102, 3, v1
    v_xor_b32 v98, v98, v102
    v_lshlrev_b32 v98, 4, v98
    v_mul_u32_u24 v97, 64, v97
    v_add_u32 v98, v98, v97
    v_add_u32 v98, v98, v6
    v_lshrrev_b32 v97, 1, v2
    v_mul_u32_u24 v97, 32, v97
    v_add_u32 v97, v97, v5
    v_mul_lo_u32 v97, s33, v97
    v_and_b32 v102, 3, v1
    v_lshl_add_u32 v102, v102, 4, v97
    v_and_b32 v97, 1, v2
    v_mul_u32_u24 v97, 64, v97
    v_add_u32 v102, v102, v97
    s_mul_i32 s34, s33, 16
    v_xor_b32 v97, 0, v96
    v_cvt_pk_bf16_f32 v16, v80, v81
    v_cvt_pk_bf16_f32 v17, v82, v83
    ds_write_b64 v97, v[16:17] offset:0
    v_cvt_pk_bf16_f32 v18, v84, v85
    v_cvt_pk_bf16_f32 v19, v86, v87
    ds_write_b64 v97, v[18:19] offset:1024
    v_xor_b32 v97, 32, v96
    v_cvt_pk_bf16_f32 v20, v88, v89
    v_cvt_pk_bf16_f32 v21, v90, v91
    ds_write_b64 v97, v[20:21] offset:0
    v_cvt_pk_bf16_f32 v22, v92, v93
    v_cvt_pk_bf16_f32 v23, v94, v95
    ds_write_b64 v97, v[22:23] offset:1024
    s_waitcnt lgkmcnt(0)
    ds_read_b128 v[48:51], v98 offset:0
    ds_read_b128 v[52:55], v98 offset:1024
    s_waitcnt lgkmcnt(1)
    buffer_store_dwordx4 v[48:51], v102, s[8:11], s30 offen sc1
    s_add_u32 s30, s30, s34
    s_waitcnt lgkmcnt(0)
    buffer_store_dwordx4 v[52:55], v102, s[8:11], s30 offen sc1
    s_add_u32 s30, s30, s34
    s_nop 1
    s_nop 0
    v_readfirstlane_b32 s36, v2
    s_nop 2
    s_waitcnt vmcnt(0)
    s_barrier
    s_cmp_lg_u32 s36, 0
    s_cbranch_scc1 Lrel_16
    s_mov_b64 exec, 1
    v_mov_b32 v5, 1
    v_mov_b32 v6, 0
    buffer_atomic_add v5, v6, s[8:11], s37 offen sc1
    s_waitcnt vmcnt(0)
    s_mov_b64 exec, -1
Lrel_16:
Lq_end64:
    s_endpgm
Lf1_entry:
    s_load_dwordx2 s[4:5], s[0:1], 104
    s_load_dwordx2 s[6:7], s[0:1], 0
    s_waitcnt lgkmcnt(0)
    s_mov_b32 s8, s4
    s_and_b32 s9, s5, 0xffff
    s_mov_b32 s10, 0x10000000
    s_mov_b32 s11, 0x00020000
    s_mov_b32 s12, s6
    s_and_b32 s13, s7, 0xffff
    s_mov_b32 s14, 0x280000
    s_mov_b32 s15, 0x00020000
    v_and_b32 v1, 63, v0
    v_lshrrev_b32 v2, 6, v0
    v_and_b32 v3, 15, v0
    v_bfe_u32 v4, v0, 4, 2
    v_lshrrev_b32 v5, 3, v0
    v_and_b32 v6, 7, v0
    v_lshlrev_b32 v6, 4, v6
    v_add_u32 v7, 0, v5
    v_mul_u32_u24 v7, 1280, v7
    v_add_u32 v7, v7, v6
    v_add_u32 v8, 32, v5
    v_mul_u32_u24 v8, 1280, v8
    v_add_u32 v8, v8, v6
    v_add_u32 v9, 64, v5
    v_mul_u32_u24 v9, 1280, v9
    v_add_u32 v9, v9, v6
    v_add_u32 v10, 96, v5
    v_mul_u32_u24 v10, 1280, v10
    v_add_u32 v10, v10, v6
    v_add_u32 v11, 0, v5
    v_mul_u32_u24 v11, 1280, v11
    v_add_u32 v11, v11, v6
    v_add_u32 v12, 32, v5
    v_mul_u32_u24 v12, 1280, v12
    v_add_u32 v12, v12, v6
    v_add_u32 v13, 64, v5
    v_mul_u32_u24 v13, 1280, v13
    v_add_u32 v13, v13, v6
    v_add_u32 v14, 96, v5
    v_mul_u32_u24 v14, 1280, v14
    v_add_u32 v14, v14, v6
    v_lshrrev_b32 v5, 3, v0
    v_and_b32 v6, 7, v0
    v_and_b32 v15, 7, v5
    v_xor_b32 v15, v15, v6
    v_lshlrev_b32 v15, 4, v15
    v_lshl_add_u32 v15, v5, 7, v15
    v_and_b32 v5, 7, v3
    v_xor_b32 v5, v5, v4
    v_lshlrev_b32 v5, 4, v5
    v_lshl_add_u32 v5, v3, 7, v5
    v_and_b32 v6, 1, v2
    v_mul_u32_u24 v6, 8192, v6
    v_add_u32 v16, v5, v6
    v_xor_b32 v17, 64, v16
    v_lshrrev_b32 v6, 1, v2
    v_mul_u32_u24 v6, 8192, v6
    v_add_u32 v18, v5, v6
    v_add_u32 v18, 16384, v18
    v_xor_b32 v19, 64, v18
    v_mov_b32 v148, 0
    v_mov_b32 v149, 0
    v_mov_b32 v150, 0
    v_mov_b32 v151, 0
    v_mov_b32 v152, 0
    v_mov_b32 v153, 0
    v_mov_b32 v154, 0
    v_mov_b32 v155, 0
    v_mov_b32 v156, 0
    v_mov_b32 v157, 0
    v_mov_b32 v158, 0
    v_mov_b32 v159, 0
    v_mov_b32 v160, 0
    v_mov_b32 v161, 0
    v_mov_b32 v162, 0
    v_mov_b32 v163, 0
    v_mov_b32 v164, 0
    v_mov_b32 v165, 0
    v_mov_b32 v166, 0
    v_mov_b32 v167, 0
    v_mov_b32 v168, 0
    v_mov_b32 v169, 0
    v_mov_b32 v170, 0
    v_mov_b32 v171, 0
    v_mov_b32 v172, 0
    v_mov_b32 v173, 0
    v_mov_b32 v174, 0
    v_mov_b32 v175, 0
    v_mov_b32 v176, 0
    v_mov_b32 v177, 0
    v_mov_b32 v178, 0
    v_mov_b32 v179, 0
    v_mov_b32 v180, 0
    v_mov_b32 v181, 0
    v_mov_b32 v182, 0
    v_mov_b32 v183, 0
    v_mov_b32 v184, 0
    v_mov_b32 v185, 0
    v_mov_b32 v186, 0
    v_mov_b32 v187, 0
    v_mov_b32 v188, 0
    v_mov_b32 v189, 0
    v_mov_b32 v190, 0
    v_mov_b32 v191, 0
    v_mov_b32 v192, 0
    v_mov_b32 v193, 0
    v_mov_b32 v194, 0
    v_mov_b32 v195, 0
    v_mov_b32 v196, 0
    v_mov_b32 v197, 0
    v_mov_b32 v198, 0
    v_mov_b32 v199, 0
    v_mov_b32 v200, 0
    v_mov_b32 v201, 0
    v_mov_b32 v202, 0
    v_mov_b32 v203, 0
    v_mov_b32 v204, 0
    v_mov_b32 v205, 0
    v_mov_b32 v206, 0
    v_mov_b32 v207, 0
    v_mov_b32 v208, 0
    v_mov_b32 v209, 0
    v_mov_b32 v210, 0
    v_mov_b32 v211, 0
    s_lshr_b32 s16, s2, 4
    s_and_b32 s17, s2, 15
    s_mul_i32 s28, s17, 163840
    s_mul_i32 s29, s16, 163840
    s_add_u32 s29, s29, 0x8d00000
    buffer_load_dwordx4 v[20:23], v7, s[12:15], s28 offen
    buffer_load_dwordx4 v[24:27], v8, s[12:15], s28 offen
    buffer_load_dwordx4 v[28:31], v9, s[12:15], s28 offen
    buffer_load_dwordx4 v[32:35], v10, s[12:15], s28 offen
    buffer_load_dwordx4 v[36:39], v11, s[8:11], s29 offen
    buffer_load_dwordx4 v[40:43], v12, s[8:11], s29 offen
    buffer_load_dwordx4 v[44:47], v13, s[8:11], s29 offen
    buffer_load_dwordx4 v[48:51], v14, s[8:11], s29 offen
    s_add_u32 s28, s28, 128
    s_add_u32 s29, s29, 128
    buffer_load_dwordx4 v[52:55], v7, s[12:15], s28 offen
    buffer_load_dwordx4 v[56:59], v8, s[12:15], s28 offen
    buffer_load_dwordx4 v[60:63], v9, s[12:15], s28 offen
    buffer_load_dwordx4 v[64:67], v10, s[12:15], s28 offen
    buffer_load_dwordx4 v[68:71], v11, s[8:11], s29 offen
    buffer_load_dwordx4 v[72:75], v12, s[8:11], s29 offen
    buffer_load_dwordx4 v[76:79], v13, s[8:11], s29 offen
    buffer_load_dwordx4 v[80:83], v14, s[8:11], s29 offen
    s_add_u32 s28, s28, 128
    s_add_u32 s29, s29, 128
    s_waitcnt vmcnt(8)
    ds_write_b128 v15, v[20:23] offset:0
    ds_write_b128 v15, v[24:27] offset:4096
    ds_write_b128 v15, v[28:31] offset:8192
    ds_write_b128 v15, v[32:35] offset:12288
    ds_write_b128 v15, v[36:39] offset:16384
    ds_write_b128 v15, v[40:43] offset:20480
    ds_write_b128 v15, v[44:47] offset:24576
    ds_write_b128 v15, v[48:51] offset:28672
    s_waitcnt lgkmcnt(0)
    s_barrier
    s_mov_b32 s35, 5
Lg_17:
    buffer_load_dwordx4 v[20:23], v7, s[12:15], s28 offen
    buffer_load_dwordx4 v[24:27], v8, s[12:15], s28 offen
    buffer_load_dwordx4 v[28:31], v9, s[12:15], s28 offen
    buffer_load_dwordx4 v[32:35], v10, s[12:15], s28 offen
    buffer_load_dwordx4 v[36:39], v11, s[8:11], s29 offen
    buffer_load_dwordx4 v[40:43], v12, s[8:11], s29 offen
    buffer_load_dwordx4 v[44:47], v13, s[8:11], s29 offen
    buffer_load_dwordx4 v[48:51], v14, s[8:11], s29 offen
    s_add_u32 s28, s28, 128
    s_add_u32 s29, s29, 128
    v_xor_b32 v15, 32768, v15
    ds_read_b128 v[84:87], v16 offset:0
    ds_read_b128 v[88:91], v16 offset:2048
    ds_read_b128 v[92:95], v16 offset:4096
    ds_read_b128 v[96:99], v16 offset:6144
    ds_read_b128 v[116:119], v18 offset:0
    ds_read_b128 v[120:123], v18 offset:2048
    ds_read_b128 v[124:127], v18 offset:4096
    ds_read_b128 v[128:131], v18 offset:6144
    ds_read_b128 v[100:103], v17 offset:0
    ds_read_b128 v[104:107], v17 offset:2048
    ds_read_b128 v[108:111], v17 offset:4096
    ds_read_b128 v[112:115], v17 offset:6144
    ds_read_b128 v[132:135], v19 offset:0
    ds_read_b128 v[136:139], v19 offset:2048
    ds_read_b128 v[140:143], v19 offset:4096
    ds_read_b128 v[144:147], v19 offset:6144
    s_waitcnt lgkmcnt(8)
    v_mfma_f32_16x16x32_bf16 v[148:151], v[84:87], v[116:119], v[148:151]
    v_mfma_f32_16x16x32_bf16 v[152:155], v[84:87], v[120:123], v[152:155]
    v_mfma_f32_16x16x32_bf16 v[156:159], v[84:87], v[124:127], v[156:159]
    v_mfma_f32_16x16x32_bf16 v[160:163], v[84:87], v[128:131], v[160:163]
    v_mfma_f32_16x16x32_bf16 v[164:167], v[88:91], v[116:119], v[164:167]
    v_mfma_f32_16x16x32_bf16 v[168:171], v[88:91], v[120:123], v[168:171]
    v_mfma_f32_16x16x32_bf16 v[172:175], v[88:91], v[124:127], v[172:175]
    v_mfma_f32_16x16x32_bf16 v[176:179], v[88:91], v[128:131], v[176:179]
    v_mfma_f32_16x16x32_bf16 v[180:183], v[92:95], v[116:119], v[180:183]
    v_mfma_f32_16x16x32_bf16 v[184:187], v[92:95], v[120:123], v[184:187]
    v_mfma_f32_16x16x32_bf16 v[188:191], v[92:95], v[124:127], v[188:191]
    v_mfma_f32_16x16x32_bf16 v[192:195], v[92:95], v[128:131], v[192:195]
    v_mfma_f32_16x16x32_bf16 v[196:199], v[96:99], v[116:119], v[196:199]
    v_mfma_f32_16x16x32_bf16 v[200:203], v[96:99], v[120:123], v[200:203]
    v_mfma_f32_16x16x32_bf16 v[204:207], v[96:99], v[124:127], v[204:207]
    v_mfma_f32_16x16x32_bf16 v[208:211], v[96:99], v[128:131], v[208:211]
    s_waitcnt lgkmcnt(0)
    v_mfma_f32_16x16x32_bf16 v[148:151], v[100:103], v[132:135], v[148:151]
    v_mfma_f32_16x16x32_bf16 v[152:155], v[100:103], v[136:139], v[152:155]
    v_mfma_f32_16x16x32_bf16 v[156:159], v[100:103], v[140:143], v[156:159]
    v_mfma_f32_16x16x32_bf16 v[160:163], v[100:103], v[144:147], v[160:163]
    v_mfma_f32_16x16x32_bf16 v[164:167], v[104:107], v[132:135], v[164:167]
    v_mfma_f32_16x16x32_bf16 v[168:171], v[104:107], v[136:139], v[168:171]
    v_mfma_f32_16x16x32_bf16 v[172:175], v[104:107], v[140:143], v[172:175]
    v_mfma_f32_16x16x32_bf16 v[176:179], v[104:107], v[144:147], v[176:179]
    v_mfma_f32_16x16x32_bf16 v[180:183], v[108:111], v[132:135], v[180:183]
    v_mfma_f32_16x16x32_bf16 v[184:187], v[108:111], v[136:139], v[184:187]
    v_mfma_f32_16x16x32_bf16 v[188:191], v[108:111], v[140:143], v[188:191]
    v_mfma_f32_16x16x32_bf16 v[192:195], v[108:111], v[144:147], v[192:195]
    v_mfma_f32_16x16x32_bf16 v[196:199], v[112:115], v[132:135], v[196:199]
    v_mfma_f32_16x16x32_bf16 v[200:203], v[112:115], v[136:139], v[200:203]
    v_mfma_f32_16x16x32_bf16 v[204:207], v[112:115], v[140:143], v[204:207]
    v_mfma_f32_16x16x32_bf16 v[208:211], v[112:115], v[144:147], v[208:211]
    s_waitcnt vmcnt(8)
    ds_write_b128 v15, v[52:55] offset:0
    ds_write_b128 v15, v[56:59] offset:4096
    ds_write_b128 v15, v[60:63] offset:8192
    ds_write_b128 v15, v[64:67] offset:12288
    ds_write_b128 v15, v[68:71] offset:16384
    ds_write_b128 v15, v[72:75] offset:20480
    ds_write_b128 v15, v[76:79] offset:24576
    ds_write_b128 v15, v[80:83] offset:28672
    v_xor_b32 v16, 32768, v16
    v_xor_b32 v17, 32768, v17
    v_xor_b32 v18, 32768, v18
    v_xor_b32 v19, 32768, v19
    s_waitcnt lgkmcnt(0)
    s_barrier
    buffer_load_dwordx4 v[52:55], v7, s[12:15], s28 offen
    buffer_load_dwordx4 v[56:59], v8, s[12:15], s28 offen
    buffer_load_dwordx4 v[60:63], v9, s[12:15], s28 offen
    buffer_load_dwordx4 v[64:67], v10, s[12:15], s28 offen
    buffer_load_dwordx4 v[68:71], v11, s[8:11], s29 offen
    buffer_load_dwordx4 v[72:75], v12, s[8:11], s29 offen
    buffer_load_dwordx4 v[76:79], v13, s[8:11], s29 offen
    buffer_load_dwordx4 v[80:83], v14, s[8:11], s29 offen
    s_add_u32 s28, s28, 128
    s_add_u32 s29, s29, 128
    v_xor_b32 v15, 32768, v15
    ds_read_b128 v[84:87], v16 offset:0
    ds_read_b128 v[88:91], v16 offset:2048
    ds_read_b128 v[92:95], v16 offset:4096
    ds_read_b128 v[96:99], v16 offset:6144
    ds_read_b128 v[116:119], v18 offset:0
    ds_read_b128 v[120:123], v18 offset:2048
    ds_read_b128 v[124:127], v18 offset:4096
    ds_read_b128 v[128:131], v18 offset:6144
    ds_read_b128 v[100:103], v17 offset:0
    ds_read_b128 v[104:107], v17 offset:2048
    ds_read_b128 v[108:111], v17 offset:4096
    ds_read_b128 v[112:115], v17 offset:6144
    ds_read_b128 v[132:135], v19 offset:0
    ds_read_b128 v[136:139], v19 offset:2048
    ds_read_b128 v[140:143], v19 offset:4096
    ds_read_b128 v[144:147], v19 offset:6144
    s_waitcnt lgkmcnt(8)
    v_mfma_f32_16x16x32_bf16 v[148:151], v[84:87], v[116:119], v[148:151]
    v_mfma_f32_16x16x32_bf16 v[152:155], v[84:87], v[120:123], v[152:155]
    v_mfma_f32_16x16x32_bf16 v[156:159], v[84:87], v[124:127], v[156:159]
    v_mfma_f32_16x16x32_bf16 v[160:163], v[84:87], v[128:131], v[160:163]
    v_mfma_f32_16x16x32_bf16 v[164:167], v[88:91], v[116:119], v[164:167]
    v_mfma_f32_16x16x32_bf16 v[168:171], v[88:91], v[120:123], v[168:171]
    v_mfma_f32_16x16x32_bf16 v[172:175], v[88:91], v[124:127], v[172:175]
    v_mfma_f32_16x16x32_bf16 v[176:179], v[88:91], v[128:131], v[176:179]
    v_mfma_f32_16x16x32_bf16 v[180:183], v[92:95], v[116:119], v[180:183]
    v_mfma_f32_16x16x32_bf16 v[184:187], v[92:95], v[120:123], v[184:187]
    v_mfma_f32_16x16x32_bf16 v[188:191], v[92:95], v[124:127], v[188:191]
    v_mfma_f32_16x16x32_bf16 v[192:195], v[92:95], v[128:131], v[192:195]
    v_mfma_f32_16x16x32_bf16 v[196:199], v[96:99], v[116:119], v[196:199]
    v_mfma_f32_16x16x32_bf16 v[200:203], v[96:99], v[120:123], v[200:203]
    v_mfma_f32_16x16x32_bf16 v[204:207], v[96:99], v[124:127], v[204:207]
    v_mfma_f32_16x16x32_bf16 v[208:211], v[96:99], v[128:131], v[208:211]
    s_waitcnt lgkmcnt(0)
    v_mfma_f32_16x16x32_bf16 v[148:151], v[100:103], v[132:135], v[148:151]
    v_mfma_f32_16x16x32_bf16 v[152:155], v[100:103], v[136:139], v[152:155]
    v_mfma_f32_16x16x32_bf16 v[156:159], v[100:103], v[140:143], v[156:159]
    v_mfma_f32_16x16x32_bf16 v[160:163], v[100:103], v[144:147], v[160:163]
    v_mfma_f32_16x16x32_bf16 v[164:167], v[104:107], v[132:135], v[164:167]
    v_mfma_f32_16x16x32_bf16 v[168:171], v[104:107], v[136:139], v[168:171]
    v_mfma_f32_16x16x32_bf16 v[172:175], v[104:107], v[140:143], v[172:175]
    v_mfma_f32_16x16x32_bf16 v[176:179], v[104:107], v[144:147], v[176:179]
    v_mfma_f32_16x16x32_bf16 v[180:183], v[108:111], v[132:135], v[180:183]
    v_mfma_f32_16x16x32_bf16 v[184:187], v[108:111], v[136:139], v[184:187]
    v_mfma_f32_16x16x32_bf16 v[188:191], v[108:111], v[140:143], v[188:191]
    v_mfma_f32_16x16x32_bf16 v[192:195], v[108:111], v[144:147], v[192:195]
    v_mfma_f32_16x16x32_bf16 v[196:199], v[112:115], v[132:135], v[196:199]
    v_mfma_f32_16x16x32_bf16 v[200:203], v[112:115], v[136:139], v[200:203]
    v_mfma_f32_16x16x32_bf16 v[204:207], v[112:115], v[140:143], v[204:207]
    v_mfma_f32_16x16x32_bf16 v[208:211], v[112:115], v[144:147], v[208:211]
    s_waitcnt vmcnt(8)
    ds_write_b128 v15, v[20:23] offset:0
    ds_write_b128 v15, v[24:27] offset:4096
    ds_write_b128 v15, v[28:31] offset:8192
    ds_write_b128 v15, v[32:35] offset:12288
    ds_write_b128 v15, v[36:39] offset:16384
    ds_write_b128 v15, v[40:43] offset:20480
    ds_write_b128 v15, v[44:47] offset:24576
    ds_write_b128 v15, v[48:51] offset:28672
    v_xor_b32 v16, 32768, v16
    v_xor_b32 v17, 32768, v17
    v_xor_b32 v18, 32768, v18
    v_xor_b32 v19, 32768, v19
    s_waitcnt lgkmcnt(0)
    s_barrier
    s_sub_u32 s35, s35, 1
    s_cmp_lg_u32 s35, 0
    s_cbranch_scc1 Lg_17
    s_waitcnt vmcnt(0)
    s_mul_i32 s28, s17, 163840
    s_mul_i32 s29, s16, 163840
    s_add_u32 s29, s29, 0x8e00000
    buffer_load_dwordx4 v[20:23], v7, s[12:15], s28 offen
    buffer_load_dwordx4 v[24:27], v8, s[12:15], s28 offen
    buffer_load_dwordx4 v[28:31], v9, s[12:15], s28 offen
    buffer_load_dwordx4 v[32:35], v10, s[12:15], s28 offen
    buffer_load_dwordx4 v[36:39], v11, s[8:11], s29 offen
    buffer_load_dwordx4 v[40:43], v12, s[8:11], s29 offen
    buffer_load_dwordx4 v[44:47], v13, s[8:11], s29 offen
    buffer_load_dwordx4 v[48:51], v14, s[8:11], s29 offen
    s_add_u32 s28, s28, 128
    s_add_u32 s29, s29, 128
    buffer_load_dwordx4 v[52:55], v7, s[12:15], s28 offen
    buffer_load_dwordx4 v[56:59], v8, s[12:15], s28 offen
    buffer_load_dwordx4 v[60:63], v9, s[12:15], s28 offen
    buffer_load_dwordx4 v[64:67], v10, s[12:15], s28 offen
    buffer_load_dwordx4 v[68:71], v11, s[8:11], s29 offen
    buffer_load_dwordx4 v[72:75], v12, s[8:11], s29 offen
    buffer_load_dwordx4 v[76:79], v13, s[8:11], s29 offen
    buffer_load_dwordx4 v[80:83], v14, s[8:11], s29 offen
    s_add_u32 s28, s28, 128
    s_add_u32 s29, s29, 128
    s_waitcnt vmcnt(8)
    ds_write_b128 v15, v[20:23] offset:0
    ds_write_b128 v15, v[24:27] offset:4096
    ds_write_b128 v15, v[28:31] offset:8192
    ds_write_b128 v15, v[32:35] offset:12288
    ds_write_b128 v15, v[36:39] offset:16384
    ds_write_b128 v15, v[40:43] offset:20480
    ds_write_b128 v15, v[44:47] offset:24576
    ds_write_b128 v15, v[48:51] offset:28672
    s_waitcnt lgkmcnt(0)
    s_barrier
    s_mov_b32 s35, 5
Lg_18:
    buffer_load_dwordx4 v[20:23], v7, s[12:15], s28 offen
    buffer_load_dwordx4 v[24:27], v8, s[12:15], s28 offen
    buffer_load_dwordx4 v[28:31], v9, s[12:15], s28 offen
    buffer_load_dwordx4 v[32:35], v10, s[12:15], s28 offen
    buffer_load_dwordx4 v[36:39], v11, s[8:11], s29 offen
    buffer_load_dwordx4 v[40:43], v12, s[8:11], s29 offen
    buffer_load_dwordx4 v[44:47], v13, s[8:11], s29 offen
    buffer_load_dwordx4 v[48:51], v14, s[8:11], s29 offen
    s_add_u32 s28, s28, 128
    s_add_u32 s29, s29, 128
    v_xor_b32 v15, 32768, v15
    ds_read_b128 v[84:87], v16 offset:0
    ds_read_b128 v[88:91], v16 offset:2048
    ds_read_b128 v[92:95], v16 offset:4096
    ds_read_b128 v[96:99], v16 offset:6144
    ds_read_b128 v[116:119], v18 offset:0
    ds_read_b128 v[120:123], v18 offset:2048
    ds_read_b128 v[124:127], v18 offset:4096
    ds_read_b128 v[128:131], v18 offset:6144
    ds_read_b128 v[100:103], v17 offset:0
    ds_read_b128 v[104:107], v17 offset:2048
    ds_read_b128 v[108:111], v17 offset:4096
    ds_read_b128 v[112:115], v17 offset:6144
    ds_read_b128 v[132:135], v19 offset:0
    ds_read_b128 v[136:139], v19 offset:2048
    ds_read_b128 v[140:143], v19 offset:4096
    ds_read_b128 v[144:147], v19 offset:6144
    s_waitcnt lgkmcnt(8)
    v_mfma_f32_16x16x32_bf16 v[148:151], v[84:87], v[116:119], v[148:151]
    v_mfma_f32_16x16x32_bf16 v[152:155], v[84:87], v[120:123], v[152:155]
    v_mfma_f32_16x16x32_bf16 v[156:159], v[84:87], v[124:127], v[156:159]
    v_mfma_f32_16x16x32_bf16 v[160:163], v[84:87], v[128:131], v[160:163]
    v_mfma_f32_16x16x32_bf16 v[164:167], v[88:91], v[116:119], v[164:167]
    v_mfma_f32_16x16x32_bf16 v[168:171], v[88:91], v[120:123], v[168:171]
    v_mfma_f32_16x16x32_bf16 v[172:175], v[88:91], v[124:127], v[172:175]
    v_mfma_f32_16x16x32_bf16 v[176:179], v[88:91], v[128:131], v[176:179]
    v_mfma_f32_16x16x32_bf16 v[180:183], v[92:95], v[116:119], v[180:183]
    v_mfma_f32_16x16x32_bf16 v[184:187], v[92:95], v[120:123], v[184:187]
    v_mfma_f32_16x16x32_bf16 v[188:191], v[92:95], v[124:127], v[188:191]
    v_mfma_f32_16x16x32_bf16 v[192:195], v[92:95], v[128:131], v[192:195]
    v_mfma_f32_16x16x32_bf16 v[196:199], v[96:99], v[116:119], v[196:199]
    v_mfma_f32_16x16x32_bf16 v[200:203], v[96:99], v[120:123], v[200:203]
    v_mfma_f32_16x16x32_bf16 v[204:207], v[96:99], v[124:127], v[204:207]
    v_mfma_f32_16x16x32_bf16 v[208:211], v[96:99], v[128:131], v[208:211]
    s_waitcnt lgkmcnt(0)
    v_mfma_f32_16x16x32_bf16 v[148:151], v[100:103], v[132:135], v[148:151]
    v_mfma_f32_16x16x32_bf16 v[152:155], v[100:103], v[136:139], v[152:155]
    v_mfma_f32_16x16x32_bf16 v[156:159], v[100:103], v[140:143], v[156:159]
    v_mfma_f32_16x16x32_bf16 v[160:163], v[100:103], v[144:147], v[160:163]
    v_mfma_f32_16x16x32_bf16 v[164:167], v[104:107], v[132:135], v[164:167]
    v_mfma_f32_16x16x32_bf16 v[168:171], v[104:107], v[136:139], v[168:171]
    v_mfma_f32_16x16x32_bf16 v[172:175], v[104:107], v[140:143], v[172:175]
    v_mfma_f32_16x16x32_bf16 v[176:179], v[104:107], v[144:147], v[176:179]
    v_mfma_f32_16x16x32_bf16 v[180:183], v[108:111], v[132:135], v[180:183]
    v_mfma_f32_16x16x32_bf16 v[184:187], v[108:111], v[136:139], v[184:187]
    v_mfma_f32_16x16x32_bf16 v[188:191], v[108:111], v[140:143], v[188:191]
    v_mfma_f32_16x16x32_bf16 v[192:195], v[108:111], v[144:147], v[192:195]
    v_mfma_f32_16x16x32_bf16 v[196:199], v[112:115], v[132:135], v[196:199]
    v_mfma_f32_16x16x32_bf16 v[200:203], v[112:115], v[136:139], v[200:203]
    v_mfma_f32_16x16x32_bf16 v[204:207], v[112:115], v[140:143], v[204:207]
    v_mfma_f32_16x16x32_bf16 v[208:211], v[112:115], v[144:147], v[208:211]
    s_waitcnt vmcnt(8)
    ds_write_b128 v15, v[52:55] offset:0
    ds_write_b128 v15, v[56:59] offset:4096
    ds_write_b128 v15, v[60:63] offset:8192
    ds_write_b128 v15, v[64:67] offset:12288
    ds_write_b128 v15, v[68:71] offset:16384
    ds_write_b128 v15, v[72:75] offset:20480
    ds_write_b128 v15, v[76:79] offset:24576
    ds_write_b128 v15, v[80:83] offset:28672
    v_xor_b32 v16, 32768, v16
    v_xor_b32 v17, 32768, v17
    v_xor_b32 v18, 32768, v18
    v_xor_b32 v19, 32768, v19
    s_waitcnt lgkmcnt(0)
    s_barrier
    buffer_load_dwordx4 v[52:55], v7, s[12:15], s28 offen
    buffer_load_dwordx4 v[56:59], v8, s[12:15], s28 offen
    buffer_load_dwordx4 v[60:63], v9, s[12:15], s28 offen
    buffer_load_dwordx4 v[64:67], v10, s[12:15], s28 offen
    buffer_load_dwordx4 v[68:71], v11, s[8:11], s29 offen
    buffer_load_dwordx4 v[72:75], v12, s[8:11], s29 offen
    buffer_load_dwordx4 v[76:79], v13, s[8:11], s29 offen
    buffer_load_dwordx4 v[80:83], v14, s[8:11], s29 offen
    s_add_u32 s28, s28, 128
    s_add_u32 s29, s29, 128
    v_xor_b32 v15, 32768, v15
    ds_read_b128 v[84:87], v16 offset:0
    ds_read_b128 v[88:91], v16 offset:2048
    ds_read_b128 v[92:95], v16 offset:4096
    ds_read_b128 v[96:99], v16 offset:6144
    ds_read_b128 v[116:119], v18 offset:0
    ds_read_b128 v[120:123], v18 offset:2048
    ds_read_b128 v[124:127], v18 offset:4096
    ds_read_b128 v[128:131], v18 offset:6144
    ds_read_b128 v[100:103], v17 offset:0
    ds_read_b128 v[104:107], v17 offset:2048
    ds_read_b128 v[108:111], v17 offset:4096
    ds_read_b128 v[112:115], v17 offset:6144
    ds_read_b128 v[132:135], v19 offset:0
    ds_read_b128 v[136:139], v19 offset:2048
    ds_read_b128 v[140:143], v19 offset:4096
    ds_read_b128 v[144:147], v19 offset:6144
    s_waitcnt lgkmcnt(8)
    v_mfma_f32_16x16x32_bf16 v[148:151], v[84:87], v[116:119], v[148:151]
    v_mfma_f32_16x16x32_bf16 v[152:155], v[84:87], v[120:123], v[152:155]
    v_mfma_f32_16x16x32_bf16 v[156:159], v[84:87], v[124:127], v[156:159]
    v_mfma_f32_16x16x32_bf16 v[160:163], v[84:87], v[128:131], v[160:163]
    v_mfma_f32_16x16x32_bf16 v[164:167], v[88:91], v[116:119], v[164:167]
    v_mfma_f32_16x16x32_bf16 v[168:171], v[88:91], v[120:123], v[168:171]
    v_mfma_f32_16x16x32_bf16 v[172:175], v[88:91], v[124:127], v[172:175]
    v_mfma_f32_16x16x32_bf16 v[176:179], v[88:91], v[128:131], v[176:179]
    v_mfma_f32_16x16x32_bf16 v[180:183], v[92:95], v[116:119], v[180:183]
    v_mfma_f32_16x16x32_bf16 v[184:187], v[92:95], v[120:123], v[184:187]
    v_mfma_f32_16x16x32_bf16 v[188:191], v[92:95], v[124:127], v[188:191]
    v_mfma_f32_16x16x32_bf16 v[192:195], v[92:95], v[128:131], v[192:195]
    v_mfma_f32_16x16x32_bf16 v[196:199], v[96:99], v[116:119], v[196:199]
    v_mfma_f32_16x16x32_bf16 v[200:203], v[96:99], v[120:123], v[200:203]
    v_mfma_f32_16x16x32_bf16 v[204:207], v[96:99], v[124:127], v[204:207]
    v_mfma_f32_16x16x32_bf16 v[208:211], v[96:99], v[128:131], v[208:211]
    s_waitcnt lgkmcnt(0)
    v_mfma_f32_16x16x32_bf16 v[148:151], v[100:103], v[132:135], v[148:151]
    v_mfma_f32_16x16x32_bf16 v[152:155], v[100:103], v[136:139], v[152:155]
    v_mfma_f32_16x16x32_bf16 v[156:159], v[100:103], v[140:143], v[156:159]
    v_mfma_f32_16x16x32_bf16 v[160:163], v[100:103], v[144:147], v[160:163]
    v_mfma_f32_16x16x32_bf16 v[164:167], v[104:107], v[132:135], v[164:167]
    v_mfma_f32_16x16x32_bf16 v[168:171], v[104:107], v[136:139], v[168:171]
    v_mfma_f32_16x16x32_bf16 v[172:175], v[104:107], v[140:143], v[172:175]
    v_mfma_f32_16x16x32_bf16 v[176:179], v[104:107], v[144:147], v[176:179]
    v_mfma_f32_16x16x32_bf16 v[180:183], v[108:111], v[132:135], v[180:183]
    v_mfma_f32_16x16x32_bf16 v[184:187], v[108:111], v[136:139], v[184:187]
    v_mfma_f32_16x16x32_bf16 v[188:191], v[108:111], v[140:143], v[188:191]
    v_mfma_f32_16x16x32_bf16 v[192:195], v[108:111], v[144:147], v[192:195]
    v_mfma_f32_16x16x32_bf16 v[196:199], v[112:115], v[132:135], v[196:199]
    v_mfma_f32_16x16x32_bf16 v[200:203], v[112:115], v[136:139], v[200:203]
    v_mfma_f32_16x16x32_bf16 v[204:207], v[112:115], v[140:143], v[204:207]
    v_mfma_f32_16x16x32_bf16 v[208:211], v[112:115], v[144:147], v[208:211]
    s_waitcnt vmcnt(8)
    ds_write_b128 v15, v[20:23] offset:0
    ds_write_b128 v15, v[24:27] offset:4096
    ds_write_b128 v15, v[28:31] offset:8192
    ds_write_b128 v15, v[32:35] offset:12288
    ds_write_b128 v15, v[36:39] offset:16384
    ds_write_b128 v15, v[40:43] offset:20480
    ds_write_b128 v15, v[44:47] offset:24576
    ds_write_b128 v15, v[48:51] offset:28672
    v_xor_b32 v16, 32768, v16
    v_xor_b32 v17, 32768, v17
    v_xor_b32 v18, 32768, v18
    v_xor_b32 v19, 32768, v19
    s_waitcnt lgkmcnt(0)
    s_barrier
    s_sub_u32 s35, s35, 1
    s_cmp_lg_u32 s35, 0
    s_cbranch_scc1 Lg_18
    s_waitcnt vmcnt(0)
    v_lshrrev_b32 v5, 1, v2
    v_lshlrev_b32 v5, 6, v5
    v_add_u32 v5, v5, v3
    v_lshlrev_b32 v212, 13, v5
    v_and_b32 v5, 1, v2
    v_lshlrev_b32 v5, 8, v5
    v_lshl_add_u32 v5, v4, 4, v5
    v_add_u32 v212, v212, v5
    s_lshl_b32 s30, s16, 20
    s_lshl_b32 s31, s17, 9
    s_add_u32 s30, s30, s31
    s_add_u32 s30, s30, 0x8f00000
    s_mov_b32 s34, 131072
    s_nop 9
    buffer_store_dwordx4 v[148:151], v212, s[8:11], s30 offen offset:0 sc1
    buffer_store_dwordx4 v[164:167], v212, s[8:11], s30 offen offset:64 sc1
    buffer_store_dwordx4 v[180:183], v212, s[8:11], s30 offen offset:128 sc1
    buffer_store_dwordx4 v[196:199], v212, s[8:11], s30 offen offset:192 sc1
    s_add_u32 s30, s30, s34
    buffer_store_dwordx4 v[152:155], v212, s[8:11], s30 offen offset:0 sc1
    buffer_store_dwordx4 v[168:171], v212, s[8:11], s30 offen offset:64 sc1
    buffer_store_dwordx4 v[184:187], v212, s[8:11], s30 offen offset:128 sc1
    buffer_store_dwordx4 v[200:203], v212, s[8:11], s30 offen offset:192 sc1
    s_add_u32 s30, s30, s34
    buffer_store_dwordx4 v[156:159], v212, s[8:11], s30 offen offset:0 sc1
    buffer_store_dwordx4 v[172:175], v212, s[8:11], s30 offen offset:64 sc1
    buffer_store_dwordx4 v[188:191], v212, s[8:11], s30 offen offset:128 sc1
    buffer_store_dwordx4 v[204:207], v212, s[8:11], s30 offen offset:192 sc1
    s_add_u32 s30, s30, s34
    buffer_store_dwordx4 v[160:163], v212, s[8:11], s30 offen offset:0 sc1
    buffer_store_dwordx4 v[176:179], v212, s[8:11], s30 offen offset:64 sc1
    buffer_store_dwordx4 v[192:195], v212, s[8:11], s30 offen offset:128 sc1
    buffer_store_dwordx4 v[208:211], v212, s[8:11], s30 offen offset:192 sc1
    v_readfirstlane_b32 s36, v2
    s_mov_b32 s37, 0x9f00880
    s_nop 2
    s_waitcnt vmcnt(0)
    s_barrier
    s_cmp_lg_u32 s36, 0
    s_cbranch_scc1 Lrel_19
    s_mov_b64 exec, 1
    v_mov_b32 v5, 1
    v_mov_b32 v6, 0
    buffer_atomic_add v5, v6, s[8:11], s37 offen sc1
    s_waitcnt vmcnt(0)
    s_mov_b64 exec, -1
Lrel_19:
Lf1_end:
    s_endpgm
Latt_entry:
    s_load_dwordx2 s[4:5], s[0:1], 104
    s_waitcnt lgkmcnt(0)
    s_mov_b32 s8, s4
    s_and_b32 s9, s5, 0xffff
    s_mov_b32 s10, 0x10000000
    s_mov_b32 s11, 0x00020000
    v_and_b32 v1, 63, v0
    v_lshrrev_b32 v2, 6, v0
    v_and_b32 v3, 15, v0
    v_bfe_u32 v4, v0, 4, 2
    s_lshr_b32 s12, s2, 3
    s_and_b32 s13, s2, 7
    s_lshl_b32 s13, s13, 2
    v_add_u32 v5, s13, v2
    v_readfirstlane_b32 s40, v2
    s_lshr_b32 s41, s12, 2
    s_lshl_b32 s41, s41, 7
    s_add_u32 s41, s41, 0x9f00000
    s_nop 2
    s_cmp_lg_u32 s40, 0
    s_cbranch_scc1 Lwo_21
    s_mov_b32 s42, 0
    v_mov_b32 v7, 0
    s_mov_b64 exec, 1
Lwc_20:
    buffer_load_dword v6, v7, s[8:11], s41 offen sc1
    s_waitcnt vmcnt(0)
    v_cmp_le_u32 vcc, 32, v6
    s_cbranch_vccnz Lwo_21x
    s_sleep 48
    s_add_u32 s42, s42, 1
    s_cmp_lt_u32 s42, 400000
    s_cbranch_scc1 Lwc_20
Lwo_21x:
    s_mov_b64 exec, -1
Lwo_21:
    s_barrier
    s_add_u32 s41, s41, 12288
    s_cmp_lg_u32 s40, 0
    s_cbranch_scc1 Lwo_23
    s_mov_b32 s42, 0
    v_mov_b32 v7, 0
    s_mov_b64 exec, 1
Lwc_22:
    buffer_load_dword v6, v7, s[8:11], s41 offen sc1
    s_waitcnt vmcnt(0)
    v_cmp_le_u32 vcc, 64, v6
    s_cbranch_vccnz Lwo_23x
    s_sleep 48
    s_add_u32 s42, s42, 1
    s_cmp_lt_u32 s42, 400000
    s_cbranch_scc1 Lwc_22
Lwo_23x:
    s_mov_b64 exec, -1
Lwo_23:
    s_barrier
    v_mul_u32_u24 v6, 16640, v3
    v_lshl_add_u32 v6, v5, 8, v6
    v_lshl_add_u32 v6, v4, 4, v6
    s_mul_i32 s14, s12, 532480
    s_add_u32 s14, s14, 0x1500000
    s_add_u32 s15, s14, 266240
    s_add_u32 s16, s14, 8192
    s_add_u32 s17, s15, 8192
    buffer_load_dwordx4 v[16:19], v6, s[8:11], s14 offen offset:0 sc1
    buffer_load_dwordx4 v[20:23], v6, s[8:11], s14 offen offset:64 sc1
    buffer_load_dwordx4 v[24:27], v6, s[8:11], s14 offen offset:128 sc1
    buffer_load_dwordx4 v[28:31], v6, s[8:11], s14 offen offset:192 sc1
    buffer_load_dwordx4 v[32:35], v6, s[8:11], s15 offen offset:0 sc1
    buffer_load_dwordx4 v[36:39], v6, s[8:11], s15 offen offset:64 sc1
    buffer_load_dwordx4 v[40:43], v6, s[8:11], s15 offen offset:128 sc1
    buffer_load_dwordx4 v[44:47], v6, s[8:11], s15 offen offset:192 sc1
    buffer_load_dwordx4 v[48:51], v6, s[8:11], s16 offen offset:0 sc1
    buffer_load_dwordx4 v[52:55], v6, s[8:11], s16 offen offset:64 sc1
    buffer_load_dwordx4 v[56:59], v6, s[8:11], s16 offen offset:128 sc1
    buffer_load_dwordx4 v[60:63], v6, s[8:11], s16 offen offset:192 sc1
    buffer_load_dwordx4 v[64:67], v6, s[8:11], s17 offen offset:0 sc1
    buffer_load_dwordx4 v[68:71], v6, s[8:11], s17 offen offset:64 sc1
    buffer_load_dwordx4 v[72:75], v6, s[8:11], s17 offen offset:128 sc1
    buffer_load_dwordx4 v[76:79], v6, s[8:11], s17 offen offset:192 sc1
    v_and_b32 v7, 7, v3
    v_lshl_add_u32 v7, v4, 3, v7
    v_lshlrev_b32 v7, 4, v7
    v_mul_u32_u24 v8, 6144, v5
    v_add_u32 v7, v7, v8
    s_mul_i32 s18, s12, 196608
    s_add_u32 s18, s18, 0x5900800
    v_mov_b32 v128, 0
    v_mov_b32 v129, 0
    v_mov_b32 v130, 0
    v_mov_b32 v131, 0
    v_mov_b32 v132, 0
    v_mov_b32 v133, 0
    v_mov_b32 v134, 0
    v_mov_b32 v135, 0
    v_mov_b32 v136, 0
    v_mov_b32 v137, 0
    v_mov_b32 v138, 0
    v_mov_b32 v139, 0
    v_mov_b32 v140, 0
    v_mov_b32 v141, 0
    v_mov_b32 v142, 0
    v_mov_b32 v143, 0
    v_and_b32 v9, 31, v1
    v_lshl_add_u32 v9, v9, 3, v8
    s_add_u32 s19, s18, 2048
    s_add_u32 s43, s12, 1
    s_mul_i32 s43, s43, 10240
    s_lshl_b32 s44, s13, 7
    s_add_u32 s43, s43, s44
    s_add_u32 s43, s43, 0x5800040
    s_cmp_lg_u32 s40, 0
    s_cbranch_scc1 Lwo_25
    s_mov_b32 s42, 0
    v_mov_b32 v13, 0
    s_mov_b64 exec, 1
Lwc_24:
    buffer_load_dword v12, v13, s[8:11], s43 offen sc1
    s_waitcnt vmcnt(0)
    v_cmp_ne_u32 vcc, -1, v12
    s_cbranch_vccnz Lwo_25x
    s_sleep 20
    s_add_u32 s42, s42, 1
    s_cmp_lt_u32 s42, 400000
    s_cbranch_scc1 Lwc_24
Lwo_25x:
    s_mov_b64 exec, -1
Lwo_25:
    s_barrier
    s_mov_b32 s42, 0
La_poll:
    buffer_load_dwordx4 v[80:83], v7, s[8:11], s18 offen offset:0 sc1
    buffer_load_dwordx4 v[84:87], v7, s[8:11], s18 offen offset:512 sc1
    buffer_load_dwordx4 v[88:91], v7, s[8:11], s18 offen offset:1024 sc1
    buffer_load_dwordx4 v[92:95], v7, s[8:11], s18 offen offset:1536 sc1
    s_mov_b32 exec_hi, 0
    buffer_load_dwordx2 v[128:129], v9, s[8:11], s19 offen offset:0 sc1
    buffer_load_dwordx2 v[130:131], v9, s[8:11], s19 offen offset:256 sc1
    buffer_load_dwordx2 v[132:133], v9, s[8:11], s19 offen offset:512 sc1
    buffer_load_dwordx2 v[134:135], v9, s[8:11], s19 offen offset:768 sc1
    buffer_load_dwordx2 v[136:137], v9, s[8:11], s19 offen offset:1024 sc1
    buffer_load_dwordx2 v[138:139], v9, s[8:11], s19 offen offset:1280 sc1
    buffer_load_dwordx2 v[140:141], v9, s[8:11], s19 offen offset:1536 sc1
    buffer_load_dwordx2 v[142:143], v9, s[8:11], s19 offen offset:1792 sc1
    s_mov_b64 exec, -1
    s_waitcnt vmcnt(0)
    v_max3_u32 v11, v80, v81, v82
    v_max3_u32 v11, v11, v83, v84
    v_max3_u32 v11, v11, v85, v86
    v_max3_u32 v11, v11, v87, v88
    v_max3_u32 v11, v11, v89, v90
    v_max3_u32 v11, v11, v91, v92
    v_max3_u32 v11, v11, v93, v94
    v_max3_u32 v11, v11, v95, v128
    v_max3_u32 v11, v11, v129, v130
    v_max3_u32 v11, v11, v131, v132
    v_max3_u32 v11, v11, v133, v134
    v_max3_u32 v11, v11, v135, v136
    v_max3_u32 v11, v11, v137, v138
    v_max3_u32 v11, v11, v139, v140
    v_max3_u32 v11, v11, v141, v142
    v_max_u32 v11, v11, v143
    v_cmp_eq_u32 vcc, -1, v11
    s_cbranch_vccz La_pollo
    s_sleep 24
    s_add_u32 s42, s42, 1
    s_cmp_lt_u32 s42, 400000
    s_cbranch_scc1 La_poll
La_pollo:
    v_lshl_add_u32 v10, v5, 7, v3
    v_mul_u32_u24 v10, 4224, v10
    v_lshl_add_u32 v10, v4, 3, v10
    s_lshl_b32 s20, s12, 6
    s_add_u32 s20, s20, 0x3600000
    buffer_load_dwordx2 v[96:97], v10, s[8:11], s20 offen sc1
    buffer_load_dwordx2 v[98:99], v10, s[8:11], s20 offen offset:32 sc1
    s_add_u32 s20, s20, 67584
    buffer_load_dwordx2 v[100:101], v10, s[8:11], s20 offen sc1
    buffer_load_dwordx2 v[102:103], v10, s[8:11], s20 offen offset:32 sc1
    s_add_u32 s20, s20, 67584
    buffer_load_dwordx2 v[104:105], v10, s[8:11], s20 offen sc1
    buffer_load_dwordx2 v[106:107], v10, s[8:11], s20 offen offset:32 sc1
    s_add_u32 s20, s20, 67584
    buffer_load_dwordx2 v[108:109], v10, s[8:11], s20 offen sc1
    buffer_load_dwordx2 v[110:111], v10, s[8:11], s20 offen offset:32 sc1
    s_add_u32 s20, s20, 67584
    buffer_load_dwordx2 v[112:113], v10, s[8:11], s20 offen sc1
    buffer_load_dwordx2 v[114:115], v10, s[8:11], s20 offen offset:32 sc1
    s_add_u32 s20, s20, 67584
    buffer_load_dwordx2 v[116:117], v10, s[8:11], s20 offen sc1
    buffer_load_dwordx2 v[118:119], v10, s[8:11], s20 offen offset:32 sc1
    s_add_u32 s20, s20, 67584
    buffer_load_dwordx2 v[120:121], v10, s[8:11], s20 offen sc1
    buffer_load_dwordx2 v[122:123], v10, s[8:11], s20 offen offset:32 sc1
    s_add_u32 s20, s20, 67584
    buffer_load_dwordx2 v[124:125], v10, s[8:11], s20 offen sc1
    buffer_load_dwordx2 v[126:127], v10, s[8:11], s20 offen offset:32 sc1
    s_add_u32 s20, s20, 67584
    s_mov_b32 s38, 0x3db504f3
    s_mov_b32 s39, 0x3fb8aa3b
    s_waitcnt vmcnt(16)
    v_mfma_f32_16x16x32_bf16 v[144:147], v[80:83], v[16:19], 0
    v_mfma_f32_16x16x32_bf16 v[148:151], v[48:51], v[16:19], 0
    v_mfma_f32_16x16x32_bf16 v[152:155], v[64:67], v[16:19], 0
    v_mfma_f32_16x16x32_bf16 v[156:159], v[80:83], v[32:35], 0
    v_mfma_f32_16x16x32_bf16 v[160:163], v[48:51], v[32:35], 0
    v_mfma_f32_16x16x32_bf16 v[164:167], v[64:67], v[32:35], 0
    v_mfma_f32_16x16x32_bf16 v[144:147], v[84:87], v[20:23], v[144:147]
    v_mfma_f32_16x16x32_bf16 v[148:151], v[52:55], v[20:23], v[148:151]
    v_mfma_f32_16x16x32_bf16 v[152:155], v[68:71], v[20:23], v[152:155]
    v_mfma_f32_16x16x32_bf16 v[156:159], v[84:87], v[36:39], v[156:159]
    v_mfma_f32_16x16x32_bf16 v[160:163], v[52:55], v[36:39], v[160:163]
    v_mfma_f32_16x16x32_bf16 v[164:167], v[68:71], v[36:39], v[164:167]
    v_mfma_f32_16x16x32_bf16 v[144:147], v[88:91], v[24:27], v[144:147]
    v_mfma_f32_16x16x32_bf16 v[148:151], v[56:59], v[24:27], v[148:151]
    v_mfma_f32_16x16x32_bf16 v[152:155], v[72:75], v[24:27], v[152:155]
    v_mfma_f32_16x16x32_bf16 v[156:159], v[88:91], v[40:43], v[156:159]
    v_mfma_f32_16x16x32_bf16 v[160:163], v[56:59], v[40:43], v[160:163]
    v_mfma_f32_16x16x32_bf16 v[164:167], v[72:75], v[40:43], v[164:167]
    v_mfma_f32_16x16x32_bf16 v[144:147], v[92:95], v[28:31], v[144:147]
    v_mfma_f32_16x16x32_bf16 v[148:151], v[60:63], v[28:31], v[148:151]
    v_mfma_f32_16x16x32_bf16 v[152:155], v[76:79], v[28:31], v[152:155]
    v_mfma_f32_16x16x32_bf16 v[156:159], v[92:95], v[44:47], v[156:159]
    v_mfma_f32_16x16x32_bf16 v[160:163], v[60:63], v[44:47], v[160:163]
    v_mfma_f32_16x16x32_bf16 v[164:167], v[76:79], v[44:47], v[164:167]
    s_nop 7
    v_cvt_pk_bf16_f32 v6, v144, v145
    v_lshlrev_b32 v144, 16, v6
    v_and_b32 v145, 0xffff0000, v6
    v_mul_f32 v144, s38, v144
    v_mul_f32 v145, s38, v145
    v_cvt_pk_bf16_f32 v6, v144, v145
    v_lshlrev_b32 v144, 16, v6
    v_and_b32 v145, 0xffff0000, v6
    v_cvt_pk_bf16_f32 v6, v146, v147
    v_lshlrev_b32 v146, 16, v6
    v_and_b32 v147, 0xffff0000, v6
    v_mul_f32 v146, s38, v146
    v_mul_f32 v147, s38, v147
    v_cvt_pk_bf16_f32 v6, v146, v147
    v_lshlrev_b32 v146, 16, v6
    v_and_b32 v147, 0xffff0000, v6
    v_cvt_pk_bf16_f32 v6, v148, v149
    v_lshlrev_b32 v148, 16, v6
    v_and_b32 v149, 0xffff0000, v6
    v_mul_f32 v148, s38, v148
    v_mul_f32 v149, s38, v149
    v_cvt_pk_bf16_f32 v6, v148, v149
    v_lshlrev_b32 v148, 16, v6
    v_and_b32 v149, 0xffff0000, v6
    v_cvt_pk_bf16_f32 v6, v150, v151
    v_lshlrev_b32 v150, 16, v6
    v_and_b32 v151, 0xffff0000, v6
    v_mul_f32 v150, s38, v150
    v_mul_f32 v151, s38, v151
    v_cvt_pk_bf16_f32 v6, v150, v151
    v_lshlrev_b32 v150, 16, v6
    v_and_b32 v151, 0xffff0000, v6
    v_cvt_pk_bf16_f32 v6, v152, v153
    v_lshlrev_b32 v152, 16, v6
    v_and_b32 v153, 0xffff0000, v6
    v_mul_f32 v152, s38, v152
    v_mul_f32 v153, s38, v153
    v_cvt_pk_bf16_f32 v6, v152, v153
    v_lshlrev_b32 v152, 16, v6
    v_and_b32 v153, 0xffff0000, v6
    v_cvt_pk_bf16_f32 v6, v154, v155
    v_lshlrev_b32 v154, 16, v6
    v_and_b32 v155, 0xffff0000, v6
    v_mul_f32 v154, s38, v154
    v_mul_f32 v155, s38, v155
    v_cvt_pk_bf16_f32 v6, v154, v155
    v_lshlrev_b32 v154, 16, v6
    v_and_b32 v155, 0xffff0000, v6
    s_mov_b32 exec_lo, 0
    v_mov_b32 v144, 0xff800000
    v_mov_b32 v145, 0xff800000
    v_mov_b32 v146, 0xff800000
    v_mov_b32 v147, 0xff800000
    s_mov_b64 exec, -1
    v_lshlrev_b32 v7, 2, v4
    v_sub_u32 v7, v3, v7
    v_add_u32 v7, 0, v7
    v_mov_b32 v8, 0xff800000
    v_cmp_gt_i32 vcc, 0, v7
    s_nop 1
    v_cndmask_b32 v148, v148, v8, vcc
    v_cmp_gt_i32 vcc, 1, v7
    s_nop 1
    v_cndmask_b32 v149, v149, v8, vcc
    v_cmp_gt_i32 vcc, 2, v7
    s_nop 1
    v_cndmask_b32 v150, v150, v8, vcc
    v_cmp_gt_i32 vcc, 3, v7
    s_nop 1
    v_cndmask_b32 v151, v151, v8, vcc
    v_cmp_gt_i32 vcc, 16, v7
    s_nop 1
    v_cndmask_b32 v152, v152, v8, vcc
    v_cmp_gt_i32 vcc, 17, v7
    s_nop 1
    v_cndmask_b32 v153, v153, v8, vcc
    v_cmp_gt_i32 vcc, 18, v7
    s_nop 1
    v_cndmask_b32 v154, v154, v8, vcc
    v_cmp_gt_i32 vcc, 19, v7
    s_nop 1
    v_cndmask_b32 v155, v155, v8, vcc
    v_max3_f32 v6, v144, v145, v146
    v_max3_f32 v6, v6, v147, v148
    v_max3_f32 v6, v6, v149, v150
    v_max3_f32 v6, v6, v151, v152
    v_max3_f32 v6, v6, v153, v154
    v_max_f32 v6, v6, v155
    v_mov_b32 v7, v6
    s_nop 1
    v_permlane16_swap_b32 v6, v7
    s_nop 0
    v_max_f32 v6, v6, v7
    v_mov_b32 v7, v6
    s_nop 1
    v_permlane32_swap_b32 v6, v7
    s_nop 0
    v_max_f32 v6, v6, v7
    v_sub_f32 v144, v144, v6
    v_mul_f32 v144, s39, v144
    v_exp_f32 v144, v144
    v_sub_f32 v145, v145, v6
    v_mul_f32 v145, s39, v145
    v_exp_f32 v145, v145
    v_sub_f32 v146, v146, v6
    v_mul_f32 v146, s39, v146
    v_exp_f32 v146, v146
    v_sub_f32 v147, v147, v6
    v_mul_f32 v147, s39, v147
    v_exp_f32 v147, v147
    v_sub_f32 v148, v148, v6
    v_mul_f32 v148, s39, v148
    v_exp_f32 v148, v148
    v_sub_f32 v149, v149, v6
    v_mul_f32 v149, s39, v149
    v_exp_f32 v149, v149
    v_sub_f32 v150, v150, v6
    v_mul_f32 v150, s39, v150
    v_exp_f32 v150, v150
    v_sub_f32 v151, v151, v6
    v_mul_f32 v151, s39, v151
    v_exp_f32 v151, v151
    v_sub_f32 v152, v152, v6
    v_mul_f32 v152, s39, v152
    v_exp_f32 v152, v152
    v_sub_f32 v153, v153, v6
    v_mul_f32 v153, s39, v153
    v_exp_f32 v153, v153
    v_sub_f32 v154, v154, v6
    v_mul_f32 v154, s39, v154
    v_exp_f32 v154, v154
    v_sub_f32 v155, v155, v6
    v_mul_f32 v155, s39, v155
    v_exp_f32 v155, v155
    s_nop 0
    v_add_f32 v6, v144, v145
    v_add_f32 v6, v6, v146
    v_add_f32 v6, v6, v147
    v_add_f32 v6, v6, v148
    v_add_f32 v6, v6, v149
    v_add_f32 v6, v6, v150
    v_add_f32 v6, v6, v151
    v_add_f32 v6, v6, v152
    v_add_f32 v6, v6, v153
    v_add_f32 v6, v6, v154
    v_add_f32 v6, v6, v155
    v_mov_b32 v7, v6
    s_nop 1
    v_permlane16_swap_b32 v6, v7
    s_nop 0
    v_add_f32 v6, v6, v7
    v_mov_b32 v7, v6
    s_nop 1
    v_permlane32_swap_b32 v6, v7
    s_nop 0
    v_add_f32 v6, v6, v7
    v_rcp_f32 v6, v6
    s_nop 0
    v_mul_f32 v144, v144, v6
    v_mul_f32 v145, v145, v6
    v_mul_f32 v146, v146, v6
    v_mul_f32 v147, v147, v6
    v_mul_f32 v148, v148, v6
    v_mul_f32 v149, v149, v6
    v_mul_f32 v150, v150, v6
    v_mul_f32 v151, v151, v6
    v_mul_f32 v152, v152, v6
    v_mul_f32 v153, v153, v6
    v_mul_f32 v154, v154, v6
    v_mul_f32 v155, v155, v6
    v_cvt_pk_bf16_f32 v176, v144, v145
    v_cvt_pk_bf16_f32 v177, v146, v147
    v_cvt_pk_bf16_f32 v168, v148, v149
    v_cvt_pk_bf16_f32 v169, v150, v151
    v_cvt_pk_bf16_f32 v170, v152, v153
    v_cvt_pk_bf16_f32 v171, v154, v155
    v_cvt_pk_bf16_f32 v6, v156, v157
    v_lshlrev_b32 v156, 16, v6
    v_and_b32 v157, 0xffff0000, v6
    v_mul_f32 v156, s38, v156
    v_mul_f32 v157, s38, v157
    v_cvt_pk_bf16_f32 v6, v156, v157
    v_lshlrev_b32 v156, 16, v6
    v_and_b32 v157, 0xffff0000, v6
    v_cvt_pk_bf16_f32 v6, v158, v159
    v_lshlrev_b32 v158, 16, v6
    v_and_b32 v159, 0xffff0000, v6
    v_mul_f32 v158, s38, v158
    v_mul_f32 v159, s38, v159
    v_cvt_pk_bf16_f32 v6, v158, v159
    v_lshlrev_b32 v158, 16, v6
    v_and_b32 v159, 0xffff0000, v6
    v_cvt_pk_bf16_f32 v6, v160, v161
    v_lshlrev_b32 v160, 16, v6
    v_and_b32 v161, 0xffff0000, v6
    v_mul_f32 v160, s38, v160
    v_mul_f32 v161, s38, v161
    v_cvt_pk_bf16_f32 v6, v160, v161
    v_lshlrev_b32 v160, 16, v6
    v_and_b32 v161, 0xffff0000, v6
    v_cvt_pk_bf16_f32 v6, v162, v163
    v_lshlrev_b32 v162, 16, v6
    v_and_b32 v163, 0xffff0000, v6
    v_mul_f32 v162, s38, v162
    v_mul_f32 v163, s38, v163
    v_cvt_pk_bf16_f32 v6, v162, v163
    v_lshlrev_b32 v162, 16, v6
    v_and_b32 v163, 0xffff0000, v6
    v_cvt_pk_bf16_f32 v6, v164, v165
    v_lshlrev_b32 v164, 16, v6
    v_and_b32 v165, 0xffff0000, v6
    v_mul_f32 v164, s38, v164
    v_mul_f32 v165, s38, v165
    v_cvt_pk_bf16_f32 v6, v164, v165
    v_lshlrev_b32 v164, 16, v6
    v_and_b32 v165, 0xffff0000, v6
    v_cvt_pk_bf16_f32 v6, v166, v167
    v_lshlrev_b32 v166, 16, v6
    v_and_b32 v167, 0xffff0000, v6
    v_mul_f32 v166, s38, v166
    v_mul_f32 v167, s38, v167
    v_cvt_pk_bf16_f32 v6, v166, v167
    v_lshlrev_b32 v166, 16, v6
    v_and_b32 v167, 0xffff0000, v6
    s_mov_b32 exec_lo, 0
    v_mov_b32 v156, 0xff800000
    v_mov_b32 v157, 0xff800000
    v_mov_b32 v158, 0xff800000
    v_mov_b32 v159, 0xff800000
    s_mov_b64 exec, -1
    v_lshlrev_b32 v7, 2, v4
    v_sub_u32 v7, v3, v7
    v_add_u32 v7, 16, v7
    v_mov_b32 v8, 0xff800000
    v_cmp_gt_i32 vcc, 0, v7
    s_nop 1
    v_cndmask_b32 v160, v160, v8, vcc
    v_cmp_gt_i32 vcc, 1, v7
    s_nop 1
    v_cndmask_b32 v161, v161, v8, vcc
    v_cmp_gt_i32 vcc, 2, v7
    s_nop 1
    v_cndmask_b32 v162, v162, v8, vcc
    v_cmp_gt_i32 vcc, 3, v7
    s_nop 1
    v_cndmask_b32 v163, v163, v8, vcc
    v_cmp_gt_i32 vcc, 16, v7
    s_nop 1
    v_cndmask_b32 v164, v164, v8, vcc
    v_cmp_gt_i32 vcc, 17, v7
    s_nop 1
    v_cndmask_b32 v165, v165, v8, vcc
    v_cmp_gt_i32 vcc, 18, v7
    s_nop 1
    v_cndmask_b32 v166, v166, v8, vcc
    v_cmp_gt_i32 vcc, 19, v7
    s_nop 1
    v_cndmask_b32 v167, v167, v8, vcc
    v_max3_f32 v6, v156, v157, v158
    v_max3_f32 v6, v6, v159, v160
    v_max3_f32 v6, v6, v161, v162
    v_max3_f32 v6, v6, v163, v164
    v_max3_f32 v6, v6, v165, v166
    v_max_f32 v6, v6, v167
    v_mov_b32 v7, v6
    s_nop 1
    v_permlane16_swap_b32 v6, v7
    s_nop 0
    v_max_f32 v6, v6, v7
    v_mov_b32 v7, v6
    s_nop 1
    v_permlane32_swap_b32 v6, v7
    s_nop 0
    v_max_f32 v6, v6, v7
    v_sub_f32 v156, v156, v6
    v_mul_f32 v156, s39, v156
    v_exp_f32 v156, v156
    v_sub_f32 v157, v157, v6
    v_mul_f32 v157, s39, v157
    v_exp_f32 v157, v157
    v_sub_f32 v158, v158, v6
    v_mul_f32 v158, s39, v158
    v_exp_f32 v158, v158
    v_sub_f32 v159, v159, v6
    v_mul_f32 v159, s39, v159
    v_exp_f32 v159, v159
    v_sub_f32 v160, v160, v6
    v_mul_f32 v160, s39, v160
    v_exp_f32 v160, v160
    v_sub_f32 v161, v161, v6
    v_mul_f32 v161, s39, v161
    v_exp_f32 v161, v161
    v_sub_f32 v162, v162, v6
    v_mul_f32 v162, s39, v162
    v_exp_f32 v162, v162
    v_sub_f32 v163, v163, v6
    v_mul_f32 v163, s39, v163
    v_exp_f32 v163, v163
    v_sub_f32 v164, v164, v6
    v_mul_f32 v164, s39, v164
    v_exp_f32 v164, v164
    v_sub_f32 v165, v165, v6
    v_mul_f32 v165, s39, v165
    v_exp_f32 v165, v165
    v_sub_f32 v166, v166, v6
    v_mul_f32 v166, s39, v166
    v_exp_f32 v166, v166
    v_sub_f32 v167, v167, v6
    v_mul_f32 v167, s39, v167
    v_exp_f32 v167, v167
    s_nop 0
    v_add_f32 v6, v156, v157
    v_add_f32 v6, v6, v158
    v_add_f32 v6, v6, v159
    v_add_f32 v6, v6, v160
    v_add_f32 v6, v6, v161
    v_add_f32 v6, v6, v162
    v_add_f32 v6, v6, v163
    v_add_f32 v6, v6, v164
    v_add_f32 v6, v6, v165
    v_add_f32 v6, v6, v166
    v_add_f32 v6, v6, v167
    v_mov_b32 v7, v6
    s_nop 1
    v_permlane16_swap_b32 v6, v7
    s_nop 0
    v_add_f32 v6, v6, v7
    v_mov_b32 v7, v6
    s_nop 1
    v_permlane32_swap_b32 v6, v7
    s_nop 0
    v_add_f32 v6, v6, v7
    v_rcp_f32 v6, v6
    s_nop 0
    v_mul_f32 v156, v156, v6
    v_mul_f32 v157, v157, v6
    v_mul_f32 v158, v158, v6
    v_mul_f32 v159, v159, v6
    v_mul_f32 v160, v160, v6
    v_mul_f32 v161, v161, v6
    v_mul_f32 v162, v162, v6
    v_mul_f32 v163, v163, v6
    v_mul_f32 v164, v164, v6
    v_mul_f32 v165, v165, v6
    v_mul_f32 v166, v166, v6
    v_mul_f32 v167, v167, v6
    v_cvt_pk_bf16_f32 v178, v156, v157
    v_cvt_pk_bf16_f32 v179, v158, v159
    v_cvt_pk_bf16_f32 v172, v160, v161
    v_cvt_pk_bf16_f32 v173, v162, v163
    v_cvt_pk_bf16_f32 v174, v164, v165
    v_cvt_pk_bf16_f32 v175, v166, v167
    s_waitcnt vmcnt(0)
    s_nop 1
    v_mfma_f32_16x16x32_bf16 v[180:183], v[96:99], v[168:171], 0
    v_mfma_f32_16x16x32_bf16 v[184:187], v[96:99], v[172:175], 0
    v_mfma_f32_16x16x32_bf16 v[188:191], v[100:103], v[168:171], 0
    v_mfma_f32_16x16x32_bf16 v[192:195], v[100:103], v[172:175], 0
    v_mfma_f32_16x16x32_bf16 v[196:199], v[104:107], v[168:171], 0
    v_mfma_f32_16x16x32_bf16 v[200:203], v[104:107], v[172:175], 0
    v_mfma_f32_16x16x32_bf16 v[204:207], v[108:111], v[168:171], 0
    v_mfma_f32_16x16x32_bf16 v[208:211], v[108:111], v[172:175], 0
    v_mfma_f32_16x16x32_bf16 v[212:215], v[112:115], v[168:171], 0
    v_mfma_f32_16x16x32_bf16 v[216:219], v[112:115], v[172:175], 0
    v_mfma_f32_16x16x32_bf16 v[220:223], v[116:119], v[168:171], 0
    v_mfma_f32_16x16x32_bf16 v[224:227], v[116:119], v[172:175], 0
    v_mfma_f32_16x16x32_bf16 v[228:231], v[120:123], v[168:171], 0
    v_mfma_f32_16x16x32_bf16 v[232:235], v[120:123], v[172:175], 0
    v_mfma_f32_16x16x32_bf16 v[236:239], v[124:127], v[168:171], 0
    v_mfma_f32_16x16x32_bf16 v[240:243], v[124:127], v[172:175], 0
    v_mfma_f32_16x16x16_bf16 v[180:183], v[128:129], v[176:177], v[180:183]
    v_mfma_f32_16x16x16_bf16 v[184:187], v[128:129], v[178:179], v[184:187]
    v_mfma_f32_16x16x16_bf16 v[188:191], v[130:131], v[176:177], v[188:191]
    v_mfma_f32_16x16x16_bf16 v[192:195], v[130:131], v[178:179], v[192:195]
    v_mfma_f32_16x16x16_bf16 v[196:199], v[132:133], v[176:177], v[196:199]
    v_mfma_f32_16x16x16_bf16 v[200:203], v[132:133], v[178:179], v[200:203]
    v_mfma_f32_16x16x16_bf16 v[204:207], v[134:135], v[176:177], v[204:207]
    v_mfma_f32_16x16x16_bf16 v[208:211], v[134:135], v[178:179], v[208:211]
    v_mfma_f32_16x16x16_bf16 v[212:215], v[136:137], v[176:177], v[212:215]
    v_mfma_f32_16x16x16_bf16 v[216:219], v[136:137], v[178:179], v[216:219]
    v_mfma_f32_16x16x16_bf16 v[220:223], v[138:139], v[176:177], v[220:223]
    v_mfma_f32_16x16x16_bf16 v[224:227], v[138:139], v[178:179], v[224:227]
    v_mfma_f32_16x16x16_bf16 v[228:231], v[140:141], v[176:177], v[228:231]
    v_mfma_f32_16x16x16_bf16 v[232:235], v[140:141], v[178:179], v[232:235]
    v_mfma_f32_16x16x16_bf16 v[236:239], v[142:143], v[176:177], v[236:239]
    v_mfma_f32_16x16x16_bf16 v[240:243], v[142:143], v[178:179], v[240:243]
    v_lshrrev_b32 v7, 1, v4
    v_xor_b32 v6, v3, v7
    v_lshlrev_b32 v6, 4, v6
    v_and_b32 v7, 1, v4
    v_lshl_add_u32 v6, v7, 3, v6
    v_lshl_add_u32 v6, v3, 8, v6
    v_lshl_add_u32 v6, v2, 13, v6
    v_lshrrev_b32 v7, 4, v1
    v_add_u32 v8, 0, v7
    v_xor_b32 v16, v8, v3
    v_lshlrev_b32 v16, 4, v16
    v_lshl_add_u32 v16, v8, 8, v16
    v_lshl_add_u32 v16, v2, 13, v16
    v_add_u32 v8, 4, v7
    v_xor_b32 v17, v8, v3
    v_lshlrev_b32 v17, 4, v17
    v_lshl_add_u32 v17, v8, 8, v17
    v_lshl_add_u32 v17, v2, 13, v17
    v_add_u32 v8, 8, v7
    v_xor_b32 v18, v8, v3
    v_lshlrev_b32 v18, 4, v18
    v_lshl_add_u32 v18, v8, 8, v18
    v_lshl_add_u32 v18, v2, 13, v18
    v_add_u32 v8, 12, v7
    v_xor_b32 v19, v8, v3
    v_lshlrev_b32 v19, 4, v19
    v_lshl_add_u32 v19, v8, 8, v19
    v_lshl_add_u32 v19, v2, 13, v19
    v_mul_u32_u24 v9, 8320, v7
    v_lshl_add_u32 v9, v5, 8, v9
    v_lshl_add_u32 v9, v3, 4, v9
    s_mul_i32 s14, s12, 266240
    s_add_u32 s14, s14, 0x4700000
    s_nop 3
    v_xor_b32 v8, 0, v6
    v_cvt_pk_bf16_f32 v144, v180, v181
    v_cvt_pk_bf16_f32 v145, v182, v183
    ds_write_b64 v8, v[144:145] offset:0
    v_cvt_pk_bf16_f32 v146, v184, v185
    v_cvt_pk_bf16_f32 v147, v186, v187
    ds_write_b64 v8, v[146:147] offset:4096
    v_xor_b32 v8, 32, v6
    v_cvt_pk_bf16_f32 v148, v188, v189
    v_cvt_pk_bf16_f32 v149, v190, v191
    ds_write_b64 v8, v[148:149] offset:0
    v_cvt_pk_bf16_f32 v150, v192, v193
    v_cvt_pk_bf16_f32 v151, v194, v195
    ds_write_b64 v8, v[150:151] offset:4096
    v_xor_b32 v8, 64, v6
    v_cvt_pk_bf16_f32 v152, v196, v197
    v_cvt_pk_bf16_f32 v153, v198, v199
    ds_write_b64 v8, v[152:153] offset:0
    v_cvt_pk_bf16_f32 v154, v200, v201
    v_cvt_pk_bf16_f32 v155, v202, v203
    ds_write_b64 v8, v[154:155] offset:4096
    v_xor_b32 v8, 96, v6
    v_cvt_pk_bf16_f32 v156, v204, v205
    v_cvt_pk_bf16_f32 v157, v206, v207
    ds_write_b64 v8, v[156:157] offset:0
    v_cvt_pk_bf16_f32 v158, v208, v209
    v_cvt_pk_bf16_f32 v159, v210, v211
    ds_write_b64 v8, v[158:159] offset:4096
    v_xor_b32 v8, 128, v6
    v_cvt_pk_bf16_f32 v160, v212, v213
    v_cvt_pk_bf16_f32 v161, v214, v215
    ds_write_b64 v8, v[160:161] offset:0
    v_cvt_pk_bf16_f32 v162, v216, v217
    v_cvt_pk_bf16_f32 v163, v218, v219
    ds_write_b64 v8, v[162:163] offset:4096
    v_xor_b32 v8, 160, v6
    v_cvt_pk_bf16_f32 v164, v220, v221
    v_cvt_pk_bf16_f32 v165, v222, v223
    ds_write_b64 v8, v[164:165] offset:0
    v_cvt_pk_bf16_f32 v166, v224, v225
    v_cvt_pk_bf16_f32 v167, v226, v227
    ds_write_b64 v8, v[166:167] offset:4096
    v_xor_b32 v8, 192, v6
    v_cvt_pk_bf16_f32 v144, v228, v229
    v_cvt_pk_bf16_f32 v145, v230, v231
    ds_write_b64 v8, v[144:145] offset:0
    v_cvt_pk_bf16_f32 v146, v232, v233
    v_cvt_pk_bf16_f32 v147, v234, v235
    ds_write_b64 v8, v[146:147] offset:4096
    v_xor_b32 v8, 224, v6
    v_cvt_pk_bf16_f32 v148, v236, v237
    v_cvt_pk_bf16_f32 v149, v238, v239
    ds_write_b64 v8, v[148:149] offset:0
    v_cvt_pk_bf16_f32 v150, v240, v241
    v_cvt_pk_bf16_f32 v151, v242, v243
    ds_write_b64 v8, v[150:151] offset:4096
    s_waitcnt lgkmcnt(0)
    ds_read_b128 v[48:51], v16 offset:0
    ds_read_b128 v[52:55], v17 offset:0
    ds_read_b128 v[56:59], v18 offset:0
    ds_read_b128 v[60:63], v19 offset:0
    ds_read_b128 v[64:67], v16 offset:4096
    ds_read_b128 v[68:71], v17 offset:4096
    ds_read_b128 v[72:75], v18 offset:4096
    ds_read_b128 v[76:79], v19 offset:4096
    s_waitcnt lgkmcnt(7)
    buffer_store_dwordx4 v[48:51], v9, s[8:11], s14 offen sc1
    s_add_u32 s14, s14, 33280
    s_waitcnt lgkmcnt(6)
    buffer_store_dwordx4 v[52:55], v9, s[8:11], s14 offen sc1
    s_add_u32 s14, s14, 33280
    s_waitcnt lgkmcnt(5)
    buffer_store_dwordx4 v[56:59], v9, s[8:11], s14 offen sc1
    s_add_u32 s14, s14, 33280
    s_waitcnt lgkmcnt(4)
    buffer_store_dwordx4 v[60:63], v9, s[8:11], s14 offen sc1
    s_add_u32 s14, s14, 33280
    s_waitcnt lgkmcnt(3)
    buffer_store_dwordx4 v[64:67], v9, s[8:11], s14 offen sc1
    s_add_u32 s14, s14, 33280
    s_waitcnt lgkmcnt(2)
    buffer_store_dwordx4 v[68:71], v9, s[8:11], s14 offen sc1
    s_add_u32 s14, s14, 33280
    s_waitcnt lgkmcnt(1)
    buffer_store_dwordx4 v[72:75], v9, s[8:11], s14 offen sc1
    s_add_u32 s14, s14, 33280
    s_waitcnt lgkmcnt(0)
    buffer_store_dwordx4 v[76:79], v9, s[8:11], s14 offen sc1
    s_add_u32 s14, s14, 33280
    s_lshr_b32 s41, s12, 1
    s_lshl_b32 s41, s41, 7
    s_add_u32 s41, s41, 0x9f01000
    s_waitcnt vmcnt(0)
    s_barrier
    s_cmp_lg_u32 s40, 0
    s_cbranch_scc1 Lrel_26
    s_mov_b64 exec, 1
    v_mov_b32 v6, 1
    v_mov_b32 v7, 0
    buffer_atomic_add v6, v7, s[8:11], s41 offen sc1
    s_waitcnt vmcnt(0)
    s_mov_b64 exec, -1
Lrel_26:
    s_endpgm
Lout_entry:
    s_load_dwordx2 s[4:5], s[0:1], 104
    s_load_dwordx2 s[6:7], s[0:1], 88
    s_waitcnt lgkmcnt(0)
    s_mov_b32 s8, s4
    s_and_b32 s9, s5, 0xffff
    s_mov_b32 s10, 0x10000000
    s_mov_b32 s11, 0x00020000
    s_mov_b32 s12, s6
    s_and_b32 s13, s7, 0xffff
    s_mov_b32 s14, 0x280000
    s_mov_b32 s15, 0x00020000
    v_and_b32 v1, 63, v0
    v_lshrrev_b32 v2, 6, v0
    v_and_b32 v3, 15, v0
    v_bfe_u32 v4, v0, 4, 2
    s_mul_i32 s18, s17, 80
    s_mul_i32 s19, s16, 64
    v_mul_u32_u24 v6, 2048, v2
    v_lshl_add_u32 v6, v4, 4, v6
    v_add_u32 v7, s18, v3
    v_add_u32 v7, 0, v7
    v_mul_u32_u24 v7, 8320, v7
    v_add_u32 v14, v7, v6
    v_add_u32 v7, s18, v3
    v_add_u32 v7, 16, v7
    v_mul_u32_u24 v7, 8320, v7
    v_add_u32 v15, v7, v6
    v_add_u32 v7, s18, v3
    v_add_u32 v7, 32, v7
    v_mul_u32_u24 v7, 8320, v7
    v_add_u32 v16, v7, v6
    v_add_u32 v7, s18, v3
    v_add_u32 v7, 48, v7
    v_mul_u32_u24 v7, 8320, v7
    v_add_u32 v17, v7, v6
    v_add_u32 v7, s18, v3
    v_add_u32 v7, 64, v7
    v_mul_u32_u24 v7, 8320, v7
    v_add_u32 v18, v7, v6
    v_add_u32 v7, s19, v3
    v_add_u32 v7, 0, v7
    v_mul_u32_u24 v7, 8320, v7
    v_add_u32 v19, v7, v6
    v_add_u32 v7, s19, v3
    v_add_u32 v7, 16, v7
    v_mul_u32_u24 v7, 8320, v7
    v_add_u32 v20, v7, v6
    v_add_u32 v7, s19, v3
    v_add_u32 v7, 32, v7
    v_mul_u32_u24 v7, 8320, v7
    v_add_u32 v21, v7, v6
    v_add_u32 v7, s19, v3
    v_add_u32 v7, 48, v7
    v_mul_u32_u24 v7, 8320, v7
    v_add_u32 v22, v7, v6
    v_mul_u32_u24 v6, 384, v2
    v_lshl_add_u32 v6, v4, 4, v6
    v_add_u32 v7, s18, v3
    v_add_u32 v7, 0, v7
    v_mul_u32_u24 v7, 1536, v7
    v_add_u32 v23, v7, v6
    v_add_u32 v7, s18, v3
    v_add_u32 v7, 16, v7
    v_mul_u32_u24 v7, 1536, v7
    v_add_u32 v24, v7, v6
    v_add_u32 v7, s18, v3
    v_add_u32 v7, 32, v7
    v_mul_u32_u24 v7, 1536, v7
    v_add_u32 v25, v7, v6
    v_add_u32 v7, s18, v3
    v_add_u32 v7, 48, v7
    v_mul_u32_u24 v7, 1536, v7
    v_add_u32 v26, v7, v6
    v_add_u32 v7, s18, v3
    v_add_u32 v7, 64, v7
    v_mul_u32_u24 v7, 1536, v7
    v_add_u32 v27, v7, v6
    v_add_u32 v7, s19, v3
    v_add_u32 v7, 0, v7
    v_mul_u32_u24 v7, 1536, v7
    v_add_u32 v28, v7, v6
    v_add_u32 v7, s19, v3
    v_add_u32 v7, 16, v7
    v_mul_u32_u24 v7, 1536, v7
    v_add_u32 v29, v7, v6
    v_add_u32 v7, s19, v3
    v_add_u32 v7, 32, v7
    v_mul_u32_u24 v7, 1536, v7
    v_add_u32 v30, v7, v6
    v_add_u32 v7, s19, v3
    v_add_u32 v7, 48, v7
    v_mul_u32_u24 v7, 1536, v7
    v_add_u32 v31, v7, v6
    s_mov_b32 s20, 0xf00000
    s_mov_b32 s21, 0x4700000
    s_mov_b32 s22, 0x9c00000
    s_mov_b32 s23, 0x9d00000
    s_mov_b32 s24, 0x9600000
    s_mov_b32 s25, 0x9900000
    s_mov_b32 s27, 0x9f00800
    v_readfirstlane_b32 s40, v2
    s_nop 2
    s_cmp_lg_u32 s40, 0
    s_cbranch_scc1 Lwo_28
    s_mov_b32 s28, 0
    v_mov_b32 v7, 0
    s_mov_b64 exec, 1
Lwc_27:
    buffer_load_dword v6, v7, s[8:11], s27 offen sc1
    s_waitcnt vmcnt(0)
    v_cmp_le_u32 vcc, 81, v6
    s_cbranch_vccnz Lwo_28x
    s_sleep 48
    s_add_u32 s28, s28, 1
    s_cmp_lt_u32 s28, 400000
    s_cbranch_scc1 Lwc_27
Lwo_28x:
    s_mov_b64 exec, -1
Lwo_28:
    s_barrier
    buffer_load_dwordx4 v[40:43], v23, s[8:11], s22 offen offset:0
    buffer_load_dwordx4 v[44:47], v24, s[8:11], s22 offen offset:0
    buffer_load_dwordx4 v[48:51], v25, s[8:11], s22 offen offset:0
    buffer_load_dwordx4 v[52:55], v26, s[8:11], s22 offen offset:0
    buffer_load_dwordx4 v[56:59], v27, s[8:11], s22 offen offset:0
    buffer_load_dwordx4 v[60:63], v28, s[8:11], s24 offen offset:0 sc1
    buffer_load_dwordx4 v[64:67], v29, s[8:11], s24 offen offset:0 sc1
    buffer_load_dwordx4 v[68:71], v30, s[8:11], s24 offen offset:0 sc1
    buffer_load_dwordx4 v[72:75], v31, s[8:11], s24 offen offset:0 sc1
    buffer_load_dwordx4 v[76:79], v23, s[8:11], s23 offen offset:0
    buffer_load_dwordx4 v[80:83], v24, s[8:11], s23 offen offset:0
    buffer_load_dwordx4 v[84:87], v25, s[8:11], s23 offen offset:0
    buffer_load_dwordx4 v[88:91], v26, s[8:11], s23 offen offset:0
    buffer_load_dwordx4 v[92:95], v27, s[8:11], s23 offen offset:0
    buffer_load_dwordx4 v[96:99], v28, s[8:11], s25 offen offset:0 sc1
    buffer_load_dwordx4 v[100:103], v29, s[8:11], s25 offen offset:0 sc1
    buffer_load_dwordx4 v[104:107], v30, s[8:11], s25 offen offset:0 sc1
    buffer_load_dwordx4 v[108:111], v31, s[8:11], s25 offen offset:0 sc1
    buffer_load_dwordx4 v[112:115], v23, s[8:11], s22 offen offset:64
    buffer_load_dwordx4 v[116:119], v24, s[8:11], s22 offen offset:64
    buffer_load_dwordx4 v[120:123], v25, s[8:11], s22 offen offset:64
    buffer_load_dwordx4 v[124:127], v26, s[8:11], s22 offen offset:64
    buffer_load_dwordx4 v[128:131], v27, s[8:11], s22 offen offset:64
    buffer_load_dwordx4 v[132:135], v28, s[8:11], s24 offen offset:64 sc1
    buffer_load_dwordx4 v[136:139], v29, s[8:11], s24 offen offset:64 sc1
    buffer_load_dwordx4 v[140:143], v30, s[8:11], s24 offen offset:64 sc1
    buffer_load_dwordx4 v[144:147], v31, s[8:11], s24 offen offset:64 sc1
    v_lshl_add_u32 v6, v2, 4, v3
    v_add_u32 v6, s19, v6
    v_mul_u32_u24 v35, 1280, v6
    v_lshlrev_b32 v6, 2, v6
    v_add_u32 v6, 0x9e00000, v6
    v_lshl_add_u32 v35, v4, 3, v35
    s_lshl_b32 s26, s18, 1
    v_add_u32 v35, s26, v35
    v_lshlrev_b32 v32, 4, v1
    v_mul_u32_u24 v7, 5120, v2
    v_mul_u32_u24 v8, 20480, v2
    v_add_u32 v34, v32, v8
    v_add_u32 v32, v32, v7
    v_add_u32 v33, 40960, v32
    s_waitcnt vmcnt(18)
    v_mfma_f32_16x16x32_bf16 a[0:3], v[40:43], v[60:63], 0
    v_mfma_f32_16x16x32_bf16 a[4:7], v[44:47], v[60:63], 0
    v_mfma_f32_16x16x32_bf16 a[8:11], v[48:51], v[60:63], 0
    v_mfma_f32_16x16x32_bf16 a[12:15], v[52:55], v[60:63], 0
    v_mfma_f32_16x16x32_bf16 a[16:19], v[56:59], v[60:63], 0
    v_mfma_f32_16x16x32_bf16 a[20:23], v[40:43], v[64:67], 0
    v_mfma_f32_16x16x32_bf16 a[24:27], v[44:47], v[64:67], 0
    v_mfma_f32_16x16x32_bf16 a[28:31], v[48:51], v[64:67], 0
    v_mfma_f32_16x16x32_bf16 a[32:35], v[52:55], v[64:67], 0
    v_mfma_f32_16x16x32_bf16 a[36:39], v[56:59], v[64:67], 0
    v_mfma_f32_16x16x32_bf16 a[40:43], v[40:43], v[68:71], 0
    v_mfma_f32_16x16x32_bf16 a[44:47], v[44:47], v[68:71], 0
    v_mfma_f32_16x16x32_bf16 a[48:51], v[48:51], v[68:71], 0
    v_mfma_f32_16x16x32_bf16 a[52:55], v[52:55], v[68:71], 0
    v_mfma_f32_16x16x32_bf16 a[56:59], v[56:59], v[68:71], 0
    v_mfma_f32_16x16x32_bf16 a[60:63], v[40:43], v[72:75], 0
    v_mfma_f32_16x16x32_bf16 a[64:67], v[44:47], v[72:75], 0
    v_mfma_f32_16x16x32_bf16 a[68:71], v[48:51], v[72:75], 0
    v_mfma_f32_16x16x32_bf16 a[72:75], v[52:55], v[72:75], 0
    v_mfma_f32_16x16x32_bf16 a[76:79], v[56:59], v[72:75], 0
    buffer_load_dwordx4 v[148:151], v23, s[8:11], s23 offen offset:64
    buffer_load_dwordx4 v[152:155], v24, s[8:11], s23 offen offset:64
    buffer_load_dwordx4 v[156:159], v25, s[8:11], s23 offen offset:64
    buffer_load_dwordx4 v[160:163], v26, s[8:11], s23 offen offset:64
    buffer_load_dwordx4 v[164:167], v27, s[8:11], s23 offen offset:64
    buffer_load_dwordx4 v[168:171], v28, s[8:11], s25 offen offset:64 sc1
    buffer_load_dwordx4 v[172:175], v29, s[8:11], s25 offen offset:64 sc1
    buffer_load_dwordx4 v[176:179], v30, s[8:11], s25 offen offset:64 sc1
    buffer_load_dwordx4 v[180:183], v31, s[8:11], s25 offen offset:64 sc1
    s_waitcnt vmcnt(18)
    v_mfma_f32_16x16x32_bf16 a[0:3], v[76:79], v[60:63], a[0:3]
    v_mfma_f32_16x16x32_bf16 a[4:7], v[80:83], v[60:63], a[4:7]
    v_mfma_f32_16x16x32_bf16 a[8:11], v[84:87], v[60:63], a[8:11]
    v_mfma_f32_16x16x32_bf16 a[12:15], v[88:91], v[60:63], a[12:15]
    v_mfma_f32_16x16x32_bf16 a[16:19], v[92:95], v[60:63], a[16:19]
    v_mfma_f32_16x16x32_bf16 a[20:23], v[76:79], v[64:67], a[20:23]
    v_mfma_f32_16x16x32_bf16 a[24:27], v[80:83], v[64:67], a[24:27]
    v_mfma_f32_16x16x32_bf16 a[28:31], v[84:87], v[64:67], a[28:31]
    v_mfma_f32_16x16x32_bf16 a[32:35], v[88:91], v[64:67], a[32:35]
    v_mfma_f32_16x16x32_bf16 a[36:39], v[92:95], v[64:67], a[36:39]
    v_mfma_f32_16x16x32_bf16 a[40:43], v[76:79], v[68:71], a[40:43]
    v_mfma_f32_16x16x32_bf16 a[44:47], v[80:83], v[68:71], a[44:47]
    v_mfma_f32_16x16x32_bf16 a[48:51], v[84:87], v[68:71], a[48:51]
    v_mfma_f32_16x16x32_bf16 a[52:55], v[88:91], v[68:71], a[52:55]
    v_mfma_f32_16x16x32_bf16 a[56:59], v[92:95], v[68:71], a[56:59]
    v_mfma_f32_16x16x32_bf16 a[60:63], v[76:79], v[72:75], a[60:63]
    v_mfma_f32_16x16x32_bf16 a[64:67], v[80:83], v[72:75], a[64:67]
    v_mfma_f32_16x16x32_bf16 a[68:71], v[84:87], v[72:75], a[68:71]
    v_mfma_f32_16x16x32_bf16 a[72:75], v[88:91], v[72:75], a[72:75]
    v_mfma_f32_16x16x32_bf16 a[76:79], v[92:95], v[72:75], a[76:79]
    v_mfma_f32_16x16x32_bf16 a[0:3], v[40:43], v[96:99], a[0:3]
    v_mfma_f32_16x16x32_bf16 a[4:7], v[44:47], v[96:99], a[4:7]
    v_mfma_f32_16x16x32_bf16 a[8:11], v[48:51], v[96:99], a[8:11]
    v_mfma_f32_16x16x32_bf16 a[12:15], v[52:55], v[96:99], a[12:15]
    v_mfma_f32_16x16x32_bf16 a[16:19], v[56:59], v[96:99], a[16:19]
    v_mfma_f32_16x16x32_bf16 a[20:23], v[40:43], v[100:103], a[20:23]
    v_mfma_f32_16x16x32_bf16 a[24:27], v[44:47], v[100:103], a[24:27]
    v_mfma_f32_16x16x32_bf16 a[28:31], v[48:51], v[100:103], a[28:31]
    v_mfma_f32_16x16x32_bf16 a[32:35], v[52:55], v[100:103], a[32:35]
    v_mfma_f32_16x16x32_bf16 a[36:39], v[56:59], v[100:103], a[36:39]
    v_mfma_f32_16x16x32_bf16 a[40:43], v[40:43], v[104:107], a[40:43]
    v_mfma_f32_16x16x32_bf16 a[44:47], v[44:47], v[104:107], a[44:47]
    v_mfma_f32_16x16x32_bf16 a[48:51], v[48:51], v[104:107], a[48:51]
    v_mfma_f32_16x16x32_bf16 a[52:55], v[52:55], v[104:107], a[52:55]
    v_mfma_f32_16x16x32_bf16 a[56:59], v[56:59], v[104:107], a[56:59]
    v_mfma_f32_16x16x32_bf16 a[60:63], v[40:43], v[108:111], a[60:63]
    v_mfma_f32_16x16x32_bf16 a[64:67], v[44:47], v[108:111], a[64:67]
    v_mfma_f32_16x16x32_bf16 a[68:71], v[48:51], v[108:111], a[68:71]
    v_mfma_f32_16x16x32_bf16 a[72:75], v[52:55], v[108:111], a[72:75]
    v_mfma_f32_16x16x32_bf16 a[76:79], v[56:59], v[108:111], a[76:79]
    buffer_load_dwordx4 v[40:43], v23, s[8:11], s22 offen offset:128
    buffer_load_dwordx4 v[44:47], v24, s[8:11], s22 offen offset:128
    buffer_load_dwordx4 v[48:51], v25, s[8:11], s22 offen offset:128
    buffer_load_dwordx4 v[52:55], v26, s[8:11], s22 offen offset:128
    buffer_load_dwordx4 v[56:59], v27, s[8:11], s22 offen offset:128
    buffer_load_dwordx4 v[60:63], v28, s[8:11], s24 offen offset:128 sc1
    buffer_load_dwordx4 v[64:67], v29, s[8:11], s24 offen offset:128 sc1
    buffer_load_dwordx4 v[68:71], v30, s[8:11], s24 offen offset:128 sc1
    buffer_load_dwordx4 v[72:75], v31, s[8:11], s24 offen offset:128 sc1
    s_waitcnt vmcnt(18)
    v_mfma_f32_16x16x32_bf16 a[0:3], v[112:115], v[132:135], a[0:3]
    v_mfma_f32_16x16x32_bf16 a[4:7], v[116:119], v[132:135], a[4:7]
    v_mfma_f32_16x16x32_bf16 a[8:11], v[120:123], v[132:135], a[8:11]
    v_mfma_f32_16x16x32_bf16 a[12:15], v[124:127], v[132:135], a[12:15]
    v_mfma_f32_16x16x32_bf16 a[16:19], v[128:131], v[132:135], a[16:19]
    v_mfma_f32_16x16x32_bf16 a[20:23], v[112:115], v[136:139], a[20:23]
    v_mfma_f32_16x16x32_bf16 a[24:27], v[116:119], v[136:139], a[24:27]
    v_mfma_f32_16x16x32_bf16 a[28:31], v[120:123], v[136:139], a[28:31]
    v_mfma_f32_16x16x32_bf16 a[32:35], v[124:127], v[136:139], a[32:35]
    v_mfma_f32_16x16x32_bf16 a[36:39], v[128:131], v[136:139], a[36:39]
    v_mfma_f32_16x16x32_bf16 a[40:43], v[112:115], v[140:143], a[40:43]
    v_mfma_f32_16x16x32_bf16 a[44:47], v[116:119], v[140:143], a[44:47]
    v_mfma_f32_16x16x32_bf16 a[48:51], v[120:123], v[140:143], a[48:51]
    v_mfma_f32_16x16x32_bf16 a[52:55], v[124:127], v[140:143], a[52:55]
    v_mfma_f32_16x16x32_bf16 a[56:59], v[128:131], v[140:143], a[56:59]
    v_mfma_f32_16x16x32_bf16 a[60:63], v[112:115], v[144:147], a[60:63]
    v_mfma_f32_16x16x32_bf16 a[64:67], v[116:119], v[144:147], a[64:67]
    v_mfma_f32_16x16x32_bf16 a[68:71], v[120:123], v[144:147], a[68:71]
    v_mfma_f32_16x16x32_bf16 a[72:75], v[124:127], v[144:147], a[72:75]
    v_mfma_f32_16x16x32_bf16 a[76:79], v[128:131], v[144:147], a[76:79]
    buffer_load_dwordx4 v[76:79], v23, s[8:11], s23 offen offset:128
    buffer_load_dwordx4 v[80:83], v24, s[8:11], s23 offen offset:128
    buffer_load_dwordx4 v[84:87], v25, s[8:11], s23 offen offset:128
    buffer_load_dwordx4 v[88:91], v26, s[8:11], s23 offen offset:128
    buffer_load_dwordx4 v[92:95], v27, s[8:11], s23 offen offset:128
    buffer_load_dwordx4 v[96:99], v28, s[8:11], s25 offen offset:128 sc1
    buffer_load_dwordx4 v[100:103], v29, s[8:11], s25 offen offset:128 sc1
    buffer_load_dwordx4 v[104:107], v30, s[8:11], s25 offen offset:128 sc1
    buffer_load_dwordx4 v[108:111], v31, s[8:11], s25 offen offset:128 sc1
    s_waitcnt vmcnt(18)
    v_mfma_f32_16x16x32_bf16 a[0:3], v[148:151], v[132:135], a[0:3]
    v_mfma_f32_16x16x32_bf16 a[4:7], v[152:155], v[132:135], a[4:7]
    v_mfma_f32_16x16x32_bf16 a[8:11], v[156:159], v[132:135], a[8:11]
    v_mfma_f32_16x16x32_bf16 a[12:15], v[160:163], v[132:135], a[12:15]
    v_mfma_f32_16x16x32_bf16 a[16:19], v[164:167], v[132:135], a[16:19]
    v_mfma_f32_16x16x32_bf16 a[20:23], v[148:151], v[136:139], a[20:23]
    v_mfma_f32_16x16x32_bf16 a[24:27], v[152:155], v[136:139], a[24:27]
    v_mfma_f32_16x16x32_bf16 a[28:31], v[156:159], v[136:139], a[28:31]
    v_mfma_f32_16x16x32_bf16 a[32:35], v[160:163], v[136:139], a[32:35]
    v_mfma_f32_16x16x32_bf16 a[36:39], v[164:167], v[136:139], a[36:39]
    v_mfma_f32_16x16x32_bf16 a[40:43], v[148:151], v[140:143], a[40:43]
    v_mfma_f32_16x16x32_bf16 a[44:47], v[152:155], v[140:143], a[44:47]
    v_mfma_f32_16x16x32_bf16 a[48:51], v[156:159], v[140:143], a[48:51]
    v_mfma_f32_16x16x32_bf16 a[52:55], v[160:163], v[140:143], a[52:55]
    v_mfma_f32_16x16x32_bf16 a[56:59], v[164:167], v[140:143], a[56:59]
    v_mfma_f32_16x16x32_bf16 a[60:63], v[148:151], v[144:147], a[60:63]
    v_mfma_f32_16x16x32_bf16 a[64:67], v[152:155], v[144:147], a[64:67]
    v_mfma_f32_16x16x32_bf16 a[68:71], v[156:159], v[144:147], a[68:71]
    v_mfma_f32_16x16x32_bf16 a[72:75], v[160:163], v[144:147], a[72:75]
    v_mfma_f32_16x16x32_bf16 a[76:79], v[164:167], v[144:147], a[76:79]
    v_mfma_f32_16x16x32_bf16 a[0:3], v[112:115], v[168:171], a[0:3]
    v_mfma_f32_16x16x32_bf16 a[4:7], v[116:119], v[168:171], a[4:7]
    v_mfma_f32_16x16x32_bf16 a[8:11], v[120:123], v[168:171], a[8:11]
    v_mfma_f32_16x16x32_bf16 a[12:15], v[124:127], v[168:171], a[12:15]
    v_mfma_f32_16x16x32_bf16 a[16:19], v[128:131], v[168:171], a[16:19]
    v_mfma_f32_16x16x32_bf16 a[20:23], v[112:115], v[172:175], a[20:23]
    v_mfma_f32_16x16x32_bf16 a[24:27], v[116:119], v[172:175], a[24:27]
    v_mfma_f32_16x16x32_bf16 a[28:31], v[120:123], v[172:175], a[28:31]
    v_mfma_f32_16x16x32_bf16 a[32:35], v[124:127], v[172:175], a[32:35]
    v_mfma_f32_16x16x32_bf16 a[36:39], v[128:131], v[172:175], a[36:39]
    v_mfma_f32_16x16x32_bf16 a[40:43], v[112:115], v[176:179], a[40:43]
    v_mfma_f32_16x16x32_bf16 a[44:47], v[116:119], v[176:179], a[44:47]
    v_mfma_f32_16x16x32_bf16 a[48:51], v[120:123], v[176:179], a[48:51]
    v_mfma_f32_16x16x32_bf16 a[52:55], v[124:127], v[176:179], a[52:55]
    v_mfma_f32_16x16x32_bf16 a[56:59], v[128:131], v[176:179], a[56:59]
    v_mfma_f32_16x16x32_bf16 a[60:63], v[112:115], v[180:183], a[60:63]
    v_mfma_f32_16x16x32_bf16 a[64:67], v[116:119], v[180:183], a[64:67]
    v_mfma_f32_16x16x32_bf16 a[68:71], v[120:123], v[180:183], a[68:71]
    v_mfma_f32_16x16x32_bf16 a[72:75], v[124:127], v[180:183], a[72:75]
    v_mfma_f32_16x16x32_bf16 a[76:79], v[128:131], v[180:183], a[76:79]
    buffer_load_dwordx4 v[112:115], v23, s[8:11], s22 offen offset:192
    buffer_load_dwordx4 v[116:119], v24, s[8:11], s22 offen offset:192
    buffer_load_dwordx4 v[120:123], v25, s[8:11], s22 offen offset:192
    buffer_load_dwordx4 v[124:127], v26, s[8:11], s22 offen offset:192
    buffer_load_dwordx4 v[128:131], v27, s[8:11], s22 offen offset:192
    buffer_load_dwordx4 v[132:135], v28, s[8:11], s24 offen offset:192 sc1
    buffer_load_dwordx4 v[136:139], v29, s[8:11], s24 offen offset:192 sc1
    buffer_load_dwordx4 v[140:143], v30, s[8:11], s24 offen offset:192 sc1
    buffer_load_dwordx4 v[144:147], v31, s[8:11], s24 offen offset:192 sc1
    s_waitcnt vmcnt(18)
    v_mfma_f32_16x16x32_bf16 a[0:3], v[40:43], v[60:63], a[0:3]
    v_mfma_f32_16x16x32_bf16 a[4:7], v[44:47], v[60:63], a[4:7]
    v_mfma_f32_16x16x32_bf16 a[8:11], v[48:51], v[60:63], a[8:11]
    v_mfma_f32_16x16x32_bf16 a[12:15], v[52:55], v[60:63], a[12:15]
    v_mfma_f32_16x16x32_bf16 a[16:19], v[56:59], v[60:63], a[16:19]
    v_mfma_f32_16x16x32_bf16 a[20:23], v[40:43], v[64:67], a[20:23]
    v_mfma_f32_16x16x32_bf16 a[24:27], v[44:47], v[64:67], a[24:27]
    v_mfma_f32_16x16x32_bf16 a[28:31], v[48:51], v[64:67], a[28:31]
    v_mfma_f32_16x16x32_bf16 a[32:35], v[52:55], v[64:67], a[32:35]
    v_mfma_f32_16x16x32_bf16 a[36:39], v[56:59], v[64:67], a[36:39]
    v_mfma_f32_16x16x32_bf16 a[40:43], v[40:43], v[68:71], a[40:43]
    v_mfma_f32_16x16x32_bf16 a[44:47], v[44:47], v[68:71], a[44:47]
    v_mfma_f32_16x16x32_bf16 a[48:51], v[48:51], v[68:71], a[48:51]
    v_mfma_f32_16x16x32_bf16 a[52:55], v[52:55], v[68:71], a[52:55]
    v_mfma_f32_16x16x32_bf16 a[56:59], v[56:59], v[68:71], a[56:59]
    v_mfma_f32_16x16x32_bf16 a[60:63], v[40:43], v[72:75], a[60:63]
    v_mfma_f32_16x16x32_bf16 a[64:67], v[44:47], v[72:75], a[64:67]
    v_mfma_f32_16x16x32_bf16 a[68:71], v[48:51], v[72:75], a[68:71]
    v_mfma_f32_16x16x32_bf16 a[72:75], v[52:55], v[72:75], a[72:75]
    v_mfma_f32_16x16x32_bf16 a[76:79], v[56:59], v[72:75], a[76:79]
    buffer_load_dwordx4 v[148:151], v23, s[8:11], s23 offen offset:192
    buffer_load_dwordx4 v[152:155], v24, s[8:11], s23 offen offset:192
    buffer_load_dwordx4 v[156:159], v25, s[8:11], s23 offen offset:192
    buffer_load_dwordx4 v[160:163], v26, s[8:11], s23 offen offset:192
    buffer_load_dwordx4 v[164:167], v27, s[8:11], s23 offen offset:192
    buffer_load_dwordx4 v[168:171], v28, s[8:11], s25 offen offset:192 sc1
    buffer_load_dwordx4 v[172:175], v29, s[8:11], s25 offen offset:192 sc1
    buffer_load_dwordx4 v[176:179], v30, s[8:11], s25 offen offset:192 sc1
    buffer_load_dwordx4 v[180:183], v31, s[8:11], s25 offen offset:192 sc1
    s_waitcnt vmcnt(18)
    v_mfma_f32_16x16x32_bf16 a[0:3], v[76:79], v[60:63], a[0:3]
    v_mfma_f32_16x16x32_bf16 a[4:7], v[80:83], v[60:63], a[4:7]
    v_mfma_f32_16x16x32_bf16 a[8:11], v[84:87], v[60:63], a[8:11]
    v_mfma_f32_16x16x32_bf16 a[12:15], v[88:91], v[60:63], a[12:15]
    v_mfma_f32_16x16x32_bf16 a[16:19], v[92:95], v[60:63], a[16:19]
    v_mfma_f32_16x16x32_bf16 a[20:23], v[76:79], v[64:67], a[20:23]
    v_mfma_f32_16x16x32_bf16 a[24:27], v[80:83], v[64:67], a[24:27]
    v_mfma_f32_16x16x32_bf16 a[28:31], v[84:87], v[64:67], a[28:31]
    v_mfma_f32_16x16x32_bf16 a[32:35], v[88:91], v[64:67], a[32:35]
    v_mfma_f32_16x16x32_bf16 a[36:39], v[92:95], v[64:67], a[36:39]
    v_mfma_f32_16x16x32_bf16 a[40:43], v[76:79], v[68:71], a[40:43]
    v_mfma_f32_16x16x32_bf16 a[44:47], v[80:83], v[68:71], a[44:47]
    v_mfma_f32_16x16x32_bf16 a[48:51], v[84:87], v[68:71], a[48:51]
    v_mfma_f32_16x16x32_bf16 a[52:55], v[88:91], v[68:71], a[52:55]
    v_mfma_f32_16x16x32_bf16 a[56:59], v[92:95], v[68:71], a[56:59]
    v_mfma_f32_16x16x32_bf16 a[60:63], v[76:79], v[72:75], a[60:63]
    v_mfma_f32_16x16x32_bf16 a[64:67], v[80:83], v[72:75], a[64:67]
    v_mfma_f32_16x16x32_bf16 a[68:71], v[84:87], v[72:75], a[68:71]
    v_mfma_f32_16x16x32_bf16 a[72:75], v[88:91], v[72:75], a[72:75]
    v_mfma_f32_16x16x32_bf16 a[76:79], v[92:95], v[72:75], a[76:79]
    v_mfma_f32_16x16x32_bf16 a[0:3], v[40:43], v[96:99], a[0:3]
    v_mfma_f32_16x16x32_bf16 a[4:7], v[44:47], v[96:99], a[4:7]
    v_mfma_f32_16x16x32_bf16 a[8:11], v[48:51], v[96:99], a[8:11]
    v_mfma_f32_16x16x32_bf16 a[12:15], v[52:55], v[96:99], a[12:15]
    v_mfma_f32_16x16x32_bf16 a[16:19], v[56:59], v[96:99], a[16:19]
    v_mfma_f32_16x16x32_bf16 a[20:23], v[40:43], v[100:103], a[20:23]
    v_mfma_f32_16x16x32_bf16 a[24:27], v[44:47], v[100:103], a[24:27]
    v_mfma_f32_16x16x32_bf16 a[28:31], v[48:51], v[100:103], a[28:31]
    v_mfma_f32_16x16x32_bf16 a[32:35], v[52:55], v[100:103], a[32:35]
    v_mfma_f32_16x16x32_bf16 a[36:39], v[56:59], v[100:103], a[36:39]
    v_mfma_f32_16x16x32_bf16 a[40:43], v[40:43], v[104:107], a[40:43]
    v_mfma_f32_16x16x32_bf16 a[44:47], v[44:47], v[104:107], a[44:47]
    v_mfma_f32_16x16x32_bf16 a[48:51], v[48:51], v[104:107], a[48:51]
    v_mfma_f32_16x16x32_bf16 a[52:55], v[52:55], v[104:107], a[52:55]
    v_mfma_f32_16x16x32_bf16 a[56:59], v[56:59], v[104:107], a[56:59]
    v_mfma_f32_16x16x32_bf16 a[60:63], v[40:43], v[108:111], a[60:63]
    v_mfma_f32_16x16x32_bf16 a[64:67], v[44:47], v[108:111], a[64:67]
    v_mfma_f32_16x16x32_bf16 a[68:71], v[48:51], v[108:111], a[68:71]
    v_mfma_f32_16x16x32_bf16 a[72:75], v[52:55], v[108:111], a[72:75]
    v_mfma_f32_16x16x32_bf16 a[76:79], v[56:59], v[108:111], a[76:79]
    buffer_load_dwordx4 v[40:43], v23, s[8:11], s22 offen offset:256
    buffer_load_dwordx4 v[44:47], v24, s[8:11], s22 offen offset:256
    buffer_load_dwordx4 v[48:51], v25, s[8:11], s22 offen offset:256
    buffer_load_dwordx4 v[52:55], v26, s[8:11], s22 offen offset:256
    buffer_load_dwordx4 v[56:59], v27, s[8:11], s22 offen offset:256
    buffer_load_dwordx4 v[60:63], v28, s[8:11], s24 offen offset:256 sc1
    buffer_load_dwordx4 v[64:67], v29, s[8:11], s24 offen offset:256 sc1
    buffer_load_dwordx4 v[68:71], v30, s[8:11], s24 offen offset:256 sc1
    buffer_load_dwordx4 v[72:75], v31, s[8:11], s24 offen offset:256 sc1
    s_waitcnt vmcnt(18)
    v_mfma_f32_16x16x32_bf16 a[0:3], v[112:115], v[132:135], a[0:3]
    v_mfma_f32_16x16x32_bf16 a[4:7], v[116:119], v[132:135], a[4:7]
    v_mfma_f32_16x16x32_bf16 a[8:11], v[120:123], v[132:135], a[8:11]
    v_mfma_f32_16x16x32_bf16 a[12:15], v[124:127], v[132:135], a[12:15]
    v_mfma_f32_16x16x32_bf16 a[16:19], v[128:131], v[132:135], a[16:19]
    v_mfma_f32_16x16x32_bf16 a[20:23], v[112:115], v[136:139], a[20:23]
    v_mfma_f32_16x16x32_bf16 a[24:27], v[116:119], v[136:139], a[24:27]
    v_mfma_f32_16x16x32_bf16 a[28:31], v[120:123], v[136:139], a[28:31]
    v_mfma_f32_16x16x32_bf16 a[32:35], v[124:127], v[136:139], a[32:35]
    v_mfma_f32_16x16x32_bf16 a[36:39], v[128:131], v[136:139], a[36:39]
    v_mfma_f32_16x16x32_bf16 a[40:43], v[112:115], v[140:143], a[40:43]
    v_mfma_f32_16x16x32_bf16 a[44:47], v[116:119], v[140:143], a[44:47]
    v_mfma_f32_16x16x32_bf16 a[48:51], v[120:123], v[140:143], a[48:51]
    v_mfma_f32_16x16x32_bf16 a[52:55], v[124:127], v[140:143], a[52:55]
    v_mfma_f32_16x16x32_bf16 a[56:59], v[128:131], v[140:143], a[56:59]
    v_mfma_f32_16x16x32_bf16 a[60:63], v[112:115], v[144:147], a[60:63]
    v_mfma_f32_16x16x32_bf16 a[64:67], v[116:119], v[144:147], a[64:67]
    v_mfma_f32_16x16x32_bf16 a[68:71], v[120:123], v[144:147], a[68:71]
    v_mfma_f32_16x16x32_bf16 a[72:75], v[124:127], v[144:147], a[72:75]
    v_mfma_f32_16x16x32_bf16 a[76:79], v[128:131], v[144:147], a[76:79]
    buffer_load_dwordx4 v[76:79], v23, s[8:11], s23 offen offset:256
    buffer_load_dwordx4 v[80:83], v24, s[8:11], s23 offen offset:256
    buffer_load_dwordx4 v[84:87], v25, s[8:11], s23 offen offset:256
    buffer_load_dwordx4 v[88:91], v26, s[8:11], s23 offen offset:256
    buffer_load_dwordx4 v[92:95], v27, s[8:11], s23 offen offset:256
    buffer_load_dwordx4 v[96:99], v28, s[8:11], s25 offen offset:256 sc1
    buffer_load_dwordx4 v[100:103], v29, s[8:11], s25 offen offset:256 sc1
    buffer_load_dwordx4 v[104:107], v30, s[8:11], s25 offen offset:256 sc1
    buffer_load_dwordx4 v[108:111], v31, s[8:11], s25 offen offset:256 sc1
    s_waitcnt vmcnt(18)
    v_mfma_f32_16x16x32_bf16 a[0:3], v[148:151], v[132:135], a[0:3]
    v_mfma_f32_16x16x32_bf16 a[4:7], v[152:155], v[132:135], a[4:7]
    v_mfma_f32_16x16x32_bf16 a[8:11], v[156:159], v[132:135], a[8:11]
    v_mfma_f32_16x16x32_bf16 a[12:15], v[160:163], v[132:135], a[12:15]
    v_mfma_f32_16x16x32_bf16 a[16:19], v[164:167], v[132:135], a[16:19]
    v_mfma_f32_16x16x32_bf16 a[20:23], v[148:151], v[136:139], a[20:23]
    v_mfma_f32_16x16x32_bf16 a[24:27], v[152:155], v[136:139], a[24:27]
    v_mfma_f32_16x16x32_bf16 a[28:31], v[156:159], v[136:139], a[28:31]
    v_mfma_f32_16x16x32_bf16 a[32:35], v[160:163], v[136:139], a[32:35]
    v_mfma_f32_16x16x32_bf16 a[36:39], v[164:167], v[136:139], a[36:39]
    v_mfma_f32_16x16x32_bf16 a[40:43], v[148:151], v[140:143], a[40:43]
    v_mfma_f32_16x16x32_bf16 a[44:47], v[152:155], v[140:143], a[44:47]
    v_mfma_f32_16x16x32_bf16 a[48:51], v[156:159], v[140:143], a[48:51]
    v_mfma_f32_16x16x32_bf16 a[52:55], v[160:163], v[140:143], a[52:55]
    v_mfma_f32_16x16x32_bf16 a[56:59], v[164:167], v[140:143], a[56:59]
    v_mfma_f32_16x16x32_bf16 a[60:63], v[148:151], v[144:147], a[60:63]
    v_mfma_f32_16x16x32_bf16 a[64:67], v[152:155], v[144:147], a[64:67]
    v_mfma_f32_16x16x32_bf16 a[68:71], v[156:159], v[144:147], a[68:71]
    v_mfma_f32_16x16x32_bf16 a[72:75], v[160:163], v[144:147], a[72:75]
    v_mfma_f32_16x16x32_bf16 a[76:79], v[164:167], v[144:147], a[76:79]
    v_mfma_f32_16x16x32_bf16 a[0:3], v[112:115], v[168:171], a[0:3]
    v_mfma_f32_16x16x32_bf16 a[4:7], v[116:119], v[168:171], a[4:7]
    v_mfma_f32_16x16x32_bf16 a[8:11], v[120:123], v[168:171], a[8:11]
    v_mfma_f32_16x16x32_bf16 a[12:15], v[124:127], v[168:171], a[12:15]
    v_mfma_f32_16x16x32_bf16 a[16:19], v[128:131], v[168:171], a[16:19]
    v_mfma_f32_16x16x32_bf16 a[20:23], v[112:115], v[172:175], a[20:23]
    v_mfma_f32_16x16x32_bf16 a[24:27], v[116:119], v[172:175], a[24:27]
    v_mfma_f32_16x16x32_bf16 a[28:31], v[120:123], v[172:175], a[28:31]
    v_mfma_f32_16x16x32_bf16 a[32:35], v[124:127], v[172:175], a[32:35]
    v_mfma_f32_16x16x32_bf16 a[36:39], v[128:131], v[172:175], a[36:39]
    v_mfma_f32_16x16x32_bf16 a[40:43], v[112:115], v[176:179], a[40:43]
    v_mfma_f32_16x16x32_bf16 a[44:47], v[116:119], v[176:179], a[44:47]
    v_mfma_f32_16x16x32_bf16 a[48:51], v[120:123], v[176:179], a[48:51]
    v_mfma_f32_16x16x32_bf16 a[52:55], v[124:127], v[176:179], a[52:55]
    v_mfma_f32_16x16x32_bf16 a[56:59], v[128:131], v[176:179], a[56:59]
    v_mfma_f32_16x16x32_bf16 a[60:63], v[112:115], v[180:183], a[60:63]
    v_mfma_f32_16x16x32_bf16 a[64:67], v[116:119], v[180:183], a[64:67]
    v_mfma_f32_16x16x32_bf16 a[68:71], v[120:123], v[180:183], a[68:71]
    v_mfma_f32_16x16x32_bf16 a[72:75], v[124:127], v[180:183], a[72:75]
    v_mfma_f32_16x16x32_bf16 a[76:79], v[128:131], v[180:183], a[76:79]
    buffer_load_dwordx4 v[112:115], v23, s[8:11], s22 offen offset:320
    buffer_load_dwordx4 v[116:119], v24, s[8:11], s22 offen offset:320
    buffer_load_dwordx4 v[120:123], v25, s[8:11], s22 offen offset:320
    buffer_load_dwordx4 v[124:127], v26, s[8:11], s22 offen offset:320
    buffer_load_dwordx4 v[128:131], v27, s[8:11], s22 offen offset:320
    buffer_load_dwordx4 v[132:135], v28, s[8:11], s24 offen offset:320 sc1
    buffer_load_dwordx4 v[136:139], v29, s[8:11], s24 offen offset:320 sc1
    buffer_load_dwordx4 v[140:143], v30, s[8:11], s24 offen offset:320 sc1
    buffer_load_dwordx4 v[144:147], v31, s[8:11], s24 offen offset:320 sc1
    s_waitcnt vmcnt(18)
    v_mfma_f32_16x16x32_bf16 a[0:3], v[40:43], v[60:63], a[0:3]
    v_mfma_f32_16x16x32_bf16 a[4:7], v[44:47], v[60:63], a[4:7]
    v_mfma_f32_16x16x32_bf16 a[8:11], v[48:51], v[60:63], a[8:11]
    v_mfma_f32_16x16x32_bf16 a[12:15], v[52:55], v[60:63], a[12:15]
    v_mfma_f32_16x16x32_bf16 a[16:19], v[56:59], v[60:63], a[16:19]
    v_mfma_f32_16x16x32_bf16 a[20:23], v[40:43], v[64:67], a[20:23]
    v_mfma_f32_16x16x32_bf16 a[24:27], v[44:47], v[64:67], a[24:27]
    v_mfma_f32_16x16x32_bf16 a[28:31], v[48:51], v[64:67], a[28:31]
    v_mfma_f32_16x16x32_bf16 a[32:35], v[52:55], v[64:67], a[32:35]
    v_mfma_f32_16x16x32_bf16 a[36:39], v[56:59], v[64:67], a[36:39]
    v_mfma_f32_16x16x32_bf16 a[40:43], v[40:43], v[68:71], a[40:43]
    v_mfma_f32_16x16x32_bf16 a[44:47], v[44:47], v[68:71], a[44:47]
    v_mfma_f32_16x16x32_bf16 a[48:51], v[48:51], v[68:71], a[48:51]
    v_mfma_f32_16x16x32_bf16 a[52:55], v[52:55], v[68:71], a[52:55]
    v_mfma_f32_16x16x32_bf16 a[56:59], v[56:59], v[68:71], a[56:59]
    v_mfma_f32_16x16x32_bf16 a[60:63], v[40:43], v[72:75], a[60:63]
    v_mfma_f32_16x16x32_bf16 a[64:67], v[44:47], v[72:75], a[64:67]
    v_mfma_f32_16x16x32_bf16 a[68:71], v[48:51], v[72:75], a[68:71]
    v_mfma_f32_16x16x32_bf16 a[72:75], v[52:55], v[72:75], a[72:75]
    v_mfma_f32_16x16x32_bf16 a[76:79], v[56:59], v[72:75], a[76:79]
    buffer_load_dwordx4 v[148:151], v23, s[8:11], s23 offen offset:320
    buffer_load_dwordx4 v[152:155], v24, s[8:11], s23 offen offset:320
    buffer_load_dwordx4 v[156:159], v25, s[8:11], s23 offen offset:320
    buffer_load_dwordx4 v[160:163], v26, s[8:11], s23 offen offset:320
    buffer_load_dwordx4 v[164:167], v27, s[8:11], s23 offen offset:320
    buffer_load_dwordx4 v[168:171], v28, s[8:11], s25 offen offset:320 sc1
    buffer_load_dwordx4 v[172:175], v29, s[8:11], s25 offen offset:320 sc1
    buffer_load_dwordx4 v[176:179], v30, s[8:11], s25 offen offset:320 sc1
    buffer_load_dwordx4 v[180:183], v31, s[8:11], s25 offen offset:320 sc1
    s_waitcnt vmcnt(18)
    v_mfma_f32_16x16x32_bf16 a[0:3], v[76:79], v[60:63], a[0:3]
    v_mfma_f32_16x16x32_bf16 a[4:7], v[80:83], v[60:63], a[4:7]
    v_mfma_f32_16x16x32_bf16 a[8:11], v[84:87], v[60:63], a[8:11]
    v_mfma_f32_16x16x32_bf16 a[12:15], v[88:91], v[60:63], a[12:15]
    v_mfma_f32_16x16x32_bf16 a[16:19], v[92:95], v[60:63], a[16:19]
    v_mfma_f32_16x16x32_bf16 a[20:23], v[76:79], v[64:67], a[20:23]
    v_mfma_f32_16x16x32_bf16 a[24:27], v[80:83], v[64:67], a[24:27]
    v_mfma_f32_16x16x32_bf16 a[28:31], v[84:87], v[64:67], a[28:31]
    v_mfma_f32_16x16x32_bf16 a[32:35], v[88:91], v[64:67], a[32:35]
    v_mfma_f32_16x16x32_bf16 a[36:39], v[92:95], v[64:67], a[36:39]
    v_mfma_f32_16x16x32_bf16 a[40:43], v[76:79], v[68:71], a[40:43]
    v_mfma_f32_16x16x32_bf16 a[44:47], v[80:83], v[68:71], a[44:47]
    v_mfma_f32_16x16x32_bf16 a[48:51], v[84:87], v[68:71], a[48:51]
    v_mfma_f32_16x16x32_bf16 a[52:55], v[88:91], v[68:71], a[52:55]
    v_mfma_f32_16x16x32_bf16 a[56:59], v[92:95], v[68:71], a[56:59]
    v_mfma_f32_16x16x32_bf16 a[60:63], v[76:79], v[72:75], a[60:63]
    v_mfma_f32_16x16x32_bf16 a[64:67], v[80:83], v[72:75], a[64:67]
    v_mfma_f32_16x16x32_bf16 a[68:71], v[84:87], v[72:75], a[68:71]
    v_mfma_f32_16x16x32_bf16 a[72:75], v[88:91], v[72:75], a[72:75]
    v_mfma_f32_16x16x32_bf16 a[76:79], v[92:95], v[72:75], a[76:79]
    v_mfma_f32_16x16x32_bf16 a[0:3], v[40:43], v[96:99], a[0:3]
    v_mfma_f32_16x16x32_bf16 a[4:7], v[44:47], v[96:99], a[4:7]
    v_mfma_f32_16x16x32_bf16 a[8:11], v[48:51], v[96:99], a[8:11]
    v_mfma_f32_16x16x32_bf16 a[12:15], v[52:55], v[96:99], a[12:15]
    v_mfma_f32_16x16x32_bf16 a[16:19], v[56:59], v[96:99], a[16:19]
    v_mfma_f32_16x16x32_bf16 a[20:23], v[40:43], v[100:103], a[20:23]
    v_mfma_f32_16x16x32_bf16 a[24:27], v[44:47], v[100:103], a[24:27]
    v_mfma_f32_16x16x32_bf16 a[28:31], v[48:51], v[100:103], a[28:31]
    v_mfma_f32_16x16x32_bf16 a[32:35], v[52:55], v[100:103], a[32:35]
    v_mfma_f32_16x16x32_bf16 a[36:39], v[56:59], v[100:103], a[36:39]
    v_mfma_f32_16x16x32_bf16 a[40:43], v[40:43], v[104:107], a[40:43]
    v_mfma_f32_16x16x32_bf16 a[44:47], v[44:47], v[104:107], a[44:47]
    v_mfma_f32_16x16x32_bf16 a[48:51], v[48:51], v[104:107], a[48:51]
    v_mfma_f32_16x16x32_bf16 a[52:55], v[52:55], v[104:107], a[52:55]
    v_mfma_f32_16x16x32_bf16 a[56:59], v[56:59], v[104:107], a[56:59]
    v_mfma_f32_16x16x32_bf16 a[60:63], v[40:43], v[108:111], a[60:63]
    v_mfma_f32_16x16x32_bf16 a[64:67], v[44:47], v[108:111], a[64:67]
    v_mfma_f32_16x16x32_bf16 a[68:71], v[48:51], v[108:111], a[68:71]
    v_mfma_f32_16x16x32_bf16 a[72:75], v[52:55], v[108:111], a[72:75]
    v_mfma_f32_16x16x32_bf16 a[76:79], v[56:59], v[108:111], a[76:79]
    s_waitcnt vmcnt(9)
    v_mfma_f32_16x16x32_bf16 a[0:3], v[112:115], v[132:135], a[0:3]
    v_mfma_f32_16x16x32_bf16 a[4:7], v[116:119], v[132:135], a[4:7]
    v_mfma_f32_16x16x32_bf16 a[8:11], v[120:123], v[132:135], a[8:11]
    v_mfma_f32_16x16x32_bf16 a[12:15], v[124:127], v[132:135], a[12:15]
    v_mfma_f32_16x16x32_bf16 a[16:19], v[128:131], v[132:135], a[16:19]
    v_mfma_f32_16x16x32_bf16 a[20:23], v[112:115], v[136:139], a[20:23]
    v_mfma_f32_16x16x32_bf16 a[24:27], v[116:119], v[136:139], a[24:27]
    v_mfma_f32_16x16x32_bf16 a[28:31], v[120:123], v[136:139], a[28:31]
    v_mfma_f32_16x16x32_bf16 a[32:35], v[124:127], v[136:139], a[32:35]
    v_mfma_f32_16x16x32_bf16 a[36:39], v[128:131], v[136:139], a[36:39]
    v_mfma_f32_16x16x32_bf16 a[40:43], v[112:115], v[140:143], a[40:43]
    v_mfma_f32_16x16x32_bf16 a[44:47], v[116:119], v[140:143], a[44:47]
    v_mfma_f32_16x16x32_bf16 a[48:51], v[120:123], v[140:143], a[48:51]
    v_mfma_f32_16x16x32_bf16 a[52:55], v[124:127], v[140:143], a[52:55]
    v_mfma_f32_16x16x32_bf16 a[56:59], v[128:131], v[140:143], a[56:59]
    v_mfma_f32_16x16x32_bf16 a[60:63], v[112:115], v[144:147], a[60:63]
    v_mfma_f32_16x16x32_bf16 a[64:67], v[116:119], v[144:147], a[64:67]
    v_mfma_f32_16x16x32_bf16 a[68:71], v[120:123], v[144:147], a[68:71]
    v_mfma_f32_16x16x32_bf16 a[72:75], v[124:127], v[144:147], a[72:75]
    v_mfma_f32_16x16x32_bf16 a[76:79], v[128:131], v[144:147], a[76:79]
    s_waitcnt vmcnt(0)
    v_mfma_f32_16x16x32_bf16 a[0:3], v[148:151], v[132:135], a[0:3]
    v_mfma_f32_16x16x32_bf16 a[4:7], v[152:155], v[132:135], a[4:7]
    v_mfma_f32_16x16x32_bf16 a[8:11], v[156:159], v[132:135], a[8:11]
    v_mfma_f32_16x16x32_bf16 a[12:15], v[160:163], v[132:135], a[12:15]
    v_mfma_f32_16x16x32_bf16 a[16:19], v[164:167], v[132:135], a[16:19]
    v_mfma_f32_16x16x32_bf16 a[20:23], v[148:151], v[136:139], a[20:23]
    v_mfma_f32_16x16x32_bf16 a[24:27], v[152:155], v[136:139], a[24:27]
    v_mfma_f32_16x16x32_bf16 a[28:31], v[156:159], v[136:139], a[28:31]
    v_mfma_f32_16x16x32_bf16 a[32:35], v[160:163], v[136:139], a[32:35]
    v_mfma_f32_16x16x32_bf16 a[36:39], v[164:167], v[136:139], a[36:39]
    v_mfma_f32_16x16x32_bf16 a[40:43], v[148:151], v[140:143], a[40:43]
    v_mfma_f32_16x16x32_bf16 a[44:47], v[152:155], v[140:143], a[44:47]
    v_mfma_f32_16x16x32_bf16 a[48:51], v[156:159], v[140:143], a[48:51]
    v_mfma_f32_16x16x32_bf16 a[52:55], v[160:163], v[140:143], a[52:55]
    v_mfma_f32_16x16x32_bf16 a[56:59], v[164:167], v[140:143], a[56:59]
    v_mfma_f32_16x16x32_bf16 a[60:63], v[148:151], v[144:147], a[60:63]
    v_mfma_f32_16x16x32_bf16 a[64:67], v[152:155], v[144:147], a[64:67]
    v_mfma_f32_16x16x32_bf16 a[68:71], v[156:159], v[144:147], a[68:71]
    v_mfma_f32_16x16x32_bf16 a[72:75], v[160:163], v[144:147], a[72:75]
    v_mfma_f32_16x16x32_bf16 a[76:79], v[164:167], v[144:147], a[76:79]
    v_mfma_f32_16x16x32_bf16 a[0:3], v[112:115], v[168:171], a[0:3]
    v_mfma_f32_16x16x32_bf16 a[4:7], v[116:119], v[168:171], a[4:7]
    v_mfma_f32_16x16x32_bf16 a[8:11], v[120:123], v[168:171], a[8:11]
    v_mfma_f32_16x16x32_bf16 a[12:15], v[124:127], v[168:171], a[12:15]
    v_mfma_f32_16x16x32_bf16 a[16:19], v[128:131], v[168:171], a[16:19]
    v_mfma_f32_16x16x32_bf16 a[20:23], v[112:115], v[172:175], a[20:23]
    v_mfma_f32_16x16x32_bf16 a[24:27], v[116:119], v[172:175], a[24:27]
    v_mfma_f32_16x16x32_bf16 a[28:31], v[120:123], v[172:175], a[28:31]
    v_mfma_f32_16x16x32_bf16 a[32:35], v[124:127], v[172:175], a[32:35]
    v_mfma_f32_16x16x32_bf16 a[36:39], v[128:131], v[172:175], a[36:39]
    v_mfma_f32_16x16x32_bf16 a[40:43], v[112:115], v[176:179], a[40:43]
    v_mfma_f32_16x16x32_bf16 a[44:47], v[116:119], v[176:179], a[44:47]
    v_mfma_f32_16x16x32_bf16 a[48:51], v[120:123], v[176:179], a[48:51]
    v_mfma_f32_16x16x32_bf16 a[52:55], v[124:127], v[176:179], a[52:55]
    v_mfma_f32_16x16x32_bf16 a[56:59], v[128:131], v[176:179], a[56:59]
    v_mfma_f32_16x16x32_bf16 a[60:63], v[112:115], v[180:183], a[60:63]
    v_mfma_f32_16x16x32_bf16 a[64:67], v[116:119], v[180:183], a[64:67]
    v_mfma_f32_16x16x32_bf16 a[68:71], v[120:123], v[180:183], a[68:71]
    v_mfma_f32_16x16x32_bf16 a[72:75], v[124:127], v[180:183], a[72:75]
    v_mfma_f32_16x16x32_bf16 a[76:79], v[128:131], v[180:183], a[76:79]
    s_lshl_b32 s27, s29, 7
    s_add_u32 s27, s27, 0x9f01000
    s_cmp_lg_u32 s40, 0
    s_cbranch_scc1 Lwo_30
    s_mov_b32 s28, 0
    v_mov_b32 v11, 0
    s_mov_b64 exec, 1
Lwc_29:
    buffer_load_dword v10, v11, s[8:11], s27 offen sc1
    s_waitcnt vmcnt(0)
    v_cmp_le_u32 vcc, 16, v10
    s_cbranch_vccnz Lwo_30x
    s_sleep 12
    s_add_u32 s28, s28, 1
    s_cmp_lt_u32 s28, 400000
    s_cbranch_scc1 Lwc_29
Lwo_30x:
    s_mov_b64 exec, -1
Lwo_30:
    s_barrier
    buffer_load_dwordx4 v[40:43], v14, s[8:11], s20 offen offset:0
    buffer_load_dwordx4 v[44:47], v15, s[8:11], s20 offen offset:0
    buffer_load_dwordx4 v[48:51], v16, s[8:11], s20 offen offset:0
    buffer_load_dwordx4 v[52:55], v17, s[8:11], s20 offen offset:0
    buffer_load_dwordx4 v[56:59], v18, s[8:11], s20 offen offset:0
    buffer_load_dwordx4 v[60:63], v19, s[8:11], s21 offen offset:0 sc1
    buffer_load_dwordx4 v[64:67], v20, s[8:11], s21 offen offset:0 sc1
    buffer_load_dwordx4 v[68:71], v21, s[8:11], s21 offen offset:0 sc1
    buffer_load_dwordx4 v[72:75], v22, s[8:11], s21 offen offset:0 sc1
    buffer_load_dwordx4 v[76:79], v14, s[8:11], s20 offen offset:64
    buffer_load_dwordx4 v[80:83], v15, s[8:11], s20 offen offset:64
    buffer_load_dwordx4 v[84:87], v16, s[8:11], s20 offen offset:64
    buffer_load_dwordx4 v[88:91], v17, s[8:11], s20 offen offset:64
    buffer_load_dwordx4 v[92:95], v18, s[8:11], s20 offen offset:64
    buffer_load_dwordx4 v[96:99], v19, s[8:11], s21 offen offset:64 sc1
    buffer_load_dwordx4 v[100:103], v20, s[8:11], s21 offen offset:64 sc1
    buffer_load_dwordx4 v[104:107], v21, s[8:11], s21 offen offset:64 sc1
    buffer_load_dwordx4 v[108:111], v22, s[8:11], s21 offen offset:64 sc1
    buffer_load_dwordx4 v[112:115], v14, s[8:11], s20 offen offset:128
    buffer_load_dwordx4 v[116:119], v15, s[8:11], s20 offen offset:128
    buffer_load_dwordx4 v[120:123], v16, s[8:11], s20 offen offset:128
    buffer_load_dwordx4 v[124:127], v17, s[8:11], s20 offen offset:128
    buffer_load_dwordx4 v[128:131], v18, s[8:11], s20 offen offset:128
    buffer_load_dwordx4 v[132:135], v19, s[8:11], s21 offen offset:128 sc1
    buffer_load_dwordx4 v[136:139], v20, s[8:11], s21 offen offset:128 sc1
    buffer_load_dwordx4 v[140:143], v21, s[8:11], s21 offen offset:128 sc1
    buffer_load_dwordx4 v[144:147], v22, s[8:11], s21 offen offset:128 sc1
    buffer_load_dwordx4 v[148:151], v14, s[8:11], s20 offen offset:192
    buffer_load_dwordx4 v[152:155], v15, s[8:11], s20 offen offset:192
    buffer_load_dwordx4 v[156:159], v16, s[8:11], s20 offen offset:192
    buffer_load_dwordx4 v[160:163], v17, s[8:11], s20 offen offset:192
    buffer_load_dwordx4 v[164:167], v18, s[8:11], s20 offen offset:192
    buffer_load_dwordx4 v[168:171], v19, s[8:11], s21 offen offset:192 sc1
    buffer_load_dwordx4 v[172:175], v20, s[8:11], s21 offen offset:192 sc1
    buffer_load_dwordx4 v[176:179], v21, s[8:11], s21 offen offset:192 sc1
    buffer_load_dwordx4 v[180:183], v22, s[8:11], s21 offen offset:192 sc1
    s_waitcnt vmcnt(27)
    v_mfma_f32_16x16x32_bf16 a[80:83], v[40:43], v[60:63], 0
    v_mfma_f32_16x16x32_bf16 a[84:87], v[44:47], v[60:63], 0
    v_mfma_f32_16x16x32_bf16 a[88:91], v[48:51], v[60:63], 0
    v_mfma_f32_16x16x32_bf16 a[92:95], v[52:55], v[60:63], 0
    v_mfma_f32_16x16x32_bf16 a[96:99], v[56:59], v[60:63], 0
    v_mfma_f32_16x16x32_bf16 a[100:103], v[40:43], v[64:67], 0
    v_mfma_f32_16x16x32_bf16 a[104:107], v[44:47], v[64:67], 0
    v_mfma_f32_16x16x32_bf16 a[108:111], v[48:51], v[64:67], 0
    v_mfma_f32_16x16x32_bf16 a[112:115], v[52:55], v[64:67], 0
    v_mfma_f32_16x16x32_bf16 a[116:119], v[56:59], v[64:67], 0
    v_mfma_f32_16x16x32_bf16 a[120:123], v[40:43], v[68:71], 0
    v_mfma_f32_16x16x32_bf16 a[124:127], v[44:47], v[68:71], 0
    v_mfma_f32_16x16x32_bf16 a[128:131], v[48:51], v[68:71], 0
    v_mfma_f32_16x16x32_bf16 a[132:135], v[52:55], v[68:71], 0
    v_mfma_f32_16x16x32_bf16 a[136:139], v[56:59], v[68:71], 0
    v_mfma_f32_16x16x32_bf16 a[140:143], v[40:43], v[72:75], 0
    v_mfma_f32_16x16x32_bf16 a[144:147], v[44:47], v[72:75], 0
    v_mfma_f32_16x16x32_bf16 a[148:151], v[48:51], v[72:75], 0
    v_mfma_f32_16x16x32_bf16 a[152:155], v[52:55], v[72:75], 0
    v_mfma_f32_16x16x32_bf16 a[156:159], v[56:59], v[72:75], 0
    buffer_load_dwordx4 v[40:43], v14, s[8:11], s20 offen offset:256
    buffer_load_dwordx4 v[44:47], v15, s[8:11], s20 offen offset:256
    buffer_load_dwordx4 v[48:51], v16, s[8:11], s20 offen offset:256
    buffer_load_dwordx4 v[52:55], v17, s[8:11], s20 offen offset:256
    buffer_load_dwordx4 v[56:59], v18, s[8:11], s20 offen offset:256
    buffer_load_dwordx4 v[60:63], v19, s[8:11], s21 offen offset:256 sc1
    buffer_load_dwordx4 v[64:67], v20, s[8:11], s21 offen offset:256 sc1
    buffer_load_dwordx4 v[68:71], v21, s[8:11], s21 offen offset:256 sc1
    buffer_load_dwordx4 v[72:75], v22, s[8:11], s21 offen offset:256 sc1
    s_waitcnt vmcnt(27)
    v_mfma_f32_16x16x32_bf16 a[80:83], v[76:79], v[96:99], a[80:83]
    v_mfma_f32_16x16x32_bf16 a[84:87], v[80:83], v[96:99], a[84:87]
    v_mfma_f32_16x16x32_bf16 a[88:91], v[84:87], v[96:99], a[88:91]
    v_mfma_f32_16x16x32_bf16 a[92:95], v[88:91], v[96:99], a[92:95]
    v_mfma_f32_16x16x32_bf16 a[96:99], v[92:95], v[96:99], a[96:99]
    v_mfma_f32_16x16x32_bf16 a[100:103], v[76:79], v[100:103], a[100:103]
    v_mfma_f32_16x16x32_bf16 a[104:107], v[80:83], v[100:103], a[104:107]
    v_mfma_f32_16x16x32_bf16 a[108:111], v[84:87], v[100:103], a[108:111]
    v_mfma_f32_16x16x32_bf16 a[112:115], v[88:91], v[100:103], a[112:115]
    v_mfma_f32_16x16x32_bf16 a[116:119], v[92:95], v[100:103], a[116:119]
    v_mfma_f32_16x16x32_bf16 a[120:123], v[76:79], v[104:107], a[120:123]
    v_mfma_f32_16x16x32_bf16 a[124:127], v[80:83], v[104:107], a[124:127]
    v_mfma_f32_16x16x32_bf16 a[128:131], v[84:87], v[104:107], a[128:131]
    v_mfma_f32_16x16x32_bf16 a[132:135], v[88:91], v[104:107], a[132:135]
    v_mfma_f32_16x16x32_bf16 a[136:139], v[92:95], v[104:107], a[136:139]
    v_mfma_f32_16x16x32_bf16 a[140:143], v[76:79], v[108:111], a[140:143]
    v_mfma_f32_16x16x32_bf16 a[144:147], v[80:83], v[108:111], a[144:147]
    v_mfma_f32_16x16x32_bf16 a[148:151], v[84:87], v[108:111], a[148:151]
    v_mfma_f32_16x16x32_bf16 a[152:155], v[88:91], v[108:111], a[152:155]
    v_mfma_f32_16x16x32_bf16 a[156:159], v[92:95], v[108:111], a[156:159]
    buffer_load_dwordx4 v[76:79], v14, s[8:11], s20 offen offset:320
    buffer_load_dwordx4 v[80:83], v15, s[8:11], s20 offen offset:320
    buffer_load_dwordx4 v[84:87], v16, s[8:11], s20 offen offset:320
    buffer_load_dwordx4 v[88:91], v17, s[8:11], s20 offen offset:320
    buffer_load_dwordx4 v[92:95], v18, s[8:11], s20 offen offset:320
    buffer_load_dwordx4 v[96:99], v19, s[8:11], s21 offen offset:320 sc1
    buffer_load_dwordx4 v[100:103], v20, s[8:11], s21 offen offset:320 sc1
    buffer_load_dwordx4 v[104:107], v21, s[8:11], s21 offen offset:320 sc1
    buffer_load_dwordx4 v[108:111], v22, s[8:11], s21 offen offset:320 sc1
    s_waitcnt vmcnt(27)
    v_mfma_f32_16x16x32_bf16 a[80:83], v[112:115], v[132:135], a[80:83]
    v_mfma_f32_16x16x32_bf16 a[84:87], v[116:119], v[132:135], a[84:87]
    v_mfma_f32_16x16x32_bf16 a[88:91], v[120:123], v[132:135], a[88:91]
    v_mfma_f32_16x16x32_bf16 a[92:95], v[124:127], v[132:135], a[92:95]
    v_mfma_f32_16x16x32_bf16 a[96:99], v[128:131], v[132:135], a[96:99]
    v_mfma_f32_16x16x32_bf16 a[100:103], v[112:115], v[136:139], a[100:103]
    v_mfma_f32_16x16x32_bf16 a[104:107], v[116:119], v[136:139], a[104:107]
    v_mfma_f32_16x16x32_bf16 a[108:111], v[120:123], v[136:139], a[108:111]
    v_mfma_f32_16x16x32_bf16 a[112:115], v[124:127], v[136:139], a[112:115]
    v_mfma_f32_16x16x32_bf16 a[116:119], v[128:131], v[136:139], a[116:119]
    v_mfma_f32_16x16x32_bf16 a[120:123], v[112:115], v[140:143], a[120:123]
    v_mfma_f32_16x16x32_bf16 a[124:127], v[116:119], v[140:143], a[124:127]
    v_mfma_f32_16x16x32_bf16 a[128:131], v[120:123], v[140:143], a[128:131]
    v_mfma_f32_16x16x32_bf16 a[132:135], v[124:127], v[140:143], a[132:135]
    v_mfma_f32_16x16x32_bf16 a[136:139], v[128:131], v[140:143], a[136:139]
    v_mfma_f32_16x16x32_bf16 a[140:143], v[112:115], v[144:147], a[140:143]
    v_mfma_f32_16x16x32_bf16 a[144:147], v[116:119], v[144:147], a[144:147]
    v_mfma_f32_16x16x32_bf16 a[148:151], v[120:123], v[144:147], a[148:151]
    v_mfma_f32_16x16x32_bf16 a[152:155], v[124:127], v[144:147], a[152:155]
    v_mfma_f32_16x16x32_bf16 a[156:159], v[128:131], v[144:147], a[156:159]
    buffer_load_dwordx4 v[112:115], v14, s[8:11], s20 offen offset:384
    buffer_load_dwordx4 v[116:119], v15, s[8:11], s20 offen offset:384
    buffer_load_dwordx4 v[120:123], v16, s[8:11], s20 offen offset:384
    buffer_load_dwordx4 v[124:127], v17, s[8:11], s20 offen offset:384
    buffer_load_dwordx4 v[128:131], v18, s[8:11], s20 offen offset:384
    buffer_load_dwordx4 v[132:135], v19, s[8:11], s21 offen offset:384 sc1
    buffer_load_dwordx4 v[136:139], v20, s[8:11], s21 offen offset:384 sc1
    buffer_load_dwordx4 v[140:143], v21, s[8:11], s21 offen offset:384 sc1
    buffer_load_dwordx4 v[144:147], v22, s[8:11], s21 offen offset:384 sc1
    s_waitcnt vmcnt(27)
    v_mfma_f32_16x16x32_bf16 a[80:83], v[148:151], v[168:171], a[80:83]
    v_mfma_f32_16x16x32_bf16 a[84:87], v[152:155], v[168:171], a[84:87]
    v_mfma_f32_16x16x32_bf16 a[88:91], v[156:159], v[168:171], a[88:91]
    v_mfma_f32_16x16x32_bf16 a[92:95], v[160:163], v[168:171], a[92:95]
    v_mfma_f32_16x16x32_bf16 a[96:99], v[164:167], v[168:171], a[96:99]
    v_mfma_f32_16x16x32_bf16 a[100:103], v[148:151], v[172:175], a[100:103]
    v_mfma_f32_16x16x32_bf16 a[104:107], v[152:155], v[172:175], a[104:107]
    v_mfma_f32_16x16x32_bf16 a[108:111], v[156:159], v[172:175], a[108:111]
    v_mfma_f32_16x16x32_bf16 a[112:115], v[160:163], v[172:175], a[112:115]
    v_mfma_f32_16x16x32_bf16 a[116:119], v[164:167], v[172:175], a[116:119]
    v_mfma_f32_16x16x32_bf16 a[120:123], v[148:151], v[176:179], a[120:123]
    v_mfma_f32_16x16x32_bf16 a[124:127], v[152:155], v[176:179], a[124:127]
    v_mfma_f32_16x16x32_bf16 a[128:131], v[156:159], v[176:179], a[128:131]
    v_mfma_f32_16x16x32_bf16 a[132:135], v[160:163], v[176:179], a[132:135]
    v_mfma_f32_16x16x32_bf16 a[136:139], v[164:167], v[176:179], a[136:139]
    v_mfma_f32_16x16x32_bf16 a[140:143], v[148:151], v[180:183], a[140:143]
    v_mfma_f32_16x16x32_bf16 a[144:147], v[152:155], v[180:183], a[144:147]
    v_mfma_f32_16x16x32_bf16 a[148:151], v[156:159], v[180:183], a[148:151]
    v_mfma_f32_16x16x32_bf16 a[152:155], v[160:163], v[180:183], a[152:155]
    v_mfma_f32_16x16x32_bf16 a[156:159], v[164:167], v[180:183], a[156:159]
    buffer_load_dwordx4 v[148:151], v14, s[8:11], s20 offen offset:448
    buffer_load_dwordx4 v[152:155], v15, s[8:11], s20 offen offset:448
    buffer_load_dwordx4 v[156:159], v16, s[8:11], s20 offen offset:448
    buffer_load_dwordx4 v[160:163], v17, s[8:11], s20 offen offset:448
    buffer_load_dwordx4 v[164:167], v18, s[8:11], s20 offen offset:448
    buffer_load_dwordx4 v[168:171], v19, s[8:11], s21 offen offset:448 sc1
    buffer_load_dwordx4 v[172:175], v20, s[8:11], s21 offen offset:448 sc1
    buffer_load_dwordx4 v[176:179], v21, s[8:11], s21 offen offset:448 sc1
    buffer_load_dwordx4 v[180:183], v22, s[8:11], s21 offen offset:448 sc1
    s_waitcnt vmcnt(27)
    v_mfma_f32_16x16x32_bf16 a[80:83], v[40:43], v[60:63], a[80:83]
    v_mfma_f32_16x16x32_bf16 a[84:87], v[44:47], v[60:63], a[84:87]
    v_mfma_f32_16x16x32_bf16 a[88:91], v[48:51], v[60:63], a[88:91]
    v_mfma_f32_16x16x32_bf16 a[92:95], v[52:55], v[60:63], a[92:95]
    v_mfma_f32_16x16x32_bf16 a[96:99], v[56:59], v[60:63], a[96:99]
    v_mfma_f32_16x16x32_bf16 a[100:103], v[40:43], v[64:67], a[100:103]
    v_mfma_f32_16x16x32_bf16 a[104:107], v[44:47], v[64:67], a[104:107]
    v_mfma_f32_16x16x32_bf16 a[108:111], v[48:51], v[64:67], a[108:111]
    v_mfma_f32_16x16x32_bf16 a[112:115], v[52:55], v[64:67], a[112:115]
    v_mfma_f32_16x16x32_bf16 a[116:119], v[56:59], v[64:67], a[116:119]
    v_mfma_f32_16x16x32_bf16 a[120:123], v[40:43], v[68:71], a[120:123]
    v_mfma_f32_16x16x32_bf16 a[124:127], v[44:47], v[68:71], a[124:127]
    v_mfma_f32_16x16x32_bf16 a[128:131], v[48:51], v[68:71], a[128:131]
    v_mfma_f32_16x16x32_bf16 a[132:135], v[52:55], v[68:71], a[132:135]
    v_mfma_f32_16x16x32_bf16 a[136:139], v[56:59], v[68:71], a[136:139]
    v_mfma_f32_16x16x32_bf16 a[140:143], v[40:43], v[72:75], a[140:143]
    v_mfma_f32_16x16x32_bf16 a[144:147], v[44:47], v[72:75], a[144:147]
    v_mfma_f32_16x16x32_bf16 a[148:151], v[48:51], v[72:75], a[148:151]
    v_mfma_f32_16x16x32_bf16 a[152:155], v[52:55], v[72:75], a[152:155]
    v_mfma_f32_16x16x32_bf16 a[156:159], v[56:59], v[72:75], a[156:159]
    buffer_load_dwordx4 v[40:43], v14, s[8:11], s20 offen offset:512
    buffer_load_dwordx4 v[44:47], v15, s[8:11], s20 offen offset:512
    buffer_load_dwordx4 v[48:51], v16, s[8:11], s20 offen offset:512
    buffer_load_dwordx4 v[52:55], v17, s[8:11], s20 offen offset:512
    buffer_load_dwordx4 v[56:59], v18, s[8:11], s20 offen offset:512
    buffer_load_dwordx4 v[60:63], v19, s[8:11], s21 offen offset:512 sc1
    buffer_load_dwordx4 v[64:67], v20, s[8:11], s21 offen offset:512 sc1
    buffer_load_dwordx4 v[68:71], v21, s[8:11], s21 offen offset:512 sc1
    buffer_load_dwordx4 v[72:75], v22, s[8:11], s21 offen offset:512 sc1
    s_waitcnt vmcnt(27)
    v_mfma_f32_16x16x32_bf16 a[80:83], v[76:79], v[96:99], a[80:83]
    v_mfma_f32_16x16x32_bf16 a[84:87], v[80:83], v[96:99], a[84:87]
    v_mfma_f32_16x16x32_bf16 a[88:91], v[84:87], v[96:99], a[88:91]
    v_mfma_f32_16x16x32_bf16 a[92:95], v[88:91], v[96:99], a[92:95]
    v_mfma_f32_16x16x32_bf16 a[96:99], v[92:95], v[96:99], a[96:99]
    v_mfma_f32_16x16x32_bf16 a[100:103], v[76:79], v[100:103], a[100:103]
    v_mfma_f32_16x16x32_bf16 a[104:107], v[80:83], v[100:103], a[104:107]
    v_mfma_f32_16x16x32_bf16 a[108:111], v[84:87], v[100:103], a[108:111]
    v_mfma_f32_16x16x32_bf16 a[112:115], v[88:91], v[100:103], a[112:115]
    v_mfma_f32_16x16x32_bf16 a[116:119], v[92:95], v[100:103], a[116:119]
    v_mfma_f32_16x16x32_bf16 a[120:123], v[76:79], v[104:107], a[120:123]
    v_mfma_f32_16x16x32_bf16 a[124:127], v[80:83], v[104:107], a[124:127]
    v_mfma_f32_16x16x32_bf16 a[128:131], v[84:87], v[104:107], a[128:131]
    v_mfma_f32_16x16x32_bf16 a[132:135], v[88:91], v[104:107], a[132:135]
    v_mfma_f32_16x16x32_bf16 a[136:139], v[92:95], v[104:107], a[136:139]
    v_mfma_f32_16x16x32_bf16 a[140:143], v[76:79], v[108:111], a[140:143]
    v_mfma_f32_16x16x32_bf16 a[144:147], v[80:83], v[108:111], a[144:147]
    v_mfma_f32_16x16x32_bf16 a[148:151], v[84:87], v[108:111], a[148:151]
    v_mfma_f32_16x16x32_bf16 a[152:155], v[88:91], v[108:111], a[152:155]
    v_mfma_f32_16x16x32_bf16 a[156:159], v[92:95], v[108:111], a[156:159]
    buffer_load_dwordx4 v[76:79], v14, s[8:11], s20 offen offset:576
    buffer_load_dwordx4 v[80:83], v15, s[8:11], s20 offen offset:576
    buffer_load_dwordx4 v[84:87], v16, s[8:11], s20 offen offset:576
    buffer_load_dwordx4 v[88:91], v17, s[8:11], s20 offen offset:576
    buffer_load_dwordx4 v[92:95], v18, s[8:11], s20 offen offset:576
    buffer_load_dwordx4 v[96:99], v19, s[8:11], s21 offen offset:576 sc1
    buffer_load_dwordx4 v[100:103], v20, s[8:11], s21 offen offset:576 sc1
    buffer_load_dwordx4 v[104:107], v21, s[8:11], s21 offen offset:576 sc1
    buffer_load_dwordx4 v[108:111], v22, s[8:11], s21 offen offset:576 sc1
    s_waitcnt vmcnt(27)
    v_mfma_f32_16x16x32_bf16 a[80:83], v[112:115], v[132:135], a[80:83]
    v_mfma_f32_16x16x32_bf16 a[84:87], v[116:119], v[132:135], a[84:87]
    v_mfma_f32_16x16x32_bf16 a[88:91], v[120:123], v[132:135], a[88:91]
    v_mfma_f32_16x16x32_bf16 a[92:95], v[124:127], v[132:135], a[92:95]
    v_mfma_f32_16x16x32_bf16 a[96:99], v[128:131], v[132:135], a[96:99]
    v_mfma_f32_16x16x32_bf16 a[100:103], v[112:115], v[136:139], a[100:103]
    v_mfma_f32_16x16x32_bf16 a[104:107], v[116:119], v[136:139], a[104:107]
    v_mfma_f32_16x16x32_bf16 a[108:111], v[120:123], v[136:139], a[108:111]
    v_mfma_f32_16x16x32_bf16 a[112:115], v[124:127], v[136:139], a[112:115]
    v_mfma_f32_16x16x32_bf16 a[116:119], v[128:131], v[136:139], a[116:119]
    v_mfma_f32_16x16x32_bf16 a[120:123], v[112:115], v[140:143], a[120:123]
    v_mfma_f32_16x16x32_bf16 a[124:127], v[116:119], v[140:143], a[124:127]
    v_mfma_f32_16x16x32_bf16 a[128:131], v[120:123], v[140:143], a[128:131]
    v_mfma_f32_16x16x32_bf16 a[132:135], v[124:127], v[140:143], a[132:135]
    v_mfma_f32_16x16x32_bf16 a[136:139], v[128:131], v[140:143], a[136:139]
    v_mfma_f32_16x16x32_bf16 a[140:143], v[112:115], v[144:147], a[140:143]
    v_mfma_f32_16x16x32_bf16 a[144:147], v[116:119], v[144:147], a[144:147]
    v_mfma_f32_16x16x32_bf16 a[148:151], v[120:123], v[144:147], a[148:151]
    v_mfma_f32_16x16x32_bf16 a[152:155], v[124:127], v[144:147], a[152:155]
    v_mfma_f32_16x16x32_bf16 a[156:159], v[128:131], v[144:147], a[156:159]
    buffer_load_dwordx4 v[112:115], v14, s[8:11], s20 offen offset:640
    buffer_load_dwordx4 v[116:119], v15, s[8:11], s20 offen offset:640
    buffer_load_dwordx4 v[120:123], v16, s[8:11], s20 offen offset:640
    buffer_load_dwordx4 v[124:127], v17, s[8:11], s20 offen offset:640
    buffer_load_dwordx4 v[128:131], v18, s[8:11], s20 offen offset:640
    buffer_load_dwordx4 v[132:135], v19, s[8:11], s21 offen offset:640 sc1
    buffer_load_dwordx4 v[136:139], v20, s[8:11], s21 offen offset:640 sc1
    buffer_load_dwordx4 v[140:143], v21, s[8:11], s21 offen offset:640 sc1
    buffer_load_dwordx4 v[144:147], v22, s[8:11], s21 offen offset:640 sc1
    s_waitcnt vmcnt(27)
    v_mfma_f32_16x16x32_bf16 a[80:83], v[148:151], v[168:171], a[80:83]
    v_mfma_f32_16x16x32_bf16 a[84:87], v[152:155], v[168:171], a[84:87]
    v_mfma_f32_16x16x32_bf16 a[88:91], v[156:159], v[168:171], a[88:91]
    v_mfma_f32_16x16x32_bf16 a[92:95], v[160:163], v[168:171], a[92:95]
    v_mfma_f32_16x16x32_bf16 a[96:99], v[164:167], v[168:171], a[96:99]
    v_mfma_f32_16x16x32_bf16 a[100:103], v[148:151], v[172:175], a[100:103]
    v_mfma_f32_16x16x32_bf16 a[104:107], v[152:155], v[172:175], a[104:107]
    v_mfma_f32_16x16x32_bf16 a[108:111], v[156:159], v[172:175], a[108:111]
    v_mfma_f32_16x16x32_bf16 a[112:115], v[160:163], v[172:175], a[112:115]
    v_mfma_f32_16x16x32_bf16 a[116:119], v[164:167], v[172:175], a[116:119]
    v_mfma_f32_16x16x32_bf16 a[120:123], v[148:151], v[176:179], a[120:123]
    v_mfma_f32_16x16x32_bf16 a[124:127], v[152:155], v[176:179], a[124:127]
    v_mfma_f32_16x16x32_bf16 a[128:131], v[156:159], v[176:179], a[128:131]
    v_mfma_f32_16x16x32_bf16 a[132:135], v[160:163], v[176:179], a[132:135]
    v_mfma_f32_16x16x32_bf16 a[136:139], v[164:167], v[176:179], a[136:139]
    v_mfma_f32_16x16x32_bf16 a[140:143], v[148:151], v[180:183], a[140:143]
    v_mfma_f32_16x16x32_bf16 a[144:147], v[152:155], v[180:183], a[144:147]
    v_mfma_f32_16x16x32_bf16 a[148:151], v[156:159], v[180:183], a[148:151]
    v_mfma_f32_16x16x32_bf16 a[152:155], v[160:163], v[180:183], a[152:155]
    v_mfma_f32_16x16x32_bf16 a[156:159], v[164:167], v[180:183], a[156:159]
    buffer_load_dwordx4 v[148:151], v14, s[8:11], s20 offen offset:704
    buffer_load_dwordx4 v[152:155], v15, s[8:11], s20 offen offset:704
    buffer_load_dwordx4 v[156:159], v16, s[8:11], s20 offen offset:704
    buffer_load_dwordx4 v[160:163], v17, s[8:11], s20 offen offset:704
    buffer_load_dwordx4 v[164:167], v18, s[8:11], s20 offen offset:704
    buffer_load_dwordx4 v[168:171], v19, s[8:11], s21 offen offset:704 sc1
    buffer_load_dwordx4 v[172:175], v20, s[8:11], s21 offen offset:704 sc1
    buffer_load_dwordx4 v[176:179], v21, s[8:11], s21 offen offset:704 sc1
    buffer_load_dwordx4 v[180:183], v22, s[8:11], s21 offen offset:704 sc1
    s_waitcnt vmcnt(27)
    v_mfma_f32_16x16x32_bf16 a[80:83], v[40:43], v[60:63], a[80:83]
    v_mfma_f32_16x16x32_bf16 a[84:87], v[44:47], v[60:63], a[84:87]
    v_mfma_f32_16x16x32_bf16 a[88:91], v[48:51], v[60:63], a[88:91]
    v_mfma_f32_16x16x32_bf16 a[92:95], v[52:55], v[60:63], a[92:95]
    v_mfma_f32_16x16x32_bf16 a[96:99], v[56:59], v[60:63], a[96:99]
    v_mfma_f32_16x16x32_bf16 a[100:103], v[40:43], v[64:67], a[100:103]
    v_mfma_f32_16x16x32_bf16 a[104:107], v[44:47], v[64:67], a[104:107]
    v_mfma_f32_16x16x32_bf16 a[108:111], v[48:51], v[64:67], a[108:111]
    v_mfma_f32_16x16x32_bf16 a[112:115], v[52:55], v[64:67], a[112:115]
    v_mfma_f32_16x16x32_bf16 a[116:119], v[56:59], v[64:67], a[116:119]
    v_mfma_f32_16x16x32_bf16 a[120:123], v[40:43], v[68:71], a[120:123]
    v_mfma_f32_16x16x32_bf16 a[124:127], v[44:47], v[68:71], a[124:127]
    v_mfma_f32_16x16x32_bf16 a[128:131], v[48:51], v[68:71], a[128:131]
    v_mfma_f32_16x16x32_bf16 a[132:135], v[52:55], v[68:71], a[132:135]
    v_mfma_f32_16x16x32_bf16 a[136:139], v[56:59], v[68:71], a[136:139]
    v_mfma_f32_16x16x32_bf16 a[140:143], v[40:43], v[72:75], a[140:143]
    v_mfma_f32_16x16x32_bf16 a[144:147], v[44:47], v[72:75], a[144:147]
    v_mfma_f32_16x16x32_bf16 a[148:151], v[48:51], v[72:75], a[148:151]
    v_mfma_f32_16x16x32_bf16 a[152:155], v[52:55], v[72:75], a[152:155]
    v_mfma_f32_16x16x32_bf16 a[156:159], v[56:59], v[72:75], a[156:159]
    buffer_load_dwordx4 v[40:43], v14, s[8:11], s20 offen offset:768
    buffer_load_dwordx4 v[44:47], v15, s[8:11], s20 offen offset:768
    buffer_load_dwordx4 v[48:51], v16, s[8:11], s20 offen offset:768
    buffer_load_dwordx4 v[52:55], v17, s[8:11], s20 offen offset:768
    buffer_load_dwordx4 v[56:59], v18, s[8:11], s20 offen offset:768
    buffer_load_dwordx4 v[60:63], v19, s[8:11], s21 offen offset:768 sc1
    buffer_load_dwordx4 v[64:67], v20, s[8:11], s21 offen offset:768 sc1
    buffer_load_dwordx4 v[68:71], v21, s[8:11], s21 offen offset:768 sc1
    buffer_load_dwordx4 v[72:75], v22, s[8:11], s21 offen offset:768 sc1
    s_waitcnt vmcnt(27)
    v_mfma_f32_16x16x32_bf16 a[80:83], v[76:79], v[96:99], a[80:83]
    v_mfma_f32_16x16x32_bf16 a[84:87], v[80:83], v[96:99], a[84:87]
    v_mfma_f32_16x16x32_bf16 a[88:91], v[84:87], v[96:99], a[88:91]
    v_mfma_f32_16x16x32_bf16 a[92:95], v[88:91], v[96:99], a[92:95]
    v_mfma_f32_16x16x32_bf16 a[96:99], v[92:95], v[96:99], a[96:99]
    v_mfma_f32_16x16x32_bf16 a[100:103], v[76:79], v[100:103], a[100:103]
    v_mfma_f32_16x16x32_bf16 a[104:107], v[80:83], v[100:103], a[104:107]
    v_mfma_f32_16x16x32_bf16 a[108:111], v[84:87], v[100:103], a[108:111]
    v_mfma_f32_16x16x32_bf16 a[112:115], v[88:91], v[100:103], a[112:115]
    v_mfma_f32_16x16x32_bf16 a[116:119], v[92:95], v[100:103], a[116:119]
    v_mfma_f32_16x16x32_bf16 a[120:123], v[76:79], v[104:107], a[120:123]
    v_mfma_f32_16x16x32_bf16 a[124:127], v[80:83], v[104:107], a[124:127]
    v_mfma_f32_16x16x32_bf16 a[128:131], v[84:87], v[104:107], a[128:131]
    v_mfma_f32_16x16x32_bf16 a[132:135], v[88:91], v[104:107], a[132:135]
    v_mfma_f32_16x16x32_bf16 a[136:139], v[92:95], v[104:107], a[136:139]
    v_mfma_f32_16x16x32_bf16 a[140:143], v[76:79], v[108:111], a[140:143]
    v_mfma_f32_16x16x32_bf16 a[144:147], v[80:83], v[108:111], a[144:147]
    v_mfma_f32_16x16x32_bf16 a[148:151], v[84:87], v[108:111], a[148:151]
    v_mfma_f32_16x16x32_bf16 a[152:155], v[88:91], v[108:111], a[152:155]
    v_mfma_f32_16x16x32_bf16 a[156:159], v[92:95], v[108:111], a[156:159]
    buffer_load_dwordx4 v[76:79], v14, s[8:11], s20 offen offset:832
    buffer_load_dwordx4 v[80:83], v15, s[8:11], s20 offen offset:832
    buffer_load_dwordx4 v[84:87], v16, s[8:11], s20 offen offset:832
    buffer_load_dwordx4 v[88:91], v17, s[8:11], s20 offen offset:832
    buffer_load_dwordx4 v[92:95], v18, s[8:11], s20 offen offset:832
    buffer_load_dwordx4 v[96:99], v19, s[8:11], s21 offen offset:832 sc1
    buffer_load_dwordx4 v[100:103], v20, s[8:11], s21 offen offset:832 sc1
    buffer_load_dwordx4 v[104:107], v21, s[8:11], s21 offen offset:832 sc1
    buffer_load_dwordx4 v[108:111], v22, s[8:11], s21 offen offset:832 sc1
    s_waitcnt vmcnt(27)
    v_mfma_f32_16x16x32_bf16 a[80:83], v[112:115], v[132:135], a[80:83]
    v_mfma_f32_16x16x32_bf16 a[84:87], v[116:119], v[132:135], a[84:87]
    v_mfma_f32_16x16x32_bf16 a[88:91], v[120:123], v[132:135], a[88:91]
    v_mfma_f32_16x16x32_bf16 a[92:95], v[124:127], v[132:135], a[92:95]
    v_mfma_f32_16x16x32_bf16 a[96:99], v[128:131], v[132:135], a[96:99]
    v_mfma_f32_16x16x32_bf16 a[100:103], v[112:115], v[136:139], a[100:103]
    v_mfma_f32_16x16x32_bf16 a[104:107], v[116:119], v[136:139], a[104:107]
    v_mfma_f32_16x16x32_bf16 a[108:111], v[120:123], v[136:139], a[108:111]
    v_mfma_f32_16x16x32_bf16 a[112:115], v[124:127], v[136:139], a[112:115]
    v_mfma_f32_16x16x32_bf16 a[116:119], v[128:131], v[136:139], a[116:119]
    v_mfma_f32_16x16x32_bf16 a[120:123], v[112:115], v[140:143], a[120:123]
    v_mfma_f32_16x16x32_bf16 a[124:127], v[116:119], v[140:143], a[124:127]
    v_mfma_f32_16x16x32_bf16 a[128:131], v[120:123], v[140:143], a[128:131]
    v_mfma_f32_16x16x32_bf16 a[132:135], v[124:127], v[140:143], a[132:135]
    v_mfma_f32_16x16x32_bf16 a[136:139], v[128:131], v[140:143], a[136:139]
    v_mfma_f32_16x16x32_bf16 a[140:143], v[112:115], v[144:147], a[140:143]
    v_mfma_f32_16x16x32_bf16 a[144:147], v[116:119], v[144:147], a[144:147]
    v_mfma_f32_16x16x32_bf16 a[148:151], v[120:123], v[144:147], a[148:151]
    v_mfma_f32_16x16x32_bf16 a[152:155], v[124:127], v[144:147], a[152:155]
    v_mfma_f32_16x16x32_bf16 a[156:159], v[128:131], v[144:147], a[156:159]
    buffer_load_dwordx4 v[112:115], v14, s[8:11], s20 offen offset:896
    buffer_load_dwordx4 v[116:119], v15, s[8:11], s20 offen offset:896
    buffer_load_dwordx4 v[120:123], v16, s[8:11], s20 offen offset:896
    buffer_load_dwordx4 v[124:127], v17, s[8:11], s20 offen offset:896
    buffer_load_dwordx4 v[128:131], v18, s[8:11], s20 offen offset:896
    buffer_load_dwordx4 v[132:135], v19, s[8:11], s21 offen offset:896 sc1
    buffer_load_dwordx4 v[136:139], v20, s[8:11], s21 offen offset:896 sc1
    buffer_load_dwordx4 v[140:143], v21, s[8:11], s21 offen offset:896 sc1
    buffer_load_dwordx4 v[144:147], v22, s[8:11], s21 offen offset:896 sc1
    s_waitcnt vmcnt(27)
    v_mfma_f32_16x16x32_bf16 a[80:83], v[148:151], v[168:171], a[80:83]
    v_mfma_f32_16x16x32_bf16 a[84:87], v[152:155], v[168:171], a[84:87]
    v_mfma_f32_16x16x32_bf16 a[88:91], v[156:159], v[168:171], a[88:91]
    v_mfma_f32_16x16x32_bf16 a[92:95], v[160:163], v[168:171], a[92:95]
    v_mfma_f32_16x16x32_bf16 a[96:99], v[164:167], v[168:171], a[96:99]
    v_mfma_f32_16x16x32_bf16 a[100:103], v[148:151], v[172:175], a[100:103]
    v_mfma_f32_16x16x32_bf16 a[104:107], v[152:155], v[172:175], a[104:107]
    v_mfma_f32_16x16x32_bf16 a[108:111], v[156:159], v[172:175], a[108:111]
    v_mfma_f32_16x16x32_bf16 a[112:115], v[160:163], v[172:175], a[112:115]
    v_mfma_f32_16x16x32_bf16 a[116:119], v[164:167], v[172:175], a[116:119]
    v_mfma_f32_16x16x32_bf16 a[120:123], v[148:151], v[176:179], a[120:123]
    v_mfma_f32_16x16x32_bf16 a[124:127], v[152:155], v[176:179], a[124:127]
    v_mfma_f32_16x16x32_bf16 a[128:131], v[156:159], v[176:179], a[128:131]
    v_mfma_f32_16x16x32_bf16 a[132:135], v[160:163], v[176:179], a[132:135]
    v_mfma_f32_16x16x32_bf16 a[136:139], v[164:167], v[176:179], a[136:139]
    v_mfma_f32_16x16x32_bf16 a[140:143], v[148:151], v[180:183], a[140:143]
    v_mfma_f32_16x16x32_bf16 a[144:147], v[152:155], v[180:183], a[144:147]
    v_mfma_f32_16x16x32_bf16 a[148:151], v[156:159], v[180:183], a[148:151]
    v_mfma_f32_16x16x32_bf16 a[152:155], v[160:163], v[180:183], a[152:155]
    v_mfma_f32_16x16x32_bf16 a[156:159], v[164:167], v[180:183], a[156:159]
    buffer_load_dwordx4 v[148:151], v14, s[8:11], s20 offen offset:960
    buffer_load_dwordx4 v[152:155], v15, s[8:11], s20 offen offset:960
    buffer_load_dwordx4 v[156:159], v16, s[8:11], s20 offen offset:960
    buffer_load_dwordx4 v[160:163], v17, s[8:11], s20 offen offset:960
    buffer_load_dwordx4 v[164:167], v18, s[8:11], s20 offen offset:960
    buffer_load_dwordx4 v[168:171], v19, s[8:11], s21 offen offset:960 sc1
    buffer_load_dwordx4 v[172:175], v20, s[8:11], s21 offen offset:960 sc1
    buffer_load_dwordx4 v[176:179], v21, s[8:11], s21 offen offset:960 sc1
    buffer_load_dwordx4 v[180:183], v22, s[8:11], s21 offen offset:960 sc1
    s_waitcnt vmcnt(27)
    v_mfma_f32_16x16x32_bf16 a[80:83], v[40:43], v[60:63], a[80:83]
    v_mfma_f32_16x16x32_bf16 a[84:87], v[44:47], v[60:63], a[84:87]
    v_mfma_f32_16x16x32_bf16 a[88:91], v[48:51], v[60:63], a[88:91]
    v_mfma_f32_16x16x32_bf16 a[92:95], v[52:55], v[60:63], a[92:95]
    v_mfma_f32_16x16x32_bf16 a[96:99], v[56:59], v[60:63], a[96:99]
    v_mfma_f32_16x16x32_bf16 a[100:103], v[40:43], v[64:67], a[100:103]
    v_mfma_f32_16x16x32_bf16 a[104:107], v[44:47], v[64:67], a[104:107]
    v_mfma_f32_16x16x32_bf16 a[108:111], v[48:51], v[64:67], a[108:111]
    v_mfma_f32_16x16x32_bf16 a[112:115], v[52:55], v[64:67], a[112:115]
    v_mfma_f32_16x16x32_bf16 a[116:119], v[56:59], v[64:67], a[116:119]
    v_mfma_f32_16x16x32_bf16 a[120:123], v[40:43], v[68:71], a[120:123]
    v_mfma_f32_16x16x32_bf16 a[124:127], v[44:47], v[68:71], a[124:127]
    v_mfma_f32_16x16x32_bf16 a[128:131], v[48:51], v[68:71], a[128:131]
    v_mfma_f32_16x16x32_bf16 a[132:135], v[52:55], v[68:71], a[132:135]
    v_mfma_f32_16x16x32_bf16 a[136:139], v[56:59], v[68:71], a[136:139]
    v_mfma_f32_16x16x32_bf16 a[140:143], v[40:43], v[72:75], a[140:143]
    v_mfma_f32_16x16x32_bf16 a[144:147], v[44:47], v[72:75], a[144:147]
    v_mfma_f32_16x16x32_bf16 a[148:151], v[48:51], v[72:75], a[148:151]
    v_mfma_f32_16x16x32_bf16 a[152:155], v[52:55], v[72:75], a[152:155]
    v_mfma_f32_16x16x32_bf16 a[156:159], v[56:59], v[72:75], a[156:159]
    buffer_load_dwordx4 v[40:43], v14, s[8:11], s20 offen offset:1024
    buffer_load_dwordx4 v[44:47], v15, s[8:11], s20 offen offset:1024
    buffer_load_dwordx4 v[48:51], v16, s[8:11], s20 offen offset:1024
    buffer_load_dwordx4 v[52:55], v17, s[8:11], s20 offen offset:1024
    buffer_load_dwordx4 v[56:59], v18, s[8:11], s20 offen offset:1024
    buffer_load_dwordx4 v[60:63], v19, s[8:11], s21 offen offset:1024 sc1
    buffer_load_dwordx4 v[64:67], v20, s[8:11], s21 offen offset:1024 sc1
    buffer_load_dwordx4 v[68:71], v21, s[8:11], s21 offen offset:1024 sc1
    buffer_load_dwordx4 v[72:75], v22, s[8:11], s21 offen offset:1024 sc1
    s_waitcnt vmcnt(27)
    v_mfma_f32_16x16x32_bf16 a[80:83], v[76:79], v[96:99], a[80:83]
    v_mfma_f32_16x16x32_bf16 a[84:87], v[80:83], v[96:99], a[84:87]
    v_mfma_f32_16x16x32_bf16 a[88:91], v[84:87], v[96:99], a[88:91]
    v_mfma_f32_16x16x32_bf16 a[92:95], v[88:91], v[96:99], a[92:95]
    v_mfma_f32_16x16x32_bf16 a[96:99], v[92:95], v[96:99], a[96:99]
    v_mfma_f32_16x16x32_bf16 a[100:103], v[76:79], v[100:103], a[100:103]
    v_mfma_f32_16x16x32_bf16 a[104:107], v[80:83], v[100:103], a[104:107]
    v_mfma_f32_16x16x32_bf16 a[108:111], v[84:87], v[100:103], a[108:111]
    v_mfma_f32_16x16x32_bf16 a[112:115], v[88:91], v[100:103], a[112:115]
    v_mfma_f32_16x16x32_bf16 a[116:119], v[92:95], v[100:103], a[116:119]
    v_mfma_f32_16x16x32_bf16 a[120:123], v[76:79], v[104:107], a[120:123]
    v_mfma_f32_16x16x32_bf16 a[124:127], v[80:83], v[104:107], a[124:127]
    v_mfma_f32_16x16x32_bf16 a[128:131], v[84:87], v[104:107], a[128:131]
    v_mfma_f32_16x16x32_bf16 a[132:135], v[88:91], v[104:107], a[132:135]
    v_mfma_f32_16x16x32_bf16 a[136:139], v[92:95], v[104:107], a[136:139]
    v_mfma_f32_16x16x32_bf16 a[140:143], v[76:79], v[108:111], a[140:143]
    v_mfma_f32_16x16x32_bf16 a[144:147], v[80:83], v[108:111], a[144:147]
    v_mfma_f32_16x16x32_bf16 a[148:151], v[84:87], v[108:111], a[148:151]
    v_mfma_f32_16x16x32_bf16 a[152:155], v[88:91], v[108:111], a[152:155]
    v_mfma_f32_16x16x32_bf16 a[156:159], v[92:95], v[108:111], a[156:159]
    buffer_load_dwordx4 v[76:79], v14, s[8:11], s20 offen offset:1088
    buffer_load_dwordx4 v[80:83], v15, s[8:11], s20 offen offset:1088
    buffer_load_dwordx4 v[84:87], v16, s[8:11], s20 offen offset:1088
    buffer_load_dwordx4 v[88:91], v17, s[8:11], s20 offen offset:1088
    buffer_load_dwordx4 v[92:95], v18, s[8:11], s20 offen offset:1088
    buffer_load_dwordx4 v[96:99], v19, s[8:11], s21 offen offset:1088 sc1
    buffer_load_dwordx4 v[100:103], v20, s[8:11], s21 offen offset:1088 sc1
    buffer_load_dwordx4 v[104:107], v21, s[8:11], s21 offen offset:1088 sc1
    buffer_load_dwordx4 v[108:111], v22, s[8:11], s21 offen offset:1088 sc1
    s_waitcnt vmcnt(27)
    v_mfma_f32_16x16x32_bf16 a[80:83], v[112:115], v[132:135], a[80:83]
    v_mfma_f32_16x16x32_bf16 a[84:87], v[116:119], v[132:135], a[84:87]
    v_mfma_f32_16x16x32_bf16 a[88:91], v[120:123], v[132:135], a[88:91]
    v_mfma_f32_16x16x32_bf16 a[92:95], v[124:127], v[132:135], a[92:95]
    v_mfma_f32_16x16x32_bf16 a[96:99], v[128:131], v[132:135], a[96:99]
    v_mfma_f32_16x16x32_bf16 a[100:103], v[112:115], v[136:139], a[100:103]
    v_mfma_f32_16x16x32_bf16 a[104:107], v[116:119], v[136:139], a[104:107]
    v_mfma_f32_16x16x32_bf16 a[108:111], v[120:123], v[136:139], a[108:111]
    v_mfma_f32_16x16x32_bf16 a[112:115], v[124:127], v[136:139], a[112:115]
    v_mfma_f32_16x16x32_bf16 a[116:119], v[128:131], v[136:139], a[116:119]
    v_mfma_f32_16x16x32_bf16 a[120:123], v[112:115], v[140:143], a[120:123]
    v_mfma_f32_16x16x32_bf16 a[124:127], v[116:119], v[140:143], a[124:127]
    v_mfma_f32_16x16x32_bf16 a[128:131], v[120:123], v[140:143], a[128:131]
    v_mfma_f32_16x16x32_bf16 a[132:135], v[124:127], v[140:143], a[132:135]
    v_mfma_f32_16x16x32_bf16 a[136:139], v[128:131], v[140:143], a[136:139]
    v_mfma_f32_16x16x32_bf16 a[140:143], v[112:115], v[144:147], a[140:143]
    v_mfma_f32_16x16x32_bf16 a[144:147], v[116:119], v[144:147], a[144:147]
    v_mfma_f32_16x16x32_bf16 a[148:151], v[120:123], v[144:147], a[148:151]
    v_mfma_f32_16x16x32_bf16 a[152:155], v[124:127], v[144:147], a[152:155]
    v_mfma_f32_16x16x32_bf16 a[156:159], v[128:131], v[144:147], a[156:159]
    buffer_load_dwordx4 v[112:115], v14, s[8:11], s20 offen offset:1152
    buffer_load_dwordx4 v[116:119], v15, s[8:11], s20 offen offset:1152
    buffer_load_dwordx4 v[120:123], v16, s[8:11], s20 offen offset:1152
    buffer_load_dwordx4 v[124:127], v17, s[8:11], s20 offen offset:1152
    buffer_load_dwordx4 v[128:131], v18, s[8:11], s20 offen offset:1152
    buffer_load_dwordx4 v[132:135], v19, s[8:11], s21 offen offset:1152 sc1
    buffer_load_dwordx4 v[136:139], v20, s[8:11], s21 offen offset:1152 sc1
    buffer_load_dwordx4 v[140:143], v21, s[8:11], s21 offen offset:1152 sc1
    buffer_load_dwordx4 v[144:147], v22, s[8:11], s21 offen offset:1152 sc1
    s_waitcnt vmcnt(27)
    v_mfma_f32_16x16x32_bf16 a[80:83], v[148:151], v[168:171], a[80:83]
    v_mfma_f32_16x16x32_bf16 a[84:87], v[152:155], v[168:171], a[84:87]
    v_mfma_f32_16x16x32_bf16 a[88:91], v[156:159], v[168:171], a[88:91]
    v_mfma_f32_16x16x32_bf16 a[92:95], v[160:163], v[168:171], a[92:95]
    v_mfma_f32_16x16x32_bf16 a[96:99], v[164:167], v[168:171], a[96:99]
    v_mfma_f32_16x16x32_bf16 a[100:103], v[148:151], v[172:175], a[100:103]
    v_mfma_f32_16x16x32_bf16 a[104:107], v[152:155], v[172:175], a[104:107]
    v_mfma_f32_16x16x32_bf16 a[108:111], v[156:159], v[172:175], a[108:111]
    v_mfma_f32_16x16x32_bf16 a[112:115], v[160:163], v[172:175], a[112:115]
    v_mfma_f32_16x16x32_bf16 a[116:119], v[164:167], v[172:175], a[116:119]
    v_mfma_f32_16x16x32_bf16 a[120:123], v[148:151], v[176:179], a[120:123]
    v_mfma_f32_16x16x32_bf16 a[124:127], v[152:155], v[176:179], a[124:127]
    v_mfma_f32_16x16x32_bf16 a[128:131], v[156:159], v[176:179], a[128:131]
    v_mfma_f32_16x16x32_bf16 a[132:135], v[160:163], v[176:179], a[132:135]
    v_mfma_f32_16x16x32_bf16 a[136:139], v[164:167], v[176:179], a[136:139]
    v_mfma_f32_16x16x32_bf16 a[140:143], v[148:151], v[180:183], a[140:143]
    v_mfma_f32_16x16x32_bf16 a[144:147], v[152:155], v[180:183], a[144:147]
    v_mfma_f32_16x16x32_bf16 a[148:151], v[156:159], v[180:183], a[148:151]
    v_mfma_f32_16x16x32_bf16 a[152:155], v[160:163], v[180:183], a[152:155]
    v_mfma_f32_16x16x32_bf16 a[156:159], v[164:167], v[180:183], a[156:159]
    buffer_load_dwordx4 v[148:151], v14, s[8:11], s20 offen offset:1216
    buffer_load_dwordx4 v[152:155], v15, s[8:11], s20 offen offset:1216
    buffer_load_dwordx4 v[156:159], v16, s[8:11], s20 offen offset:1216
    buffer_load_dwordx4 v[160:163], v17, s[8:11], s20 offen offset:1216
    buffer_load_dwordx4 v[164:167], v18, s[8:11], s20 offen offset:1216
    buffer_load_dwordx4 v[168:171], v19, s[8:11], s21 offen offset:1216 sc1
    buffer_load_dwordx4 v[172:175], v20, s[8:11], s21 offen offset:1216 sc1
    buffer_load_dwordx4 v[176:179], v21, s[8:11], s21 offen offset:1216 sc1
    buffer_load_dwordx4 v[180:183], v22, s[8:11], s21 offen offset:1216 sc1
    s_waitcnt vmcnt(27)
    v_mfma_f32_16x16x32_bf16 a[80:83], v[40:43], v[60:63], a[80:83]
    v_mfma_f32_16x16x32_bf16 a[84:87], v[44:47], v[60:63], a[84:87]
    v_mfma_f32_16x16x32_bf16 a[88:91], v[48:51], v[60:63], a[88:91]
    v_mfma_f32_16x16x32_bf16 a[92:95], v[52:55], v[60:63], a[92:95]
    v_mfma_f32_16x16x32_bf16 a[96:99], v[56:59], v[60:63], a[96:99]
    v_mfma_f32_16x16x32_bf16 a[100:103], v[40:43], v[64:67], a[100:103]
    v_mfma_f32_16x16x32_bf16 a[104:107], v[44:47], v[64:67], a[104:107]
    v_mfma_f32_16x16x32_bf16 a[108:111], v[48:51], v[64:67], a[108:111]
    v_mfma_f32_16x16x32_bf16 a[112:115], v[52:55], v[64:67], a[112:115]
    v_mfma_f32_16x16x32_bf16 a[116:119], v[56:59], v[64:67], a[116:119]
    v_mfma_f32_16x16x32_bf16 a[120:123], v[40:43], v[68:71], a[120:123]
    v_mfma_f32_16x16x32_bf16 a[124:127], v[44:47], v[68:71], a[124:127]
    v_mfma_f32_16x16x32_bf16 a[128:131], v[48:51], v[68:71], a[128:131]
    v_mfma_f32_16x16x32_bf16 a[132:135], v[52:55], v[68:71], a[132:135]
    v_mfma_f32_16x16x32_bf16 a[136:139], v[56:59], v[68:71], a[136:139]
    v_mfma_f32_16x16x32_bf16 a[140:143], v[40:43], v[72:75], a[140:143]
    v_mfma_f32_16x16x32_bf16 a[144:147], v[44:47], v[72:75], a[144:147]
    v_mfma_f32_16x16x32_bf16 a[148:151], v[48:51], v[72:75], a[148:151]
    v_mfma_f32_16x16x32_bf16 a[152:155], v[52:55], v[72:75], a[152:155]
    v_mfma_f32_16x16x32_bf16 a[156:159], v[56:59], v[72:75], a[156:159]
    buffer_load_dwordx4 v[40:43], v14, s[8:11], s20 offen offset:1280
    buffer_load_dwordx4 v[44:47], v15, s[8:11], s20 offen offset:1280
    buffer_load_dwordx4 v[48:51], v16, s[8:11], s20 offen offset:1280
    buffer_load_dwordx4 v[52:55], v17, s[8:11], s20 offen offset:1280
    buffer_load_dwordx4 v[56:59], v18, s[8:11], s20 offen offset:1280
    buffer_load_dwordx4 v[60:63], v19, s[8:11], s21 offen offset:1280 sc1
    buffer_load_dwordx4 v[64:67], v20, s[8:11], s21 offen offset:1280 sc1
    buffer_load_dwordx4 v[68:71], v21, s[8:11], s21 offen offset:1280 sc1
    buffer_load_dwordx4 v[72:75], v22, s[8:11], s21 offen offset:1280 sc1
    s_waitcnt vmcnt(27)
    v_mfma_f32_16x16x32_bf16 a[80:83], v[76:79], v[96:99], a[80:83]
    v_mfma_f32_16x16x32_bf16 a[84:87], v[80:83], v[96:99], a[84:87]
    v_mfma_f32_16x16x32_bf16 a[88:91], v[84:87], v[96:99], a[88:91]
    v_mfma_f32_16x16x32_bf16 a[92:95], v[88:91], v[96:99], a[92:95]
    v_mfma_f32_16x16x32_bf16 a[96:99], v[92:95], v[96:99], a[96:99]
    v_mfma_f32_16x16x32_bf16 a[100:103], v[76:79], v[100:103], a[100:103]
    v_mfma_f32_16x16x32_bf16 a[104:107], v[80:83], v[100:103], a[104:107]
    v_mfma_f32_16x16x32_bf16 a[108:111], v[84:87], v[100:103], a[108:111]
    v_mfma_f32_16x16x32_bf16 a[112:115], v[88:91], v[100:103], a[112:115]
    v_mfma_f32_16x16x32_bf16 a[116:119], v[92:95], v[100:103], a[116:119]
    v_mfma_f32_16x16x32_bf16 a[120:123], v[76:79], v[104:107], a[120:123]
    v_mfma_f32_16x16x32_bf16 a[124:127], v[80:83], v[104:107], a[124:127]
    v_mfma_f32_16x16x32_bf16 a[128:131], v[84:87], v[104:107], a[128:131]
    v_mfma_f32_16x16x32_bf16 a[132:135], v[88:91], v[104:107], a[132:135]
    v_mfma_f32_16x16x32_bf16 a[136:139], v[92:95], v[104:107], a[136:139]
    v_mfma_f32_16x16x32_bf16 a[140:143], v[76:79], v[108:111], a[140:143]
    v_mfma_f32_16x16x32_bf16 a[144:147], v[80:83], v[108:111], a[144:147]
    v_mfma_f32_16x16x32_bf16 a[148:151], v[84:87], v[108:111], a[148:151]
    v_mfma_f32_16x16x32_bf16 a[152:155], v[88:91], v[108:111], a[152:155]
    v_mfma_f32_16x16x32_bf16 a[156:159], v[92:95], v[108:111], a[156:159]
    buffer_load_dwordx4 v[76:79], v14, s[8:11], s20 offen offset:1344
    buffer_load_dwordx4 v[80:83], v15, s[8:11], s20 offen offset:1344
    buffer_load_dwordx4 v[84:87], v16, s[8:11], s20 offen offset:1344
    buffer_load_dwordx4 v[88:91], v17, s[8:11], s20 offen offset:1344
    buffer_load_dwordx4 v[92:95], v18, s[8:11], s20 offen offset:1344
    buffer_load_dwordx4 v[96:99], v19, s[8:11], s21 offen offset:1344 sc1
    buffer_load_dwordx4 v[100:103], v20, s[8:11], s21 offen offset:1344 sc1
    buffer_load_dwordx4 v[104:107], v21, s[8:11], s21 offen offset:1344 sc1
    buffer_load_dwordx4 v[108:111], v22, s[8:11], s21 offen offset:1344 sc1
    s_waitcnt vmcnt(27)
    v_mfma_f32_16x16x32_bf16 a[80:83], v[112:115], v[132:135], a[80:83]
    v_mfma_f32_16x16x32_bf16 a[84:87], v[116:119], v[132:135], a[84:87]
    v_mfma_f32_16x16x32_bf16 a[88:91], v[120:123], v[132:135], a[88:91]
    v_mfma_f32_16x16x32_bf16 a[92:95], v[124:127], v[132:135], a[92:95]
    v_mfma_f32_16x16x32_bf16 a[96:99], v[128:131], v[132:135], a[96:99]
    v_mfma_f32_16x16x32_bf16 a[100:103], v[112:115], v[136:139], a[100:103]
    v_mfma_f32_16x16x32_bf16 a[104:107], v[116:119], v[136:139], a[104:107]
    v_mfma_f32_16x16x32_bf16 a[108:111], v[120:123], v[136:139], a[108:111]
    v_mfma_f32_16x16x32_bf16 a[112:115], v[124:127], v[136:139], a[112:115]
    v_mfma_f32_16x16x32_bf16 a[116:119], v[128:131], v[136:139], a[116:119]
    v_mfma_f32_16x16x32_bf16 a[120:123], v[112:115], v[140:143], a[120:123]
    v_mfma_f32_16x16x32_bf16 a[124:127], v[116:119], v[140:143], a[124:127]
    v_mfma_f32_16x16x32_bf16 a[128:131], v[120:123], v[140:143], a[128:131]
    v_mfma_f32_16x16x32_bf16 a[132:135], v[124:127], v[140:143], a[132:135]
    v_mfma_f32_16x16x32_bf16 a[136:139], v[128:131], v[140:143], a[136:139]
    v_mfma_f32_16x16x32_bf16 a[140:143], v[112:115], v[144:147], a[140:143]
    v_mfma_f32_16x16x32_bf16 a[144:147], v[116:119], v[144:147], a[144:147]
    v_mfma_f32_16x16x32_bf16 a[148:151], v[120:123], v[144:147], a[148:151]
    v_mfma_f32_16x16x32_bf16 a[152:155], v[124:127], v[144:147], a[152:155]
    v_mfma_f32_16x16x32_bf16 a[156:159], v[128:131], v[144:147], a[156:159]
    buffer_load_dwordx4 v[112:115], v14, s[8:11], s20 offen offset:1408
    buffer_load_dwordx4 v[116:119], v15, s[8:11], s20 offen offset:1408
    buffer_load_dwordx4 v[120:123], v16, s[8:11], s20 offen offset:1408
    buffer_load_dwordx4 v[124:127], v17, s[8:11], s20 offen offset:1408
    buffer_load_dwordx4 v[128:131], v18, s[8:11], s20 offen offset:1408
    buffer_load_dwordx4 v[132:135], v19, s[8:11], s21 offen offset:1408 sc1
    buffer_load_dwordx4 v[136:139], v20, s[8:11], s21 offen offset:1408 sc1
    buffer_load_dwordx4 v[140:143], v21, s[8:11], s21 offen offset:1408 sc1
    buffer_load_dwordx4 v[144:147], v22, s[8:11], s21 offen offset:1408 sc1
    s_waitcnt vmcnt(27)
    v_mfma_f32_16x16x32_bf16 a[80:83], v[148:151], v[168:171], a[80:83]
    v_mfma_f32_16x16x32_bf16 a[84:87], v[152:155], v[168:171], a[84:87]
    v_mfma_f32_16x16x32_bf16 a[88:91], v[156:159], v[168:171], a[88:91]
    v_mfma_f32_16x16x32_bf16 a[92:95], v[160:163], v[168:171], a[92:95]
    v_mfma_f32_16x16x32_bf16 a[96:99], v[164:167], v[168:171], a[96:99]
    v_mfma_f32_16x16x32_bf16 a[100:103], v[148:151], v[172:175], a[100:103]
    v_mfma_f32_16x16x32_bf16 a[104:107], v[152:155], v[172:175], a[104:107]
    v_mfma_f32_16x16x32_bf16 a[108:111], v[156:159], v[172:175], a[108:111]
    v_mfma_f32_16x16x32_bf16 a[112:115], v[160:163], v[172:175], a[112:115]
    v_mfma_f32_16x16x32_bf16 a[116:119], v[164:167], v[172:175], a[116:119]
    v_mfma_f32_16x16x32_bf16 a[120:123], v[148:151], v[176:179], a[120:123]
    v_mfma_f32_16x16x32_bf16 a[124:127], v[152:155], v[176:179], a[124:127]
    v_mfma_f32_16x16x32_bf16 a[128:131], v[156:159], v[176:179], a[128:131]
    v_mfma_f32_16x16x32_bf16 a[132:135], v[160:163], v[176:179], a[132:135]
    v_mfma_f32_16x16x32_bf16 a[136:139], v[164:167], v[176:179], a[136:139]
    v_mfma_f32_16x16x32_bf16 a[140:143], v[148:151], v[180:183], a[140:143]
    v_mfma_f32_16x16x32_bf16 a[144:147], v[152:155], v[180:183], a[144:147]
    v_mfma_f32_16x16x32_bf16 a[148:151], v[156:159], v[180:183], a[148:151]
    v_mfma_f32_16x16x32_bf16 a[152:155], v[160:163], v[180:183], a[152:155]
    v_mfma_f32_16x16x32_bf16 a[156:159], v[164:167], v[180:183], a[156:159]
    buffer_load_dwordx4 v[148:151], v14, s[8:11], s20 offen offset:1472
    buffer_load_dwordx4 v[152:155], v15, s[8:11], s20 offen offset:1472
    buffer_load_dwordx4 v[156:159], v16, s[8:11], s20 offen offset:1472
    buffer_load_dwordx4 v[160:163], v17, s[8:11], s20 offen offset:1472
    buffer_load_dwordx4 v[164:167], v18, s[8:11], s20 offen offset:1472
    buffer_load_dwordx4 v[168:171], v19, s[8:11], s21 offen offset:1472 sc1
    buffer_load_dwordx4 v[172:175], v20, s[8:11], s21 offen offset:1472 sc1
    buffer_load_dwordx4 v[176:179], v21, s[8:11], s21 offen offset:1472 sc1
    buffer_load_dwordx4 v[180:183], v22, s[8:11], s21 offen offset:1472 sc1
    s_waitcnt vmcnt(27)
    v_mfma_f32_16x16x32_bf16 a[80:83], v[40:43], v[60:63], a[80:83]
    v_mfma_f32_16x16x32_bf16 a[84:87], v[44:47], v[60:63], a[84:87]
    v_mfma_f32_16x16x32_bf16 a[88:91], v[48:51], v[60:63], a[88:91]
    v_mfma_f32_16x16x32_bf16 a[92:95], v[52:55], v[60:63], a[92:95]
    v_mfma_f32_16x16x32_bf16 a[96:99], v[56:59], v[60:63], a[96:99]
    v_mfma_f32_16x16x32_bf16 a[100:103], v[40:43], v[64:67], a[100:103]
    v_mfma_f32_16x16x32_bf16 a[104:107], v[44:47], v[64:67], a[104:107]
    v_mfma_f32_16x16x32_bf16 a[108:111], v[48:51], v[64:67], a[108:111]
    v_mfma_f32_16x16x32_bf16 a[112:115], v[52:55], v[64:67], a[112:115]
    v_mfma_f32_16x16x32_bf16 a[116:119], v[56:59], v[64:67], a[116:119]
    v_mfma_f32_16x16x32_bf16 a[120:123], v[40:43], v[68:71], a[120:123]
    v_mfma_f32_16x16x32_bf16 a[124:127], v[44:47], v[68:71], a[124:127]
    v_mfma_f32_16x16x32_bf16 a[128:131], v[48:51], v[68:71], a[128:131]
    v_mfma_f32_16x16x32_bf16 a[132:135], v[52:55], v[68:71], a[132:135]
    v_mfma_f32_16x16x32_bf16 a[136:139], v[56:59], v[68:71], a[136:139]
    v_mfma_f32_16x16x32_bf16 a[140:143], v[40:43], v[72:75], a[140:143]
    v_mfma_f32_16x16x32_bf16 a[144:147], v[44:47], v[72:75], a[144:147]
    v_mfma_f32_16x16x32_bf16 a[148:151], v[48:51], v[72:75], a[148:151]
    v_mfma_f32_16x16x32_bf16 a[152:155], v[52:55], v[72:75], a[152:155]
    v_mfma_f32_16x16x32_bf16 a[156:159], v[56:59], v[72:75], a[156:159]
    buffer_load_dwordx4 v[40:43], v14, s[8:11], s20 offen offset:1536
    buffer_load_dwordx4 v[44:47], v15, s[8:11], s20 offen offset:1536
    buffer_load_dwordx4 v[48:51], v16, s[8:11], s20 offen offset:1536
    buffer_load_dwordx4 v[52:55], v17, s[8:11], s20 offen offset:1536
    buffer_load_dwordx4 v[56:59], v18, s[8:11], s20 offen offset:1536
    buffer_load_dwordx4 v[60:63], v19, s[8:11], s21 offen offset:1536 sc1
    buffer_load_dwordx4 v[64:67], v20, s[8:11], s21 offen offset:1536 sc1
    buffer_load_dwordx4 v[68:71], v21, s[8:11], s21 offen offset:1536 sc1
    buffer_load_dwordx4 v[72:75], v22, s[8:11], s21 offen offset:1536 sc1
    s_waitcnt vmcnt(27)
    v_mfma_f32_16x16x32_bf16 a[80:83], v[76:79], v[96:99], a[80:83]
    v_mfma_f32_16x16x32_bf16 a[84:87], v[80:83], v[96:99], a[84:87]
    v_mfma_f32_16x16x32_bf16 a[88:91], v[84:87], v[96:99], a[88:91]
    v_mfma_f32_16x16x32_bf16 a[92:95], v[88:91], v[96:99], a[92:95]
    v_mfma_f32_16x16x32_bf16 a[96:99], v[92:95], v[96:99], a[96:99]
    v_mfma_f32_16x16x32_bf16 a[100:103], v[76:79], v[100:103], a[100:103]
    v_mfma_f32_16x16x32_bf16 a[104:107], v[80:83], v[100:103], a[104:107]
    v_mfma_f32_16x16x32_bf16 a[108:111], v[84:87], v[100:103], a[108:111]
    v_mfma_f32_16x16x32_bf16 a[112:115], v[88:91], v[100:103], a[112:115]
    v_mfma_f32_16x16x32_bf16 a[116:119], v[92:95], v[100:103], a[116:119]
    v_mfma_f32_16x16x32_bf16 a[120:123], v[76:79], v[104:107], a[120:123]
    v_mfma_f32_16x16x32_bf16 a[124:127], v[80:83], v[104:107], a[124:127]
    v_mfma_f32_16x16x32_bf16 a[128:131], v[84:87], v[104:107], a[128:131]
    v_mfma_f32_16x16x32_bf16 a[132:135], v[88:91], v[104:107], a[132:135]
    v_mfma_f32_16x16x32_bf16 a[136:139], v[92:95], v[104:107], a[136:139]
    v_mfma_f32_16x16x32_bf16 a[140:143], v[76:79], v[108:111], a[140:143]
    v_mfma_f32_16x16x32_bf16 a[144:147], v[80:83], v[108:111], a[144:147]
    v_mfma_f32_16x16x32_bf16 a[148:151], v[84:87], v[108:111], a[148:151]
    v_mfma_f32_16x16x32_bf16 a[152:155], v[88:91], v[108:111], a[152:155]
    v_mfma_f32_16x16x32_bf16 a[156:159], v[92:95], v[108:111], a[156:159]
    buffer_load_dwordx4 v[76:79], v14, s[8:11], s20 offen offset:1600
    buffer_load_dwordx4 v[80:83], v15, s[8:11], s20 offen offset:1600
    buffer_load_dwordx4 v[84:87], v16, s[8:11], s20 offen offset:1600
    buffer_load_dwordx4 v[88:91], v17, s[8:11], s20 offen offset:1600
    buffer_load_dwordx4 v[92:95], v18, s[8:11], s20 offen offset:1600
    buffer_load_dwordx4 v[96:99], v19, s[8:11], s21 offen offset:1600 sc1
    buffer_load_dwordx4 v[100:103], v20, s[8:11], s21 offen offset:1600 sc1
    buffer_load_dwordx4 v[104:107], v21, s[8:11], s21 offen offset:1600 sc1
    buffer_load_dwordx4 v[108:111], v22, s[8:11], s21 offen offset:1600 sc1
    s_waitcnt vmcnt(27)
    v_mfma_f32_16x16x32_bf16 a[80:83], v[112:115], v[132:135], a[80:83]
    v_mfma_f32_16x16x32_bf16 a[84:87], v[116:119], v[132:135], a[84:87]
    v_mfma_f32_16x16x32_bf16 a[88:91], v[120:123], v[132:135], a[88:91]
    v_mfma_f32_16x16x32_bf16 a[92:95], v[124:127], v[132:135], a[92:95]
    v_mfma_f32_16x16x32_bf16 a[96:99], v[128:131], v[132:135], a[96:99]
    v_mfma_f32_16x16x32_bf16 a[100:103], v[112:115], v[136:139], a[100:103]
    v_mfma_f32_16x16x32_bf16 a[104:107], v[116:119], v[136:139], a[104:107]
    v_mfma_f32_16x16x32_bf16 a[108:111], v[120:123], v[136:139], a[108:111]
    v_mfma_f32_16x16x32_bf16 a[112:115], v[124:127], v[136:139], a[112:115]
    v_mfma_f32_16x16x32_bf16 a[116:119], v[128:131], v[136:139], a[116:119]
    v_mfma_f32_16x16x32_bf16 a[120:123], v[112:115], v[140:143], a[120:123]
    v_mfma_f32_16x16x32_bf16 a[124:127], v[116:119], v[140:143], a[124:127]
    v_mfma_f32_16x16x32_bf16 a[128:131], v[120:123], v[140:143], a[128:131]
    v_mfma_f32_16x16x32_bf16 a[132:135], v[124:127], v[140:143], a[132:135]
    v_mfma_f32_16x16x32_bf16 a[136:139], v[128:131], v[140:143], a[136:139]
    v_mfma_f32_16x16x32_bf16 a[140:143], v[112:115], v[144:147], a[140:143]
    v_mfma_f32_16x16x32_bf16 a[144:147], v[116:119], v[144:147], a[144:147]
    v_mfma_f32_16x16x32_bf16 a[148:151], v[120:123], v[144:147], a[148:151]
    v_mfma_f32_16x16x32_bf16 a[152:155], v[124:127], v[144:147], a[152:155]
    v_mfma_f32_16x16x32_bf16 a[156:159], v[128:131], v[144:147], a[156:159]
    buffer_load_dwordx4 v[112:115], v14, s[8:11], s20 offen offset:1664
    buffer_load_dwordx4 v[116:119], v15, s[8:11], s20 offen offset:1664
    buffer_load_dwordx4 v[120:123], v16, s[8:11], s20 offen offset:1664
    buffer_load_dwordx4 v[124:127], v17, s[8:11], s20 offen offset:1664
    buffer_load_dwordx4 v[128:131], v18, s[8:11], s20 offen offset:1664
    buffer_load_dwordx4 v[132:135], v19, s[8:11], s21 offen offset:1664 sc1
    buffer_load_dwordx4 v[136:139], v20, s[8:11], s21 offen offset:1664 sc1
    buffer_load_dwordx4 v[140:143], v21, s[8:11], s21 offen offset:1664 sc1
    buffer_load_dwordx4 v[144:147], v22, s[8:11], s21 offen offset:1664 sc1
    s_waitcnt vmcnt(27)
    v_mfma_f32_16x16x32_bf16 a[80:83], v[148:151], v[168:171], a[80:83]
    v_mfma_f32_16x16x32_bf16 a[84:87], v[152:155], v[168:171], a[84:87]
    v_mfma_f32_16x16x32_bf16 a[88:91], v[156:159], v[168:171], a[88:91]
    v_mfma_f32_16x16x32_bf16 a[92:95], v[160:163], v[168:171], a[92:95]
    v_mfma_f32_16x16x32_bf16 a[96:99], v[164:167], v[168:171], a[96:99]
    v_mfma_f32_16x16x32_bf16 a[100:103], v[148:151], v[172:175], a[100:103]
    v_mfma_f32_16x16x32_bf16 a[104:107], v[152:155], v[172:175], a[104:107]
    v_mfma_f32_16x16x32_bf16 a[108:111], v[156:159], v[172:175], a[108:111]
    v_mfma_f32_16x16x32_bf16 a[112:115], v[160:163], v[172:175], a[112:115]
    v_mfma_f32_16x16x32_bf16 a[116:119], v[164:167], v[172:175], a[116:119]
    v_mfma_f32_16x16x32_bf16 a[120:123], v[148:151], v[176:179], a[120:123]
    v_mfma_f32_16x16x32_bf16 a[124:127], v[152:155], v[176:179], a[124:127]
    v_mfma_f32_16x16x32_bf16 a[128:131], v[156:159], v[176:179], a[128:131]
    v_mfma_f32_16x16x32_bf16 a[132:135], v[160:163], v[176:179], a[132:135]
    v_mfma_f32_16x16x32_bf16 a[136:139], v[164:167], v[176:179], a[136:139]
    v_mfma_f32_16x16x32_bf16 a[140:143], v[148:151], v[180:183], a[140:143]
    v_mfma_f32_16x16x32_bf16 a[144:147], v[152:155], v[180:183], a[144:147]
    v_mfma_f32_16x16x32_bf16 a[148:151], v[156:159], v[180:183], a[148:151]
    v_mfma_f32_16x16x32_bf16 a[152:155], v[160:163], v[180:183], a[152:155]
    v_mfma_f32_16x16x32_bf16 a[156:159], v[164:167], v[180:183], a[156:159]
    buffer_load_dwordx4 v[148:151], v14, s[8:11], s20 offen offset:1728
    buffer_load_dwordx4 v[152:155], v15, s[8:11], s20 offen offset:1728
    buffer_load_dwordx4 v[156:159], v16, s[8:11], s20 offen offset:1728
    buffer_load_dwordx4 v[160:163], v17, s[8:11], s20 offen offset:1728
    buffer_load_dwordx4 v[164:167], v18, s[8:11], s20 offen offset:1728
    buffer_load_dwordx4 v[168:171], v19, s[8:11], s21 offen offset:1728 sc1
    buffer_load_dwordx4 v[172:175], v20, s[8:11], s21 offen offset:1728 sc1
    buffer_load_dwordx4 v[176:179], v21, s[8:11], s21 offen offset:1728 sc1
    buffer_load_dwordx4 v[180:183], v22, s[8:11], s21 offen offset:1728 sc1
    s_waitcnt vmcnt(27)
    v_mfma_f32_16x16x32_bf16 a[80:83], v[40:43], v[60:63], a[80:83]
    v_mfma_f32_16x16x32_bf16 a[84:87], v[44:47], v[60:63], a[84:87]
    v_mfma_f32_16x16x32_bf16 a[88:91], v[48:51], v[60:63], a[88:91]
    v_mfma_f32_16x16x32_bf16 a[92:95], v[52:55], v[60:63], a[92:95]
    v_mfma_f32_16x16x32_bf16 a[96:99], v[56:59], v[60:63], a[96:99]
    v_mfma_f32_16x16x32_bf16 a[100:103], v[40:43], v[64:67], a[100:103]
    v_mfma_f32_16x16x32_bf16 a[104:107], v[44:47], v[64:67], a[104:107]
    v_mfma_f32_16x16x32_bf16 a[108:111], v[48:51], v[64:67], a[108:111]
    v_mfma_f32_16x16x32_bf16 a[112:115], v[52:55], v[64:67], a[112:115]
    v_mfma_f32_16x16x32_bf16 a[116:119], v[56:59], v[64:67], a[116:119]
    v_mfma_f32_16x16x32_bf16 a[120:123], v[40:43], v[68:71], a[120:123]
    v_mfma_f32_16x16x32_bf16 a[124:127], v[44:47], v[68:71], a[124:127]
    v_mfma_f32_16x16x32_bf16 a[128:131], v[48:51], v[68:71], a[128:131]
    v_mfma_f32_16x16x32_bf16 a[132:135], v[52:55], v[68:71], a[132:135]
    v_mfma_f32_16x16x32_bf16 a[136:139], v[56:59], v[68:71], a[136:139]
    v_mfma_f32_16x16x32_bf16 a[140:143], v[40:43], v[72:75], a[140:143]
    v_mfma_f32_16x16x32_bf16 a[144:147], v[44:47], v[72:75], a[144:147]
    v_mfma_f32_16x16x32_bf16 a[148:151], v[48:51], v[72:75], a[148:151]
    v_mfma_f32_16x16x32_bf16 a[152:155], v[52:55], v[72:75], a[152:155]
    v_mfma_f32_16x16x32_bf16 a[156:159], v[56:59], v[72:75], a[156:159]
    buffer_load_dwordx4 v[40:43], v14, s[8:11], s20 offen offset:1792
    buffer_load_dwordx4 v[44:47], v15, s[8:11], s20 offen offset:1792
    buffer_load_dwordx4 v[48:51], v16, s[8:11], s20 offen offset:1792
    buffer_load_dwordx4 v[52:55], v17, s[8:11], s20 offen offset:1792
    buffer_load_dwordx4 v[56:59], v18, s[8:11], s20 offen offset:1792
    buffer_load_dwordx4 v[60:63], v19, s[8:11], s21 offen offset:1792 sc1
    buffer_load_dwordx4 v[64:67], v20, s[8:11], s21 offen offset:1792 sc1
    buffer_load_dwordx4 v[68:71], v21, s[8:11], s21 offen offset:1792 sc1
    buffer_load_dwordx4 v[72:75], v22, s[8:11], s21 offen offset:1792 sc1
    s_waitcnt vmcnt(27)
    v_mfma_f32_16x16x32_bf16 a[80:83], v[76:79], v[96:99], a[80:83]
    v_mfma_f32_16x16x32_bf16 a[84:87], v[80:83], v[96:99], a[84:87]
    v_mfma_f32_16x16x32_bf16 a[88:91], v[84:87], v[96:99], a[88:91]
    v_mfma_f32_16x16x32_bf16 a[92:95], v[88:91], v[96:99], a[92:95]
    v_mfma_f32_16x16x32_bf16 a[96:99], v[92:95], v[96:99], a[96:99]
    v_mfma_f32_16x16x32_bf16 a[100:103], v[76:79], v[100:103], a[100:103]
    v_mfma_f32_16x16x32_bf16 a[104:107], v[80:83], v[100:103], a[104:107]
    v_mfma_f32_16x16x32_bf16 a[108:111], v[84:87], v[100:103], a[108:111]
    v_mfma_f32_16x16x32_bf16 a[112:115], v[88:91], v[100:103], a[112:115]
    v_mfma_f32_16x16x32_bf16 a[116:119], v[92:95], v[100:103], a[116:119]
    v_mfma_f32_16x16x32_bf16 a[120:123], v[76:79], v[104:107], a[120:123]
    v_mfma_f32_16x16x32_bf16 a[124:127], v[80:83], v[104:107], a[124:127]
    v_mfma_f32_16x16x32_bf16 a[128:131], v[84:87], v[104:107], a[128:131]
    v_mfma_f32_16x16x32_bf16 a[132:135], v[88:91], v[104:107], a[132:135]
    v_mfma_f32_16x16x32_bf16 a[136:139], v[92:95], v[104:107], a[136:139]
    v_mfma_f32_16x16x32_bf16 a[140:143], v[76:79], v[108:111], a[140:143]
    v_mfma_f32_16x16x32_bf16 a[144:147], v[80:83], v[108:111], a[144:147]
    v_mfma_f32_16x16x32_bf16 a[148:151], v[84:87], v[108:111], a[148:151]
    v_mfma_f32_16x16x32_bf16 a[152:155], v[88:91], v[108:111], a[152:155]
    v_mfma_f32_16x16x32_bf16 a[156:159], v[92:95], v[108:111], a[156:159]
    buffer_load_dwordx4 v[76:79], v14, s[8:11], s20 offen offset:1856
    buffer_load_dwordx4 v[80:83], v15, s[8:11], s20 offen offset:1856
    buffer_load_dwordx4 v[84:87], v16, s[8:11], s20 offen offset:1856
    buffer_load_dwordx4 v[88:91], v17, s[8:11], s20 offen offset:1856
    buffer_load_dwordx4 v[92:95], v18, s[8:11], s20 offen offset:1856
    buffer_load_dwordx4 v[96:99], v19, s[8:11], s21 offen offset:1856 sc1
    buffer_load_dwordx4 v[100:103], v20, s[8:11], s21 offen offset:1856 sc1
    buffer_load_dwordx4 v[104:107], v21, s[8:11], s21 offen offset:1856 sc1
    buffer_load_dwordx4 v[108:111], v22, s[8:11], s21 offen offset:1856 sc1
    s_waitcnt vmcnt(27)
    v_mfma_f32_16x16x32_bf16 a[80:83], v[112:115], v[132:135], a[80:83]
    v_mfma_f32_16x16x32_bf16 a[84:87], v[116:119], v[132:135], a[84:87]
    v_mfma_f32_16x16x32_bf16 a[88:91], v[120:123], v[132:135], a[88:91]
    v_mfma_f32_16x16x32_bf16 a[92:95], v[124:127], v[132:135], a[92:95]
    v_mfma_f32_16x16x32_bf16 a[96:99], v[128:131], v[132:135], a[96:99]
    v_mfma_f32_16x16x32_bf16 a[100:103], v[112:115], v[136:139], a[100:103]
    v_mfma_f32_16x16x32_bf16 a[104:107], v[116:119], v[136:139], a[104:107]
    v_mfma_f32_16x16x32_bf16 a[108:111], v[120:123], v[136:139], a[108:111]
    v_mfma_f32_16x16x32_bf16 a[112:115], v[124:127], v[136:139], a[112:115]
    v_mfma_f32_16x16x32_bf16 a[116:119], v[128:131], v[136:139], a[116:119]
    v_mfma_f32_16x16x32_bf16 a[120:123], v[112:115], v[140:143], a[120:123]
    v_mfma_f32_16x16x32_bf16 a[124:127], v[116:119], v[140:143], a[124:127]
    v_mfma_f32_16x16x32_bf16 a[128:131], v[120:123], v[140:143], a[128:131]
    v_mfma_f32_16x16x32_bf16 a[132:135], v[124:127], v[140:143], a[132:135]
    v_mfma_f32_16x16x32_bf16 a[136:139], v[128:131], v[140:143], a[136:139]
    v_mfma_f32_16x16x32_bf16 a[140:143], v[112:115], v[144:147], a[140:143]
    v_mfma_f32_16x16x32_bf16 a[144:147], v[116:119], v[144:147], a[144:147]
    v_mfma_f32_16x16x32_bf16 a[148:151], v[120:123], v[144:147], a[148:151]
    v_mfma_f32_16x16x32_bf16 a[152:155], v[124:127], v[144:147], a[152:155]
    v_mfma_f32_16x16x32_bf16 a[156:159], v[128:131], v[144:147], a[156:159]
    buffer_load_dwordx4 v[112:115], v14, s[8:11], s20 offen offset:1920
    buffer_load_dwordx4 v[116:119], v15, s[8:11], s20 offen offset:1920
    buffer_load_dwordx4 v[120:123], v16, s[8:11], s20 offen offset:1920
    buffer_load_dwordx4 v[124:127], v17, s[8:11], s20 offen offset:1920
    buffer_load_dwordx4 v[128:131], v18, s[8:11], s20 offen offset:1920
    buffer_load_dwordx4 v[132:135], v19, s[8:11], s21 offen offset:1920 sc1
    buffer_load_dwordx4 v[136:139], v20, s[8:11], s21 offen offset:1920 sc1
    buffer_load_dwordx4 v[140:143], v21, s[8:11], s21 offen offset:1920 sc1
    buffer_load_dwordx4 v[144:147], v22, s[8:11], s21 offen offset:1920 sc1
    s_waitcnt vmcnt(27)
    v_mfma_f32_16x16x32_bf16 a[80:83], v[148:151], v[168:171], a[80:83]
    v_mfma_f32_16x16x32_bf16 a[84:87], v[152:155], v[168:171], a[84:87]
    v_mfma_f32_16x16x32_bf16 a[88:91], v[156:159], v[168:171], a[88:91]
    v_mfma_f32_16x16x32_bf16 a[92:95], v[160:163], v[168:171], a[92:95]
    v_mfma_f32_16x16x32_bf16 a[96:99], v[164:167], v[168:171], a[96:99]
    v_mfma_f32_16x16x32_bf16 a[100:103], v[148:151], v[172:175], a[100:103]
    v_mfma_f32_16x16x32_bf16 a[104:107], v[152:155], v[172:175], a[104:107]
    v_mfma_f32_16x16x32_bf16 a[108:111], v[156:159], v[172:175], a[108:111]
    v_mfma_f32_16x16x32_bf16 a[112:115], v[160:163], v[172:175], a[112:115]
    v_mfma_f32_16x16x32_bf16 a[116:119], v[164:167], v[172:175], a[116:119]
    v_mfma_f32_16x16x32_bf16 a[120:123], v[148:151], v[176:179], a[120:123]
    v_mfma_f32_16x16x32_bf16 a[124:127], v[152:155], v[176:179], a[124:127]
    v_mfma_f32_16x16x32_bf16 a[128:131], v[156:159], v[176:179], a[128:131]
    v_mfma_f32_16x16x32_bf16 a[132:135], v[160:163], v[176:179], a[132:135]
    v_mfma_f32_16x16x32_bf16 a[136:139], v[164:167], v[176:179], a[136:139]
    v_mfma_f32_16x16x32_bf16 a[140:143], v[148:151], v[180:183], a[140:143]
    v_mfma_f32_16x16x32_bf16 a[144:147], v[152:155], v[180:183], a[144:147]
    v_mfma_f32_16x16x32_bf16 a[148:151], v[156:159], v[180:183], a[148:151]
    v_mfma_f32_16x16x32_bf16 a[152:155], v[160:163], v[180:183], a[152:155]
    v_mfma_f32_16x16x32_bf16 a[156:159], v[164:167], v[180:183], a[156:159]
    buffer_load_dwordx4 v[148:151], v14, s[8:11], s20 offen offset:1984
    buffer_load_dwordx4 v[152:155], v15, s[8:11], s20 offen offset:1984
    buffer_load_dwordx4 v[156:159], v16, s[8:11], s20 offen offset:1984
    buffer_load_dwordx4 v[160:163], v17, s[8:11], s20 offen offset:1984
    buffer_load_dwordx4 v[164:167], v18, s[8:11], s20 offen offset:1984
    buffer_load_dwordx4 v[168:171], v19, s[8:11], s21 offen offset:1984 sc1
    buffer_load_dwordx4 v[172:175], v20, s[8:11], s21 offen offset:1984 sc1
    buffer_load_dwordx4 v[176:179], v21, s[8:11], s21 offen offset:1984 sc1
    buffer_load_dwordx4 v[180:183], v22, s[8:11], s21 offen offset:1984 sc1
    s_waitcnt vmcnt(27)
    v_mfma_f32_16x16x32_bf16 a[80:83], v[40:43], v[60:63], a[80:83]
    v_mfma_f32_16x16x32_bf16 a[84:87], v[44:47], v[60:63], a[84:87]
    v_mfma_f32_16x16x32_bf16 a[88:91], v[48:51], v[60:63], a[88:91]
    v_mfma_f32_16x16x32_bf16 a[92:95], v[52:55], v[60:63], a[92:95]
    v_mfma_f32_16x16x32_bf16 a[96:99], v[56:59], v[60:63], a[96:99]
    v_mfma_f32_16x16x32_bf16 a[100:103], v[40:43], v[64:67], a[100:103]
    v_mfma_f32_16x16x32_bf16 a[104:107], v[44:47], v[64:67], a[104:107]
    v_mfma_f32_16x16x32_bf16 a[108:111], v[48:51], v[64:67], a[108:111]
    v_mfma_f32_16x16x32_bf16 a[112:115], v[52:55], v[64:67], a[112:115]
    v_mfma_f32_16x16x32_bf16 a[116:119], v[56:59], v[64:67], a[116:119]
    v_mfma_f32_16x16x32_bf16 a[120:123], v[40:43], v[68:71], a[120:123]
    v_mfma_f32_16x16x32_bf16 a[124:127], v[44:47], v[68:71], a[124:127]
    v_mfma_f32_16x16x32_bf16 a[128:131], v[48:51], v[68:71], a[128:131]
    v_mfma_f32_16x16x32_bf16 a[132:135], v[52:55], v[68:71], a[132:135]
    v_mfma_f32_16x16x32_bf16 a[136:139], v[56:59], v[68:71], a[136:139]
    v_mfma_f32_16x16x32_bf16 a[140:143], v[40:43], v[72:75], a[140:143]
    v_mfma_f32_16x16x32_bf16 a[144:147], v[44:47], v[72:75], a[144:147]
    v_mfma_f32_16x16x32_bf16 a[148:151], v[48:51], v[72:75], a[148:151]
    v_mfma_f32_16x16x32_bf16 a[152:155], v[52:55], v[72:75], a[152:155]
    v_mfma_f32_16x16x32_bf16 a[156:159], v[56:59], v[72:75], a[156:159]
    s_waitcnt vmcnt(18)
    v_mfma_f32_16x16x32_bf16 a[80:83], v[76:79], v[96:99], a[80:83]
    v_mfma_f32_16x16x32_bf16 a[84:87], v[80:83], v[96:99], a[84:87]
    v_mfma_f32_16x16x32_bf16 a[88:91], v[84:87], v[96:99], a[88:91]
    v_mfma_f32_16x16x32_bf16 a[92:95], v[88:91], v[96:99], a[92:95]
    v_mfma_f32_16x16x32_bf16 a[96:99], v[92:95], v[96:99], a[96:99]
    v_mfma_f32_16x16x32_bf16 a[100:103], v[76:79], v[100:103], a[100:103]
    v_mfma_f32_16x16x32_bf16 a[104:107], v[80:83], v[100:103], a[104:107]
    v_mfma_f32_16x16x32_bf16 a[108:111], v[84:87], v[100:103], a[108:111]
    v_mfma_f32_16x16x32_bf16 a[112:115], v[88:91], v[100:103], a[112:115]
    v_mfma_f32_16x16x32_bf16 a[116:119], v[92:95], v[100:103], a[116:119]
    v_mfma_f32_16x16x32_bf16 a[120:123], v[76:79], v[104:107], a[120:123]
    v_mfma_f32_16x16x32_bf16 a[124:127], v[80:83], v[104:107], a[124:127]
    v_mfma_f32_16x16x32_bf16 a[128:131], v[84:87], v[104:107], a[128:131]
    v_mfma_f32_16x16x32_bf16 a[132:135], v[88:91], v[104:107], a[132:135]
    v_mfma_f32_16x16x32_bf16 a[136:139], v[92:95], v[104:107], a[136:139]
    v_mfma_f32_16x16x32_bf16 a[140:143], v[76:79], v[108:111], a[140:143]
    v_mfma_f32_16x16x32_bf16 a[144:147], v[80:83], v[108:111], a[144:147]
    v_mfma_f32_16x16x32_bf16 a[148:151], v[84:87], v[108:111], a[148:151]
    v_mfma_f32_16x16x32_bf16 a[152:155], v[88:91], v[108:111], a[152:155]
    v_mfma_f32_16x16x32_bf16 a[156:159], v[92:95], v[108:111], a[156:159]
    s_waitcnt vmcnt(9)
    v_mfma_f32_16x16x32_bf16 a[80:83], v[112:115], v[132:135], a[80:83]
    v_mfma_f32_16x16x32_bf16 a[84:87], v[116:119], v[132:135], a[84:87]
    v_mfma_f32_16x16x32_bf16 a[88:91], v[120:123], v[132:135], a[88:91]
    v_mfma_f32_16x16x32_bf16 a[92:95], v[124:127], v[132:135], a[92:95]
    v_mfma_f32_16x16x32_bf16 a[96:99], v[128:131], v[132:135], a[96:99]
    v_mfma_f32_16x16x32_bf16 a[100:103], v[112:115], v[136:139], a[100:103]
    v_mfma_f32_16x16x32_bf16 a[104:107], v[116:119], v[136:139], a[104:107]
    v_mfma_f32_16x16x32_bf16 a[108:111], v[120:123], v[136:139], a[108:111]
    v_mfma_f32_16x16x32_bf16 a[112:115], v[124:127], v[136:139], a[112:115]
    v_mfma_f32_16x16x32_bf16 a[116:119], v[128:131], v[136:139], a[116:119]
    v_mfma_f32_16x16x32_bf16 a[120:123], v[112:115], v[140:143], a[120:123]
    v_mfma_f32_16x16x32_bf16 a[124:127], v[116:119], v[140:143], a[124:127]
    v_mfma_f32_16x16x32_bf16 a[128:131], v[120:123], v[140:143], a[128:131]
    v_mfma_f32_16x16x32_bf16 a[132:135], v[124:127], v[140:143], a[132:135]
    v_mfma_f32_16x16x32_bf16 a[136:139], v[128:131], v[140:143], a[136:139]
    v_mfma_f32_16x16x32_bf16 a[140:143], v[112:115], v[144:147], a[140:143]
    v_mfma_f32_16x16x32_bf16 a[144:147], v[116:119], v[144:147], a[144:147]
    v_mfma_f32_16x16x32_bf16 a[148:151], v[120:123], v[144:147], a[148:151]
    v_mfma_f32_16x16x32_bf16 a[152:155], v[124:127], v[144:147], a[152:155]
    v_mfma_f32_16x16x32_bf16 a[156:159], v[128:131], v[144:147], a[156:159]
    buffer_load_dword v36, v6, s[8:11], 0 offen
    s_waitcnt vmcnt(1)
    v_mfma_f32_16x16x32_bf16 a[80:83], v[148:151], v[168:171], a[80:83]
    v_mfma_f32_16x16x32_bf16 a[84:87], v[152:155], v[168:171], a[84:87]
    v_mfma_f32_16x16x32_bf16 a[88:91], v[156:159], v[168:171], a[88:91]
    v_mfma_f32_16x16x32_bf16 a[92:95], v[160:163], v[168:171], a[92:95]
    v_mfma_f32_16x16x32_bf16 a[96:99], v[164:167], v[168:171], a[96:99]
    v_mfma_f32_16x16x32_bf16 a[100:103], v[148:151], v[172:175], a[100:103]
    v_mfma_f32_16x16x32_bf16 a[104:107], v[152:155], v[172:175], a[104:107]
    v_mfma_f32_16x16x32_bf16 a[108:111], v[156:159], v[172:175], a[108:111]
    v_mfma_f32_16x16x32_bf16 a[112:115], v[160:163], v[172:175], a[112:115]
    v_mfma_f32_16x16x32_bf16 a[116:119], v[164:167], v[172:175], a[116:119]
    v_mfma_f32_16x16x32_bf16 a[120:123], v[148:151], v[176:179], a[120:123]
    v_mfma_f32_16x16x32_bf16 a[124:127], v[152:155], v[176:179], a[124:127]
    v_mfma_f32_16x16x32_bf16 a[128:131], v[156:159], v[176:179], a[128:131]
    v_mfma_f32_16x16x32_bf16 a[132:135], v[160:163], v[176:179], a[132:135]
    v_mfma_f32_16x16x32_bf16 a[136:139], v[164:167], v[176:179], a[136:139]
    v_mfma_f32_16x16x32_bf16 a[140:143], v[148:151], v[180:183], a[140:143]
    v_mfma_f32_16x16x32_bf16 a[144:147], v[152:155], v[180:183], a[144:147]
    v_mfma_f32_16x16x32_bf16 a[148:151], v[156:159], v[180:183], a[148:151]
    v_mfma_f32_16x16x32_bf16 a[152:155], v[160:163], v[180:183], a[152:155]
    v_mfma_f32_16x16x32_bf16 a[156:159], v[164:167], v[180:183], a[156:159]
    s_nop 9
    ds_write_b128 v32, a[80:83] offset:0
    ds_write_b128 v32, a[84:87] offset:1024
    ds_write_b128 v32, a[88:91] offset:2048
    ds_write_b128 v32, a[92:95] offset:3072
    ds_write_b128 v32, a[96:99] offset:4096
    ds_write_b128 v32, a[100:103] offset:20480
    ds_write_b128 v32, a[104:107] offset:21504
    ds_write_b128 v32, a[108:111] offset:22528
    ds_write_b128 v32, a[112:115] offset:23552
    ds_write_b128 v32, a[116:119] offset:24576
    ds_write_b128 v33, a[120:123] offset:0
    ds_write_b128 v33, a[124:127] offset:1024
    ds_write_b128 v33, a[128:131] offset:2048
    ds_write_b128 v33, a[132:135] offset:3072
    ds_write_b128 v33, a[136:139] offset:4096
    ds_write_b128 v33, a[140:143] offset:20480
    ds_write_b128 v33, a[144:147] offset:21504
    ds_write_b128 v33, a[148:151] offset:22528
    ds_write_b128 v33, a[152:155] offset:23552
    ds_write_b128 v33, a[156:159] offset:24576
    s_waitcnt lgkmcnt(0)
    s_barrier
    ds_read_b128 v[40:43], v34 offset:0
    ds_read_b128 v[44:47], v34 offset:1024
    ds_read_b128 v[48:51], v34 offset:2048
    ds_read_b128 v[52:55], v34 offset:3072
    ds_read_b128 v[56:59], v34 offset:4096
    ds_read_b128 v[60:63], v34 offset:5120
    ds_read_b128 v[64:67], v34 offset:6144
    ds_read_b128 v[68:71], v34 offset:7168
    ds_read_b128 v[72:75], v34 offset:8192
    ds_read_b128 v[76:79], v34 offset:9216
    ds_read_b128 v[80:83], v34 offset:10240
    ds_read_b128 v[84:87], v34 offset:11264
    ds_read_b128 v[88:91], v34 offset:12288
    ds_read_b128 v[92:95], v34 offset:13312
    ds_read_b128 v[96:99], v34 offset:14336
    ds_read_b128 v[100:103], v34 offset:15360
    ds_read_b128 v[104:107], v34 offset:16384
    ds_read_b128 v[108:111], v34 offset:17408
    ds_read_b128 v[112:115], v34 offset:18432
    ds_read_b128 v[116:119], v34 offset:19456
    s_waitcnt lgkmcnt(0)
    v_add_f32 v40, v40, v60
    v_add_f32 v80, v80, v100
    v_add_f32 v120, v40, v80
    v_add_f32 v41, v41, v61
    v_add_f32 v81, v81, v101
    v_add_f32 v121, v41, v81
    v_add_f32 v42, v42, v62
    v_add_f32 v82, v82, v102
    v_add_f32 v122, v42, v82
    v_add_f32 v43, v43, v63
    v_add_f32 v83, v83, v103
    v_add_f32 v123, v43, v83
    v_add_f32 v44, v44, v64
    v_add_f32 v84, v84, v104
    v_add_f32 v124, v44, v84
    v_add_f32 v45, v45, v65
    v_add_f32 v85, v85, v105
    v_add_f32 v125, v45, v85
    v_add_f32 v46, v46, v66
    v_add_f32 v86, v86, v106
    v_add_f32 v126, v46, v86
    v_add_f32 v47, v47, v67
    v_add_f32 v87, v87, v107
    v_add_f32 v127, v47, v87
    v_add_f32 v48, v48, v68
    v_add_f32 v88, v88, v108
    v_add_f32 v128, v48, v88
    v_add_f32 v49, v49, v69
    v_add_f32 v89, v89, v109
    v_add_f32 v129, v49, v89
    v_add_f32 v50, v50, v70
    v_add_f32 v90, v90, v110
    v_add_f32 v130, v50, v90
    v_add_f32 v51, v51, v71
    v_add_f32 v91, v91, v111
    v_add_f32 v131, v51, v91
    v_add_f32 v52, v52, v72
    v_add_f32 v92, v92, v112
    v_add_f32 v132, v52, v92
    v_add_f32 v53, v53, v73
    v_add_f32 v93, v93, v113
    v_add_f32 v133, v53, v93
    v_add_f32 v54, v54, v74
    v_add_f32 v94, v94, v114
    v_add_f32 v134, v54, v94
    v_add_f32 v55, v55, v75
    v_add_f32 v95, v95, v115
    v_add_f32 v135, v55, v95
    v_add_f32 v56, v56, v76
    v_add_f32 v96, v96, v116
    v_add_f32 v136, v56, v96
    v_add_f32 v57, v57, v77
    v_add_f32 v97, v97, v117
    v_add_f32 v137, v57, v97
    v_add_f32 v58, v58, v78
    v_add_f32 v98, v98, v118
    v_add_f32 v138, v58, v98
    v_add_f32 v59, v59, v79
    v_add_f32 v99, v99, v119
    v_add_f32 v139, v59, v99
    s_barrier
    ds_write_b128 v32, a[0:3] offset:0
    ds_write_b128 v32, a[4:7] offset:1024
    ds_write_b128 v32, a[8:11] offset:2048
    ds_write_b128 v32, a[12:15] offset:3072
    ds_write_b128 v32, a[16:19] offset:4096
    ds_write_b128 v32, a[20:23] offset:20480
    ds_write_b128 v32, a[24:27] offset:21504
    ds_write_b128 v32, a[28:31] offset:22528
    ds_write_b128 v32, a[32:35] offset:23552
    ds_write_b128 v32, a[36:39] offset:24576
    ds_write_b128 v33, a[40:43] offset:0
    ds_write_b128 v33, a[44:47] offset:1024
    ds_write_b128 v33, a[48:51] offset:2048
    ds_write_b128 v33, a[52:55] offset:3072
    ds_write_b128 v33, a[56:59] offset:4096
    ds_write_b128 v33, a[60:63] offset:20480
    ds_write_b128 v33, a[64:67] offset:21504
    ds_write_b128 v33, a[68:71] offset:22528
    ds_write_b128 v33, a[72:75] offset:23552
    ds_write_b128 v33, a[76:79] offset:24576
    s_waitcnt lgkmcnt(0)
    s_barrier
    ds_read_b128 v[40:43], v34 offset:0
    ds_read_b128 v[44:47], v34 offset:1024
    ds_read_b128 v[48:51], v34 offset:2048
    ds_read_b128 v[52:55], v34 offset:3072
    ds_read_b128 v[56:59], v34 offset:4096
    ds_read_b128 v[60:63], v34 offset:5120
    ds_read_b128 v[64:67], v34 offset:6144
    ds_read_b128 v[68:71], v34 offset:7168
    ds_read_b128 v[72:75], v34 offset:8192
    ds_read_b128 v[76:79], v34 offset:9216
    ds_read_b128 v[80:83], v34 offset:10240
    ds_read_b128 v[84:87], v34 offset:11264
    ds_read_b128 v[88:91], v34 offset:12288
    ds_read_b128 v[92:95], v34 offset:13312
    ds_read_b128 v[96:99], v34 offset:14336
    ds_read_b128 v[100:103], v34 offset:15360
    ds_read_b128 v[104:107], v34 offset:16384
    ds_read_b128 v[108:111], v34 offset:17408
    ds_read_b128 v[112:115], v34 offset:18432
    ds_read_b128 v[116:119], v34 offset:19456
    s_waitcnt lgkmcnt(0)
    v_add_f32 v40, v40, v60
    v_add_f32 v80, v80, v100
    v_add_f32 v184, v40, v80
    v_add_f32 v41, v41, v61
    v_add_f32 v81, v81, v101
    v_add_f32 v185, v41, v81
    v_add_f32 v42, v42, v62
    v_add_f32 v82, v82, v102
    v_add_f32 v186, v42, v82
    v_add_f32 v43, v43, v63
    v_add_f32 v83, v83, v103
    v_add_f32 v187, v43, v83
    v_add_f32 v44, v44, v64
    v_add_f32 v84, v84, v104
    v_add_f32 v188, v44, v84
    v_add_f32 v45, v45, v65
    v_add_f32 v85, v85, v105
    v_add_f32 v189, v45, v85
    v_add_f32 v46, v46, v66
    v_add_f32 v86, v86, v106
    v_add_f32 v190, v46, v86
    v_add_f32 v47, v47, v67
    v_add_f32 v87, v87, v107
    v_add_f32 v191, v47, v87
    v_add_f32 v48, v48, v68
    v_add_f32 v88, v88, v108
    v_add_f32 v192, v48, v88
    v_add_f32 v49, v49, v69
    v_add_f32 v89, v89, v109
    v_add_f32 v193, v49, v89
    v_add_f32 v50, v50, v70
    v_add_f32 v90, v90, v110
    v_add_f32 v194, v50, v90
    v_add_f32 v51, v51, v71
    v_add_f32 v91, v91, v111
    v_add_f32 v195, v51, v91
    v_add_f32 v52, v52, v72
    v_add_f32 v92, v92, v112
    v_add_f32 v196, v52, v92
    v_add_f32 v53, v53, v73
    v_add_f32 v93, v93, v113
    v_add_f32 v197, v53, v93
    v_add_f32 v54, v54, v74
    v_add_f32 v94, v94, v114
    v_add_f32 v198, v54, v94
    v_add_f32 v55, v55, v75
    v_add_f32 v95, v95, v115
    v_add_f32 v199, v55, v95
    v_add_f32 v56, v56, v76
    v_add_f32 v96, v96, v116
    v_add_f32 v200, v56, v96
    v_add_f32 v57, v57, v77
    v_add_f32 v97, v97, v117
    v_add_f32 v201, v57, v97
    v_add_f32 v58, v58, v78
    v_add_f32 v98, v98, v118
    v_add_f32 v202, v58, v98
    v_add_f32 v59, v59, v79
    v_add_f32 v99, v99, v119
    v_add_f32 v203, v59, v99
    s_barrier
    s_cmp_ge_u32 s40, 4
    s_cbranch_scc1 Lf_end
    s_waitcnt vmcnt(0)
    v_sub_f32 v37, 1.0, v36
    v_cvt_pk_bf16_f32 v37, v37, v37
    v_lshlrev_b32 v37, 16, v37
    v_cvt_pk_bf16_f32 v12, v184, v185
    v_lshlrev_b32 v184, 16, v12
    v_and_b32 v185, 0xffff0000, v12
    v_cvt_pk_bf16_f32 v12, v120, v121
    v_lshlrev_b32 v120, 16, v12
    v_and_b32 v121, 0xffff0000, v12
    v_mul_f32 v184, v36, v184
    v_mul_f32 v120, v37, v120
    v_mul_f32 v185, v36, v185
    v_mul_f32 v121, v37, v121
    v_cvt_pk_bf16_f32 v12, v184, v185
    v_lshlrev_b32 v184, 16, v12
    v_and_b32 v185, 0xffff0000, v12
    v_cvt_pk_bf16_f32 v12, v120, v121
    v_lshlrev_b32 v120, 16, v12
    v_and_b32 v121, 0xffff0000, v12
    v_add_f32 v184, v184, v120
    v_add_f32 v185, v185, v121
    v_cvt_pk_bf16_f32 v12, v186, v187
    v_lshlrev_b32 v186, 16, v12
    v_and_b32 v187, 0xffff0000, v12
    v_cvt_pk_bf16_f32 v12, v122, v123
    v_lshlrev_b32 v122, 16, v12
    v_and_b32 v123, 0xffff0000, v12
    v_mul_f32 v186, v36, v186
    v_mul_f32 v122, v37, v122
    v_mul_f32 v187, v36, v187
    v_mul_f32 v123, v37, v123
    v_cvt_pk_bf16_f32 v12, v186, v187
    v_lshlrev_b32 v186, 16, v12
    v_and_b32 v187, 0xffff0000, v12
    v_cvt_pk_bf16_f32 v12, v122, v123
    v_lshlrev_b32 v122, 16, v12
    v_and_b32 v123, 0xffff0000, v12
    v_add_f32 v186, v186, v122
    v_add_f32 v187, v187, v123
    v_cvt_pk_bf16_f32 v8, v184, v185
    v_cvt_pk_bf16_f32 v9, v186, v187
    buffer_store_dwordx2 v[8:9], v35, s[12:15], 0 offen offset:0
    v_cvt_pk_bf16_f32 v12, v188, v189
    v_lshlrev_b32 v188, 16, v12
    v_and_b32 v189, 0xffff0000, v12
    v_cvt_pk_bf16_f32 v12, v124, v125
    v_lshlrev_b32 v124, 16, v12
    v_and_b32 v125, 0xffff0000, v12
    v_mul_f32 v188, v36, v188
    v_mul_f32 v124, v37, v124
    v_mul_f32 v189, v36, v189
    v_mul_f32 v125, v37, v125
    v_cvt_pk_bf16_f32 v12, v188, v189
    v_lshlrev_b32 v188, 16, v12
    v_and_b32 v189, 0xffff0000, v12
    v_cvt_pk_bf16_f32 v12, v124, v125
    v_lshlrev_b32 v124, 16, v12
    v_and_b32 v125, 0xffff0000, v12
    v_add_f32 v188, v188, v124
    v_add_f32 v189, v189, v125
    v_cvt_pk_bf16_f32 v12, v190, v191
    v_lshlrev_b32 v190, 16, v12
    v_and_b32 v191, 0xffff0000, v12
    v_cvt_pk_bf16_f32 v12, v126, v127
    v_lshlrev_b32 v126, 16, v12
    v_and_b32 v127, 0xffff0000, v12
    v_mul_f32 v190, v36, v190
    v_mul_f32 v126, v37, v126
    v_mul_f32 v191, v36, v191
    v_mul_f32 v127, v37, v127
    v_cvt_pk_bf16_f32 v12, v190, v191
    v_lshlrev_b32 v190, 16, v12
    v_and_b32 v191, 0xffff0000, v12
    v_cvt_pk_bf16_f32 v12, v126, v127
    v_lshlrev_b32 v126, 16, v12
    v_and_b32 v127, 0xffff0000, v12
    v_add_f32 v190, v190, v126
    v_add_f32 v191, v191, v127
    v_cvt_pk_bf16_f32 v10, v188, v189
    v_cvt_pk_bf16_f32 v11, v190, v191
    buffer_store_dwordx2 v[10:11], v35, s[12:15], 0 offen offset:32
    v_cvt_pk_bf16_f32 v12, v192, v193
    v_lshlrev_b32 v192, 16, v12
    v_and_b32 v193, 0xffff0000, v12
    v_cvt_pk_bf16_f32 v12, v128, v129
    v_lshlrev_b32 v128, 16, v12
    v_and_b32 v129, 0xffff0000, v12
    v_mul_f32 v192, v36, v192
    v_mul_f32 v128, v37, v128
    v_mul_f32 v193, v36, v193
    v_mul_f32 v129, v37, v129
    v_cvt_pk_bf16_f32 v12, v192, v193
    v_lshlrev_b32 v192, 16, v12
    v_and_b32 v193, 0xffff0000, v12
    v_cvt_pk_bf16_f32 v12, v128, v129
    v_lshlrev_b32 v128, 16, v12
    v_and_b32 v129, 0xffff0000, v12
    v_add_f32 v192, v192, v128
    v_add_f32 v193, v193, v129
    v_cvt_pk_bf16_f32 v12, v194, v195
    v_lshlrev_b32 v194, 16, v12
    v_and_b32 v195, 0xffff0000, v12
    v_cvt_pk_bf16_f32 v12, v130, v131
    v_lshlrev_b32 v130, 16, v12
    v_and_b32 v131, 0xffff0000, v12
    v_mul_f32 v194, v36, v194
    v_mul_f32 v130, v37, v130
    v_mul_f32 v195, v36, v195
    v_mul_f32 v131, v37, v131
    v_cvt_pk_bf16_f32 v12, v194, v195
    v_lshlrev_b32 v194, 16, v12
    v_and_b32 v195, 0xffff0000, v12
    v_cvt_pk_bf16_f32 v12, v130, v131
    v_lshlrev_b32 v130, 16, v12
    v_and_b32 v131, 0xffff0000, v12
    v_add_f32 v194, v194, v130
    v_add_f32 v195, v195, v131
    v_cvt_pk_bf16_f32 v8, v192, v193
    v_cvt_pk_bf16_f32 v9, v194, v195
    buffer_store_dwordx2 v[8:9], v35, s[12:15], 0 offen offset:64
    v_cvt_pk_bf16_f32 v12, v196, v197
    v_lshlrev_b32 v196, 16, v12
    v_and_b32 v197, 0xffff0000, v12
    v_cvt_pk_bf16_f32 v12, v132, v133
    v_lshlrev_b32 v132, 16, v12
    v_and_b32 v133, 0xffff0000, v12
    v_mul_f32 v196, v36, v196
    v_mul_f32 v132, v37, v132
    v_mul_f32 v197, v36, v197
    v_mul_f32 v133, v37, v133
    v_cvt_pk_bf16_f32 v12, v196, v197
    v_lshlrev_b32 v196, 16, v12
    v_and_b32 v197, 0xffff0000, v12
    v_cvt_pk_bf16_f32 v12, v132, v133
    v_lshlrev_b32 v132, 16, v12
    v_and_b32 v133, 0xffff0000, v12
    v_add_f32 v196, v196, v132
    v_add_f32 v197, v197, v133
    v_cvt_pk_bf16_f32 v12, v198, v199
    v_lshlrev_b32 v198, 16, v12
    v_and_b32 v199, 0xffff0000, v12
    v_cvt_pk_bf16_f32 v12, v134, v135
    v_lshlrev_b32 v134, 16, v12
    v_and_b32 v135, 0xffff0000, v12
    v_mul_f32 v198, v36, v198
    v_mul_f32 v134, v37, v134
    v_mul_f32 v199, v36, v199
    v_mul_f32 v135, v37, v135
    v_cvt_pk_bf16_f32 v12, v198, v199
    v_lshlrev_b32 v198, 16, v12
    v_and_b32 v199, 0xffff0000, v12
    v_cvt_pk_bf16_f32 v12, v134, v135
    v_lshlrev_b32 v134, 16, v12
    v_and_b32 v135, 0xffff0000, v12
    v_add_f32 v198, v198, v134
    v_add_f32 v199, v199, v135
    v_cvt_pk_bf16_f32 v10, v196, v197
    v_cvt_pk_bf16_f32 v11, v198, v199
    buffer_store_dwordx2 v[10:11], v35, s[12:15], 0 offen offset:96
    v_cvt_pk_bf16_f32 v12, v200, v201
    v_lshlrev_b32 v200, 16, v12
    v_and_b32 v201, 0xffff0000, v12
    v_cvt_pk_bf16_f32 v12, v136, v137
    v_lshlrev_b32 v136, 16, v12
    v_and_b32 v137, 0xffff0000, v12
    v_mul_f32 v200, v36, v200
    v_mul_f32 v136, v37, v136
    v_mul_f32 v201, v36, v201
    v_mul_f32 v137, v37, v137
    v_cvt_pk_bf16_f32 v12, v200, v201
    v_lshlrev_b32 v200, 16, v12
    v_and_b32 v201, 0xffff0000, v12
    v_cvt_pk_bf16_f32 v12, v136, v137
    v_lshlrev_b32 v136, 16, v12
    v_and_b32 v137, 0xffff0000, v12
    v_add_f32 v200, v200, v136
    v_add_f32 v201, v201, v137
    v_cvt_pk_bf16_f32 v12, v202, v203
    v_lshlrev_b32 v202, 16, v12
    v_and_b32 v203, 0xffff0000, v12
    v_cvt_pk_bf16_f32 v12, v138, v139
    v_lshlrev_b32 v138, 16, v12
    v_and_b32 v139, 0xffff0000, v12
    v_mul_f32 v202, v36, v202
    v_mul_f32 v138, v37, v138
    v_mul_f32 v203, v36, v203
    v_mul_f32 v139, v37, v139
    v_cvt_pk_bf16_f32 v12, v202, v203
    v_lshlrev_b32 v202, 16, v12
    v_and_b32 v203, 0xffff0000, v12
    v_cvt_pk_bf16_f32 v12, v138, v139
    v_lshlrev_b32 v138, 16, v12
    v_and_b32 v139, 0xffff0000, v12
    v_add_f32 v202, v202, v138
    v_add_f32 v203, v203, v139
    v_cvt_pk_bf16_f32 v8, v200, v201
    v_cvt_pk_bf16_f32 v9, v202, v203
    buffer_store_dwordx2 v[8:9], v35, s[12:15], 0 offen offset:128
Lf_end:
    s_endpgm
Lout_entry_m:
    s_load_dwordx2 s[4:5], s[0:1], 104
    s_load_dwordx2 s[6:7], s[0:1], 88
    s_waitcnt lgkmcnt(0)
    s_mov_b32 s8, s4
    s_and_b32 s9, s5, 0xffff
    s_mov_b32 s10, 0x10000000
    s_mov_b32 s11, 0x00020000
    s_mov_b32 s12, s6
    s_and_b32 s13, s7, 0xffff
    s_mov_b32 s14, 0x280000
    s_mov_b32 s15, 0x00020000
    v_and_b32 v1, 63, v0
    v_lshrrev_b32 v2, 6, v0
    v_and_b32 v3, 15, v0
    v_bfe_u32 v4, v0, 4, 2
    s_mul_i32 s18, s17, 16
    s_mul_i32 s19, s16, 16
    v_mul_u32_u24 v6, 2048, v2
    v_lshl_add_u32 v6, v4, 4, v6
    v_add_u32 v7, s18, v3
    v_add_u32 v7, 0, v7
    v_mul_u32_u24 v7, 8320, v7
    v_add_u32 v14, v7, v6
    v_add_u32 v7, s19, v3
    v_add_u32 v7, 0, v7
    v_mul_u32_u24 v7, 8320, v7
    v_add_u32 v15, v7, v6
    v_mul_u32_u24 v6, 384, v2
    v_lshl_add_u32 v6, v4, 4, v6
    v_add_u32 v7, s18, v3
    v_add_u32 v7, 0, v7
    v_mul_u32_u24 v7, 1536, v7
    v_add_u32 v16, v7, v6
    v_add_u32 v7, s19, v3
    v_add_u32 v7, 0, v7
    v_mul_u32_u24 v7, 1536, v7
    v_add_u32 v17, v7, v6
    s_mov_b32 s20, 0xf00000
    s_mov_b32 s21, 0x4700000
    s_mov_b32 s22, 0x9c00000
    s_mov_b32 s23, 0x9d00000
    s_mov_b32 s24, 0x9600000
    s_mov_b32 s25, 0x9900000
    s_mov_b32 s27, 0x9f00800
    v_readfirstlane_b32 s40, v2
    s_nop 2
    s_cmp_lg_u32 s40, 0
    s_cbranch_scc1 Lwo_32
    s_mov_b32 s28, 0
    v_mov_b32 v7, 0
    s_mov_b64 exec, 1
Lwc_31:
    buffer_load_dword v6, v7, s[8:11], s27 offen sc1
    s_waitcnt vmcnt(0)
    v_cmp_le_u32 vcc, 81, v6
    s_cbranch_vccnz Lwo_32x
    s_sleep 48
    s_add_u32 s28, s28, 1
    s_cmp_lt_u32 s28, 400000
    s_cbranch_scc1 Lwc_31
Lwo_32x:
    s_mov_b64 exec, -1
Lwo_32:
    s_barrier
    buffer_load_dwordx4 v[24:27], v16, s[8:11], s22 offen offset:0
    buffer_load_dwordx4 v[28:31], v17, s[8:11], s24 offen offset:0 sc1
    buffer_load_dwordx4 v[32:35], v16, s[8:11], s23 offen offset:0
    buffer_load_dwordx4 v[36:39], v17, s[8:11], s25 offen offset:0 sc1
    buffer_load_dwordx4 v[40:43], v16, s[8:11], s22 offen offset:64
    buffer_load_dwordx4 v[44:47], v17, s[8:11], s24 offen offset:64 sc1
    v_lshl_add_u32 v6, v2, 4, v3
    v_add_u32 v6, s19, v6
    v_mul_u32_u24 v21, 1280, v6
    v_lshlrev_b32 v6, 2, v6
    v_add_u32 v6, 0x9e00000, v6
    v_lshl_add_u32 v21, v4, 3, v21
    s_lshl_b32 s26, s18, 1
    v_add_u32 v21, s26, v21
    v_lshlrev_b32 v18, 4, v1
    v_mul_u32_u24 v7, 1024, v2
    v_mul_u32_u24 v8, 4096, v2
    v_add_u32 v20, v18, v8
    v_add_u32 v18, v18, v7
    v_add_u32 v19, 8192, v18
    s_waitcnt vmcnt(4)
    v_mfma_f32_16x16x32_bf16 a[0:3], v[24:27], v[28:31], 0
    buffer_load_dwordx4 v[48:51], v16, s[8:11], s23 offen offset:64
    buffer_load_dwordx4 v[52:55], v17, s[8:11], s25 offen offset:64 sc1
    s_waitcnt vmcnt(4)
    v_mfma_f32_16x16x32_bf16 a[0:3], v[32:35], v[28:31], a[0:3]
    v_mfma_f32_16x16x32_bf16 a[0:3], v[24:27], v[36:39], a[0:3]
    buffer_load_dwordx4 v[24:27], v16, s[8:11], s22 offen offset:128
    buffer_load_dwordx4 v[28:31], v17, s[8:11], s24 offen offset:128 sc1
    s_waitcnt vmcnt(4)
    v_mfma_f32_16x16x32_bf16 a[0:3], v[40:43], v[44:47], a[0:3]
    buffer_load_dwordx4 v[32:35], v16, s[8:11], s23 offen offset:128
    buffer_load_dwordx4 v[36:39], v17, s[8:11], s25 offen offset:128 sc1
    s_waitcnt vmcnt(4)
    v_mfma_f32_16x16x32_bf16 a[0:3], v[48:51], v[44:47], a[0:3]
    v_mfma_f32_16x16x32_bf16 a[0:3], v[40:43], v[52:55], a[0:3]
    buffer_load_dwordx4 v[40:43], v16, s[8:11], s22 offen offset:192
    buffer_load_dwordx4 v[44:47], v17, s[8:11], s24 offen offset:192 sc1
    s_waitcnt vmcnt(4)
    v_mfma_f32_16x16x32_bf16 a[0:3], v[24:27], v[28:31], a[0:3]
    buffer_load_dwordx4 v[48:51], v16, s[8:11], s23 offen offset:192
    buffer_load_dwordx4 v[52:55], v17, s[8:11], s25 offen offset:192 sc1
    s_waitcnt vmcnt(4)
    v_mfma_f32_16x16x32_bf16 a[0:3], v[32:35], v[28:31], a[0:3]
    v_mfma_f32_16x16x32_bf16 a[0:3], v[24:27], v[36:39], a[0:3]
    buffer_load_dwordx4 v[24:27], v16, s[8:11], s22 offen offset:256
    buffer_load_dwordx4 v[28:31], v17, s[8:11], s24 offen offset:256 sc1
    s_waitcnt vmcnt(4)
    v_mfma_f32_16x16x32_bf16 a[0:3], v[40:43], v[44:47], a[0:3]
    buffer_load_dwordx4 v[32:35], v16, s[8:11], s23 offen offset:256
    buffer_load_dwordx4 v[36:39], v17, s[8:11], s25 offen offset:256 sc1
    s_waitcnt vmcnt(4)
    v_mfma_f32_16x16x32_bf16 a[0:3], v[48:51], v[44:47], a[0:3]
    v_mfma_f32_16x16x32_bf16 a[0:3], v[40:43], v[52:55], a[0:3]
    buffer_load_dwordx4 v[40:43], v16, s[8:11], s22 offen offset:320
    buffer_load_dwordx4 v[44:47], v17, s[8:11], s24 offen offset:320 sc1
    s_waitcnt vmcnt(4)
    v_mfma_f32_16x16x32_bf16 a[0:3], v[24:27], v[28:31], a[0:3]
    buffer_load_dwordx4 v[48:51], v16, s[8:11], s23 offen offset:320
    buffer_load_dwordx4 v[52:55], v17, s[8:11], s25 offen offset:320 sc1
    s_waitcnt vmcnt(4)
    v_mfma_f32_16x16x32_bf16 a[0:3], v[32:35], v[28:31], a[0:3]
    v_mfma_f32_16x16x32_bf16 a[0:3], v[24:27], v[36:39], a[0:3]
    s_waitcnt vmcnt(2)
    v_mfma_f32_16x16x32_bf16 a[0:3], v[40:43], v[44:47], a[0:3]
    s_waitcnt vmcnt(0)
    v_mfma_f32_16x16x32_bf16 a[0:3], v[48:51], v[44:47], a[0:3]
    v_mfma_f32_16x16x32_bf16 a[0:3], v[40:43], v[52:55], a[0:3]
    s_lshl_b32 s27, s29, 7
    s_add_u32 s27, s27, 0x9f01000
    s_cmp_lg_u32 s40, 0
    s_cbranch_scc1 Lwo_34
    s_mov_b32 s28, 0
    v_mov_b32 v11, 0
    s_mov_b64 exec, 1
Lwc_33:
    buffer_load_dword v10, v11, s[8:11], s27 offen sc1
    s_waitcnt vmcnt(0)
    v_cmp_le_u32 vcc, 16, v10
    s_cbranch_vccnz Lwo_34x
    s_sleep 12
    s_add_u32 s28, s28, 1
    s_cmp_lt_u32 s28, 400000
    s_cbranch_scc1 Lwc_33
Lwo_34x:
    s_mov_b64 exec, -1
Lwo_34:
    s_barrier
    buffer_load_dwordx4 v[24:27], v14, s[8:11], s20 offen offset:0
    buffer_load_dwordx4 v[28:31], v15, s[8:11], s21 offen offset:0 sc1
    buffer_load_dwordx4 v[32:35], v14, s[8:11], s20 offen offset:64
    buffer_load_dwordx4 v[36:39], v15, s[8:11], s21 offen offset:64 sc1
    buffer_load_dwordx4 v[40:43], v14, s[8:11], s20 offen offset:128
    buffer_load_dwordx4 v[44:47], v15, s[8:11], s21 offen offset:128 sc1
    buffer_load_dwordx4 v[48:51], v14, s[8:11], s20 offen offset:192
    buffer_load_dwordx4 v[52:55], v15, s[8:11], s21 offen offset:192 sc1
    s_waitcnt vmcnt(6)
    v_mfma_f32_16x16x32_bf16 a[80:83], v[24:27], v[28:31], 0
    buffer_load_dwordx4 v[24:27], v14, s[8:11], s20 offen offset:256
    buffer_load_dwordx4 v[28:31], v15, s[8:11], s21 offen offset:256 sc1
    s_waitcnt vmcnt(6)
    v_mfma_f32_16x16x32_bf16 a[80:83], v[32:35], v[36:39], a[80:83]
    buffer_load_dwordx4 v[32:35], v14, s[8:11], s20 offen offset:320
    buffer_load_dwordx4 v[36:39], v15, s[8:11], s21 offen offset:320 sc1
    s_waitcnt vmcnt(6)
    v_mfma_f32_16x16x32_bf16 a[80:83], v[40:43], v[44:47], a[80:83]
    buffer_load_dwordx4 v[40:43], v14, s[8:11], s20 offen offset:384
    buffer_load_dwordx4 v[44:47], v15, s[8:11], s21 offen offset:384 sc1
    s_waitcnt vmcnt(6)
    v_mfma_f32_16x16x32_bf16 a[80:83], v[48:51], v[52:55], a[80:83]
    buffer_load_dwordx4 v[48:51], v14, s[8:11], s20 offen offset:448
    buffer_load_dwordx4 v[52:55], v15, s[8:11], s21 offen offset:448 sc1
    s_waitcnt vmcnt(6)
    v_mfma_f32_16x16x32_bf16 a[80:83], v[24:27], v[28:31], a[80:83]
    buffer_load_dwordx4 v[24:27], v14, s[8:11], s20 offen offset:512
    buffer_load_dwordx4 v[28:31], v15, s[8:11], s21 offen offset:512 sc1
    s_waitcnt vmcnt(6)
    v_mfma_f32_16x16x32_bf16 a[80:83], v[32:35], v[36:39], a[80:83]
    buffer_load_dwordx4 v[32:35], v14, s[8:11], s20 offen offset:576
    buffer_load_dwordx4 v[36:39], v15, s[8:11], s21 offen offset:576 sc1
    s_waitcnt vmcnt(6)
    v_mfma_f32_16x16x32_bf16 a[80:83], v[40:43], v[44:47], a[80:83]
    buffer_load_dwordx4 v[40:43], v14, s[8:11], s20 offen offset:640
    buffer_load_dwordx4 v[44:47], v15, s[8:11], s21 offen offset:640 sc1
    s_waitcnt vmcnt(6)
    v_mfma_f32_16x16x32_bf16 a[80:83], v[48:51], v[52:55], a[80:83]
    buffer_load_dwordx4 v[48:51], v14, s[8:11], s20 offen offset:704
    buffer_load_dwordx4 v[52:55], v15, s[8:11], s21 offen offset:704 sc1
    s_waitcnt vmcnt(6)
    v_mfma_f32_16x16x32_bf16 a[80:83], v[24:27], v[28:31], a[80:83]
    buffer_load_dwordx4 v[24:27], v14, s[8:11], s20 offen offset:768
    buffer_load_dwordx4 v[28:31], v15, s[8:11], s21 offen offset:768 sc1
    s_waitcnt vmcnt(6)
    v_mfma_f32_16x16x32_bf16 a[80:83], v[32:35], v[36:39], a[80:83]
    buffer_load_dwordx4 v[32:35], v14, s[8:11], s20 offen offset:832
    buffer_load_dwordx4 v[36:39], v15, s[8:11], s21 offen offset:832 sc1
    s_waitcnt vmcnt(6)
    v_mfma_f32_16x16x32_bf16 a[80:83], v[40:43], v[44:47], a[80:83]
    buffer_load_dwordx4 v[40:43], v14, s[8:11], s20 offen offset:896
    buffer_load_dwordx4 v[44:47], v15, s[8:11], s21 offen offset:896 sc1
    s_waitcnt vmcnt(6)
    v_mfma_f32_16x16x32_bf16 a[80:83], v[48:51], v[52:55], a[80:83]
    buffer_load_dwordx4 v[48:51], v14, s[8:11], s20 offen offset:960
    buffer_load_dwordx4 v[52:55], v15, s[8:11], s21 offen offset:960 sc1
    s_waitcnt vmcnt(6)
    v_mfma_f32_16x16x32_bf16 a[80:83], v[24:27], v[28:31], a[80:83]
    buffer_load_dwordx4 v[24:27], v14, s[8:11], s20 offen offset:1024
    buffer_load_dwordx4 v[28:31], v15, s[8:11], s21 offen offset:1024 sc1
    s_waitcnt vmcnt(6)
    v_mfma_f32_16x16x32_bf16 a[80:83], v[32:35], v[36:39], a[80:83]
    buffer_load_dwordx4 v[32:35], v14, s[8:11], s20 offen offset:1088
    buffer_load_dwordx4 v[36:39], v15, s[8:11], s21 offen offset:1088 sc1
    s_waitcnt vmcnt(6)
    v_mfma_f32_16x16x32_bf16 a[80:83], v[40:43], v[44:47], a[80:83]
    buffer_load_dwordx4 v[40:43], v14, s[8:11], s20 offen offset:1152
    buffer_load_dwordx4 v[44:47], v15, s[8:11], s21 offen offset:1152 sc1
    s_waitcnt vmcnt(6)
    v_mfma_f32_16x16x32_bf16 a[80:83], v[48:51], v[52:55], a[80:83]
    buffer_load_dwordx4 v[48:51], v14, s[8:11], s20 offen offset:1216
    buffer_load_dwordx4 v[52:55], v15, s[8:11], s21 offen offset:1216 sc1
    s_waitcnt vmcnt(6)
    v_mfma_f32_16x16x32_bf16 a[80:83], v[24:27], v[28:31], a[80:83]
    buffer_load_dwordx4 v[24:27], v14, s[8:11], s20 offen offset:1280
    buffer_load_dwordx4 v[28:31], v15, s[8:11], s21 offen offset:1280 sc1
    s_waitcnt vmcnt(6)
    v_mfma_f32_16x16x32_bf16 a[80:83], v[32:35], v[36:39], a[80:83]
    buffer_load_dwordx4 v[32:35], v14, s[8:11], s20 offen offset:1344
    buffer_load_dwordx4 v[36:39], v15, s[8:11], s21 offen offset:1344 sc1
    s_waitcnt vmcnt(6)
    v_mfma_f32_16x16x32_bf16 a[80:83], v[40:43], v[44:47], a[80:83]
    buffer_load_dwordx4 v[40:43], v14, s[8:11], s20 offen offset:1408
    buffer_load_dwordx4 v[44:47], v15, s[8:11], s21 offen offset:1408 sc1
    s_waitcnt vmcnt(6)
    v_mfma_f32_16x16x32_bf16 a[80:83], v[48:51], v[52:55], a[80:83]
    buffer_load_dwordx4 v[48:51], v14, s[8:11], s20 offen offset:1472
    buffer_load_dwordx4 v[52:55], v15, s[8:11], s21 offen offset:1472 sc1
    s_waitcnt vmcnt(6)
    v_mfma_f32_16x16x32_bf16 a[80:83], v[24:27], v[28:31], a[80:83]
    buffer_load_dwordx4 v[24:27], v14, s[8:11], s20 offen offset:1536
    buffer_load_dwordx4 v[28:31], v15, s[8:11], s21 offen offset:1536 sc1
    s_waitcnt vmcnt(6)
    v_mfma_f32_16x16x32_bf16 a[80:83], v[32:35], v[36:39], a[80:83]
    buffer_load_dwordx4 v[32:35], v14, s[8:11], s20 offen offset:1600
    buffer_load_dwordx4 v[36:39], v15, s[8:11], s21 offen offset:1600 sc1
    s_waitcnt vmcnt(6)
    v_mfma_f32_16x16x32_bf16 a[80:83], v[40:43], v[44:47], a[80:83]
    buffer_load_dwordx4 v[40:43], v14, s[8:11], s20 offen offset:1664
    buffer_load_dwordx4 v[44:47], v15, s[8:11], s21 offen offset:1664 sc1
    s_waitcnt vmcnt(6)
    v_mfma_f32_16x16x32_bf16 a[80:83], v[48:51], v[52:55], a[80:83]
    buffer_load_dwordx4 v[48:51], v14, s[8:11], s20 offen offset:1728
    buffer_load_dwordx4 v[52:55], v15, s[8:11], s21 offen offset:1728 sc1
    s_waitcnt vmcnt(6)
    v_mfma_f32_16x16x32_bf16 a[80:83], v[24:27], v[28:31], a[80:83]
    buffer_load_dwordx4 v[24:27], v14, s[8:11], s20 offen offset:1792
    buffer_load_dwordx4 v[28:31], v15, s[8:11], s21 offen offset:1792 sc1
    s_waitcnt vmcnt(6)
    v_mfma_f32_16x16x32_bf16 a[80:83], v[32:35], v[36:39], a[80:83]
    buffer_load_dwordx4 v[32:35], v14, s[8:11], s20 offen offset:1856
    buffer_load_dwordx4 v[36:39], v15, s[8:11], s21 offen offset:1856 sc1
    s_waitcnt vmcnt(6)
    v_mfma_f32_16x16x32_bf16 a[80:83], v[40:43], v[44:47], a[80:83]
    buffer_load_dwordx4 v[40:43], v14, s[8:11], s20 offen offset:1920
    buffer_load_dwordx4 v[44:47], v15, s[8:11], s21 offen offset:1920 sc1
    s_waitcnt vmcnt(6)
    v_mfma_f32_16x16x32_bf16 a[80:83], v[48:51], v[52:55], a[80:83]
    buffer_load_dwordx4 v[48:51], v14, s[8:11], s20 offen offset:1984
    buffer_load_dwordx4 v[52:55], v15, s[8:11], s21 offen offset:1984 sc1
    s_waitcnt vmcnt(6)
    v_mfma_f32_16x16x32_bf16 a[80:83], v[24:27], v[28:31], a[80:83]
    s_waitcnt vmcnt(4)
    v_mfma_f32_16x16x32_bf16 a[80:83], v[32:35], v[36:39], a[80:83]
    s_waitcnt vmcnt(2)
    v_mfma_f32_16x16x32_bf16 a[80:83], v[40:43], v[44:47], a[80:83]
    buffer_load_dword v22, v6, s[8:11], 0 offen
    s_waitcnt vmcnt(1)
    v_mfma_f32_16x16x32_bf16 a[80:83], v[48:51], v[52:55], a[80:83]
    s_nop 9
    ds_write_b128 v18, a[80:83] offset:0
    s_waitcnt lgkmcnt(0)
    s_barrier
    ds_read_b128 v[24:27], v20 offset:0
    ds_read_b128 v[44:47], v20 offset:1024
    ds_read_b128 v[64:67], v20 offset:2048
    ds_read_b128 v[84:87], v20 offset:3072
    s_waitcnt lgkmcnt(0)
    v_add_f32 v24, v24, v44
    v_add_f32 v64, v64, v84
    v_add_f32 v104, v24, v64
    v_add_f32 v25, v25, v45
    v_add_f32 v65, v65, v85
    v_add_f32 v105, v25, v65
    v_add_f32 v26, v26, v46
    v_add_f32 v66, v66, v86
    v_add_f32 v106, v26, v66
    v_add_f32 v27, v27, v47
    v_add_f32 v67, v67, v87
    v_add_f32 v107, v27, v67
    s_barrier
    ds_write_b128 v18, a[0:3] offset:0
    s_waitcnt lgkmcnt(0)
    s_barrier
    ds_read_b128 v[24:27], v20 offset:0
    ds_read_b128 v[44:47], v20 offset:1024
    ds_read_b128 v[64:67], v20 offset:2048
    ds_read_b128 v[84:87], v20 offset:3072
    s_waitcnt lgkmcnt(0)
    v_add_f32 v24, v24, v44
    v_add_f32 v64, v64, v84
    v_add_f32 v124, v24, v64
    v_add_f32 v25, v25, v45
    v_add_f32 v65, v65, v85
    v_add_f32 v125, v25, v65
    v_add_f32 v26, v26, v46
    v_add_f32 v66, v66, v86
    v_add_f32 v126, v26, v66
    v_add_f32 v27, v27, v47
    v_add_f32 v67, v67, v87
    v_add_f32 v127, v27, v67
    s_barrier
    s_cmp_ge_u32 s40, 1
    s_cbranch_scc1 Lf_end_m
    s_waitcnt vmcnt(0)
    v_sub_f32 v23, 1.0, v22
    v_cvt_pk_bf16_f32 v23, v23, v23
    v_lshlrev_b32 v23, 16, v23
    v_cvt_pk_bf16_f32 v12, v124, v125
    v_lshlrev_b32 v124, 16, v12
    v_and_b32 v125, 0xffff0000, v12
    v_cvt_pk_bf16_f32 v12, v104, v105
    v_lshlrev_b32 v104, 16, v12
    v_and_b32 v105, 0xffff0000, v12
    v_mul_f32 v124, v22, v124
    v_mul_f32 v104, v23, v104
    v_mul_f32 v125, v22, v125
    v_mul_f32 v105, v23, v105
    v_cvt_pk_bf16_f32 v12, v124, v125
    v_lshlrev_b32 v124, 16, v12
    v_and_b32 v125, 0xffff0000, v12
    v_cvt_pk_bf16_f32 v12, v104, v105
    v_lshlrev_b32 v104, 16, v12
    v_and_b32 v105, 0xffff0000, v12
    v_add_f32 v124, v124, v104
    v_add_f32 v125, v125, v105
    v_cvt_pk_bf16_f32 v12, v126, v127
    v_lshlrev_b32 v126, 16, v12
    v_and_b32 v127, 0xffff0000, v12
    v_cvt_pk_bf16_f32 v12, v106, v107
    v_lshlrev_b32 v106, 16, v12
    v_and_b32 v107, 0xffff0000, v12
    v_mul_f32 v126, v22, v126
    v_mul_f32 v106, v23, v106
    v_mul_f32 v127, v22, v127
    v_mul_f32 v107, v23, v107
    v_cvt_pk_bf16_f32 v12, v126, v127
    v_lshlrev_b32 v126, 16, v12
    v_and_b32 v127, 0xffff0000, v12
    v_cvt_pk_bf16_f32 v12, v106, v107
    v_lshlrev_b32 v106, 16, v12
    v_and_b32 v107, 0xffff0000, v12
    v_add_f32 v126, v126, v106
    v_add_f32 v127, v127, v107
    v_cvt_pk_bf16_f32 v8, v124, v125
    v_cvt_pk_bf16_f32 v9, v126, v127
    buffer_store_dwordx2 v[8:9], v21, s[12:15], 0 offen offset:0
Lf_end_m:
    s_endpgm
Lout_entry_d:
    s_load_dwordx2 s[4:5], s[0:1], 104
    s_load_dwordx2 s[6:7], s[0:1], 88
    s_waitcnt lgkmcnt(0)
    s_mov_b32 s8, s4
    s_and_b32 s9, s5, 0xffff
    s_mov_b32 s10, 0x10000000
    s_mov_b32 s11, 0x00020000
    s_mov_b32 s12, s6
    s_and_b32 s13, s7, 0xffff
    s_mov_b32 s14, 0x280000
    s_mov_b32 s15, 0x00020000
    v_and_b32 v1, 63, v0
    v_lshrrev_b32 v2, 6, v0
    v_and_b32 v3, 15, v0
    v_bfe_u32 v4, v0, 4, 2
    s_mul_i32 s18, s17, 32
    s_mul_i32 s19, s16, 32
    v_mul_u32_u24 v6, 2048, v2
    v_lshl_add_u32 v6, v4, 4, v6
    v_add_u32 v7, s18, v3
    v_add_u32 v7, 0, v7
    v_mul_u32_u24 v7, 8320, v7
    v_add_u32 v14, v7, v6
    v_add_u32 v7, s18, v3
    v_add_u32 v7, 16, v7
    v_mul_u32_u24 v7, 8320, v7
    v_add_u32 v15, v7, v6
    v_add_u32 v7, s19, v3
    v_add_u32 v7, 0, v7
    v_mul_u32_u24 v7, 8320, v7
    v_add_u32 v16, v7, v6
    v_add_u32 v7, s19, v3
    v_add_u32 v7, 16, v7
    v_mul_u32_u24 v7, 8320, v7
    v_add_u32 v17, v7, v6
    v_mul_u32_u24 v6, 384, v2
    v_lshl_add_u32 v6, v4, 4, v6
    v_add_u32 v7, s18, v3
    v_add_u32 v7, 0, v7
    v_mul_u32_u24 v7, 1536, v7
    v_add_u32 v18, v7, v6
    v_add_u32 v7, s18, v3
    v_add_u32 v7, 16, v7
    v_mul_u32_u24 v7, 1536, v7
    v_add_u32 v19, v7, v6
    v_add_u32 v7, s19, v3
    v_add_u32 v7, 0, v7
    v_mul_u32_u24 v7, 1536, v7
    v_add_u32 v20, v7, v6
    v_add_u32 v7, s19, v3
    v_add_u32 v7, 16, v7
    v_mul_u32_u24 v7, 1536, v7
    v_add_u32 v21, v7, v6
    s_mov_b32 s20, 0xf00000
    s_mov_b32 s21, 0x4700000
    s_mov_b32 s22, 0x9c00000
    s_mov_b32 s23, 0x9d00000
    s_mov_b32 s24, 0x9600000
    s_mov_b32 s25, 0x9900000
    s_mov_b32 s27, 0x9f00800
    v_readfirstlane_b32 s40, v2
    s_nop 2
    s_cmp_lg_u32 s40, 0
    s_cbranch_scc1 Lwo_36
    s_mov_b32 s28, 0
    v_mov_b32 v7, 0
    s_mov_b64 exec, 1
Lwc_35:
    buffer_load_dword v6, v7, s[8:11], s27 offen sc1
    s_waitcnt vmcnt(0)
    v_cmp_le_u32 vcc, 81, v6
    s_cbranch_vccnz Lwo_36x
    s_sleep 48
    s_add_u32 s28, s28, 1
    s_cmp_lt_u32 s28, 400000
    s_cbranch_scc1 Lwc_35
Lwo_36x:
    s_mov_b64 exec, -1
Lwo_36:
    s_barrier
    buffer_load_dwordx4 v[28:31], v18, s[8:11], s22 offen offset:0
    buffer_load_dwordx4 v[32:35], v19, s[8:11], s22 offen offset:0
    buffer_load_dwordx4 v[36:39], v20, s[8:11], s24 offen offset:0 sc1
    buffer_load_dwordx4 v[40:43], v21, s[8:11], s24 offen offset:0 sc1
    buffer_load_dwordx4 v[44:47], v18, s[8:11], s23 offen offset:0
    buffer_load_dwordx4 v[48:51], v19, s[8:11], s23 offen offset:0
    buffer_load_dwordx4 v[52:55], v20, s[8:11], s25 offen offset:0 sc1
    buffer_load_dwordx4 v[56:59], v21, s[8:11], s25 offen offset:0 sc1
    buffer_load_dwordx4 v[60:63], v18, s[8:11], s22 offen offset:64
    buffer_load_dwordx4 v[64:67], v19, s[8:11], s22 offen offset:64
    buffer_load_dwordx4 v[68:71], v20, s[8:11], s24 offen offset:64 sc1
    buffer_load_dwordx4 v[72:75], v21, s[8:11], s24 offen offset:64 sc1
    v_lshl_add_u32 v6, v2, 4, v3
    v_add_u32 v6, s19, v6
    v_mul_u32_u24 v25, 1280, v6
    v_lshlrev_b32 v6, 2, v6
    v_add_u32 v6, 0x9e00000, v6
    v_lshl_add_u32 v25, v4, 3, v25
    s_lshl_b32 s26, s18, 1
    v_add_u32 v25, s26, v25
    v_lshlrev_b32 v22, 4, v1
    v_mul_u32_u24 v7, 2048, v2
    v_mul_u32_u24 v8, 8192, v2
    v_add_u32 v24, v22, v8
    v_add_u32 v22, v22, v7
    v_add_u32 v23, 16384, v22
    s_waitcnt vmcnt(8)
    v_mfma_f32_16x16x32_bf16 a[0:3], v[28:31], v[36:39], 0
    v_mfma_f32_16x16x32_bf16 a[4:7], v[32:35], v[36:39], 0
    v_mfma_f32_16x16x32_bf16 a[8:11], v[28:31], v[40:43], 0
    v_mfma_f32_16x16x32_bf16 a[12:15], v[32:35], v[40:43], 0
    buffer_load_dwordx4 v[76:79], v18, s[8:11], s23 offen offset:64
    buffer_load_dwordx4 v[80:83], v19, s[8:11], s23 offen offset:64
    buffer_load_dwordx4 v[84:87], v20, s[8:11], s25 offen offset:64 sc1
    buffer_load_dwordx4 v[88:91], v21, s[8:11], s25 offen offset:64 sc1
    s_waitcnt vmcnt(8)
    v_mfma_f32_16x16x32_bf16 a[0:3], v[44:47], v[36:39], a[0:3]
    v_mfma_f32_16x16x32_bf16 a[4:7], v[48:51], v[36:39], a[4:7]
    v_mfma_f32_16x16x32_bf16 a[8:11], v[44:47], v[40:43], a[8:11]
    v_mfma_f32_16x16x32_bf16 a[12:15], v[48:51], v[40:43], a[12:15]
    v_mfma_f32_16x16x32_bf16 a[0:3], v[28:31], v[52:55], a[0:3]
    v_mfma_f32_16x16x32_bf16 a[4:7], v[32:35], v[52:55], a[4:7]
    v_mfma_f32_16x16x32_bf16 a[8:11], v[28:31], v[56:59], a[8:11]
    v_mfma_f32_16x16x32_bf16 a[12:15], v[32:35], v[56:59], a[12:15]
    buffer_load_dwordx4 v[28:31], v18, s[8:11], s22 offen offset:128
    buffer_load_dwordx4 v[32:35], v19, s[8:11], s22 offen offset:128
    buffer_load_dwordx4 v[36:39], v20, s[8:11], s24 offen offset:128 sc1
    buffer_load_dwordx4 v[40:43], v21, s[8:11], s24 offen offset:128 sc1
    s_waitcnt vmcnt(8)
    v_mfma_f32_16x16x32_bf16 a[0:3], v[60:63], v[68:71], a[0:3]
    v_mfma_f32_16x16x32_bf16 a[4:7], v[64:67], v[68:71], a[4:7]
    v_mfma_f32_16x16x32_bf16 a[8:11], v[60:63], v[72:75], a[8:11]
    v_mfma_f32_16x16x32_bf16 a[12:15], v[64:67], v[72:75], a[12:15]
    buffer_load_dwordx4 v[44:47], v18, s[8:11], s23 offen offset:128
    buffer_load_dwordx4 v[48:51], v19, s[8:11], s23 offen offset:128
    buffer_load_dwordx4 v[52:55], v20, s[8:11], s25 offen offset:128 sc1
    buffer_load_dwordx4 v[56:59], v21, s[8:11], s25 offen offset:128 sc1
    s_waitcnt vmcnt(8)
    v_mfma_f32_16x16x32_bf16 a[0:3], v[76:79], v[68:71], a[0:3]
    v_mfma_f32_16x16x32_bf16 a[4:7], v[80:83], v[68:71], a[4:7]
    v_mfma_f32_16x16x32_bf16 a[8:11], v[76:79], v[72:75], a[8:11]
    v_mfma_f32_16x16x32_bf16 a[12:15], v[80:83], v[72:75], a[12:15]
    v_mfma_f32_16x16x32_bf16 a[0:3], v[60:63], v[84:87], a[0:3]
    v_mfma_f32_16x16x32_bf16 a[4:7], v[64:67], v[84:87], a[4:7]
    v_mfma_f32_16x16x32_bf16 a[8:11], v[60:63], v[88:91], a[8:11]
    v_mfma_f32_16x16x32_bf16 a[12:15], v[64:67], v[88:91], a[12:15]
    buffer_load_dwordx4 v[60:63], v18, s[8:11], s22 offen offset:192
    buffer_load_dwordx4 v[64:67], v19, s[8:11], s22 offen offset:192
    buffer_load_dwordx4 v[68:71], v20, s[8:11], s24 offen offset:192 sc1
    buffer_load_dwordx4 v[72:75], v21, s[8:11], s24 offen offset:192 sc1
    s_waitcnt vmcnt(8)
    v_mfma_f32_16x16x32_bf16 a[0:3], v[28:31], v[36:39], a[0:3]
    v_mfma_f32_16x16x32_bf16 a[4:7], v[32:35], v[36:39], a[4:7]
    v_mfma_f32_16x16x32_bf16 a[8:11], v[28:31], v[40:43], a[8:11]
    v_mfma_f32_16x16x32_bf16 a[12:15], v[32:35], v[40:43], a[12:15]
    buffer_load_dwordx4 v[76:79], v18, s[8:11], s23 offen offset:192
    buffer_load_dwordx4 v[80:83], v19, s[8:11], s23 offen offset:192
    buffer_load_dwordx4 v[84:87], v20, s[8:11], s25 offen offset:192 sc1
    buffer_load_dwordx4 v[88:91], v21, s[8:11], s25 offen offset:192 sc1
    s_waitcnt vmcnt(8)
    v_mfma_f32_16x16x32_bf16 a[0:3], v[44:47], v[36:39], a[0:3]
    v_mfma_f32_16x16x32_bf16 a[4:7], v[48:51], v[36:39], a[4:7]
    v_mfma_f32_16x16x32_bf16 a[8:11], v[44:47], v[40:43], a[8:11]
    v_mfma_f32_16x16x32_bf16 a[12:15], v[48:51], v[40:43], a[12:15]
    v_mfma_f32_16x16x32_bf16 a[0:3], v[28:31], v[52:55], a[0:3]
    v_mfma_f32_16x16x32_bf16 a[4:7], v[32:35], v[52:55], a[4:7]
    v_mfma_f32_16x16x32_bf16 a[8:11], v[28:31], v[56:59], a[8:11]
    v_mfma_f32_16x16x32_bf16 a[12:15], v[32:35], v[56:59], a[12:15]
    buffer_load_dwordx4 v[28:31], v18, s[8:11], s22 offen offset:256
    buffer_load_dwordx4 v[32:35], v19, s[8:11], s22 offen offset:256
    buffer_load_dwordx4 v[36:39], v20, s[8:11], s24 offen offset:256 sc1
    buffer_load_dwordx4 v[40:43], v21, s[8:11], s24 offen offset:256 sc1
    s_waitcnt vmcnt(8)
    v_mfma_f32_16x16x32_bf16 a[0:3], v[60:63], v[68:71], a[0:3]
    v_mfma_f32_16x16x32_bf16 a[4:7], v[64:67], v[68:71], a[4:7]
    v_mfma_f32_16x16x32_bf16 a[8:11], v[60:63], v[72:75], a[8:11]
    v_mfma_f32_16x16x32_bf16 a[12:15], v[64:67], v[72:75], a[12:15]
    buffer_load_dwordx4 v[44:47], v18, s[8:11], s23 offen offset:256
    buffer_load_dwordx4 v[48:51], v19, s[8:11], s23 offen offset:256
    buffer_load_dwordx4 v[52:55], v20, s[8:11], s25 offen offset:256 sc1
    buffer_load_dwordx4 v[56:59], v21, s[8:11], s25 offen offset:256 sc1
    s_waitcnt vmcnt(8)
    v_mfma_f32_16x16x32_bf16 a[0:3], v[76:79], v[68:71], a[0:3]
    v_mfma_f32_16x16x32_bf16 a[4:7], v[80:83], v[68:71], a[4:7]
    v_mfma_f32_16x16x32_bf16 a[8:11], v[76:79], v[72:75], a[8:11]
    v_mfma_f32_16x16x32_bf16 a[12:15], v[80:83], v[72:75], a[12:15]
    v_mfma_f32_16x16x32_bf16 a[0:3], v[60:63], v[84:87], a[0:3]
    v_mfma_f32_16x16x32_bf16 a[4:7], v[64:67], v[84:87], a[4:7]
    v_mfma_f32_16x16x32_bf16 a[8:11], v[60:63], v[88:91], a[8:11]
    v_mfma_f32_16x16x32_bf16 a[12:15], v[64:67], v[88:91], a[12:15]
    buffer_load_dwordx4 v[60:63], v18, s[8:11], s22 offen offset:320
    buffer_load_dwordx4 v[64:67], v19, s[8:11], s22 offen offset:320
    buffer_load_dwordx4 v[68:71], v20, s[8:11], s24 offen offset:320 sc1
    buffer_load_dwordx4 v[72:75], v21, s[8:11], s24 offen offset:320 sc1
    s_waitcnt vmcnt(8)
    v_mfma_f32_16x16x32_bf16 a[0:3], v[28:31], v[36:39], a[0:3]
    v_mfma_f32_16x16x32_bf16 a[4:7], v[32:35], v[36:39], a[4:7]
    v_mfma_f32_16x16x32_bf16 a[8:11], v[28:31], v[40:43], a[8:11]
    v_mfma_f32_16x16x32_bf16 a[12:15], v[32:35], v[40:43], a[12:15]
    buffer_load_dwordx4 v[76:79], v18, s[8:11], s23 offen offset:320
    buffer_load_dwordx4 v[80:83], v19, s[8:11], s23 offen offset:320
    buffer_load_dwordx4 v[84:87], v20, s[8:11], s25 offen offset:320 sc1
    buffer_load_dwordx4 v[88:91], v21, s[8:11], s25 offen offset:320 sc1
    s_waitcnt vmcnt(8)
    v_mfma_f32_16x16x32_bf16 a[0:3], v[44:47], v[36:39], a[0:3]
    v_mfma_f32_16x16x32_bf16 a[4:7], v[48:51], v[36:39], a[4:7]
    v_mfma_f32_16x16x32_bf16 a[8:11], v[44:47], v[40:43], a[8:11]
    v_mfma_f32_16x16x32_bf16 a[12:15], v[48:51], v[40:43], a[12:15]
    v_mfma_f32_16x16x32_bf16 a[0:3], v[28:31], v[52:55], a[0:3]
    v_mfma_f32_16x16x32_bf16 a[4:7], v[32:35], v[52:55], a[4:7]
    v_mfma_f32_16x16x32_bf16 a[8:11], v[28:31], v[56:59], a[8:11]
    v_mfma_f32_16x16x32_bf16 a[12:15], v[32:35], v[56:59], a[12:15]
    s_waitcnt vmcnt(4)
    v_mfma_f32_16x16x32_bf16 a[0:3], v[60:63], v[68:71], a[0:3]
    v_mfma_f32_16x16x32_bf16 a[4:7], v[64:67], v[68:71], a[4:7]
    v_mfma_f32_16x16x32_bf16 a[8:11], v[60:63], v[72:75], a[8:11]
    v_mfma_f32_16x16x32_bf16 a[12:15], v[64:67], v[72:75], a[12:15]
    s_waitcnt vmcnt(0)
    v_mfma_f32_16x16x32_bf16 a[0:3], v[76:79], v[68:71], a[0:3]
    v_mfma_f32_16x16x32_bf16 a[4:7], v[80:83], v[68:71], a[4:7]
    v_mfma_f32_16x16x32_bf16 a[8:11], v[76:79], v[72:75], a[8:11]
    v_mfma_f32_16x16x32_bf16 a[12:15], v[80:83], v[72:75], a[12:15]
    v_mfma_f32_16x16x32_bf16 a[0:3], v[60:63], v[84:87], a[0:3]
    v_mfma_f32_16x16x32_bf16 a[4:7], v[64:67], v[84:87], a[4:7]
    v_mfma_f32_16x16x32_bf16 a[8:11], v[60:63], v[88:91], a[8:11]
    v_mfma_f32_16x16x32_bf16 a[12:15], v[64:67], v[88:91], a[12:15]
    s_lshl_b32 s27, s29, 7
    s_add_u32 s27, s27, 0x9f01000
    s_cmp_lg_u32 s40, 0
    s_cbranch_scc1 Lwo_38
    s_mov_b32 s28, 0
    v_mov_b32 v11, 0
    s_mov_b64 exec, 1
Lwc_37:
    buffer_load_dword v10, v11, s[8:11], s27 offen sc1
    s_waitcnt vmcnt(0)
    v_cmp_le_u32 vcc, 16, v10
    s_cbranch_vccnz Lwo_38x
    s_sleep 12
    s_add_u32 s28, s28, 1
    s_cmp_lt_u32 s28, 400000
    s_cbranch_scc1 Lwc_37
Lwo_38x:
    s_mov_b64 exec, -1
Lwo_38:
    s_barrier
    buffer_load_dwordx4 v[28:31], v14, s[8:11], s20 offen offset:0
    buffer_load_dwordx4 v[32:35], v15, s[8:11], s20 offen offset:0
    buffer_load_dwordx4 v[36:39], v16, s[8:11], s21 offen offset:0 sc1
    buffer_load_dwordx4 v[40:43], v17, s[8:11], s21 offen offset:0 sc1
    buffer_load_dwordx4 v[44:47], v14, s[8:11], s20 offen offset:64
    buffer_load_dwordx4 v[48:51], v15, s[8:11], s20 offen offset:64
    buffer_load_dwordx4 v[52:55], v16, s[8:11], s21 offen offset:64 sc1
    buffer_load_dwordx4 v[56:59], v17, s[8:11], s21 offen offset:64 sc1
    buffer_load_dwordx4 v[60:63], v14, s[8:11], s20 offen offset:128
    buffer_load_dwordx4 v[64:67], v15, s[8:11], s20 offen offset:128
    buffer_load_dwordx4 v[68:71], v16, s[8:11], s21 offen offset:128 sc1
    buffer_load_dwordx4 v[72:75], v17, s[8:11], s21 offen offset:128 sc1
    buffer_load_dwordx4 v[76:79], v14, s[8:11], s20 offen offset:192
    buffer_load_dwordx4 v[80:83], v15, s[8:11], s20 offen offset:192
    buffer_load_dwordx4 v[84:87], v16, s[8:11], s21 offen offset:192 sc1
    buffer_load_dwordx4 v[88:91], v17, s[8:11], s21 offen offset:192 sc1
    s_waitcnt vmcnt(12)
    v_mfma_f32_16x16x32_bf16 a[80:83], v[28:31], v[36:39], 0
    v_mfma_f32_16x16x32_bf16 a[84:87], v[32:35], v[36:39], 0
    v_mfma_f32_16x16x32_bf16 a[88:91], v[28:31], v[40:43], 0
    v_mfma_f32_16x16x32_bf16 a[92:95], v[32:35], v[40:43], 0
    buffer_load_dwordx4 v[28:31], v14, s[8:11], s20 offen offset:256
    buffer_load_dwordx4 v[32:35], v15, s[8:11], s20 offen offset:256
    buffer_load_dwordx4 v[36:39], v16, s[8:11], s21 offen offset:256 sc1
    buffer_load_dwordx4 v[40:43], v17, s[8:11], s21 offen offset:256 sc1
    s_waitcnt vmcnt(12)
    v_mfma_f32_16x16x32_bf16 a[80:83], v[44:47], v[52:55], a[80:83]
    v_mfma_f32_16x16x32_bf16 a[84:87], v[48:51], v[52:55], a[84:87]
    v_mfma_f32_16x16x32_bf16 a[88:91], v[44:47], v[56:59], a[88:91]
    v_mfma_f32_16x16x32_bf16 a[92:95], v[48:51], v[56:59], a[92:95]
    buffer_load_dwordx4 v[44:47], v14, s[8:11], s20 offen offset:320
    buffer_load_dwordx4 v[48:51], v15, s[8:11], s20 offen offset:320
    buffer_load_dwordx4 v[52:55], v16, s[8:11], s21 offen offset:320 sc1
    buffer_load_dwordx4 v[56:59], v17, s[8:11], s21 offen offset:320 sc1
    s_waitcnt vmcnt(12)
    v_mfma_f32_16x16x32_bf16 a[80:83], v[60:63], v[68:71], a[80:83]
    v_mfma_f32_16x16x32_bf16 a[84:87], v[64:67], v[68:71], a[84:87]
    v_mfma_f32_16x16x32_bf16 a[88:91], v[60:63], v[72:75], a[88:91]
    v_mfma_f32_16x16x32_bf16 a[92:95], v[64:67], v[72:75], a[92:95]
    buffer_load_dwordx4 v[60:63], v14, s[8:11], s20 offen offset:384
    buffer_load_dwordx4 v[64:67], v15, s[8:11], s20 offen offset:384
    buffer_load_dwordx4 v[68:71], v16, s[8:11], s21 offen offset:384 sc1
    buffer_load_dwordx4 v[72:75], v17, s[8:11], s21 offen offset:384 sc1
    s_waitcnt vmcnt(12)
    v_mfma_f32_16x16x32_bf16 a[80:83], v[76:79], v[84:87], a[80:83]
    v_mfma_f32_16x16x32_bf16 a[84:87], v[80:83], v[84:87], a[84:87]
    v_mfma_f32_16x16x32_bf16 a[88:91], v[76:79], v[88:91], a[88:91]
    v_mfma_f32_16x16x32_bf16 a[92:95], v[80:83], v[88:91], a[92:95]
    buffer_load_dwordx4 v[76:79], v14, s[8:11], s20 offen offset:448
    buffer_load_dwordx4 v[80:83], v15, s[8:11], s20 offen offset:448
    buffer_load_dwordx4 v[84:87], v16, s[8:11], s21 offen offset:448 sc1
    buffer_load_dwordx4 v[88:91], v17, s[8:11], s21 offen offset:448 sc1
    s_waitcnt vmcnt(12)
    v_mfma_f32_16x16x32_bf16 a[80:83], v[28:31], v[36:39], a[80:83]
    v_mfma_f32_16x16x32_bf16 a[84:87], v[32:35], v[36:39], a[84:87]
    v_mfma_f32_16x16x32_bf16 a[88:91], v[28:31], v[40:43], a[88:91]
    v_mfma_f32_16x16x32_bf16 a[92:95], v[32:35], v[40:43], a[92:95]
    buffer_load_dwordx4 v[28:31], v14, s[8:11], s20 offen offset:512
    buffer_load_dwordx4 v[32:35], v15, s[8:11], s20 offen offset:512
    buffer_load_dwordx4 v[36:39], v16, s[8:11], s21 offen offset:512 sc1
    buffer_load_dwordx4 v[40:43], v17, s[8:11], s21 offen offset:512 sc1
    s_waitcnt vmcnt(12)
    v_mfma_f32_16x16x32_bf16 a[80:83], v[44:47], v[52:55], a[80:83]
    v_mfma_f32_16x16x32_bf16 a[84:87], v[48:51], v[52:55], a[84:87]
    v_mfma_f32_16x16x32_bf16 a[88:91], v[44:47], v[56:59], a[88:91]
    v_mfma_f32_16x16x32_bf16 a[92:95], v[48:51], v[56:59], a[92:95]
    buffer_load_dwordx4 v[44:47], v14, s[8:11], s20 offen offset:576
    buffer_load_dwordx4 v[48:51], v15, s[8:11], s20 offen offset:576
    buffer_load_dwordx4 v[52:55], v16, s[8:11], s21 offen offset:576 sc1
    buffer_load_dwordx4 v[56:59], v17, s[8:11], s21 offen offset:576 sc1
    s_waitcnt vmcnt(12)
    v_mfma_f32_16x16x32_bf16 a[80:83], v[60:63], v[68:71], a[80:83]
    v_mfma_f32_16x16x32_bf16 a[84:87], v[64:67], v[68:71], a[84:87]
    v_mfma_f32_16x16x32_bf16 a[88:91], v[60:63], v[72:75], a[88:91]
    v_mfma_f32_16x16x32_bf16 a[92:95], v[64:67], v[72:75], a[92:95]
    buffer_load_dwordx4 v[60:63], v14, s[8:11], s20 offen offset:640
    buffer_load_dwordx4 v[64:67], v15, s[8:11], s20 offen offset:640
    buffer_load_dwordx4 v[68:71], v16, s[8:11], s21 offen offset:640 sc1
    buffer_load_dwordx4 v[72:75], v17, s[8:11], s21 offen offset:640 sc1
    s_waitcnt vmcnt(12)
    v_mfma_f32_16x16x32_bf16 a[80:83], v[76:79], v[84:87], a[80:83]
    v_mfma_f32_16x16x32_bf16 a[84:87], v[80:83], v[84:87], a[84:87]
    v_mfma_f32_16x16x32_bf16 a[88:91], v[76:79], v[88:91], a[88:91]
    v_mfma_f32_16x16x32_bf16 a[92:95], v[80:83], v[88:91], a[92:95]
    buffer_load_dwordx4 v[76:79], v14, s[8:11], s20 offen offset:704
    buffer_load_dwordx4 v[80:83], v15, s[8:11], s20 offen offset:704
    buffer_load_dwordx4 v[84:87], v16, s[8:11], s21 offen offset:704 sc1
    buffer_load_dwordx4 v[88:91], v17, s[8:11], s21 offen offset:704 sc1
    s_waitcnt vmcnt(12)
    v_mfma_f32_16x16x32_bf16 a[80:83], v[28:31], v[36:39], a[80:83]
    v_mfma_f32_16x16x32_bf16 a[84:87], v[32:35], v[36:39], a[84:87]
    v_mfma_f32_16x16x32_bf16 a[88:91], v[28:31], v[40:43], a[88:91]
    v_mfma_f32_16x16x32_bf16 a[92:95], v[32:35], v[40:43], a[92:95]
    buffer_load_dwordx4 v[28:31], v14, s[8:11], s20 offen offset:768
    buffer_load_dwordx4 v[32:35], v15, s[8:11], s20 offen offset:768
    buffer_load_dwordx4 v[36:39], v16, s[8:11], s21 offen offset:768 sc1
    buffer_load_dwordx4 v[40:43], v17, s[8:11], s21 offen offset:768 sc1
    s_waitcnt vmcnt(12)
    v_mfma_f32_16x16x32_bf16 a[80:83], v[44:47], v[52:55], a[80:83]
    v_mfma_f32_16x16x32_bf16 a[84:87], v[48:51], v[52:55], a[84:87]
    v_mfma_f32_16x16x32_bf16 a[88:91], v[44:47], v[56:59], a[88:91]
    v_mfma_f32_16x16x32_bf16 a[92:95], v[48:51], v[56:59], a[92:95]
    buffer_load_dwordx4 v[44:47], v14, s[8:11], s20 offen offset:832
    buffer_load_dwordx4 v[48:51], v15, s[8:11], s20 offen offset:832
    buffer_load_dwordx4 v[52:55], v16, s[8:11], s21 offen offset:832 sc1
    buffer_load_dwordx4 v[56:59], v17, s[8:11], s21 offen offset:832 sc1
    s_waitcnt vmcnt(12)
    v_mfma_f32_16x16x32_bf16 a[80:83], v[60:63], v[68:71], a[80:83]
    v_mfma_f32_16x16x32_bf16 a[84:87], v[64:67], v[68:71], a[84:87]
    v_mfma_f32_16x16x32_bf16 a[88:91], v[60:63], v[72:75], a[88:91]
    v_mfma_f32_16x16x32_bf16 a[92:95], v[64:67], v[72:75], a[92:95]
    buffer_load_dwordx4 v[60:63], v14, s[8:11], s20 offen offset:896
    buffer_load_dwordx4 v[64:67], v15, s[8:11], s20 offen offset:896
    buffer_load_dwordx4 v[68:71], v16, s[8:11], s21 offen offset:896 sc1
    buffer_load_dwordx4 v[72:75], v17, s[8:11], s21 offen offset:896 sc1
    s_waitcnt vmcnt(12)
    v_mfma_f32_16x16x32_bf16 a[80:83], v[76:79], v[84:87], a[80:83]
    v_mfma_f32_16x16x32_bf16 a[84:87], v[80:83], v[84:87], a[84:87]
    v_mfma_f32_16x16x32_bf16 a[88:91], v[76:79], v[88:91], a[88:91]
    v_mfma_f32_16x16x32_bf16 a[92:95], v[80:83], v[88:91], a[92:95]
    buffer_load_dwordx4 v[76:79], v14, s[8:11], s20 offen offset:960
    buffer_load_dwordx4 v[80:83], v15, s[8:11], s20 offen offset:960
    buffer_load_dwordx4 v[84:87], v16, s[8:11], s21 offen offset:960 sc1
    buffer_load_dwordx4 v[88:91], v17, s[8:11], s21 offen offset:960 sc1
    s_waitcnt vmcnt(12)
    v_mfma_f32_16x16x32_bf16 a[80:83], v[28:31], v[36:39], a[80:83]
    v_mfma_f32_16x16x32_bf16 a[84:87], v[32:35], v[36:39], a[84:87]
    v_mfma_f32_16x16x32_bf16 a[88:91], v[28:31], v[40:43], a[88:91]
    v_mfma_f32_16x16x32_bf16 a[92:95], v[32:35], v[40:43], a[92:95]
    buffer_load_dwordx4 v[28:31], v14, s[8:11], s20 offen offset:1024
    buffer_load_dwordx4 v[32:35], v15, s[8:11], s20 offen offset:1024
    buffer_load_dwordx4 v[36:39], v16, s[8:11], s21 offen offset:1024 sc1
    buffer_load_dwordx4 v[40:43], v17, s[8:11], s21 offen offset:1024 sc1
    s_waitcnt vmcnt(12)
    v_mfma_f32_16x16x32_bf16 a[80:83], v[44:47], v[52:55], a[80:83]
    v_mfma_f32_16x16x32_bf16 a[84:87], v[48:51], v[52:55], a[84:87]
    v_mfma_f32_16x16x32_bf16 a[88:91], v[44:47], v[56:59], a[88:91]
    v_mfma_f32_16x16x32_bf16 a[92:95], v[48:51], v[56:59], a[92:95]
    buffer_load_dwordx4 v[44:47], v14, s[8:11], s20 offen offset:1088
    buffer_load_dwordx4 v[48:51], v15, s[8:11], s20 offen offset:1088
    buffer_load_dwordx4 v[52:55], v16, s[8:11], s21 offen offset:1088 sc1
    buffer_load_dwordx4 v[56:59], v17, s[8:11], s21 offen offset:1088 sc1
    s_waitcnt vmcnt(12)
    v_mfma_f32_16x16x32_bf16 a[80:83], v[60:63], v[68:71], a[80:83]
    v_mfma_f32_16x16x32_bf16 a[84:87], v[64:67], v[68:71], a[84:87]
    v_mfma_f32_16x16x32_bf16 a[88:91], v[60:63], v[72:75], a[88:91]
    v_mfma_f32_16x16x32_bf16 a[92:95], v[64:67], v[72:75], a[92:95]
    buffer_load_dwordx4 v[60:63], v14, s[8:11], s20 offen offset:1152
    buffer_load_dwordx4 v[64:67], v15, s[8:11], s20 offen offset:1152
    buffer_load_dwordx4 v[68:71], v16, s[8:11], s21 offen offset:1152 sc1
    buffer_load_dwordx4 v[72:75], v17, s[8:11], s21 offen offset:1152 sc1
    s_waitcnt vmcnt(12)
    v_mfma_f32_16x16x32_bf16 a[80:83], v[76:79], v[84:87], a[80:83]
    v_mfma_f32_16x16x32_bf16 a[84:87], v[80:83], v[84:87], a[84:87]
    v_mfma_f32_16x16x32_bf16 a[88:91], v[76:79], v[88:91], a[88:91]
    v_mfma_f32_16x16x32_bf16 a[92:95], v[80:83], v[88:91], a[92:95]
    buffer_load_dwordx4 v[76:79], v14, s[8:11], s20 offen offset:1216
    buffer_load_dwordx4 v[80:83], v15, s[8:11], s20 offen offset:1216
    buffer_load_dwordx4 v[84:87], v16, s[8:11], s21 offen offset:1216 sc1
    buffer_load_dwordx4 v[88:91], v17, s[8:11], s21 offen offset:1216 sc1
    s_waitcnt vmcnt(12)
    v_mfma_f32_16x16x32_bf16 a[80:83], v[28:31], v[36:39], a[80:83]
    v_mfma_f32_16x16x32_bf16 a[84:87], v[32:35], v[36:39], a[84:87]
    v_mfma_f32_16x16x32_bf16 a[88:91], v[28:31], v[40:43], a[88:91]
    v_mfma_f32_16x16x32_bf16 a[92:95], v[32:35], v[40:43], a[92:95]
    buffer_load_dwordx4 v[28:31], v14, s[8:11], s20 offen offset:1280
    buffer_load_dwordx4 v[32:35], v15, s[8:11], s20 offen offset:1280
    buffer_load_dwordx4 v[36:39], v16, s[8:11], s21 offen offset:1280 sc1
    buffer_load_dwordx4 v[40:43], v17, s[8:11], s21 offen offset:1280 sc1
    s_waitcnt vmcnt(12)
    v_mfma_f32_16x16x32_bf16 a[80:83], v[44:47], v[52:55], a[80:83]
    v_mfma_f32_16x16x32_bf16 a[84:87], v[48:51], v[52:55], a[84:87]
    v_mfma_f32_16x16x32_bf16 a[88:91], v[44:47], v[56:59], a[88:91]
    v_mfma_f32_16x16x32_bf16 a[92:95], v[48:51], v[56:59], a[92:95]
    buffer_load_dwordx4 v[44:47], v14, s[8:11], s20 offen offset:1344
    buffer_load_dwordx4 v[48:51], v15, s[8:11], s20 offen offset:1344
    buffer_load_dwordx4 v[52:55], v16, s[8:11], s21 offen offset:1344 sc1
    buffer_load_dwordx4 v[56:59], v17, s[8:11], s21 offen offset:1344 sc1
    s_waitcnt vmcnt(12)
    v_mfma_f32_16x16x32_bf16 a[80:83], v[60:63], v[68:71], a[80:83]
    v_mfma_f32_16x16x32_bf16 a[84:87], v[64:67], v[68:71], a[84:87]
    v_mfma_f32_16x16x32_bf16 a[88:91], v[60:63], v[72:75], a[88:91]
    v_mfma_f32_16x16x32_bf16 a[92:95], v[64:67], v[72:75], a[92:95]
    buffer_load_dwordx4 v[60:63], v14, s[8:11], s20 offen offset:1408
    buffer_load_dwordx4 v[64:67], v15, s[8:11], s20 offen offset:1408
    buffer_load_dwordx4 v[68:71], v16, s[8:11], s21 offen offset:1408 sc1
    buffer_load_dwordx4 v[72:75], v17, s[8:11], s21 offen offset:1408 sc1
    s_waitcnt vmcnt(12)
    v_mfma_f32_16x16x32_bf16 a[80:83], v[76:79], v[84:87], a[80:83]
    v_mfma_f32_16x16x32_bf16 a[84:87], v[80:83], v[84:87], a[84:87]
    v_mfma_f32_16x16x32_bf16 a[88:91], v[76:79], v[88:91], a[88:91]
    v_mfma_f32_16x16x32_bf16 a[92:95], v[80:83], v[88:91], a[92:95]
    buffer_load_dwordx4 v[76:79], v14, s[8:11], s20 offen offset:1472
    buffer_load_dwordx4 v[80:83], v15, s[8:11], s20 offen offset:1472
    buffer_load_dwordx4 v[84:87], v16, s[8:11], s21 offen offset:1472 sc1
    buffer_load_dwordx4 v[88:91], v17, s[8:11], s21 offen offset:1472 sc1
    s_waitcnt vmcnt(12)
    v_mfma_f32_16x16x32_bf16 a[80:83], v[28:31], v[36:39], a[80:83]
    v_mfma_f32_16x16x32_bf16 a[84:87], v[32:35], v[36:39], a[84:87]
    v_mfma_f32_16x16x32_bf16 a[88:91], v[28:31], v[40:43], a[88:91]
    v_mfma_f32_16x16x32_bf16 a[92:95], v[32:35], v[40:43], a[92:95]
    buffer_load_dwordx4 v[28:31], v14, s[8:11], s20 offen offset:1536
    buffer_load_dwordx4 v[32:35], v15, s[8:11], s20 offen offset:1536
    buffer_load_dwordx4 v[36:39], v16, s[8:11], s21 offen offset:1536 sc1
    buffer_load_dwordx4 v[40:43], v17, s[8:11], s21 offen offset:1536 sc1
    s_waitcnt vmcnt(12)
    v_mfma_f32_16x16x32_bf16 a[80:83], v[44:47], v[52:55], a[80:83]
    v_mfma_f32_16x16x32_bf16 a[84:87], v[48:51], v[52:55], a[84:87]
    v_mfma_f32_16x16x32_bf16 a[88:91], v[44:47], v[56:59], a[88:91]
    v_mfma_f32_16x16x32_bf16 a[92:95], v[48:51], v[56:59], a[92:95]
    buffer_load_dwordx4 v[44:47], v14, s[8:11], s20 offen offset:1600
    buffer_load_dwordx4 v[48:51], v15, s[8:11], s20 offen offset:1600
    buffer_load_dwordx4 v[52:55], v16, s[8:11], s21 offen offset:1600 sc1
    buffer_load_dwordx4 v[56:59], v17, s[8:11], s21 offen offset:1600 sc1
    s_waitcnt vmcnt(12)
    v_mfma_f32_16x16x32_bf16 a[80:83], v[60:63], v[68:71], a[80:83]
    v_mfma_f32_16x16x32_bf16 a[84:87], v[64:67], v[68:71], a[84:87]
    v_mfma_f32_16x16x32_bf16 a[88:91], v[60:63], v[72:75], a[88:91]
    v_mfma_f32_16x16x32_bf16 a[92:95], v[64:67], v[72:75], a[92:95]
    buffer_load_dwordx4 v[60:63], v14, s[8:11], s20 offen offset:1664
    buffer_load_dwordx4 v[64:67], v15, s[8:11], s20 offen offset:1664
    buffer_load_dwordx4 v[68:71], v16, s[8:11], s21 offen offset:1664 sc1
    buffer_load_dwordx4 v[72:75], v17, s[8:11], s21 offen offset:1664 sc1
    s_waitcnt vmcnt(12)
    v_mfma_f32_16x16x32_bf16 a[80:83], v[76:79], v[84:87], a[80:83]
    v_mfma_f32_16x16x32_bf16 a[84:87], v[80:83], v[84:87], a[84:87]
    v_mfma_f32_16x16x32_bf16 a[88:91], v[76:79], v[88:91], a[88:91]
    v_mfma_f32_16x16x32_bf16 a[92:95], v[80:83], v[88:91], a[92:95]
    buffer_load_dwordx4 v[76:79], v14, s[8:11], s20 offen offset:1728
    buffer_load_dwordx4 v[80:83], v15, s[8:11], s20 offen offset:1728
    buffer_load_dwordx4 v[84:87], v16, s[8:11], s21 offen offset:1728 sc1
    buffer_load_dwordx4 v[88:91], v17, s[8:11], s21 offen offset:1728 sc1
    s_waitcnt vmcnt(12)
    v_mfma_f32_16x16x32_bf16 a[80:83], v[28:31], v[36:39], a[80:83]
    v_mfma_f32_16x16x32_bf16 a[84:87], v[32:35], v[36:39], a[84:87]
    v_mfma_f32_16x16x32_bf16 a[88:91], v[28:31], v[40:43], a[88:91]
    v_mfma_f32_16x16x32_bf16 a[92:95], v[32:35], v[40:43], a[92:95]
    buffer_load_dwordx4 v[28:31], v14, s[8:11], s20 offen offset:1792
    buffer_load_dwordx4 v[32:35], v15, s[8:11], s20 offen offset:1792
    buffer_load_dwordx4 v[36:39], v16, s[8:11], s21 offen offset:1792 sc1
    buffer_load_dwordx4 v[40:43], v17, s[8:11], s21 offen offset:1792 sc1
    s_waitcnt vmcnt(12)
    v_mfma_f32_16x16x32_bf16 a[80:83], v[44:47], v[52:55], a[80:83]
    v_mfma_f32_16x16x32_bf16 a[84:87], v[48:51], v[52:55], a[84:87]
    v_mfma_f32_16x16x32_bf16 a[88:91], v[44:47], v[56:59], a[88:91]
    v_mfma_f32_16x16x32_bf16 a[92:95], v[48:51], v[56:59], a[92:95]
    buffer_load_dwordx4 v[44:47], v14, s[8:11], s20 offen offset:1856
    buffer_load_dwordx4 v[48:51], v15, s[8:11], s20 offen offset:1856
    buffer_load_dwordx4 v[52:55], v16, s[8:11], s21 offen offset:1856 sc1
    buffer_load_dwordx4 v[56:59], v17, s[8:11], s21 offen offset:1856 sc1
    s_waitcnt vmcnt(12)
    v_mfma_f32_16x16x32_bf16 a[80:83], v[60:63], v[68:71], a[80:83]
    v_mfma_f32_16x16x32_bf16 a[84:87], v[64:67], v[68:71], a[84:87]
    v_mfma_f32_16x16x32_bf16 a[88:91], v[60:63], v[72:75], a[88:91]
    v_mfma_f32_16x16x32_bf16 a[92:95], v[64:67], v[72:75], a[92:95]
    buffer_load_dwordx4 v[60:63], v14, s[8:11], s20 offen offset:1920
    buffer_load_dwordx4 v[64:67], v15, s[8:11], s20 offen offset:1920
    buffer_load_dwordx4 v[68:71], v16, s[8:11], s21 offen offset:1920 sc1
    buffer_load_dwordx4 v[72:75], v17, s[8:11], s21 offen offset:1920 sc1
    s_waitcnt vmcnt(12)
    v_mfma_f32_16x16x32_bf16 a[80:83], v[76:79], v[84:87], a[80:83]
    v_mfma_f32_16x16x32_bf16 a[84:87], v[80:83], v[84:87], a[84:87]
    v_mfma_f32_16x16x32_bf16 a[88:91], v[76:79], v[88:91], a[88:91]
    v_mfma_f32_16x16x32_bf16 a[92:95], v[80:83], v[88:91], a[92:95]
    buffer_load_dwordx4 v[76:79], v14, s[8:11], s20 offen offset:1984
    buffer_load_dwordx4 v[80:83], v15, s[8:11], s20 offen offset:1984
    buffer_load_dwordx4 v[84:87], v16, s[8:11], s21 offen offset:1984 sc1
    buffer_load_dwordx4 v[88:91], v17, s[8:11], s21 offen offset:1984 sc1
    s_waitcnt vmcnt(12)
    v_mfma_f32_16x16x32_bf16 a[80:83], v[28:31], v[36:39], a[80:83]
    v_mfma_f32_16x16x32_bf16 a[84:87], v[32:35], v[36:39], a[84:87]
    v_mfma_f32_16x16x32_bf16 a[88:91], v[28:31], v[40:43], a[88:91]
    v_mfma_f32_16x16x32_bf16 a[92:95], v[32:35], v[40:43], a[92:95]
    s_waitcnt vmcnt(8)
    v_mfma_f32_16x16x32_bf16 a[80:83], v[44:47], v[52:55], a[80:83]
    v_mfma_f32_16x16x32_bf16 a[84:87], v[48:51], v[52:55], a[84:87]
    v_mfma_f32_16x16x32_bf16 a[88:91], v[44:47], v[56:59], a[88:91]
    v_mfma_f32_16x16x32_bf16 a[92:95], v[48:51], v[56:59], a[92:95]
    s_waitcnt vmcnt(4)
    v_mfma_f32_16x16x32_bf16 a[80:83], v[60:63], v[68:71], a[80:83]
    v_mfma_f32_16x16x32_bf16 a[84:87], v[64:67], v[68:71], a[84:87]
    v_mfma_f32_16x16x32_bf16 a[88:91], v[60:63], v[72:75], a[88:91]
    v_mfma_f32_16x16x32_bf16 a[92:95], v[64:67], v[72:75], a[92:95]
    buffer_load_dword v26, v6, s[8:11], 0 offen
    s_waitcnt vmcnt(1)
    v_mfma_f32_16x16x32_bf16 a[80:83], v[76:79], v[84:87], a[80:83]
    v_mfma_f32_16x16x32_bf16 a[84:87], v[80:83], v[84:87], a[84:87]
    v_mfma_f32_16x16x32_bf16 a[88:91], v[76:79], v[88:91], a[88:91]
    v_mfma_f32_16x16x32_bf16 a[92:95], v[80:83], v[88:91], a[92:95]
    s_nop 9
    ds_write_b128 v22, a[80:83] offset:0
    ds_write_b128 v22, a[84:87] offset:1024
    ds_write_b128 v22, a[88:91] offset:8192
    ds_write_b128 v22, a[92:95] offset:9216
    s_waitcnt lgkmcnt(0)
    s_barrier
    ds_read_b128 v[28:31], v24 offset:0
    ds_read_b128 v[32:35], v24 offset:1024
    ds_read_b128 v[48:51], v24 offset:2048
    ds_read_b128 v[52:55], v24 offset:3072
    ds_read_b128 v[68:71], v24 offset:4096
    ds_read_b128 v[72:75], v24 offset:5120
    ds_read_b128 v[88:91], v24 offset:6144
    ds_read_b128 v[92:95], v24 offset:7168
    s_waitcnt lgkmcnt(0)
    v_add_f32 v28, v28, v48
    v_add_f32 v68, v68, v88
    v_add_f32 v108, v28, v68
    v_add_f32 v29, v29, v49
    v_add_f32 v69, v69, v89
    v_add_f32 v109, v29, v69
    v_add_f32 v30, v30, v50
    v_add_f32 v70, v70, v90
    v_add_f32 v110, v30, v70
    v_add_f32 v31, v31, v51
    v_add_f32 v71, v71, v91
    v_add_f32 v111, v31, v71
    v_add_f32 v32, v32, v52
    v_add_f32 v72, v72, v92
    v_add_f32 v112, v32, v72
    v_add_f32 v33, v33, v53
    v_add_f32 v73, v73, v93
    v_add_f32 v113, v33, v73
    v_add_f32 v34, v34, v54
    v_add_f32 v74, v74, v94
    v_add_f32 v114, v34, v74
    v_add_f32 v35, v35, v55
    v_add_f32 v75, v75, v95
    v_add_f32 v115, v35, v75
    s_barrier
    ds_write_b128 v22, a[0:3] offset:0
    ds_write_b128 v22, a[4:7] offset:1024
    ds_write_b128 v22, a[8:11] offset:8192
    ds_write_b128 v22, a[12:15] offset:9216
    s_waitcnt lgkmcnt(0)
    s_barrier
    ds_read_b128 v[28:31], v24 offset:0
    ds_read_b128 v[32:35], v24 offset:1024
    ds_read_b128 v[48:51], v24 offset:2048
    ds_read_b128 v[52:55], v24 offset:3072
    ds_read_b128 v[68:71], v24 offset:4096
    ds_read_b128 v[72:75], v24 offset:5120
    ds_read_b128 v[88:91], v24 offset:6144
    ds_read_b128 v[92:95], v24 offset:7168
    s_waitcnt lgkmcnt(0)
    v_add_f32 v28, v28, v48
    v_add_f32 v68, v68, v88
    v_add_f32 v128, v28, v68
    v_add_f32 v29, v29, v49
    v_add_f32 v69, v69, v89
    v_add_f32 v129, v29, v69
    v_add_f32 v30, v30, v50
    v_add_f32 v70, v70, v90
    v_add_f32 v130, v30, v70
    v_add_f32 v31, v31, v51
    v_add_f32 v71, v71, v91
    v_add_f32 v131, v31, v71
    v_add_f32 v32, v32, v52
    v_add_f32 v72, v72, v92
    v_add_f32 v132, v32, v72
    v_add_f32 v33, v33, v53
    v_add_f32 v73, v73, v93
    v_add_f32 v133, v33, v73
    v_add_f32 v34, v34, v54
    v_add_f32 v74, v74, v94
    v_add_f32 v134, v34, v74
    v_add_f32 v35, v35, v55
    v_add_f32 v75, v75, v95
    v_add_f32 v135, v35, v75
    s_barrier
    s_cmp_ge_u32 s40, 2
    s_cbranch_scc1 Lf_end_d
    s_waitcnt vmcnt(0)
    v_sub_f32 v27, 1.0, v26
    v_cvt_pk_bf16_f32 v27, v27, v27
    v_lshlrev_b32 v27, 16, v27
    v_cvt_pk_bf16_f32 v12, v128, v129
    v_lshlrev_b32 v128, 16, v12
    v_and_b32 v129, 0xffff0000, v12
    v_cvt_pk_bf16_f32 v12, v108, v109
    v_lshlrev_b32 v108, 16, v12
    v_and_b32 v109, 0xffff0000, v12
    v_mul_f32 v128, v26, v128
    v_mul_f32 v108, v27, v108
    v_mul_f32 v129, v26, v129
    v_mul_f32 v109, v27, v109
    v_cvt_pk_bf16_f32 v12, v128, v129
    v_lshlrev_b32 v128, 16, v12
    v_and_b32 v129, 0xffff0000, v12
    v_cvt_pk_bf16_f32 v12, v108, v109
    v_lshlrev_b32 v108, 16, v12
    v_and_b32 v109, 0xffff0000, v12
    v_add_f32 v128, v128, v108
    v_add_f32 v129, v129, v109
    v_cvt_pk_bf16_f32 v12, v130, v131
    v_lshlrev_b32 v130, 16, v12
    v_and_b32 v131, 0xffff0000, v12
    v_cvt_pk_bf16_f32 v12, v110, v111
    v_lshlrev_b32 v110, 16, v12
    v_and_b32 v111, 0xffff0000, v12
    v_mul_f32 v130, v26, v130
    v_mul_f32 v110, v27, v110
    v_mul_f32 v131, v26, v131
    v_mul_f32 v111, v27, v111
    v_cvt_pk_bf16_f32 v12, v130, v131
    v_lshlrev_b32 v130, 16, v12
    v_and_b32 v131, 0xffff0000, v12
    v_cvt_pk_bf16_f32 v12, v110, v111
    v_lshlrev_b32 v110, 16, v12
    v_and_b32 v111, 0xffff0000, v12
    v_add_f32 v130, v130, v110
    v_add_f32 v131, v131, v111
    v_cvt_pk_bf16_f32 v8, v128, v129
    v_cvt_pk_bf16_f32 v9, v130, v131
    buffer_store_dwordx2 v[8:9], v25, s[12:15], 0 offen offset:0
    v_cvt_pk_bf16_f32 v12, v132, v133
    v_lshlrev_b32 v132, 16, v12
    v_and_b32 v133, 0xffff0000, v12
    v_cvt_pk_bf16_f32 v12, v112, v113
    v_lshlrev_b32 v112, 16, v12
    v_and_b32 v113, 0xffff0000, v12
    v_mul_f32 v132, v26, v132
    v_mul_f32 v112, v27, v112
    v_mul_f32 v133, v26, v133
    v_mul_f32 v113, v27, v113
    v_cvt_pk_bf16_f32 v12, v132, v133
    v_lshlrev_b32 v132, 16, v12
    v_and_b32 v133, 0xffff0000, v12
    v_cvt_pk_bf16_f32 v12, v112, v113
    v_lshlrev_b32 v112, 16, v12
    v_and_b32 v113, 0xffff0000, v12
    v_add_f32 v132, v132, v112
    v_add_f32 v133, v133, v113
    v_cvt_pk_bf16_f32 v12, v134, v135
    v_lshlrev_b32 v134, 16, v12
    v_and_b32 v135, 0xffff0000, v12
    v_cvt_pk_bf16_f32 v12, v114, v115
    v_lshlrev_b32 v114, 16, v12
    v_and_b32 v115, 0xffff0000, v12
    v_mul_f32 v134, v26, v134
    v_mul_f32 v114, v27, v114
    v_mul_f32 v135, v26, v135
    v_mul_f32 v115, v27, v115
    v_cvt_pk_bf16_f32 v12, v134, v135
    v_lshlrev_b32 v134, 16, v12
    v_and_b32 v135, 0xffff0000, v12
    v_cvt_pk_bf16_f32 v12, v114, v115
    v_lshlrev_b32 v114, 16, v12
    v_and_b32 v115, 0xffff0000, v12
    v_add_f32 v134, v134, v114
    v_add_f32 v135, v135, v115
    v_cvt_pk_bf16_f32 v10, v132, v133
    v_cvt_pk_bf16_f32 v11, v134, v135
    buffer_store_dwordx2 v[10:11], v25, s[12:15], 0 offen offset:32
Lf_end_d:
    s_endpgm
.section .rodata,"a"
.p2align 6
.amdhsa_kernel prep_kernel
  .amdhsa_next_free_vgpr 96
  .amdhsa_next_free_sgpr 102
  .amdhsa_accum_offset 96
  .amdhsa_group_segment_fixed_size 0
  .amdhsa_kernarg_size 112
  .amdhsa_user_sgpr_count 2
  .amdhsa_user_sgpr_kernarg_segment_ptr 1
  .amdhsa_system_sgpr_workgroup_id_x 1
.end_amdhsa_kernel
.p2align 6
.amdhsa_kernel rec_kernel
  .amdhsa_next_free_vgpr 500
  .amdhsa_next_free_sgpr 102
  .amdhsa_accum_offset 244
  .amdhsa_group_segment_fixed_size 0
  .amdhsa_kernarg_size 112
  .amdhsa_user_sgpr_count 2
  .amdhsa_user_sgpr_kernarg_segment_ptr 1
  .amdhsa_system_sgpr_workgroup_id_x 1
.end_amdhsa_kernel
```
